```python
import torch

def _softmax(x, axis=-1):
    return torch.softmax(x, dim=axis)
def _gelu(x):
    return torch.nn.functional.gelu(x, approximate="tanh")
def _silu(x):
    return torch.nn.functional.silu(x)
def _sigmoid(x):
    return torch.sigmoid(x)
def _layernorm(x, axis=-1, eps=1e-5):
    m = x.mean(dim=axis, keepdim=True)
    v = x.var(dim=axis, keepdim=True, unbiased=False)
    return (x - m) / torch.sqrt(v + eps)
def _scatter_add(tgt, idx, src, axis=0):
    return tgt.clone().index_add_(axis, idx, src)
def _segment_sum(src, seg, n):
    out = torch.zeros((n,) + src.shape[1:], dtype=src.dtype)
    return out.index_add_(0, seg, src)
def _pad(x, pw):
    flat = tuple(v for pair in reversed(pw) for v in pair)
    return torch.nn.functional.pad(x, flat)

kernel_name = 'gated_mix__ssm_conv_s5__dense_activation_silu__prompt'

def setup_inputs():

    _w = (lambda a: (lambda t: t.to(torch.bfloat16) if t.is_floating_point() else t)(torch.as_tensor(a)))
    def _A_setup():
        B, S, D = 1, 2048, 640
        P = D
        Lambda_re = -0.5 * (lambda _x: torch.exp(torch.as_tensor(_x)))((lambda *s: torch.randn(*s, dtype=torch.bfloat16) * 0.2)(P))
        Lambda_im = (lambda *s: torch.randn(*s, dtype=torch.bfloat16) * 0.4)(P) * 1.0
        B_re = (lambda *s: torch.randn(*s, dtype=torch.bfloat16) * 0.2)(P, D) * (D ** -0.5)
        B_im = (lambda *s: torch.randn(*s, dtype=torch.bfloat16) * 0.2)(P, D) * (D ** -0.5)
        C_re = (lambda *s: torch.randn(*s, dtype=torch.bfloat16) * 0.2)(D, P) * (P ** -0.5)
        C_im = (lambda *s: torch.randn(*s, dtype=torch.bfloat16) * 0.2)(D, P) * (P ** -0.5)
        log_dt = (lambda *s: torch.randn(*s, dtype=torch.bfloat16) * 0.2)(P) * 0.3 - 2.0
        Dskip = (lambda *s: torch.randn(*s, dtype=torch.bfloat16) * 0.05)(D)
        return {
            "x": _w((lambda *s: torch.randn(*s, dtype=torch.bfloat16) * 0.05)(B, S, D)),
            "Lambda_re": _w(Lambda_re),
            "Lambda_im": _w(Lambda_im),
            "B_re": _w(B_re),
            "B_im": _w(B_im),
            "C_re": _w(C_re),
            "C_im": _w(C_im),
            "log_dt": _w(log_dt),
            "Dskip": _w(Dskip),
        }
    _A_in = _A_setup()

    def _B_setup():
        B, S, D, F = 1, 2048, 640, 1536
        return {
            "x": _w((lambda *s: torch.randn(*s, dtype=torch.bfloat16) * 0.05)(B, S, D)),
            "w1": _w((lambda *s: torch.randn(*s, dtype=torch.bfloat16) * 3.2)(D, F) * (D ** -0.5)),
            "w2": _w((lambda *s: torch.randn(*s, dtype=torch.bfloat16) * 0.1)(F, D) * (F ** -0.5)),
        }
    _B_in = _B_setup()

    return {
        "A_x": _A_in["x"],
        "A_Lambda_re": _A_in["Lambda_re"],
        "A_Lambda_im": _A_in["Lambda_im"],
        "A_B_re": _A_in["B_re"],
        "A_B_im": _A_in["B_im"],
        "A_C_re": _A_in["C_re"],
        "A_C_im": _A_in["C_im"],
        "A_log_dt": _A_in["log_dt"],
        "A_Dskip": _A_in["Dskip"],
        "B_x": _B_in["x"],
        "B_w1": _B_in["w1"],
        "B_w2": _B_in["w2"],
        "gate_w": _w((lambda *s: torch.randn(*s, dtype=torch.bfloat16) * 0.05)(640) * 16.0),
    }

def reference(A_x, A_Lambda_re, A_Lambda_im, A_B_re, A_B_im, A_C_re, A_C_im, A_log_dt, A_Dskip, B_x, B_w1, B_w2, gate_w):
    def _A_ref(x, Lambda_re, Lambda_im, B_re, B_im, C_re, C_im, log_dt, Dskip):
        Bsz, L, H = x.shape
        Lam = Lambda_re + 1j * Lambda_im
        Bmat = B_re + 1j * B_im
        Cmat = C_re + 1j * C_im
        dt = torch.exp(log_dt)
        Lam_bar = torch.exp(dt * Lam)
        B_bar = ((Lam_bar - 1.0) / Lam)[:, None] * Bmat
        Bu = torch.einsum("bld,pd->blp", x + 0j, B_bar)
        h = torch.zeros_like(Bu[:, 0, :])
        hs = []
        for t in range(L):
            h = Lam_bar[None, :] * h + Bu[:, t, :]
            hs.append(h)
        hseq = torch.stack(hs, 1)
        y = 2.0 * torch.einsum("blp,dp->bld", hseq, Cmat).real + x * Dskip[None, None, :]
        return y

    def _B_ref(x, w1, w2):
        h = torch.einsum("bsd,df->bsf", x, w1)
        h = _silu(h)
        out = torch.einsum("bsf,fd->bsd", h, w2)
        return out

    x = A_x
    g = _sigmoid((x * gate_w).sum(-1, keepdims=True))
    a = _A_ref(x, A_Lambda_re, A_Lambda_im, A_B_re, A_B_im, A_C_re, A_C_im, A_log_dt, A_Dskip)
    b = _B_ref(x, B_w1, B_w2)
    return g * a + (1 - g) * b
```

```asm
; @launch grid=(256,1,1) block=(256,1,1) lds=163840
.amdgcn_target "amdgcn-amd-amdhsa--gfx950"
.text
.globl gated_mix__ssm_conv_s5__dense_activation_silu__prompt_kernel
.p2align 8
.type gated_mix__ssm_conv_s5__dense_activation_silu__prompt_kernel,@function
gated_mix__ssm_conv_s5__dense_activation_silu__prompt_kernel:
    s_cmp_ge_u32 s2, 256
    s_cbranch_scc1 L_end
    s_load_dwordx16 s[40:55], s[0:1], 0
    s_load_dwordx16 s[56:71], s[0:1], 64
    s_memrealtime s[100:101]
    s_getpc_b64 s[96:97]
    s_lshr_b32 s3, s2, 3
    s_mul_i32 s3, s3, 2560
    v_lshrrev_b32 v2, 6, v0
    v_and_b32 v3, 63, v0
    v_mad_u32_u24 v2, v2, 5, v3
    v_lshl_add_u32 v2, v2, 7, s3
    s_mov_b64 exec, 31
    global_load_dword a255, v2, s[96:97]
    s_mov_b64 exec, -1
    v_lshrrev_b32 v1, 6, v0
    v_and_b32 v0, 63, v0
    v_readfirstlane_b32 s3, v1
    v_lshlrev_b32 v1, 4, v0
    s_and_b32 s84, s2, 7
    s_lshr_b32 s85, s2, 3
    s_and_b32 s76, s84, 1
    s_lshl_b32 s76, s76, 3
    s_and_b32 s86, s85, 7
    s_add_u32 s76, s76, s86
    s_lshr_b32 s87, s85, 3
    s_add_u32 s80, s87, s86
    s_lshl_b32 s80, s80, 2
    s_mov_b32 s96, 1107846176
    s_mov_b32 s97, 134
    s_lshr_b64 s[96:97], s[96:97], s80
    s_and_b32 s80, s96, 15
    s_and_b32 s77, s3, 1
    s_lshr_b32 s78, s3, 1
    v_and_b32 v128, 7, v0
    v_lshrrev_b32 v129, 3, v0
    v_and_b32 v130, 15, v0
    v_lshrrev_b32 v131, 4, v0
    s_lshl_b32 s96, s3, 3
    v_and_b32 v120, 32, v0
    v_and_b32 v121, 3, v129
    v_add3_u32 v120, v120, v121, s96
    v_mul_u32_u24 v120, 1280, v120
    v_xor_b32 v121, v131, v128
    v_lshlrev_b32 v126, 4, v121
    v_xor_b32 v127, 64, v126
    v_add_u32 v2, v120, v126
    s_mov_b32 s97, 80896
    v_add3_u32 v3, v120, v127, s97
    s_mov_b32 s97, 3072
    v_add3_u32 v4, v120, v126, s97
    s_mov_b32 s97, 83968
    v_add3_u32 v5, v120, v127, s97
    s_lshl_b32 s96, s3, 4
    v_add_u32 v120, s96, v129
    v_mul_u32_u24 v121, 1280, v120
    v_add_u32 v6, v121, v126
    v_add_u32 v7, v121, v127
    v_add_u32 v7, 9216, v7
    v_mul_u32_u24 v121, 3072, v120
    v_and_b32 v124, 2, v129
    v_xor_b32 v125, v124, v128
    v_lshl_add_u32 v8, v125, 4, v121
    v_xor_b32 v125, 4, v125
    v_lshl_add_u32 v9, v125, 4, v121
    v_add_u32 v9, 23552, v9
    v_mov_b32 v34, 0
    s_waitcnt lgkmcnt(0)
    s_mov_b32 s4, s40
    s_mov_b32 s5, s41
    s_mov_b32 s6, 2621440
    s_mov_b32 s7, 0x20000
    s_mov_b32 s16, s60
    s_mov_b32 s17, s61
    s_mov_b32 s18, 1966080
    s_mov_b32 s19, 0x20000
    s_mov_b32 s24, s66
    s_mov_b32 s25, s67
    s_mov_b32 s26, 5242880
    s_mov_b32 s27, 0x20000
    s_mov_b32 s20, s70
    s_mov_b32 s21, s71
    s_mov_b32 s22, 268435456
    s_mov_b32 s23, 0x20000
    s_lshl_b32 s58, s3, 12
    s_lshl_b32 s59, s3, 11
    s_add_u32 s59, s59, 16384
    s_lshr_b32 s60, s84, 1
    s_mul_i32 s61, s76, 163840
    s_cmp_eq_u32 s87, 3
    s_cbranch_scc1 L_typeZ
    s_cmp_eq_u32 s87, 2
    s_cselect_b32 s96, s60, 0
    s_cmp_ge_u32 s96, 2
    s_cbranch_scc1 L_typeY
L_typeX:
    s_mov_b32 s8, s46
    s_mov_b32 s9, s47
    s_mov_b32 s10, 819200
    s_mov_b32 s11, 0x20000
    s_mov_b32 s12, s48
    s_mov_b32 s13, s49
    s_mov_b32 s14, 819200
    s_mov_b32 s15, 0x20000
    s_mul_i32 s93, s60, 3
    s_lshl_b32 s96, s60, 1
    s_add_u32 s96, s96, 2
    s_cmp_lt_u32 s60, 2
    s_cselect_b32 s93, s93, s96
    s_add_u32 s93, s93, s87
    s_lshl_b32 s79, s93, 7
    s_mul_i32 s66, s93, 81920
    s_lshl_b32 s96, s3, 5
    s_add_u32 s96, s96, s79
    v_lshl_add_u32 v120, v130, 1, s96
    global_load_ushort v136, v120, s[42:43]
    global_load_ushort v137, v120, s[44:45]
    global_load_ushort v138, v120, s[54:55]
    s_lshl_b32 s84, s80, 7
    s_add_u32 s81, s61, s84
    s_add_u32 m0, s58, 0
    s_nop 0
    buffer_load_dwordx4 v2, s[4:7], s81 offen offset:0  lds
    s_add_u32 s82, s66, s84
    s_mul_i32 s83, s80, 196608
    buffer_load_dwordx4 v3, s[4:7], s81 offen offset:1024  lds
    s_add_u32 s83, s83, s79
    s_add_u32 s80, s80, 1
    buffer_load_dwordx4 v4, s[4:7], s81 offen offset:2048  lds
    s_cmp_eq_u32 s80, 10
    s_cselect_b32 s80, 0, s80
    buffer_load_dwordx4 v5, s[4:7], s81 offen offset:3072  lds
    s_add_u32 m0, s59, 0
    s_nop 0
    buffer_load_dwordx4 v6, s[8:11], s82 offen offset:0  lds
    buffer_load_dwordx4 v7, s[8:11], s82 offen offset:1024  lds
    s_add_u32 m0, s59, 8192
    s_nop 0
    buffer_load_dwordx4 v6, s[12:15], s82 offen offset:0  lds
    buffer_load_dwordx4 v7, s[12:15], s82 offen offset:1024  lds
    s_add_u32 m0, s59, 16384
    s_nop 0
    buffer_load_dwordx4 v8, s[16:19], s83 offen offset:0  lds
    buffer_load_dwordx4 v9, s[16:19], s83 offen offset:1024  lds
    s_or_b32 s96, s2, s3
    s_cmp_lg_u32 s96, 0
    s_cbranch_scc1 L_notag1
    s_or_b32 s96, s100, 1
    v_mov_b32 v35, s96
    s_mov_b64 exec, 1
    global_store_dword v34, v35, s[68:69] sc1
    s_mov_b64 exec, -1
L_notag1:
    s_mov_b32 s101, 400000
    s_bfe_u32 s92, s2, 0x10002
    s_and_b32 s89, s76, 8
    s_and_b32 s90, s2, 2
    s_lshl_b32 s90, s90, 1
    s_add_u32 s89, s89, s90
    s_add_u32 s89, s89, s87
    s_mov_b32 s90, s86
    s_mul_i32 s0, s76, 393216
    s_mul_i32 s96, s77, 196608
    s_add_u32 s0, s0, s96
    s_lshl_b32 s96, s79, 4
    s_add_u32 s0, s0, s96
    s_lshl_b32 s96, s78, 10
    s_add_u32 s0, s0, s96
    s_add_u32 s0, s0, 6291456
    s_mul_i32 s1, s76, 12288
    s_lshl_b32 s96, s79, 2
    s_add_u32 s1, s1, s96
    s_lshl_b32 s96, s3, 7
    s_add_u32 s1, s1, s96
    s_add_u32 s1, s1, 24248320
    s_lshl_b32 s95, s89, 9
    s_lshl_b32 s96, s92, 8
    s_add_u32 s95, s95, s96
    s_lshl_b32 s96, s3, 6
    s_add_u32 s95, s95, s96
    s_add_u32 s95, s95, 17301504
    s_lshr_b32 s70, s90, 2
    s_and_b32 s71, s90, 3
    s_cmp_eq_u32 s92, 0
    s_cbranch_scc1 L_wsP2
    s_mov_b32 s28, s62
    s_mov_b32 s29, s63
    s_mov_b32 s30, 1966080
    s_mov_b32 s31, 0x20000
    s_mov_b32 s36, s62
    s_mov_b32 s37, s63
    s_mov_b32 s38, 1966080
    s_mov_b32 s39, 0x20000
    s_mul_i32 s50, s70, 320
    s_lshl_b32 s96, s71, 6
    s_add_u32 s50, s50, s96
    s_mul_i32 s51, s71, -48
    s_add_u32 s51, s51, 192
    s_lshr_b32 s96, s87, 1
    s_add_u32 s52, s96, s87
    s_mul_i32 s91, s3, 491520
    s_lshl_b32 s96, s50, 1
    s_add_u32 s91, s91, s96
    s_add_u32 s55, s91, 491520
    s_mul_i32 s96, s52, 81920
    s_add_u32 s91, s91, s96
    s_mov_b32 s64, 40960
    s_mov_b32 s65, 81920
    s_mov_b32 s54, 0
    v_mul_u32_u24 v121, 1280, v129
    v_lshlrev_b32 v120, 1, v131
    v_xor_b32 v120, v120, v128
    v_lshl_add_u32 v248, v120, 4, v121
    v_add_u32 v249, 9216, v248
    v_add_u32 v250, 18432, v248
    v_add_u32 v251, 27648, v248
    v_add_u32 v253, 0, v248
    v_lshrrev_b32 v120, 3, v0
    v_and_b32 v120, 3, v120
    v_lshlrev_b32 v120, 5, v120
    v_lshrrev_b32 v121, 2, v0
    v_lshl_add_u32 v120, v121, 7, v120
    v_and_b32 v121, 3, v0
    v_lshl_add_u32 v38, v121, 3, v120
    v_mov_b32 v39, v38
    s_branch L_wsE2
L_wsP2:
    s_mov_b32 s28, s50
    s_mov_b32 s29, s51
    s_mov_b32 s30, 819200
    s_mov_b32 s31, 0x20000
    s_mov_b32 s36, s52
    s_mov_b32 s37, s53
    s_mov_b32 s38, 819200
    s_mov_b32 s39, 0x20000
    s_mul_i32 s50, s70, 320
    s_lshl_b32 s96, s71, 6
    s_add_u32 s50, s50, s96
    s_mul_i32 s51, s71, -48
    s_add_u32 s51, s51, 192
    s_mul_i32 s54, s3, 5
    s_add_u32 s54, s54, 1
    s_lshr_b32 s54, s54, 1
    s_and_b32 s52, s87, 1
    s_mul_i32 s91, s50, 1280
    s_lshl_b32 s96, s54, 7
    s_add_u32 s91, s91, s96
    s_mov_b32 s64, 51200
    s_mul_i32 s54, s77, -320
    s_add_u32 s54, s54, 256
    s_add_u32 s54, s54, s91
    s_lshl_b32 s96, s52, 7
    s_add_u32 s91, s91, s96
    s_mul_i32 s65, s52, -256
    s_add_u32 s65, s65, 128
    s_mov_b32 s55, -1
    v_mul_u32_u24 v120, 1280, v129
    v_add_u32 v248, v120, v126
    v_add_u32 v249, v120, v127
    v_add_u32 v249, 9216, v249
    v_add_u32 v250, v120, v126
    v_add_u32 v250, 18432, v250
    v_add_u32 v251, v120, v127
    v_add_u32 v251, 27648, v251
    v_add_u32 v253, v120, v126
    v_add_u32 v253, 40960, v253
    v_lshrrev_b32 v120, 2, v0
    v_mul_u32_u24 v120, 1280, v120
    v_and_b32 v121, 3, v0
    v_xor_b32 v121, v121, v131
    v_lshl_add_u32 v120, v121, 4, v120
    v_accvgpr_write_b32 a254, v120
    v_lshrrev_b32 v121, 1, v131
    v_and_b32 v122, 1, v131
    v_lshrrev_b32 v120, 1, v130
    v_xor_b32 v120, v120, v121
    v_lshlrev_b32 v120, 4, v120
    v_lshl_add_u32 v120, v130, 7, v120
    v_lshl_add_u32 v38, v122, 3, v120
    v_lshrrev_b32 v120, 2, v130
    v_xor_b32 v120, v120, v121
    v_lshlrev_b32 v120, 4, v120
    v_lshl_add_u32 v120, v130, 6, v120
    v_lshl_add_u32 v39, v122, 3, v120
L_wsE2:
    s_xor_b32 s53, s92, 1
    s_mul_i32 s53, s53, s51
    s_mul_i32 s53, s53, 1280
    s_mul_i32 s94, s89, 163840
    s_mul_i32 s96, s3, 40960
    s_add_u32 s94, s94, s96
    s_mul_i32 s96, s92, 20480
    s_add_u32 s94, s94, s96
    s_lshl_b32 s96, s50, 1
    s_add_u32 s94, s94, s96
    s_mul_i32 s63, s3, 10240
    v_add_u32 v38, s63, v38
    v_add_u32 v39, s63, v39
    s_lshl_b32 s96, s51, 1
    v_mov_b32 v124, s96
    v_mul_u32_u24 v120, 205, v0
    v_lshrrev_b32 v120, 12, v120
    v_mul_u32_u24 v122, 20, v120
    v_sub_u32 v122, v0, v122
    v_cmp_le_u32 vcc, 16, v122
    v_lshlrev_b32 v122, 3, v122
    s_nop 0
    v_cndmask_b32 v121, 0, v124, vcc
    v_add_u32 v122, v122, v121
    v_mul_u32_u24 v120, 1280, v120
    v_add_u32 v120, v120, v122
    v_cmp_le_u32 vcc, 12, v130
    v_lshl_add_u32 v123, v130, 3, 32
    s_nop 0
    v_cndmask_b32 v121, 0, v124, vcc
    v_add_u32 v123, v123, v121
    v_mul_u32_u24 v121, 5120, v131
    v_add_u32 v121, v121, v123
    v_add_u32 v121, 3840, v121
    s_lshl_b32 s96, s50, 1
    v_add_u32 v122, s96, v122
    v_add_u32 v123, s96, v123
    v_accvgpr_write_b32 a240, v120
    v_accvgpr_write_b32 a241, v121
    v_accvgpr_write_b32 a242, v122
    v_accvgpr_write_b32 a243, v123
    s_lshl_b32 s67, s89, 6
    s_lshl_b32 s96, s90, 3
    s_add_u32 s67, s67, s96
    s_lshl_b32 s96, s92, 2
    s_add_u32 s67, s67, s96
    s_add_u32 s67, s67, s3
    s_mul_i32 s67, s67, 3072
    s_add_u32 s67, s67, 17825792
    s_mul_i32 s71, s92, 14
    s_add_u32 s71, s71, 10
    s_lshl_b32 s70, s89, 2
    s_add_u32 s70, s70, s3
    s_mul_i32 s32, s70, s71
    s_lshl_b32 s32, s32, 7
    s_mul_i32 s71, s92, 131072
    s_add_u32 s32, s32, s71
    s_add_u32 s32, s32, 24117248
    s_lshl_b32 s70, s89, 5
    s_add_u32 s70, s70, s3
    s_lshl_b32 s71, s92, 11
    s_add_u32 s71, s71, 10240
    s_mul_i32 s33, s70, s71
    s_mul_i32 s71, s92, 6291456
    s_add_u32 s33, s33, s71
    v_lshrrev_b32 v120, 1, v130
    v_xor_b32 v120, v120, v131
    v_lshlrev_b32 v120, 4, v120
    v_lshl_add_u32 v120, v130, 7, v120
    v_xor_b32 v121, 64, v120
    s_lshl_b32 s96, s77, 13
    v_add_u32 v10, s96, v120
    v_add_u32 v11, s96, v121
    s_xor_b32 s96, s96, 8192
    v_add_u32 v16, s96, v120
    v_add_u32 v17, s96, v121
    v_add_u32 v12, s59, v120
    v_add_u32 v13, s59, v121
    v_lshrrev_b32 v122, 2, v130
    v_lshl_add_u32 v123, v131, 3, v122
    v_lshlrev_b32 v123, 7, v123
    v_and_b32 v124, 3, v0
    v_lshl_add_u32 v123, v124, 3, v123
    v_lshrrev_b32 v122, 1, v122
    v_and_b32 v124, 1, v131
    v_lshl_add_u32 v122, v124, 1, v122
    s_lshl_b32 s96, s78, 1
    v_xor_b32 v122, s96, v122
    v_lshl_add_u32 v14, v122, 5, v123
    v_add_u32 v14, 16384, v14
    v_xor_b32 v122, 1, v122
    v_lshl_add_u32 v15, v122, 5, v123
    v_add_u32 v15, 16384, v15
    v_add_u32 v18, 40960, v10
    v_add_u32 v19, 40960, v11
    v_add_u32 v20, 40960, v12
    v_add_u32 v21, 40960, v13
    v_add_u32 v22, 40960, v14
    v_add_u32 v23, 40960, v15
    v_add_u32 v24, 40960, v16
    v_add_u32 v25, 40960, v17
    v_add_u32 v26, 81920, v10
    v_add_u32 v27, 81920, v11
    v_add_u32 v28, 81920, v12
    v_add_u32 v29, 81920, v13
    v_add_u32 v30, 81920, v14
    v_add_u32 v31, 81920, v15
    v_add_u32 v32, 81920, v16
    v_add_u32 v33, 81920, v17
    s_mul_i32 s34, s76, 327680
    s_lshl_b32 s96, s93, 12
    s_add_u32 s34, s34, s96
    s_lshl_b32 s96, s3, 10
    s_add_u32 s34, s34, s96
    s_mul_i32 s35, s76, 5120
    s_lshl_b32 s96, s93, 9
    s_add_u32 s35, s35, s96
    s_lshl_b32 s96, s3, 7
    s_add_u32 s35, s35, s96
    s_add_u32 s35, s35, 24117248
    s_lshl_b32 s70, s93, 14
    s_lshl_b32 s96, s3, 12
    s_add_u32 s70, s70, s96
    s_add_u32 s70, s70, 16777216
    s_add_u32 s72, s20, s70
    s_addc_u32 s73, s21, 0
    s_mov_b32 s74, 4096
    s_mov_b32 s75, 0x20000
    s_waitcnt vmcnt(10)
    v_lshlrev_b32 v136, 16, v136
    v_lshlrev_b32 v137, 16, v137
    v_lshlrev_b32 v138, 16, v138
    v_mul_f32 v138, 0x3fb8aa3b, v138
    v_exp_f32 v138, v138
    s_nop 0
    v_cvt_pk_bf16_f32 v138, v138, v138
    v_lshlrev_b32 v138, 16, v138
    v_mul_f32 v140, v138, v136
    v_mul_f32 v141, v138, v137
    v_mul_f32 v140, 0x3fb8aa3b, v140
    v_exp_f32 v140, v140
    v_mul_f32 v141, 0x3e22f983, v141
    v_rndne_f32 v142, v141
    v_sub_f32 v141, v141, v142
    v_cos_f32 v142, v141
    v_sin_f32 v143, v141
    v_mul_f32 v232, v140, v142
    v_mul_f32 v234, v140, v143
    v_add_f32 v140, -1.0, v232
    v_mul_f32 v141, v136, v136
    v_fmac_f32 v141, v137, v137
    v_rcp_f32 v141, v141
    v_mul_f32 v142, v140, v136
    v_fmac_f32 v142, v234, v137
    v_mul_f32 v143, v234, v136
    v_fma_f32 v143, -v140, v137, v143
    v_add_f32 v141, v141, v141
    v_mul_f32 v236, v142, v141
    v_mul_f32 v237, v143, v141
    v_mul_f32 v233, v232, v232
    v_mul_f32 v235, v232, v234
    v_fma_f32 v233, -v234, v234, v233
    v_fmac_f32 v235, v234, v232
    v_mul_f32 v144, v233, v233
    v_mul_f32 v145, v233, v235
    v_fma_f32 v144, -v235, v235, v144
    v_fmac_f32 v145, v235, v233
    v_mul_f32 v146, v144, v144
    v_mul_f32 v147, v144, v145
    v_fma_f32 v146, -v145, v145, v146
    v_fmac_f32 v147, v145, v144
    v_mul_f32 v148, v146, v146
    v_mul_f32 v149, v146, v147
    v_fma_f32 v148, -v147, v147, v148
    v_fmac_f32 v149, v147, v146
    v_mul_f32 v240, v148, v148
    v_mul_f32 v241, v148, v149
    v_fma_f32 v240, -v149, v149, v240
    v_fmac_f32 v241, v149, v148
    v_mul_f32 v150, v240, v240
    v_mul_f32 v151, v240, v241
    v_fma_f32 v150, -v241, v241, v150
    v_fmac_f32 v151, v241, v240
    v_mul_f32 v152, v150, v240
    v_mul_f32 v153, v150, v241
    v_fma_f32 v152, -v151, v241, v152
    v_fmac_f32 v153, v151, v240
    v_mul_f32 v154, v150, v150
    v_mul_f32 v155, v150, v151
    v_fma_f32 v154, -v151, v151, v154
    v_fmac_f32 v155, v151, v150
    v_mul_f32 v156, v154, v154
    v_mul_f32 v157, v154, v155
    v_fma_f32 v156, -v155, v155, v156
    v_fmac_f32 v157, v155, v154
    v_mul_f32 v158, v156, v154
    v_mul_f32 v159, v156, v155
    v_fma_f32 v158, -v157, v155, v158
    v_fmac_f32 v159, v157, v154
    v_mul_f32 v244, v156, v156
    v_mul_f32 v245, v156, v157
    v_fma_f32 v244, -v157, v157, v244
    v_fmac_f32 v245, v157, v156
    v_mov_b32 v238, v152
    v_mov_b32 v239, v153
    v_cmp_ne_u32 vcc, 1, v131
    s_nop 1
    v_cndmask_b32 v238, v150, v238, vcc
    v_cndmask_b32 v239, v151, v239, vcc
    v_cmp_ne_u32 vcc, 2, v131
    s_nop 1
    v_cndmask_b32 v238, v240, v238, vcc
    v_cndmask_b32 v239, v241, v239, vcc
    v_cmp_ne_u32 vcc, 3, v131
    s_nop 1
    v_cndmask_b32 v238, 1.0, v238, vcc
    v_cndmask_b32 v239, 0, v239, vcc
    v_mov_b32 v160, 1.0
    v_mov_b32 v161, 0
    v_cmp_ne_u32 vcc, 1, v131
    s_nop 1
    v_cndmask_b32 v160, v240, v160, vcc
    v_cndmask_b32 v161, v241, v161, vcc
    v_cmp_ne_u32 vcc, 2, v131
    s_nop 1
    v_cndmask_b32 v160, v150, v160, vcc
    v_cndmask_b32 v161, v151, v161, vcc
    v_cmp_ne_u32 vcc, 3, v131
    s_nop 1
    v_cndmask_b32 v160, v152, v160, vcc
    v_cndmask_b32 v161, v153, v161, vcc
    v_mov_b32 v246, 1.0
    v_mov_b32 v247, 0
    v_cmp_ne_u32 vcc, 1, v131
    s_nop 1
    v_cndmask_b32 v246, v154, v246, vcc
    v_cndmask_b32 v247, v155, v247, vcc
    v_cmp_ne_u32 vcc, 2, v131
    s_nop 1
    v_cndmask_b32 v246, v156, v246, vcc
    v_cndmask_b32 v247, v157, v247, vcc
    v_cmp_ne_u32 vcc, 3, v131
    s_nop 1
    v_cndmask_b32 v246, v158, v246, vcc
    v_cndmask_b32 v247, v159, v247, vcc
    v_mul_f32 v242, v160, v236
    v_mul_f32 v243, v160, v237
    v_fma_f32 v242, -v161, v237, v242
    v_fmac_f32 v243, v161, v236
    s_lshl_b32 s84, s80, 7
    s_add_u32 s81, s61, s84
    s_add_u32 m0, s58, 40960
    s_nop 0
    buffer_load_dwordx4 v2, s[4:7], s81 offen offset:0  lds
    s_add_u32 s82, s66, s84
    s_mul_i32 s83, s80, 196608
    buffer_load_dwordx4 v3, s[4:7], s81 offen offset:1024  lds
    s_add_u32 s83, s83, s79
    s_add_u32 s80, s80, 1
    buffer_load_dwordx4 v4, s[4:7], s81 offen offset:2048  lds
    s_cmp_eq_u32 s80, 10
    s_cselect_b32 s80, 0, s80
    buffer_load_dwordx4 v5, s[4:7], s81 offen offset:3072  lds
    s_add_u32 m0, s59, 40960
    s_nop 0
    buffer_load_dwordx4 v6, s[8:11], s82 offen offset:0  lds
    buffer_load_dwordx4 v7, s[8:11], s82 offen offset:1024  lds
    s_add_u32 m0, s59, 49152
    s_nop 0
    buffer_load_dwordx4 v6, s[12:15], s82 offen offset:0  lds
    buffer_load_dwordx4 v7, s[12:15], s82 offen offset:1024  lds
    s_add_u32 m0, s59, 57344
    s_nop 0
    buffer_load_dwordx4 v8, s[16:19], s83 offen offset:0  lds
    buffer_load_dwordx4 v9, s[16:19], s83 offen offset:1024  lds
    v_min_u32 v120, 9, v0
    v_lshlrev_b32 v120, 7, v120
    global_load_dword a255, v120, s[56:57]
    s_waitcnt vmcnt(11)
    s_barrier
    ds_read_b128 v[72:75], v12 offset:0
    ds_read_b128 v[40:43], v10 offset:0
    ds_read_b128 v[76:79], v12 offset:8192
    ds_read_b128 v[44:47], v10 offset:2048
    ds_read_b128 v[48:51], v10 offset:4096
    ds_read_b128 v[52:55], v10 offset:6144
    ds_read_b128 v[56:59], v16 offset:0
    ds_read_b128 v[60:63], v16 offset:2048
    ds_read_b128 v[64:67], v16 offset:4096
    ds_read_b128 v[68:71], v16 offset:6144
    ds_read_b64_tr_b16 v[80:81], v14 offset:16384
    ds_read_b64_tr_b16 v[82:83], v14 offset:16896
    ds_read_b64_tr_b16 v[84:85], v15 offset:16384
    ds_read_b64_tr_b16 v[86:87], v15 offset:16896
    s_waitcnt lgkmcnt(0)
    v_mfma_f32_16x16x32_bf16 v[136:139], v[40:43], v[72:75], 0
    ds_read_b128 v[120:123], v13 offset:0
    v_mfma_f32_16x16x32_bf16 v[140:143], v[44:47], v[72:75], 0
    ds_read_b128 v[88:91], v11 offset:0
    v_mfma_f32_16x16x32_bf16 v[144:147], v[48:51], v[72:75], 0
    ds_read_b128 v[124:127], v13 offset:8192
    s_lshl_b32 s84, s80, 7
    s_add_u32 s81, s61, s84
    s_add_u32 m0, s58, 81920
    v_mfma_f32_16x16x32_bf16 v[148:151], v[52:55], v[72:75], 0
    buffer_load_dwordx4 v2, s[4:7], s81 offen offset:0  lds
    v_mfma_f32_16x16x32_bf16 v[152:155], v[56:59], v[72:75], 0
    ds_read_b128 v[92:95], v11 offset:2048
    v_mfma_f32_16x16x32_bf16 v[156:159], v[60:63], v[72:75], 0
    ds_read_b128 v[96:99], v11 offset:4096
    v_mfma_f32_16x16x32_bf16 v[160:163], v[64:67], v[72:75], 0
    ds_read_b128 v[100:103], v11 offset:6144
    s_add_u32 s82, s66, s84
    s_mul_i32 s83, s80, 196608
    v_mfma_f32_16x16x32_bf16 v[164:167], v[68:71], v[72:75], 0
    buffer_load_dwordx4 v3, s[4:7], s81 offen offset:1024  lds
    v_mfma_f32_16x16x32_bf16 v[168:171], v[40:43], v[76:79], 0
    ds_read_b128 v[104:107], v17 offset:0
    v_mfma_f32_16x16x32_bf16 v[172:175], v[44:47], v[76:79], 0
    ds_read_b128 v[108:111], v17 offset:2048
    v_mfma_f32_16x16x32_bf16 v[176:179], v[48:51], v[76:79], 0
    ds_read_b128 v[112:115], v17 offset:4096
    s_add_u32 s83, s83, s79
    s_add_u32 s80, s80, 1
    v_mfma_f32_16x16x32_bf16 v[180:183], v[52:55], v[76:79], 0
    buffer_load_dwordx4 v4, s[4:7], s81 offen offset:2048  lds
    v_mfma_f32_16x16x32_bf16 v[184:187], v[56:59], v[76:79], 0
    ds_read_b128 v[116:119], v17 offset:6144
    v_mfma_f32_16x16x32_bf16 v[188:191], v[60:63], v[76:79], 0
    ds_read_b64_tr_b16 v[128:129], v14 offset:20480
    v_mfma_f32_16x16x32_bf16 v[192:195], v[64:67], v[76:79], 0
    ds_read_b64_tr_b16 v[130:131], v14 offset:20992
    s_cmp_eq_u32 s80, 10
    s_cselect_b32 s80, 0, s80
    v_mfma_f32_16x16x32_bf16 v[196:199], v[68:71], v[76:79], 0
    buffer_load_dwordx4 v5, s[4:7], s81 offen offset:3072  lds
    v_mfma_f32_16x16x32_bf16 v[200:203], v[80:83], v[40:43], 0
    ds_read_b64_tr_b16 v[132:133], v15 offset:20480
    v_mfma_f32_16x16x32_bf16 v[204:207], v[80:83], v[44:47], 0
    ds_read_b64_tr_b16 v[134:135], v15 offset:20992
    v_mfma_f32_16x16x32_bf16 v[208:211], v[80:83], v[48:51], 0
    s_add_u32 m0, s59, 81920
    v_mfma_f32_16x16x32_bf16 v[212:215], v[80:83], v[52:55], 0
    buffer_load_dwordx4 v6, s[8:11], s82 offen offset:0  lds
    v_mfma_f32_16x16x32_bf16 v[216:219], v[84:87], v[40:43], 0
    v_mfma_f32_16x16x32_bf16 v[220:223], v[84:87], v[44:47], 0
    v_mfma_f32_16x16x32_bf16 v[224:227], v[84:87], v[48:51], 0
    v_mfma_f32_16x16x32_bf16 v[228:231], v[84:87], v[52:55], 0
    buffer_load_dwordx4 v7, s[8:11], s82 offen offset:1024  lds
    s_waitcnt lgkmcnt(0)
    s_waitcnt vmcnt(7)
    s_barrier
    v_mfma_f32_16x16x32_bf16 v[136:139], v[88:91], v[120:123], v[136:139]
    ds_read_b128 v[72:75], v20 offset:0
    v_mfma_f32_16x16x32_bf16 v[140:143], v[92:95], v[120:123], v[140:143]
    ds_read_b128 v[40:43], v18 offset:0
    v_mfma_f32_16x16x32_bf16 v[144:147], v[96:99], v[120:123], v[144:147]
    ds_read_b128 v[76:79], v20 offset:8192
    s_add_u32 m0, s59, 90112
    v_mfma_f32_16x16x32_bf16 v[148:151], v[100:103], v[120:123], v[148:151]
    buffer_load_dwordx4 v6, s[12:15], s82 offen offset:0  lds
    v_mfma_f32_16x16x32_bf16 v[152:155], v[104:107], v[120:123], v[152:155]
    ds_read_b128 v[44:47], v18 offset:2048
    v_mfma_f32_16x16x32_bf16 v[156:159], v[108:111], v[120:123], v[156:159]
    ds_read_b128 v[48:51], v18 offset:4096
    v_mfma_f32_16x16x32_bf16 v[160:163], v[112:115], v[120:123], v[160:163]
    ds_read_b128 v[52:55], v18 offset:6144
    v_mfma_f32_16x16x32_bf16 v[164:167], v[116:119], v[120:123], v[164:167]
    buffer_load_dwordx4 v7, s[12:15], s82 offen offset:1024  lds
    v_mfma_f32_16x16x32_bf16 v[168:171], v[88:91], v[124:127], v[168:171]
    ds_read_b128 v[56:59], v24 offset:0
    v_mfma_f32_16x16x32_bf16 v[172:175], v[92:95], v[124:127], v[172:175]
    ds_read_b128 v[60:63], v24 offset:2048
    v_mfma_f32_16x16x32_bf16 v[176:179], v[96:99], v[124:127], v[176:179]
    ds_read_b128 v[64:67], v24 offset:4096
    s_add_u32 m0, s59, 98304
    v_mfma_f32_16x16x32_bf16 v[180:183], v[100:103], v[124:127], v[180:183]
    buffer_load_dwordx4 v8, s[16:19], s83 offen offset:0  lds
    v_mfma_f32_16x16x32_bf16 v[184:187], v[104:107], v[124:127], v[184:187]
    ds_read_b128 v[68:71], v24 offset:6144
    v_mfma_f32_16x16x32_bf16 v[188:191], v[108:111], v[124:127], v[188:191]
    ds_read_b64_tr_b16 v[80:81], v22 offset:16384
    v_mfma_f32_16x16x32_bf16 v[192:195], v[112:115], v[124:127], v[192:195]
    ds_read_b64_tr_b16 v[82:83], v22 offset:16896
    global_load_dword v35, v34, s[68:69] sc1
    v_mfma_f32_16x16x32_bf16 v[196:199], v[116:119], v[124:127], v[196:199]
    buffer_load_dwordx4 v9, s[16:19], s83 offen offset:1024  lds
    v_mfma_f32_16x16x32_bf16 v[200:203], v[128:131], v[88:91], v[200:203]
    ds_read_b64_tr_b16 v[84:85], v23 offset:16384
    v_mfma_f32_16x16x32_bf16 v[204:207], v[128:131], v[92:95], v[204:207]
    ds_read_b64_tr_b16 v[86:87], v23 offset:16896
    v_mfma_f32_16x16x32_bf16 v[208:211], v[128:131], v[96:99], v[208:211]
    s_lshl_b32 s84, s80, 7
    s_add_u32 s81, s61, s84
    s_add_u32 m0, s58, 0
    v_mfma_f32_16x16x32_bf16 v[212:215], v[128:131], v[100:103], v[212:215]
    buffer_load_dwordx4 v2, s[4:7], s81 offen offset:0  lds
    v_mfma_f32_16x16x32_bf16 v[216:219], v[132:135], v[88:91], v[216:219]
    v_mfma_f32_16x16x32_bf16 v[220:223], v[132:135], v[92:95], v[220:223]
    v_mfma_f32_16x16x32_bf16 v[224:227], v[132:135], v[96:99], v[224:227]
    s_add_u32 s82, s66, s84
    s_mul_i32 s83, s80, 196608
    v_mfma_f32_16x16x32_bf16 v[228:231], v[132:135], v[100:103], v[228:231]
    buffer_load_dwordx4 v3, s[4:7], s81 offen offset:1024  lds
    s_waitcnt lgkmcnt(0)
    v_mfma_f32_16x16x32_bf16 v[136:139], v[40:43], v[72:75], v[136:139]
    ds_read_b128 v[120:123], v21 offset:0
    v_mfma_f32_16x16x32_bf16 v[140:143], v[44:47], v[72:75], v[140:143]
    ds_read_b128 v[88:91], v19 offset:0
    v_mfma_f32_16x16x32_bf16 v[144:147], v[48:51], v[72:75], v[144:147]
    ds_read_b128 v[124:127], v21 offset:8192
    s_add_u32 s83, s83, s79
    s_add_u32 s80, s80, 1
    v_mfma_f32_16x16x32_bf16 v[148:151], v[52:55], v[72:75], v[148:151]
    buffer_load_dwordx4 v4, s[4:7], s81 offen offset:2048  lds
    v_mfma_f32_16x16x32_bf16 v[152:155], v[56:59], v[72:75], v[152:155]
    ds_read_b128 v[92:95], v19 offset:2048
    v_mfma_f32_16x16x32_bf16 v[156:159], v[60:63], v[72:75], v[156:159]
    ds_read_b128 v[96:99], v19 offset:4096
    v_mfma_f32_16x16x32_bf16 v[160:163], v[64:67], v[72:75], v[160:163]
    ds_read_b128 v[100:103], v19 offset:6144
    s_cmp_eq_u32 s80, 10
    s_cselect_b32 s80, 0, s80
    v_mfma_f32_16x16x32_bf16 v[164:167], v[68:71], v[72:75], v[164:167]
    buffer_load_dwordx4 v5, s[4:7], s81 offen offset:3072  lds
    v_mfma_f32_16x16x32_bf16 v[168:171], v[40:43], v[76:79], v[168:171]
    ds_read_b128 v[104:107], v25 offset:0
    v_mfma_f32_16x16x32_bf16 v[172:175], v[44:47], v[76:79], v[172:175]
    ds_read_b128 v[108:111], v25 offset:2048
    v_mfma_f32_16x16x32_bf16 v[176:179], v[48:51], v[76:79], v[176:179]
    ds_read_b128 v[112:115], v25 offset:4096
    s_add_u32 m0, s59, 0
    v_mfma_f32_16x16x32_bf16 v[180:183], v[52:55], v[76:79], v[180:183]
    buffer_load_dwordx4 v6, s[8:11], s82 offen offset:0  lds
    v_mfma_f32_16x16x32_bf16 v[184:187], v[56:59], v[76:79], v[184:187]
    ds_read_b128 v[116:119], v25 offset:6144
    v_mfma_f32_16x16x32_bf16 v[188:191], v[60:63], v[76:79], v[188:191]
    ds_read_b64_tr_b16 v[128:129], v22 offset:20480
    v_mfma_f32_16x16x32_bf16 v[192:195], v[64:67], v[76:79], v[192:195]
    ds_read_b64_tr_b16 v[130:131], v22 offset:20992
    v_mfma_f32_16x16x32_bf16 v[196:199], v[68:71], v[76:79], v[196:199]
    buffer_load_dwordx4 v7, s[8:11], s82 offen offset:1024  lds
    v_mfma_f32_16x16x32_bf16 v[200:203], v[80:83], v[40:43], v[200:203]
    ds_read_b64_tr_b16 v[132:133], v23 offset:20480
    v_mfma_f32_16x16x32_bf16 v[204:207], v[80:83], v[44:47], v[204:207]
    ds_read_b64_tr_b16 v[134:135], v23 offset:20992
    v_mfma_f32_16x16x32_bf16 v[208:211], v[80:83], v[48:51], v[208:211]
    s_add_u32 m0, s59, 8192
    v_mfma_f32_16x16x32_bf16 v[212:215], v[80:83], v[52:55], v[212:215]
    buffer_load_dwordx4 v6, s[12:15], s82 offen offset:0  lds
    v_mfma_f32_16x16x32_bf16 v[216:219], v[84:87], v[40:43], v[216:219]
    v_mfma_f32_16x16x32_bf16 v[220:223], v[84:87], v[44:47], v[220:223]
    v_mfma_f32_16x16x32_bf16 v[224:227], v[84:87], v[48:51], v[224:227]
    v_mfma_f32_16x16x32_bf16 v[228:231], v[84:87], v[52:55], v[228:231]
    buffer_load_dwordx4 v7, s[12:15], s82 offen offset:1024  lds
    s_waitcnt lgkmcnt(0)
    s_waitcnt vmcnt(8)
    s_barrier
    v_mfma_f32_16x16x32_bf16 v[136:139], v[88:91], v[120:123], v[136:139]
    ds_read_b128 v[72:75], v28 offset:0
    v_mfma_f32_16x16x32_bf16 v[140:143], v[92:95], v[120:123], v[140:143]
    ds_read_b128 v[40:43], v26 offset:0
    v_mfma_f32_16x16x32_bf16 v[144:147], v[96:99], v[120:123], v[144:147]
    ds_read_b128 v[76:79], v28 offset:8192
    s_add_u32 m0, s59, 16384
    v_mfma_f32_16x16x32_bf16 v[148:151], v[100:103], v[120:123], v[148:151]
    buffer_load_dwordx4 v8, s[16:19], s83 offen offset:0  lds
    v_mfma_f32_16x16x32_bf16 v[152:155], v[104:107], v[120:123], v[152:155]
    ds_read_b128 v[44:47], v26 offset:2048
    v_mfma_f32_16x16x32_bf16 v[156:159], v[108:111], v[120:123], v[156:159]
    ds_read_b128 v[48:51], v26 offset:4096
    v_mfma_f32_16x16x32_bf16 v[160:163], v[112:115], v[120:123], v[160:163]
    ds_read_b128 v[52:55], v26 offset:6144
    v_mfma_f32_16x16x32_bf16 v[164:167], v[116:119], v[120:123], v[164:167]
    buffer_load_dwordx4 v9, s[16:19], s83 offen offset:1024  lds
    v_mfma_f32_16x16x32_bf16 v[168:171], v[88:91], v[124:127], v[168:171]
    ds_read_b128 v[56:59], v32 offset:0
    v_mfma_f32_16x16x32_bf16 v[172:175], v[92:95], v[124:127], v[172:175]
    ds_read_b128 v[60:63], v32 offset:2048
    v_mfma_f32_16x16x32_bf16 v[176:179], v[96:99], v[124:127], v[176:179]
    ds_read_b128 v[64:67], v32 offset:4096
    s_lshl_b32 s84, s80, 7
    s_add_u32 s81, s61, s84
    s_add_u32 m0, s58, 40960
    v_mfma_f32_16x16x32_bf16 v[180:183], v[100:103], v[124:127], v[180:183]
    buffer_load_dwordx4 v2, s[4:7], s81 offen offset:0  lds
    v_mfma_f32_16x16x32_bf16 v[184:187], v[104:107], v[124:127], v[184:187]
    ds_read_b128 v[68:71], v32 offset:6144
    v_mfma_f32_16x16x32_bf16 v[188:191], v[108:111], v[124:127], v[188:191]
    ds_read_b64_tr_b16 v[80:81], v30 offset:16384
    v_mfma_f32_16x16x32_bf16 v[192:195], v[112:115], v[124:127], v[192:195]
    ds_read_b64_tr_b16 v[82:83], v30 offset:16896
    s_add_u32 s82, s66, s84
    s_mul_i32 s83, s80, 196608
    v_mfma_f32_16x16x32_bf16 v[196:199], v[116:119], v[124:127], v[196:199]
    buffer_load_dwordx4 v3, s[4:7], s81 offen offset:1024  lds
    v_mfma_f32_16x16x32_bf16 v[200:203], v[128:131], v[88:91], v[200:203]
    ds_read_b64_tr_b16 v[84:85], v31 offset:16384
    v_mfma_f32_16x16x32_bf16 v[204:207], v[128:131], v[92:95], v[204:207]
    ds_read_b64_tr_b16 v[86:87], v31 offset:16896
    v_mfma_f32_16x16x32_bf16 v[208:211], v[128:131], v[96:99], v[208:211]
    s_add_u32 s83, s83, s79
    s_add_u32 s80, s80, 1
    v_mfma_f32_16x16x32_bf16 v[212:215], v[128:131], v[100:103], v[212:215]
    buffer_load_dwordx4 v4, s[4:7], s81 offen offset:2048  lds
    v_mfma_f32_16x16x32_bf16 v[216:219], v[132:135], v[88:91], v[216:219]
    v_mfma_f32_16x16x32_bf16 v[220:223], v[132:135], v[92:95], v[220:223]
    v_mfma_f32_16x16x32_bf16 v[224:227], v[132:135], v[96:99], v[224:227]
    s_cmp_eq_u32 s80, 10
    s_cselect_b32 s80, 0, s80
    v_mfma_f32_16x16x32_bf16 v[228:231], v[132:135], v[100:103], v[228:231]
    buffer_load_dwordx4 v5, s[4:7], s81 offen offset:3072  lds
    s_waitcnt lgkmcnt(0)
    v_mfma_f32_16x16x32_bf16 v[136:139], v[40:43], v[72:75], v[136:139]
    ds_read_b128 v[120:123], v29 offset:0
    v_mfma_f32_16x16x32_bf16 v[140:143], v[44:47], v[72:75], v[140:143]
    ds_read_b128 v[88:91], v27 offset:0
    v_mfma_f32_16x16x32_bf16 v[144:147], v[48:51], v[72:75], v[144:147]
    ds_read_b128 v[124:127], v29 offset:8192
    s_add_u32 m0, s59, 40960
    v_mfma_f32_16x16x32_bf16 v[148:151], v[52:55], v[72:75], v[148:151]
    buffer_load_dwordx4 v6, s[8:11], s82 offen offset:0  lds
    v_mfma_f32_16x16x32_bf16 v[152:155], v[56:59], v[72:75], v[152:155]
    ds_read_b128 v[92:95], v27 offset:2048
    v_mfma_f32_16x16x32_bf16 v[156:159], v[60:63], v[72:75], v[156:159]
    ds_read_b128 v[96:99], v27 offset:4096
    v_mfma_f32_16x16x32_bf16 v[160:163], v[64:67], v[72:75], v[160:163]
    ds_read_b128 v[100:103], v27 offset:6144
    v_mfma_f32_16x16x32_bf16 v[164:167], v[68:71], v[72:75], v[164:167]
    buffer_load_dwordx4 v7, s[8:11], s82 offen offset:1024  lds
    v_mfma_f32_16x16x32_bf16 v[168:171], v[40:43], v[76:79], v[168:171]
    ds_read_b128 v[104:107], v33 offset:0
    v_mfma_f32_16x16x32_bf16 v[172:175], v[44:47], v[76:79], v[172:175]
    ds_read_b128 v[108:111], v33 offset:2048
    v_mfma_f32_16x16x32_bf16 v[176:179], v[48:51], v[76:79], v[176:179]
    ds_read_b128 v[112:115], v33 offset:4096
    s_add_u32 m0, s59, 49152
    v_mfma_f32_16x16x32_bf16 v[180:183], v[52:55], v[76:79], v[180:183]
    buffer_load_dwordx4 v6, s[12:15], s82 offen offset:0  lds
    v_mfma_f32_16x16x32_bf16 v[184:187], v[56:59], v[76:79], v[184:187]
    ds_read_b128 v[116:119], v33 offset:6144
    v_mfma_f32_16x16x32_bf16 v[188:191], v[60:63], v[76:79], v[188:191]
    ds_read_b64_tr_b16 v[128:129], v30 offset:20480
    v_mfma_f32_16x16x32_bf16 v[192:195], v[64:67], v[76:79], v[192:195]
    ds_read_b64_tr_b16 v[130:131], v30 offset:20992
    v_mfma_f32_16x16x32_bf16 v[196:199], v[68:71], v[76:79], v[196:199]
    buffer_load_dwordx4 v7, s[12:15], s82 offen offset:1024  lds
    v_mfma_f32_16x16x32_bf16 v[200:203], v[80:83], v[40:43], v[200:203]
    ds_read_b64_tr_b16 v[132:133], v31 offset:20480
    v_mfma_f32_16x16x32_bf16 v[204:207], v[80:83], v[44:47], v[204:207]
    ds_read_b64_tr_b16 v[134:135], v31 offset:20992
    v_mfma_f32_16x16x32_bf16 v[208:211], v[80:83], v[48:51], v[208:211]
    s_add_u32 m0, s59, 57344
    v_mfma_f32_16x16x32_bf16 v[212:215], v[80:83], v[52:55], v[212:215]
    buffer_load_dwordx4 v8, s[16:19], s83 offen offset:0  lds
    v_mfma_f32_16x16x32_bf16 v[216:219], v[84:87], v[40:43], v[216:219]
    v_mfma_f32_16x16x32_bf16 v[220:223], v[84:87], v[44:47], v[220:223]
    v_mfma_f32_16x16x32_bf16 v[224:227], v[84:87], v[48:51], v[224:227]
    v_mfma_f32_16x16x32_bf16 v[228:231], v[84:87], v[52:55], v[228:231]
    buffer_load_dwordx4 v9, s[16:19], s83 offen offset:1024  lds
    s_waitcnt lgkmcnt(0)
    s_waitcnt vmcnt(10)
    s_barrier
    v_mfma_f32_16x16x32_bf16 v[136:139], v[88:91], v[120:123], v[136:139]
    ds_read_b128 v[72:75], v12 offset:0
    v_mfma_f32_16x16x32_bf16 v[140:143], v[92:95], v[120:123], v[140:143]
    ds_read_b128 v[40:43], v10 offset:0
    v_mfma_f32_16x16x32_bf16 v[144:147], v[96:99], v[120:123], v[144:147]
    ds_read_b128 v[76:79], v12 offset:8192
    s_lshl_b32 s84, s80, 7
    s_add_u32 s81, s61, s84
    s_add_u32 m0, s58, 81920
    v_mfma_f32_16x16x32_bf16 v[148:151], v[100:103], v[120:123], v[148:151]
    buffer_load_dwordx4 v2, s[4:7], s81 offen offset:0  lds
    v_mfma_f32_16x16x32_bf16 v[152:155], v[104:107], v[120:123], v[152:155]
    ds_read_b128 v[44:47], v10 offset:2048
    v_mfma_f32_16x16x32_bf16 v[156:159], v[108:111], v[120:123], v[156:159]
    ds_read_b128 v[48:51], v10 offset:4096
    v_mfma_f32_16x16x32_bf16 v[160:163], v[112:115], v[120:123], v[160:163]
    ds_read_b128 v[52:55], v10 offset:6144
    s_add_u32 s82, s66, s84
    s_mul_i32 s83, s80, 196608
    v_mfma_f32_16x16x32_bf16 v[164:167], v[116:119], v[120:123], v[164:167]
    buffer_load_dwordx4 v3, s[4:7], s81 offen offset:1024  lds
    v_mfma_f32_16x16x32_bf16 v[168:171], v[88:91], v[124:127], v[168:171]
    ds_read_b128 v[56:59], v16 offset:0
    v_mfma_f32_16x16x32_bf16 v[172:175], v[92:95], v[124:127], v[172:175]
    ds_read_b128 v[60:63], v16 offset:2048
    v_mfma_f32_16x16x32_bf16 v[176:179], v[96:99], v[124:127], v[176:179]
    ds_read_b128 v[64:67], v16 offset:4096
    s_add_u32 s83, s83, s79
    s_add_u32 s80, s80, 1
    v_mfma_f32_16x16x32_bf16 v[180:183], v[100:103], v[124:127], v[180:183]
    buffer_load_dwordx4 v4, s[4:7], s81 offen offset:2048  lds
    v_mfma_f32_16x16x32_bf16 v[184:187], v[104:107], v[124:127], v[184:187]
    ds_read_b128 v[68:71], v16 offset:6144
    v_mfma_f32_16x16x32_bf16 v[188:191], v[108:111], v[124:127], v[188:191]
    ds_read_b64_tr_b16 v[80:81], v14 offset:16384
    v_mfma_f32_16x16x32_bf16 v[192:195], v[112:115], v[124:127], v[192:195]
    ds_read_b64_tr_b16 v[82:83], v14 offset:16896
    s_cmp_eq_u32 s80, 10
    s_cselect_b32 s80, 0, s80
    v_mfma_f32_16x16x32_bf16 v[196:199], v[116:119], v[124:127], v[196:199]
    buffer_load_dwordx4 v5, s[4:7], s81 offen offset:3072  lds
    v_mfma_f32_16x16x32_bf16 v[200:203], v[128:131], v[88:91], v[200:203]
    ds_read_b64_tr_b16 v[84:85], v15 offset:16384
    v_mfma_f32_16x16x32_bf16 v[204:207], v[128:131], v[92:95], v[204:207]
    ds_read_b64_tr_b16 v[86:87], v15 offset:16896
    v_mfma_f32_16x16x32_bf16 v[208:211], v[128:131], v[96:99], v[208:211]
    s_add_u32 m0, s59, 81920
    v_mfma_f32_16x16x32_bf16 v[212:215], v[128:131], v[100:103], v[212:215]
    buffer_load_dwordx4 v6, s[8:11], s82 offen offset:0  lds
    v_mfma_f32_16x16x32_bf16 v[216:219], v[132:135], v[88:91], v[216:219]
    v_mfma_f32_16x16x32_bf16 v[220:223], v[132:135], v[92:95], v[220:223]
    v_mfma_f32_16x16x32_bf16 v[224:227], v[132:135], v[96:99], v[224:227]
    v_mfma_f32_16x16x32_bf16 v[228:231], v[132:135], v[100:103], v[228:231]
    s_waitcnt lgkmcnt(0)
    v_mfma_f32_16x16x32_bf16 v[136:139], v[40:43], v[72:75], v[136:139]
    ds_read_b128 v[120:123], v13 offset:0
    v_mfma_f32_16x16x32_bf16 v[140:143], v[44:47], v[72:75], v[140:143]
    ds_read_b128 v[88:91], v11 offset:0
    v_mfma_f32_16x16x32_bf16 v[144:147], v[48:51], v[72:75], v[144:147]
    ds_read_b128 v[124:127], v13 offset:8192
    v_mfma_f32_16x16x32_bf16 v[148:151], v[52:55], v[72:75], v[148:151]
    buffer_load_dwordx4 v7, s[8:11], s82 offen offset:1024  lds
    v_mfma_f32_16x16x32_bf16 v[152:155], v[56:59], v[72:75], v[152:155]
    ds_read_b128 v[92:95], v11 offset:2048
    v_mfma_f32_16x16x32_bf16 v[156:159], v[60:63], v[72:75], v[156:159]
    ds_read_b128 v[96:99], v11 offset:4096
    v_mfma_f32_16x16x32_bf16 v[160:163], v[64:67], v[72:75], v[160:163]
    ds_read_b128 v[100:103], v11 offset:6144
    s_add_u32 m0, s59, 90112
    v_mfma_f32_16x16x32_bf16 v[164:167], v[68:71], v[72:75], v[164:167]
    buffer_load_dwordx4 v6, s[12:15], s82 offen offset:0  lds
    v_mfma_f32_16x16x32_bf16 v[168:171], v[40:43], v[76:79], v[168:171]
    ds_read_b128 v[104:107], v17 offset:0
    v_mfma_f32_16x16x32_bf16 v[172:175], v[44:47], v[76:79], v[172:175]
    ds_read_b128 v[108:111], v17 offset:2048
    v_mfma_f32_16x16x32_bf16 v[176:179], v[48:51], v[76:79], v[176:179]
    ds_read_b128 v[112:115], v17 offset:4096
    v_mfma_f32_16x16x32_bf16 v[180:183], v[52:55], v[76:79], v[180:183]
    buffer_load_dwordx4 v7, s[12:15], s82 offen offset:1024  lds
    v_mfma_f32_16x16x32_bf16 v[184:187], v[56:59], v[76:79], v[184:187]
    ds_read_b128 v[116:119], v17 offset:6144
    v_mfma_f32_16x16x32_bf16 v[188:191], v[60:63], v[76:79], v[188:191]
    ds_read_b64_tr_b16 v[128:129], v14 offset:20480
    v_mfma_f32_16x16x32_bf16 v[192:195], v[64:67], v[76:79], v[192:195]
    ds_read_b64_tr_b16 v[130:131], v14 offset:20992
    s_add_u32 m0, s59, 98304
    v_readfirstlane_b32 s88, v35
    s_nop 1
    s_cmp_eq_u32 s88, 0
    s_cbranch_scc1 L_tagslow3
L_tagok3:
    v_mov_b32 v36, s88
    v_mov_b32 v37, s88
    v_mfma_f32_16x16x32_bf16 v[196:199], v[68:71], v[76:79], v[196:199]
    buffer_load_dwordx4 v8, s[16:19], s83 offen offset:0  lds
    v_mfma_f32_16x16x32_bf16 v[200:203], v[80:83], v[40:43], v[200:203]
    ds_read_b64_tr_b16 v[132:133], v15 offset:20480
    v_mfma_f32_16x16x32_bf16 v[204:207], v[80:83], v[44:47], v[204:207]
    ds_read_b64_tr_b16 v[134:135], v15 offset:20992
    v_mfma_f32_16x16x32_bf16 v[208:211], v[80:83], v[48:51], v[208:211]
    v_mfma_f32_16x16x32_bf16 v[212:215], v[80:83], v[52:55], v[212:215]
    buffer_load_dwordx4 v9, s[16:19], s83 offen offset:1024  lds
    v_mfma_f32_16x16x32_bf16 v[216:219], v[84:87], v[40:43], v[216:219]
    v_mfma_f32_16x16x32_bf16 v[220:223], v[84:87], v[44:47], v[220:223]
    v_mfma_f32_16x16x32_bf16 v[224:227], v[84:87], v[48:51], v[224:227]
    v_mfma_f32_16x16x32_bf16 v[228:231], v[84:87], v[52:55], v[228:231]
    s_waitcnt lgkmcnt(0)
    s_waitcnt vmcnt(10)
    s_barrier
    v_mfma_f32_16x16x32_bf16 v[136:139], v[88:91], v[120:123], v[136:139]
    ds_read_b128 v[72:75], v20 offset:0
    v_mfma_f32_16x16x32_bf16 v[140:143], v[92:95], v[120:123], v[140:143]
    ds_read_b128 v[40:43], v18 offset:0
    v_mfma_f32_16x16x32_bf16 v[144:147], v[96:99], v[120:123], v[144:147]
    ds_read_b128 v[76:79], v20 offset:8192
    s_lshl_b32 s84, s80, 7
    s_add_u32 s81, s61, s84
    s_add_u32 m0, s58, 0
    v_mfma_f32_16x16x32_bf16 v[148:151], v[100:103], v[120:123], v[148:151]
    buffer_load_dwordx4 v2, s[4:7], s81 offen offset:0  lds
    v_mfma_f32_16x16x32_bf16 v[152:155], v[104:107], v[120:123], v[152:155]
    ds_read_b128 v[44:47], v18 offset:2048
    v_mfma_f32_16x16x32_bf16 v[156:159], v[108:111], v[120:123], v[156:159]
    ds_read_b128 v[48:51], v18 offset:4096
    v_mfma_f32_16x16x32_bf16 v[160:163], v[112:115], v[120:123], v[160:163]
    ds_read_b128 v[52:55], v18 offset:6144
    s_add_u32 s82, s66, s84
    s_mul_i32 s83, s80, 196608
    v_mfma_f32_16x16x32_bf16 v[164:167], v[116:119], v[120:123], v[164:167]
    buffer_load_dwordx4 v3, s[4:7], s81 offen offset:1024  lds
    v_mfma_f32_16x16x32_bf16 v[168:171], v[88:91], v[124:127], v[168:171]
    ds_read_b128 v[56:59], v24 offset:0
    v_mfma_f32_16x16x32_bf16 v[172:175], v[92:95], v[124:127], v[172:175]
    ds_read_b128 v[60:63], v24 offset:2048
    v_mfma_f32_16x16x32_bf16 v[176:179], v[96:99], v[124:127], v[176:179]
    ds_read_b128 v[64:67], v24 offset:4096
    s_add_u32 s83, s83, s79
    s_add_u32 s80, s80, 1
    v_mfma_f32_16x16x32_bf16 v[180:183], v[100:103], v[124:127], v[180:183]
    buffer_load_dwordx4 v4, s[4:7], s81 offen offset:2048  lds
    v_mfma_f32_16x16x32_bf16 v[184:187], v[104:107], v[124:127], v[184:187]
    ds_read_b128 v[68:71], v24 offset:6144
    v_mfma_f32_16x16x32_bf16 v[188:191], v[108:111], v[124:127], v[188:191]
    ds_read_b64_tr_b16 v[80:81], v22 offset:16384
    v_mfma_f32_16x16x32_bf16 v[192:195], v[112:115], v[124:127], v[192:195]
    ds_read_b64_tr_b16 v[82:83], v22 offset:16896
    s_cmp_eq_u32 s80, 10
    s_cselect_b32 s80, 0, s80
    v_mfma_f32_16x16x32_bf16 v[196:199], v[116:119], v[124:127], v[196:199]
    buffer_load_dwordx4 v5, s[4:7], s81 offen offset:3072  lds
    v_mfma_f32_16x16x32_bf16 v[200:203], v[128:131], v[88:91], v[200:203]
    ds_read_b64_tr_b16 v[84:85], v23 offset:16384
    v_mfma_f32_16x16x32_bf16 v[204:207], v[128:131], v[92:95], v[204:207]
    ds_read_b64_tr_b16 v[86:87], v23 offset:16896
    v_mfma_f32_16x16x32_bf16 v[208:211], v[128:131], v[96:99], v[208:211]
    s_add_u32 m0, s59, 0
    v_mfma_f32_16x16x32_bf16 v[212:215], v[128:131], v[100:103], v[212:215]
    buffer_load_dwordx4 v6, s[8:11], s82 offen offset:0  lds
    v_mfma_f32_16x16x32_bf16 v[216:219], v[132:135], v[88:91], v[216:219]
    v_mfma_f32_16x16x32_bf16 v[220:223], v[132:135], v[92:95], v[220:223]
    v_mfma_f32_16x16x32_bf16 v[224:227], v[132:135], v[96:99], v[224:227]
    v_mfma_f32_16x16x32_bf16 v[228:231], v[132:135], v[100:103], v[228:231]
    s_waitcnt lgkmcnt(0)
    v_mfma_f32_16x16x32_bf16 v[136:139], v[40:43], v[72:75], v[136:139]
    ds_read_b128 v[120:123], v21 offset:0
    v_mfma_f32_16x16x32_bf16 v[140:143], v[44:47], v[72:75], v[140:143]
    ds_read_b128 v[88:91], v19 offset:0
    v_mfma_f32_16x16x32_bf16 v[144:147], v[48:51], v[72:75], v[144:147]
    ds_read_b128 v[124:127], v21 offset:8192
    v_mfma_f32_16x16x32_bf16 v[148:151], v[52:55], v[72:75], v[148:151]
    buffer_load_dwordx4 v7, s[8:11], s82 offen offset:1024  lds
    v_mfma_f32_16x16x32_bf16 v[152:155], v[56:59], v[72:75], v[152:155]
    ds_read_b128 v[92:95], v19 offset:2048
    v_mfma_f32_16x16x32_bf16 v[156:159], v[60:63], v[72:75], v[156:159]
    ds_read_b128 v[96:99], v19 offset:4096
    v_mfma_f32_16x16x32_bf16 v[160:163], v[64:67], v[72:75], v[160:163]
    ds_read_b128 v[100:103], v19 offset:6144
    s_add_u32 m0, s59, 8192
    v_mfma_f32_16x16x32_bf16 v[164:167], v[68:71], v[72:75], v[164:167]
    buffer_load_dwordx4 v6, s[12:15], s82 offen offset:0  lds
    v_mfma_f32_16x16x32_bf16 v[168:171], v[40:43], v[76:79], v[168:171]
    ds_read_b128 v[104:107], v25 offset:0
    v_mfma_f32_16x16x32_bf16 v[172:175], v[44:47], v[76:79], v[172:175]
    ds_read_b128 v[108:111], v25 offset:2048
    v_mfma_f32_16x16x32_bf16 v[176:179], v[48:51], v[76:79], v[176:179]
    ds_read_b128 v[112:115], v25 offset:4096
    v_mfma_f32_16x16x32_bf16 v[180:183], v[52:55], v[76:79], v[180:183]
    buffer_load_dwordx4 v7, s[12:15], s82 offen offset:1024  lds
    v_mfma_f32_16x16x32_bf16 v[184:187], v[56:59], v[76:79], v[184:187]
    ds_read_b128 v[116:119], v25 offset:6144
    v_mfma_f32_16x16x32_bf16 v[188:191], v[60:63], v[76:79], v[188:191]
    ds_read_b64_tr_b16 v[128:129], v22 offset:20480
    v_mfma_f32_16x16x32_bf16 v[192:195], v[64:67], v[76:79], v[192:195]
    ds_read_b64_tr_b16 v[130:131], v22 offset:20992
    s_add_u32 m0, s59, 16384
    v_mfma_f32_16x16x32_bf16 v[196:199], v[68:71], v[76:79], v[196:199]
    buffer_load_dwordx4 v8, s[16:19], s83 offen offset:0  lds
    v_mfma_f32_16x16x32_bf16 v[200:203], v[80:83], v[40:43], v[200:203]
    ds_read_b64_tr_b16 v[132:133], v23 offset:20480
    v_mfma_f32_16x16x32_bf16 v[204:207], v[80:83], v[44:47], v[204:207]
    ds_read_b64_tr_b16 v[134:135], v23 offset:20992
    v_mfma_f32_16x16x32_bf16 v[208:211], v[80:83], v[48:51], v[208:211]
    v_mfma_f32_16x16x32_bf16 v[212:215], v[80:83], v[52:55], v[212:215]
    buffer_load_dwordx4 v9, s[16:19], s83 offen offset:1024  lds
    v_mfma_f32_16x16x32_bf16 v[216:219], v[84:87], v[40:43], v[216:219]
    v_mfma_f32_16x16x32_bf16 v[220:223], v[84:87], v[44:47], v[220:223]
    v_mfma_f32_16x16x32_bf16 v[224:227], v[84:87], v[48:51], v[224:227]
    v_mfma_f32_16x16x32_bf16 v[228:231], v[84:87], v[52:55], v[228:231]
    s_waitcnt lgkmcnt(0)
    s_waitcnt vmcnt(10)
    s_barrier
    v_mfma_f32_16x16x32_bf16 v[136:139], v[88:91], v[120:123], v[136:139]
    ds_read_b128 v[72:75], v28 offset:0
    v_mfma_f32_16x16x32_bf16 v[140:143], v[92:95], v[120:123], v[140:143]
    ds_read_b128 v[40:43], v26 offset:0
    v_mfma_f32_16x16x32_bf16 v[144:147], v[96:99], v[120:123], v[144:147]
    ds_read_b128 v[76:79], v28 offset:8192
    s_lshl_b32 s84, s80, 7
    s_add_u32 s81, s61, s84
    s_add_u32 m0, s58, 40960
    v_mfma_f32_16x16x32_bf16 v[148:151], v[100:103], v[120:123], v[148:151]
    buffer_load_dwordx4 v2, s[4:7], s81 offen offset:0  lds
    v_mfma_f32_16x16x32_bf16 v[152:155], v[104:107], v[120:123], v[152:155]
    ds_read_b128 v[44:47], v26 offset:2048
    v_mfma_f32_16x16x32_bf16 v[156:159], v[108:111], v[120:123], v[156:159]
    ds_read_b128 v[48:51], v26 offset:4096
    v_mfma_f32_16x16x32_bf16 v[160:163], v[112:115], v[120:123], v[160:163]
    ds_read_b128 v[52:55], v26 offset:6144
    s_add_u32 s82, s66, s84
    s_mul_i32 s83, s80, 196608
    v_mfma_f32_16x16x32_bf16 v[164:167], v[116:119], v[120:123], v[164:167]
    buffer_load_dwordx4 v3, s[4:7], s81 offen offset:1024  lds
    v_mfma_f32_16x16x32_bf16 v[168:171], v[88:91], v[124:127], v[168:171]
    ds_read_b128 v[56:59], v32 offset:0
    v_mfma_f32_16x16x32_bf16 v[172:175], v[92:95], v[124:127], v[172:175]
    ds_read_b128 v[60:63], v32 offset:2048
    v_mfma_f32_16x16x32_bf16 v[176:179], v[96:99], v[124:127], v[176:179]
    ds_read_b128 v[64:67], v32 offset:4096
    s_add_u32 s83, s83, s79
    s_add_u32 s80, s80, 1
    v_mfma_f32_16x16x32_bf16 v[180:183], v[100:103], v[124:127], v[180:183]
    buffer_load_dwordx4 v4, s[4:7], s81 offen offset:2048  lds
    v_mfma_f32_16x16x32_bf16 v[184:187], v[104:107], v[124:127], v[184:187]
    ds_read_b128 v[68:71], v32 offset:6144
    v_mfma_f32_16x16x32_bf16 v[188:191], v[108:111], v[124:127], v[188:191]
    ds_read_b64_tr_b16 v[80:81], v30 offset:16384
    v_mfma_f32_16x16x32_bf16 v[192:195], v[112:115], v[124:127], v[192:195]
    ds_read_b64_tr_b16 v[82:83], v30 offset:16896
    s_cmp_eq_u32 s80, 10
    s_cselect_b32 s80, 0, s80
    v_mfma_f32_16x16x32_bf16 v[196:199], v[116:119], v[124:127], v[196:199]
    buffer_load_dwordx4 v5, s[4:7], s81 offen offset:3072  lds
    v_mfma_f32_16x16x32_bf16 v[200:203], v[128:131], v[88:91], v[200:203]
    ds_read_b64_tr_b16 v[84:85], v31 offset:16384
    v_mfma_f32_16x16x32_bf16 v[204:207], v[128:131], v[92:95], v[204:207]
    ds_read_b64_tr_b16 v[86:87], v31 offset:16896
    v_mfma_f32_16x16x32_bf16 v[208:211], v[128:131], v[96:99], v[208:211]
    s_add_u32 m0, s59, 40960
    v_mfma_f32_16x16x32_bf16 v[212:215], v[128:131], v[100:103], v[212:215]
    buffer_load_dwordx4 v6, s[8:11], s82 offen offset:0  lds
    v_mfma_f32_16x16x32_bf16 v[216:219], v[132:135], v[88:91], v[216:219]
    v_mfma_f32_16x16x32_bf16 v[220:223], v[132:135], v[92:95], v[220:223]
    v_mfma_f32_16x16x32_bf16 v[224:227], v[132:135], v[96:99], v[224:227]
    v_mfma_f32_16x16x32_bf16 v[228:231], v[132:135], v[100:103], v[228:231]
    s_waitcnt lgkmcnt(0)
    v_mfma_f32_16x16x32_bf16 v[136:139], v[40:43], v[72:75], v[136:139]
    ds_read_b128 v[120:123], v29 offset:0
    v_mfma_f32_16x16x32_bf16 v[140:143], v[44:47], v[72:75], v[140:143]
    ds_read_b128 v[88:91], v27 offset:0
    v_mfma_f32_16x16x32_bf16 v[144:147], v[48:51], v[72:75], v[144:147]
    ds_read_b128 v[124:127], v29 offset:8192
    v_mfma_f32_16x16x32_bf16 v[148:151], v[52:55], v[72:75], v[148:151]
    buffer_load_dwordx4 v7, s[8:11], s82 offen offset:1024  lds
    v_mfma_f32_16x16x32_bf16 v[152:155], v[56:59], v[72:75], v[152:155]
    ds_read_b128 v[92:95], v27 offset:2048
    v_mfma_f32_16x16x32_bf16 v[156:159], v[60:63], v[72:75], v[156:159]
    ds_read_b128 v[96:99], v27 offset:4096
    v_mfma_f32_16x16x32_bf16 v[160:163], v[64:67], v[72:75], v[160:163]
    ds_read_b128 v[100:103], v27 offset:6144
    s_add_u32 m0, s59, 49152
    v_mfma_f32_16x16x32_bf16 v[164:167], v[68:71], v[72:75], v[164:167]
    buffer_load_dwordx4 v6, s[12:15], s82 offen offset:0  lds
    v_mfma_f32_16x16x32_bf16 v[168:171], v[40:43], v[76:79], v[168:171]
    ds_read_b128 v[104:107], v33 offset:0
    v_mfma_f32_16x16x32_bf16 v[172:175], v[44:47], v[76:79], v[172:175]
    ds_read_b128 v[108:111], v33 offset:2048
    v_mfma_f32_16x16x32_bf16 v[176:179], v[48:51], v[76:79], v[176:179]
    ds_read_b128 v[112:115], v33 offset:4096
    v_mfma_f32_16x16x32_bf16 v[180:183], v[52:55], v[76:79], v[180:183]
    buffer_load_dwordx4 v7, s[12:15], s82 offen offset:1024  lds
    v_mfma_f32_16x16x32_bf16 v[184:187], v[56:59], v[76:79], v[184:187]
    ds_read_b128 v[116:119], v33 offset:6144
    v_mfma_f32_16x16x32_bf16 v[188:191], v[60:63], v[76:79], v[188:191]
    ds_read_b64_tr_b16 v[128:129], v30 offset:20480
    v_mfma_f32_16x16x32_bf16 v[192:195], v[64:67], v[76:79], v[192:195]
    ds_read_b64_tr_b16 v[130:131], v30 offset:20992
    s_add_u32 m0, s59, 57344
    v_mfma_f32_16x16x32_bf16 v[196:199], v[68:71], v[76:79], v[196:199]
    buffer_load_dwordx4 v8, s[16:19], s83 offen offset:0  lds
    v_mfma_f32_16x16x32_bf16 v[200:203], v[80:83], v[40:43], v[200:203]
    ds_read_b64_tr_b16 v[132:133], v31 offset:20480
    v_mfma_f32_16x16x32_bf16 v[204:207], v[80:83], v[44:47], v[204:207]
    ds_read_b64_tr_b16 v[134:135], v31 offset:20992
    v_mfma_f32_16x16x32_bf16 v[208:211], v[80:83], v[48:51], v[208:211]
    v_mfma_f32_16x16x32_bf16 v[212:215], v[80:83], v[52:55], v[212:215]
    buffer_load_dwordx4 v9, s[16:19], s83 offen offset:1024  lds
    v_mfma_f32_16x16x32_bf16 v[216:219], v[84:87], v[40:43], v[216:219]
    v_mfma_f32_16x16x32_bf16 v[220:223], v[84:87], v[44:47], v[220:223]
    v_mfma_f32_16x16x32_bf16 v[224:227], v[84:87], v[48:51], v[224:227]
    v_mfma_f32_16x16x32_bf16 v[228:231], v[84:87], v[52:55], v[228:231]
    s_waitcnt lgkmcnt(0)
    s_waitcnt vmcnt(10)
    s_barrier
    v_mfma_f32_16x16x32_bf16 v[136:139], v[88:91], v[120:123], v[136:139]
    ds_read_b128 v[72:75], v12 offset:0
    v_mfma_f32_16x16x32_bf16 v[140:143], v[92:95], v[120:123], v[140:143]
    ds_read_b128 v[40:43], v10 offset:0
    v_mfma_f32_16x16x32_bf16 v[144:147], v[96:99], v[120:123], v[144:147]
    ds_read_b128 v[76:79], v12 offset:8192
    s_lshl_b32 s84, s80, 7
    s_add_u32 s81, s61, s84
    s_add_u32 m0, s58, 81920
    v_mfma_f32_16x16x32_bf16 v[148:151], v[100:103], v[120:123], v[148:151]
    buffer_load_dwordx4 v2, s[4:7], s81 offen offset:0  lds
    v_mfma_f32_16x16x32_bf16 v[152:155], v[104:107], v[120:123], v[152:155]
    ds_read_b128 v[44:47], v10 offset:2048
    v_mfma_f32_16x16x32_bf16 v[156:159], v[108:111], v[120:123], v[156:159]
    ds_read_b128 v[48:51], v10 offset:4096
    v_mfma_f32_16x16x32_bf16 v[160:163], v[112:115], v[120:123], v[160:163]
    ds_read_b128 v[52:55], v10 offset:6144
    s_add_u32 s82, s66, s84
    s_mul_i32 s83, s80, 196608
    v_mfma_f32_16x16x32_bf16 v[164:167], v[116:119], v[120:123], v[164:167]
    buffer_load_dwordx4 v3, s[4:7], s81 offen offset:1024  lds
    v_mfma_f32_16x16x32_bf16 v[168:171], v[88:91], v[124:127], v[168:171]
    ds_read_b128 v[56:59], v16 offset:0
    v_mfma_f32_16x16x32_bf16 v[172:175], v[92:95], v[124:127], v[172:175]
    ds_read_b128 v[60:63], v16 offset:2048
    v_mfma_f32_16x16x32_bf16 v[176:179], v[96:99], v[124:127], v[176:179]
    ds_read_b128 v[64:67], v16 offset:4096
    s_add_u32 s83, s83, s79
    s_add_u32 s80, s80, 1
    v_mfma_f32_16x16x32_bf16 v[180:183], v[100:103], v[124:127], v[180:183]
    buffer_load_dwordx4 v4, s[4:7], s81 offen offset:2048  lds
    v_mfma_f32_16x16x32_bf16 v[184:187], v[104:107], v[124:127], v[184:187]
    ds_read_b128 v[68:71], v16 offset:6144
    v_mfma_f32_16x16x32_bf16 v[188:191], v[108:111], v[124:127], v[188:191]
    ds_read_b64_tr_b16 v[80:81], v14 offset:16384
    v_mfma_f32_16x16x32_bf16 v[192:195], v[112:115], v[124:127], v[192:195]
    ds_read_b64_tr_b16 v[82:83], v14 offset:16896
    s_cmp_eq_u32 s80, 10
    s_cselect_b32 s80, 0, s80
    v_mfma_f32_16x16x32_bf16 v[196:199], v[116:119], v[124:127], v[196:199]
    buffer_load_dwordx4 v5, s[4:7], s81 offen offset:3072  lds
    v_mfma_f32_16x16x32_bf16 v[200:203], v[128:131], v[88:91], v[200:203]
    ds_read_b64_tr_b16 v[84:85], v15 offset:16384
    v_mfma_f32_16x16x32_bf16 v[204:207], v[128:131], v[92:95], v[204:207]
    ds_read_b64_tr_b16 v[86:87], v15 offset:16896
    v_mfma_f32_16x16x32_bf16 v[208:211], v[128:131], v[96:99], v[208:211]
    s_add_u32 m0, s59, 81920
    v_mfma_f32_16x16x32_bf16 v[212:215], v[128:131], v[100:103], v[212:215]
    buffer_load_dwordx4 v6, s[8:11], s82 offen offset:0  lds
    v_mfma_f32_16x16x32_bf16 v[216:219], v[132:135], v[88:91], v[216:219]
    v_mfma_f32_16x16x32_bf16 v[220:223], v[132:135], v[92:95], v[220:223]
    v_mfma_f32_16x16x32_bf16 v[224:227], v[132:135], v[96:99], v[224:227]
    v_mfma_f32_16x16x32_bf16 v[228:231], v[132:135], v[100:103], v[228:231]
    s_waitcnt lgkmcnt(0)
    v_mfma_f32_16x16x32_bf16 v[136:139], v[40:43], v[72:75], v[136:139]
    ds_read_b128 v[120:123], v13 offset:0
    v_mfma_f32_16x16x32_bf16 v[140:143], v[44:47], v[72:75], v[140:143]
    ds_read_b128 v[88:91], v11 offset:0
    v_mfma_f32_16x16x32_bf16 v[144:147], v[48:51], v[72:75], v[144:147]
    ds_read_b128 v[124:127], v13 offset:8192
    v_mfma_f32_16x16x32_bf16 v[148:151], v[52:55], v[72:75], v[148:151]
    buffer_load_dwordx4 v7, s[8:11], s82 offen offset:1024  lds
    v_mfma_f32_16x16x32_bf16 v[152:155], v[56:59], v[72:75], v[152:155]
    ds_read_b128 v[92:95], v11 offset:2048
    v_mfma_f32_16x16x32_bf16 v[156:159], v[60:63], v[72:75], v[156:159]
    ds_read_b128 v[96:99], v11 offset:4096
    v_mfma_f32_16x16x32_bf16 v[160:163], v[64:67], v[72:75], v[160:163]
    ds_read_b128 v[100:103], v11 offset:6144
    s_add_u32 m0, s59, 90112
    v_mfma_f32_16x16x32_bf16 v[164:167], v[68:71], v[72:75], v[164:167]
    buffer_load_dwordx4 v6, s[12:15], s82 offen offset:0  lds
    v_mfma_f32_16x16x32_bf16 v[168:171], v[40:43], v[76:79], v[168:171]
    ds_read_b128 v[104:107], v17 offset:0
    v_mfma_f32_16x16x32_bf16 v[172:175], v[44:47], v[76:79], v[172:175]
    ds_read_b128 v[108:111], v17 offset:2048
    v_mfma_f32_16x16x32_bf16 v[176:179], v[48:51], v[76:79], v[176:179]
    ds_read_b128 v[112:115], v17 offset:4096
    v_mfma_f32_16x16x32_bf16 v[180:183], v[52:55], v[76:79], v[180:183]
    buffer_load_dwordx4 v7, s[12:15], s82 offen offset:1024  lds
    v_mfma_f32_16x16x32_bf16 v[184:187], v[56:59], v[76:79], v[184:187]
    ds_read_b128 v[116:119], v17 offset:6144
    v_mfma_f32_16x16x32_bf16 v[188:191], v[60:63], v[76:79], v[188:191]
    ds_read_b64_tr_b16 v[128:129], v14 offset:20480
    v_mfma_f32_16x16x32_bf16 v[192:195], v[64:67], v[76:79], v[192:195]
    ds_read_b64_tr_b16 v[130:131], v14 offset:20992
    s_add_u32 m0, s59, 98304
    v_mfma_f32_16x16x32_bf16 v[196:199], v[68:71], v[76:79], v[196:199]
    buffer_load_dwordx4 v8, s[16:19], s83 offen offset:0  lds
    v_mfma_f32_16x16x32_bf16 v[200:203], v[80:83], v[40:43], v[200:203]
    ds_read_b64_tr_b16 v[132:133], v15 offset:20480
    v_mfma_f32_16x16x32_bf16 v[204:207], v[80:83], v[44:47], v[204:207]
    ds_read_b64_tr_b16 v[134:135], v15 offset:20992
    v_mfma_f32_16x16x32_bf16 v[208:211], v[80:83], v[48:51], v[208:211]
    v_mfma_f32_16x16x32_bf16 v[212:215], v[80:83], v[52:55], v[212:215]
    buffer_load_dwordx4 v9, s[16:19], s83 offen offset:1024  lds
    v_mfma_f32_16x16x32_bf16 v[216:219], v[84:87], v[40:43], v[216:219]
    v_mfma_f32_16x16x32_bf16 v[220:223], v[84:87], v[44:47], v[220:223]
    v_mfma_f32_16x16x32_bf16 v[224:227], v[84:87], v[48:51], v[224:227]
    v_accvgpr_read_b32 v254, a242
    v_accvgpr_read_b32 v255, a243
    v_mfma_f32_16x16x32_bf16 v[228:231], v[84:87], v[52:55], v[228:231]
    global_load_dwordx2 a[250:251], v254, s[56:57]
    s_waitcnt lgkmcnt(0)
    s_waitcnt vmcnt(11)
    s_barrier
    v_mfma_f32_16x16x32_bf16 v[136:139], v[88:91], v[120:123], v[136:139]
    ds_read_b128 v[72:75], v20 offset:0
    v_mfma_f32_16x16x32_bf16 v[140:143], v[92:95], v[120:123], v[140:143]
    ds_read_b128 v[40:43], v18 offset:0
    v_mfma_f32_16x16x32_bf16 v[144:147], v[96:99], v[120:123], v[144:147]
    ds_read_b128 v[76:79], v20 offset:8192
    v_mfma_f32_16x16x32_bf16 v[148:151], v[100:103], v[120:123], v[148:151]
    global_load_dwordx2 a[252:253], v255, s[56:57]
    v_mfma_f32_16x16x32_bf16 v[152:155], v[104:107], v[120:123], v[152:155]
    ds_read_b128 v[44:47], v18 offset:2048
    v_mfma_f32_16x16x32_bf16 v[156:159], v[108:111], v[120:123], v[156:159]
    ds_read_b128 v[48:51], v18 offset:4096
    v_mfma_f32_16x16x32_bf16 v[160:163], v[112:115], v[120:123], v[160:163]
    ds_read_b128 v[52:55], v18 offset:6144
    v_accvgpr_read_b32 v254, a240
    v_accvgpr_read_b32 v255, a241
    v_mfma_f32_16x16x32_bf16 v[164:167], v[116:119], v[120:123], v[164:167]
    buffer_load_dwordx2 a[248:249], v255, s[4:7], s94 offen
    v_mfma_f32_16x16x32_bf16 v[168:171], v[88:91], v[124:127], v[168:171]
    ds_read_b128 v[56:59], v24 offset:0
    v_mfma_f32_16x16x32_bf16 v[172:175], v[92:95], v[124:127], v[172:175]
    ds_read_b128 v[60:63], v24 offset:2048
    v_mfma_f32_16x16x32_bf16 v[176:179], v[96:99], v[124:127], v[176:179]
    ds_read_b128 v[64:67], v24 offset:4096
    s_add_u32 s85, s94, 0
    v_mfma_f32_16x16x32_bf16 v[180:183], v[100:103], v[124:127], v[180:183]
    buffer_load_dwordx2 a[240:241], v254, s[4:7], s85 offen
    v_mfma_f32_16x16x32_bf16 v[184:187], v[104:107], v[124:127], v[184:187]
    ds_read_b128 v[68:71], v24 offset:6144
    v_mfma_f32_16x16x32_bf16 v[188:191], v[108:111], v[124:127], v[188:191]
    ds_read_b64_tr_b16 v[80:81], v22 offset:16384
    v_mfma_f32_16x16x32_bf16 v[192:195], v[112:115], v[124:127], v[192:195]
    ds_read_b64_tr_b16 v[82:83], v22 offset:16896
    s_add_u32 s85, s94, 5120
    v_mfma_f32_16x16x32_bf16 v[196:199], v[116:119], v[124:127], v[196:199]
    buffer_load_dwordx2 a[242:243], v254, s[4:7], s85 offen
    v_mfma_f32_16x16x32_bf16 v[200:203], v[128:131], v[88:91], v[200:203]
    ds_read_b64_tr_b16 v[84:85], v23 offset:16384
    v_mfma_f32_16x16x32_bf16 v[204:207], v[128:131], v[92:95], v[204:207]
    ds_read_b64_tr_b16 v[86:87], v23 offset:16896
    v_mfma_f32_16x16x32_bf16 v[208:211], v[128:131], v[96:99], v[208:211]
    s_add_u32 s85, s94, 10240
    v_mfma_f32_16x16x32_bf16 v[212:215], v[128:131], v[100:103], v[212:215]
    buffer_load_dwordx2 a[244:245], v254, s[4:7], s85 offen
    v_mfma_f32_16x16x32_bf16 v[216:219], v[132:135], v[88:91], v[216:219]
    v_mfma_f32_16x16x32_bf16 v[220:223], v[132:135], v[92:95], v[220:223]
    v_mfma_f32_16x16x32_bf16 v[224:227], v[132:135], v[96:99], v[224:227]
    s_add_u32 s85, s94, 15360
    s_lshl_b32 s94, s94, 1
    v_mfma_f32_16x16x32_bf16 v[228:231], v[132:135], v[100:103], v[228:231]
    buffer_load_dwordx2 a[246:247], v254, s[4:7], s85 offen
    s_waitcnt lgkmcnt(0)
    v_mfma_f32_16x16x32_bf16 v[136:139], v[40:43], v[72:75], v[136:139]
    ds_read_b128 v[120:123], v21 offset:0
    v_mfma_f32_16x16x32_bf16 v[140:143], v[44:47], v[72:75], v[140:143]
    ds_read_b128 v[88:91], v19 offset:0
    v_mfma_f32_16x16x32_bf16 v[144:147], v[48:51], v[72:75], v[144:147]
    ds_read_b128 v[124:127], v21 offset:8192
    s_lshl_b32 s84, s80, 7
    s_add_u32 s81, s61, s84
    s_add_u32 m0, s58, 0
    v_mfma_f32_16x16x32_bf16 v[148:151], v[52:55], v[72:75], v[148:151]
    buffer_load_dwordx4 v2, s[4:7], s81 offen offset:0  lds
    v_mfma_f32_16x16x32_bf16 v[152:155], v[56:59], v[72:75], v[152:155]
    ds_read_b128 v[92:95], v19 offset:2048
    v_mfma_f32_16x16x32_bf16 v[156:159], v[60:63], v[72:75], v[156:159]
    ds_read_b128 v[96:99], v19 offset:4096
    v_mfma_f32_16x16x32_bf16 v[160:163], v[64:67], v[72:75], v[160:163]
    ds_read_b128 v[100:103], v19 offset:6144
    s_add_u32 s82, s66, s84
    s_mul_i32 s83, s80, 196608
    v_mfma_f32_16x16x32_bf16 v[164:167], v[68:71], v[72:75], v[164:167]
    buffer_load_dwordx4 v3, s[4:7], s81 offen offset:1024  lds
    v_mfma_f32_16x16x32_bf16 v[168:171], v[40:43], v[76:79], v[168:171]
    ds_read_b128 v[104:107], v25 offset:0
    v_mfma_f32_16x16x32_bf16 v[172:175], v[44:47], v[76:79], v[172:175]
    ds_read_b128 v[108:111], v25 offset:2048
    v_mfma_f32_16x16x32_bf16 v[176:179], v[48:51], v[76:79], v[176:179]
    ds_read_b128 v[112:115], v25 offset:4096
    s_add_u32 s83, s83, s79
    s_add_u32 s80, s80, 1
    v_mfma_f32_16x16x32_bf16 v[180:183], v[52:55], v[76:79], v[180:183]
    buffer_load_dwordx4 v4, s[4:7], s81 offen offset:2048  lds
    v_mfma_f32_16x16x32_bf16 v[184:187], v[56:59], v[76:79], v[184:187]
    ds_read_b128 v[116:119], v25 offset:6144
    v_mfma_f32_16x16x32_bf16 v[188:191], v[60:63], v[76:79], v[188:191]
    ds_read_b64_tr_b16 v[128:129], v22 offset:20480
    v_mfma_f32_16x16x32_bf16 v[192:195], v[64:67], v[76:79], v[192:195]
    ds_read_b64_tr_b16 v[130:131], v22 offset:20992
    s_cmp_eq_u32 s80, 10
    s_cselect_b32 s80, 0, s80
    v_mfma_f32_16x16x32_bf16 v[196:199], v[68:71], v[76:79], v[196:199]
    buffer_load_dwordx4 v5, s[4:7], s81 offen offset:3072  lds
    v_mfma_f32_16x16x32_bf16 v[200:203], v[80:83], v[40:43], v[200:203]
    ds_read_b64_tr_b16 v[132:133], v23 offset:20480
    v_mfma_f32_16x16x32_bf16 v[204:207], v[80:83], v[44:47], v[204:207]
    ds_read_b64_tr_b16 v[134:135], v23 offset:20992
    v_mfma_f32_16x16x32_bf16 v[208:211], v[80:83], v[48:51], v[208:211]
    s_add_u32 m0, s59, 0
    v_mfma_f32_16x16x32_bf16 v[212:215], v[80:83], v[52:55], v[212:215]
    buffer_load_dwordx4 v6, s[8:11], s82 offen offset:0  lds
    v_mfma_f32_16x16x32_bf16 v[216:219], v[84:87], v[40:43], v[216:219]
    v_mfma_f32_16x16x32_bf16 v[220:223], v[84:87], v[44:47], v[220:223]
    v_mfma_f32_16x16x32_bf16 v[224:227], v[84:87], v[48:51], v[224:227]
    v_mfma_f32_16x16x32_bf16 v[228:231], v[84:87], v[52:55], v[228:231]
    buffer_load_dwordx4 v7, s[8:11], s82 offen offset:1024  lds
    s_waitcnt lgkmcnt(0)
    s_waitcnt vmcnt(13)
    s_barrier
    v_mfma_f32_16x16x32_bf16 v[136:139], v[88:91], v[120:123], v[136:139]
    ds_read_b128 v[72:75], v28 offset:0
    v_mfma_f32_16x16x32_bf16 v[140:143], v[92:95], v[120:123], v[140:143]
    ds_read_b128 v[40:43], v26 offset:0
    v_mfma_f32_16x16x32_bf16 v[144:147], v[96:99], v[120:123], v[144:147]
    ds_read_b128 v[76:79], v28 offset:8192
    s_add_u32 m0, s59, 8192
    v_mfma_f32_16x16x32_bf16 v[148:151], v[100:103], v[120:123], v[148:151]
    buffer_load_dwordx4 v6, s[12:15], s82 offen offset:0  lds
    v_mfma_f32_16x16x32_bf16 v[152:155], v[104:107], v[120:123], v[152:155]
    ds_read_b128 v[44:47], v26 offset:2048
    v_mfma_f32_16x16x32_bf16 v[156:159], v[108:111], v[120:123], v[156:159]
    ds_read_b128 v[48:51], v26 offset:4096
    v_mfma_f32_16x16x32_bf16 v[160:163], v[112:115], v[120:123], v[160:163]
    ds_read_b128 v[52:55], v26 offset:6144
    v_mfma_f32_16x16x32_bf16 v[164:167], v[116:119], v[120:123], v[164:167]
    buffer_load_dwordx4 v7, s[12:15], s82 offen offset:1024  lds
    v_mfma_f32_16x16x32_bf16 v[168:171], v[88:91], v[124:127], v[168:171]
    ds_read_b128 v[56:59], v32 offset:0
    v_mfma_f32_16x16x32_bf16 v[172:175], v[92:95], v[124:127], v[172:175]
    ds_read_b128 v[60:63], v32 offset:2048
    v_mfma_f32_16x16x32_bf16 v[176:179], v[96:99], v[124:127], v[176:179]
    ds_read_b128 v[64:67], v32 offset:4096
    s_add_u32 m0, s59, 16384
    v_mfma_f32_16x16x32_bf16 v[180:183], v[100:103], v[124:127], v[180:183]
    buffer_load_dwordx4 v8, s[16:19], s83 offen offset:0  lds
    v_mfma_f32_16x16x32_bf16 v[184:187], v[104:107], v[124:127], v[184:187]
    ds_read_b128 v[68:71], v32 offset:6144
    v_mfma_f32_16x16x32_bf16 v[188:191], v[108:111], v[124:127], v[188:191]
    ds_read_b64_tr_b16 v[80:81], v30 offset:16384
    v_mfma_f32_16x16x32_bf16 v[192:195], v[112:115], v[124:127], v[192:195]
    ds_read_b64_tr_b16 v[82:83], v30 offset:16896
    v_mfma_f32_16x16x32_bf16 v[196:199], v[116:119], v[124:127], v[196:199]
    buffer_load_dwordx4 v9, s[16:19], s83 offen offset:1024  lds
    v_mfma_f32_16x16x32_bf16 v[200:203], v[128:131], v[88:91], v[200:203]
    ds_read_b64_tr_b16 v[84:85], v31 offset:16384
    v_mfma_f32_16x16x32_bf16 v[204:207], v[128:131], v[92:95], v[204:207]
    ds_read_b64_tr_b16 v[86:87], v31 offset:16896
    v_mfma_f32_16x16x32_bf16 v[208:211], v[128:131], v[96:99], v[208:211]
    v_mfma_f32_16x16x32_bf16 v[212:215], v[128:131], v[100:103], v[212:215]
    v_mfma_f32_16x16x32_bf16 v[216:219], v[132:135], v[88:91], v[216:219]
    v_mfma_f32_16x16x32_bf16 v[220:223], v[132:135], v[92:95], v[220:223]
    v_mfma_f32_16x16x32_bf16 v[224:227], v[132:135], v[96:99], v[224:227]
    v_mfma_f32_16x16x32_bf16 v[228:231], v[132:135], v[100:103], v[228:231]
    s_waitcnt lgkmcnt(0)
    v_mfma_f32_16x16x32_bf16 v[136:139], v[40:43], v[72:75], v[136:139]
    ds_read_b128 v[120:123], v29 offset:0
    v_mfma_f32_16x16x32_bf16 v[140:143], v[44:47], v[72:75], v[140:143]
    ds_read_b128 v[88:91], v27 offset:0
    v_mfma_f32_16x16x32_bf16 v[144:147], v[48:51], v[72:75], v[144:147]
    ds_read_b128 v[124:127], v29 offset:8192
    s_mov_b32 s62, s91
    s_add_u32 m0, s63, 122880
    v_mfma_f32_16x16x32_bf16 v[148:151], v[52:55], v[72:75], v[148:151]
    buffer_load_dwordx4 v248, s[28:31], s62 offen offset:0  lds
    v_mfma_f32_16x16x32_bf16 v[152:155], v[56:59], v[72:75], v[152:155]
    ds_read_b128 v[92:95], v27 offset:2048
    v_mfma_f32_16x16x32_bf16 v[156:159], v[60:63], v[72:75], v[156:159]
    ds_read_b128 v[96:99], v27 offset:4096
    v_mfma_f32_16x16x32_bf16 v[160:163], v[64:67], v[72:75], v[160:163]
    ds_read_b128 v[100:103], v27 offset:6144
    v_mfma_f32_16x16x32_bf16 v[164:167], v[68:71], v[72:75], v[164:167]
    buffer_load_dwordx4 v249, s[28:31], s62 offen offset:1024  lds
    v_mfma_f32_16x16x32_bf16 v[168:171], v[40:43], v[76:79], v[168:171]
    ds_read_b128 v[104:107], v33 offset:0
    v_mfma_f32_16x16x32_bf16 v[172:175], v[44:47], v[76:79], v[172:175]
    ds_read_b128 v[108:111], v33 offset:2048
    v_mfma_f32_16x16x32_bf16 v[176:179], v[48:51], v[76:79], v[176:179]
    ds_read_b128 v[112:115], v33 offset:4096
    v_mfma_f32_16x16x32_bf16 v[180:183], v[52:55], v[76:79], v[180:183]
    buffer_load_dwordx4 v250, s[28:31], s62 offen offset:2048  lds
    v_mfma_f32_16x16x32_bf16 v[184:187], v[56:59], v[76:79], v[184:187]
    ds_read_b128 v[116:119], v33 offset:6144
    v_mfma_f32_16x16x32_bf16 v[188:191], v[60:63], v[76:79], v[188:191]
    ds_read_b64_tr_b16 v[128:129], v30 offset:20480
    v_mfma_f32_16x16x32_bf16 v[192:195], v[64:67], v[76:79], v[192:195]
    ds_read_b64_tr_b16 v[130:131], v30 offset:20992
    v_mfma_f32_16x16x32_bf16 v[196:199], v[68:71], v[76:79], v[196:199]
    buffer_load_dwordx4 v251, s[28:31], s62 offen offset:3072  lds
    v_mfma_f32_16x16x32_bf16 v[200:203], v[80:83], v[40:43], v[200:203]
    ds_read_b64_tr_b16 v[132:133], v31 offset:20480
    v_mfma_f32_16x16x32_bf16 v[204:207], v[80:83], v[44:47], v[204:207]
    ds_read_b64_tr_b16 v[134:135], v31 offset:20992
    v_mfma_f32_16x16x32_bf16 v[208:211], v[80:83], v[48:51], v[208:211]
    v_mfma_f32_16x16x32_bf16 v[212:215], v[80:83], v[52:55], v[212:215]
    v_mfma_f32_16x16x32_bf16 v[216:219], v[84:87], v[40:43], v[216:219]
    v_mfma_f32_16x16x32_bf16 v[220:223], v[84:87], v[44:47], v[220:223]
    v_mfma_f32_16x16x32_bf16 v[224:227], v[84:87], v[48:51], v[224:227]
    v_mfma_f32_16x16x32_bf16 v[228:231], v[84:87], v[52:55], v[228:231]
    s_waitcnt lgkmcnt(0)
    s_waitcnt vmcnt(4)
    s_barrier
    v_mfma_f32_16x16x32_bf16 v[136:139], v[88:91], v[120:123], v[136:139]
    ds_read_b128 v[72:75], v12 offset:0
    v_mfma_f32_16x16x32_bf16 v[140:143], v[92:95], v[120:123], v[140:143]
    ds_read_b128 v[40:43], v10 offset:0
    v_mfma_f32_16x16x32_bf16 v[144:147], v[96:99], v[120:123], v[144:147]
    ds_read_b128 v[76:79], v12 offset:8192
    s_add_u32 m0, s63, 126976
    v_mfma_f32_16x16x32_bf16 v[148:151], v[100:103], v[120:123], v[148:151]
    s_cmp_eq_u32 s92, 1
    s_cbranch_scc1 L_s54
    buffer_load_dwordx4 v253, s[28:31], s62 offen offset:0  lds
L_s54:
    v_mfma_f32_16x16x32_bf16 v[152:155], v[104:107], v[120:123], v[152:155]
    ds_read_b128 v[44:47], v10 offset:2048
    v_mfma_f32_16x16x32_bf16 v[156:159], v[108:111], v[120:123], v[156:159]
    ds_read_b128 v[48:51], v10 offset:4096
    v_mfma_f32_16x16x32_bf16 v[160:163], v[112:115], v[120:123], v[160:163]
    ds_read_b128 v[52:55], v10 offset:6144
    s_add_u32 s62, s62, s64
    s_add_u32 m0, s63, 128000
    v_mfma_f32_16x16x32_bf16 v[164:167], v[116:119], v[120:123], v[164:167]
    buffer_load_dwordx4 v248, s[28:31], s62 offen offset:0  lds
    v_mfma_f32_16x16x32_bf16 v[168:171], v[88:91], v[124:127], v[168:171]
    ds_read_b128 v[56:59], v16 offset:0
    v_mfma_f32_16x16x32_bf16 v[172:175], v[92:95], v[124:127], v[172:175]
    ds_read_b128 v[60:63], v16 offset:2048
    v_mfma_f32_16x16x32_bf16 v[176:179], v[96:99], v[124:127], v[176:179]
    ds_read_b128 v[64:67], v16 offset:4096
    v_mfma_f32_16x16x32_bf16 v[180:183], v[100:103], v[124:127], v[180:183]
    buffer_load_dwordx4 v249, s[28:31], s62 offen offset:1024  lds
    v_mfma_f32_16x16x32_bf16 v[184:187], v[104:107], v[124:127], v[184:187]
    ds_read_b128 v[68:71], v16 offset:6144
    v_mfma_f32_16x16x32_bf16 v[188:191], v[108:111], v[124:127], v[188:191]
    ds_read_b64_tr_b16 v[80:81], v14 offset:16384
    v_mfma_f32_16x16x32_bf16 v[192:195], v[112:115], v[124:127], v[192:195]
    ds_read_b64_tr_b16 v[82:83], v14 offset:16896
    v_mfma_f32_16x16x32_bf16 v[196:199], v[116:119], v[124:127], v[196:199]
    buffer_load_dwordx4 v250, s[28:31], s62 offen offset:2048  lds
    v_mfma_f32_16x16x32_bf16 v[200:203], v[128:131], v[88:91], v[200:203]
    ds_read_b64_tr_b16 v[84:85], v15 offset:16384
    v_mfma_f32_16x16x32_bf16 v[204:207], v[128:131], v[92:95], v[204:207]
    ds_read_b64_tr_b16 v[86:87], v15 offset:16896
    v_mfma_f32_16x16x32_bf16 v[208:211], v[128:131], v[96:99], v[208:211]
    v_mfma_f32_16x16x32_bf16 v[212:215], v[128:131], v[100:103], v[212:215]
    v_mfma_f32_16x16x32_bf16 v[216:219], v[132:135], v[88:91], v[216:219]
    v_mfma_f32_16x16x32_bf16 v[220:223], v[132:135], v[92:95], v[220:223]
    v_mfma_f32_16x16x32_bf16 v[224:227], v[132:135], v[96:99], v[224:227]
    v_mfma_f32_16x16x32_bf16 v[228:231], v[132:135], v[100:103], v[228:231]
    s_waitcnt lgkmcnt(0)
    v_mfma_f32_16x16x32_bf16 v[136:139], v[40:43], v[72:75], v[136:139]
    ds_read_b128 v[120:123], v13 offset:0
    v_mfma_f32_16x16x32_bf16 v[140:143], v[44:47], v[72:75], v[140:143]
    ds_read_b128 v[88:91], v11 offset:0
    v_mfma_f32_16x16x32_bf16 v[144:147], v[48:51], v[72:75], v[144:147]
    ds_read_b128 v[124:127], v13 offset:8192
    s_add_u32 s62, s62, s53
    v_mfma_f32_16x16x32_bf16 v[148:151], v[52:55], v[72:75], v[148:151]
    buffer_load_dwordx4 v251, s[28:31], s62 offen offset:3072  lds
    v_mfma_f32_16x16x32_bf16 v[152:155], v[56:59], v[72:75], v[152:155]
    ds_read_b128 v[92:95], v11 offset:2048
    v_mfma_f32_16x16x32_bf16 v[156:159], v[60:63], v[72:75], v[156:159]
    ds_read_b128 v[96:99], v11 offset:4096
    v_mfma_f32_16x16x32_bf16 v[160:163], v[64:67], v[72:75], v[160:163]
    ds_read_b128 v[100:103], v11 offset:6144
    s_add_u32 m0, s63, 132096
    v_mfma_f32_16x16x32_bf16 v[164:167], v[68:71], v[72:75], v[164:167]
    s_cmp_eq_u32 s92, 1
    s_cbranch_scc1 L_s55
    buffer_load_dwordx4 v253, s[28:31], s62 offen offset:0  lds
L_s55:
    v_mfma_f32_16x16x32_bf16 v[168:171], v[40:43], v[76:79], v[168:171]
    ds_read_b128 v[104:107], v17 offset:0
    v_mfma_f32_16x16x32_bf16 v[172:175], v[44:47], v[76:79], v[172:175]
    ds_read_b128 v[108:111], v17 offset:2048
    v_mfma_f32_16x16x32_bf16 v[176:179], v[48:51], v[76:79], v[176:179]
    ds_read_b128 v[112:115], v17 offset:4096
    s_mul_i32 s96, s92, 81920
    s_add_u32 s91, s91, s96
    s_cmp_ge_u32 s91, s55
    s_cselect_b32 s96, 491520, 0
    s_sub_u32 s91, s91, s96
    s_mov_b32 s62, s91
    s_add_u32 m0, s63, 40960
    v_mfma_f32_16x16x32_bf16 v[180:183], v[52:55], v[76:79], v[180:183]
    buffer_load_dwordx4 v248, s[36:39], s62 offen offset:0  lds
    v_mfma_f32_16x16x32_bf16 v[184:187], v[56:59], v[76:79], v[184:187]
    ds_read_b128 v[116:119], v17 offset:6144
    v_mfma_f32_16x16x32_bf16 v[188:191], v[60:63], v[76:79], v[188:191]
    ds_read_b64_tr_b16 v[128:129], v14 offset:20480
    v_mfma_f32_16x16x32_bf16 v[192:195], v[64:67], v[76:79], v[192:195]
    ds_read_b64_tr_b16 v[130:131], v14 offset:20992
    v_mfma_f32_16x16x32_bf16 v[196:199], v[68:71], v[76:79], v[196:199]
    buffer_load_dwordx4 v249, s[36:39], s62 offen offset:1024  lds
    v_mfma_f32_16x16x32_bf16 v[200:203], v[80:83], v[40:43], v[200:203]
    ds_read_b64_tr_b16 v[132:133], v15 offset:20480
    v_mfma_f32_16x16x32_bf16 v[204:207], v[80:83], v[44:47], v[204:207]
    ds_read_b64_tr_b16 v[134:135], v15 offset:20992
    v_mfma_f32_16x16x32_bf16 v[208:211], v[80:83], v[48:51], v[208:211]
    v_mfma_f32_16x16x32_bf16 v[212:215], v[80:83], v[52:55], v[212:215]
    v_mfma_f32_16x16x32_bf16 v[216:219], v[84:87], v[40:43], v[216:219]
    v_mfma_f32_16x16x32_bf16 v[220:223], v[84:87], v[44:47], v[220:223]
    v_mfma_f32_16x16x32_bf16 v[224:227], v[84:87], v[48:51], v[224:227]
    v_mfma_f32_16x16x32_bf16 v[228:231], v[84:87], v[52:55], v[228:231]
    s_waitcnt lgkmcnt(0)
    s_barrier
    v_mfma_f32_16x16x32_bf16 v[136:139], v[88:91], v[120:123], v[136:139]
    v_and_b32 v254, 15, v0
    v_mfma_f32_16x16x32_bf16 v[140:143], v[92:95], v[120:123], v[140:143]
    v_lshrrev_b32 v255, 4, v0
    v_mfma_f32_16x16x32_bf16 v[144:147], v[96:99], v[120:123], v[144:147]
    s_mul_i32 s85, s3, 5376
    v_mfma_f32_16x16x32_bf16 v[148:151], v[100:103], v[120:123], v[148:151]
    buffer_load_dwordx4 v250, s[36:39], s62 offen offset:2048  lds
    s_add_u32 s85, s85, 33792
    v_mfma_f32_16x16x32_bf16 v[152:155], v[104:107], v[120:123], v[152:155]
    v_mul_u32_u24 v2, 336, v254
    v_mfma_f32_16x16x32_bf16 v[156:159], v[108:111], v[120:123], v[156:159]
    v_lshl_add_u32 v2, v255, 4, v2
    v_mfma_f32_16x16x32_bf16 v[160:163], v[112:115], v[120:123], v[160:163]
    v_add_u32 v2, s85, v2
    v_mfma_f32_16x16x32_bf16 v[164:167], v[116:119], v[120:123], v[164:167]
    buffer_load_dwordx4 v251, s[36:39], s62 offen offset:3072  lds
    v_mul_u32_u24 v8, 205, v0
    v_mfma_f32_16x16x32_bf16 v[168:171], v[88:91], v[124:127], v[168:171]
    v_lshrrev_b32 v8, 12, v8
    v_mfma_f32_16x16x32_bf16 v[172:175], v[92:95], v[124:127], v[172:175]
    v_mul_u32_u24 v9, 20, v8
    v_mfma_f32_16x16x32_bf16 v[176:179], v[96:99], v[124:127], v[176:179]
    s_add_u32 m0, s63, 45056
    v_sub_u32 v9, v0, v9
    v_mfma_f32_16x16x32_bf16 v[180:183], v[100:103], v[124:127], v[180:183]
    s_cmp_eq_u32 s92, 1
    s_cbranch_scc1 L_s56
    buffer_load_dwordx4 v253, s[36:39], s62 offen offset:0  lds
L_s56:
    s_mul_i32 s85, s3, 1344
    v_mfma_f32_16x16x32_bf16 v[184:187], v[104:107], v[124:127], v[184:187]
    s_add_u32 s85, s85, 33792
    v_mfma_f32_16x16x32_bf16 v[188:191], v[108:111], v[124:127], v[188:191]
    v_mul_u32_u24 v3, 336, v8
    v_mfma_f32_16x16x32_bf16 v[192:195], v[112:115], v[124:127], v[192:195]
    s_add_u32 s62, s62, s64
    s_add_u32 m0, s63, 46080
    v_lshl_add_u32 v3, v9, 4, v3
    v_mfma_f32_16x16x32_bf16 v[196:199], v[116:119], v[124:127], v[196:199]
    buffer_load_dwordx4 v248, s[36:39], s62 offen offset:0  lds
    v_add_u32 v3, s85, v3
    v_mfma_f32_16x16x32_bf16 v[200:203], v[128:131], v[88:91], v[200:203]
    s_add_u32 s85, s85, 1072
    v_mfma_f32_16x16x32_bf16 v[204:207], v[128:131], v[92:95], v[204:207]
    v_lshl_add_u32 v4, v254, 4, s85
    v_mfma_f32_16x16x32_bf16 v[208:211], v[128:131], v[96:99], v[208:211]
    v_xor_b32 v5, 2, v255
    v_mfma_f32_16x16x32_bf16 v[212:215], v[128:131], v[100:103], v[212:215]
    v_and_b32 v6, 2, v5
    v_mfma_f32_16x16x32_bf16 v[216:219], v[132:135], v[88:91], v[216:219]
    v_add_u32 v5, v5, v6
    v_mfma_f32_16x16x32_bf16 v[220:223], v[132:135], v[92:95], v[220:223]
    s_movk_i32 s85, 21504
    v_mfma_f32_16x16x32_bf16 v[224:227], v[132:135], v[96:99], v[224:227]
    v_mad_u32_u24 v5, v5, s85, v4
    v_mfma_f32_16x16x32_bf16 v[228:231], v[132:135], v[100:103], v[228:231]
    v_mad_u32_u24 v4, v255, s85, v4
    s_lshl_b32 s85, s51, 2
    v_lshrrev_b32 v6, 4, v9
    v_mul_u32_u24 v6, s85, v6
    v_lshl_add_u32 v6, v9, 4, v6
    s_movk_i32 s86, 2560
    v_mad_u32_u24 v6, v8, s86, v6
    v_add_u32 v7, 4, v254
    v_lshrrev_b32 v7, 4, v7
    v_mul_u32_u24 v7, s85, v7
    v_lshl_add_u32 v7, v254, 4, v7
    s_movk_i32 s86, 10240
    v_mad_u32_u24 v7, v255, s86, v7
    v_add_u32 v7, 7744, v7
    v_lshl_add_u32 v9, v8, 8, v9
    s_mul_i32 s86, s92, 14
    s_add_u32 s86, s86, 9
    v_min_u32 v8, s86, v0
    v_lshlrev_b32 v8, 7, v8
    s_lshl_b32 s86, s89, 1
    s_add_u32 s86, s86, s92
    s_lshl_b32 s86, s86, 7
    s_add_u32 s86, s86, 24510464
    s_sub_u32 s86, s86, s32
    v_writelane_b32 v8, s86, 63
    s_cmp_eq_u32 s92, 1
    s_cbranch_scc1 L_xq
    s_cmp_eq_u32 s77, 1
    s_cbranch_scc1 L_xep10
    v_and_b32 v50, 15, v0
    v_bfe_u32 v51, v0, 4, 1
    v_lshlrev_b32 v50, 4, v50
    v_lshl_add_u32 v50, v51, 3, v50
    s_lshl_b32 s70, s76, 8
    v_pk_fma_f32 v[44:45], v[136:137], v[232:233], v[138:139] op_sel:[0,1,0] op_sel_hi:[1,1,1]
    v_pk_fma_f32 v[46:47], v[168:169], v[232:233], v[170:171] op_sel:[0,1,0] op_sel_hi:[1,1,1]
    v_pk_fma_f32 v[44:45], v[168:169], v[234:235], v[44:45] op_sel:[0,1,0] op_sel_hi:[1,1,1] neg_lo:[0,1,0] neg_hi:[0,1,0]
    v_pk_fma_f32 v[46:47], v[136:137], v[234:235], v[46:47] op_sel:[0,1,0] op_sel_hi:[1,1,1]
    v_pk_fma_f32 v[40:41], v[44:45], v[232:233], v[140:141] op_sel:[0,1,0] op_sel_hi:[1,1,1]
    v_pk_fma_f32 v[42:43], v[46:47], v[232:233], v[172:173] op_sel:[0,1,0] op_sel_hi:[1,1,1]
    v_pk_fma_f32 v[40:41], v[46:47], v[234:235], v[40:41] op_sel:[0,1,0] op_sel_hi:[1,1,1] neg_lo:[0,1,0] neg_hi:[0,1,0]
    v_pk_fma_f32 v[42:43], v[44:45], v[234:235], v[42:43] op_sel:[0,1,0] op_sel_hi:[1,1,1]
    v_pk_fma_f32 v[44:45], v[40:41], v[232:233], v[142:143] op_sel:[0,1,0] op_sel_hi:[1,1,1]
    v_pk_fma_f32 v[46:47], v[42:43], v[232:233], v[174:175] op_sel:[0,1,0] op_sel_hi:[1,1,1]
    v_pk_fma_f32 v[44:45], v[42:43], v[234:235], v[44:45] op_sel:[0,1,0] op_sel_hi:[1,1,1] neg_lo:[0,1,0] neg_hi:[0,1,0]
    v_pk_fma_f32 v[46:47], v[40:41], v[234:235], v[46:47] op_sel:[0,1,0] op_sel_hi:[1,1,1]
    v_pk_fma_f32 v[40:41], v[44:45], v[232:233], v[144:145] op_sel:[0,1,0] op_sel_hi:[1,1,1]
    v_pk_fma_f32 v[42:43], v[46:47], v[232:233], v[176:177] op_sel:[0,1,0] op_sel_hi:[1,1,1]
    v_pk_fma_f32 v[40:41], v[46:47], v[234:235], v[40:41] op_sel:[0,1,0] op_sel_hi:[1,1,1] neg_lo:[0,1,0] neg_hi:[0,1,0]
    v_pk_fma_f32 v[42:43], v[44:45], v[234:235], v[42:43] op_sel:[0,1,0] op_sel_hi:[1,1,1]
    v_pk_fma_f32 v[44:45], v[40:41], v[232:233], v[146:147] op_sel:[0,1,0] op_sel_hi:[1,1,1]
    v_pk_fma_f32 v[46:47], v[42:43], v[232:233], v[178:179] op_sel:[0,1,0] op_sel_hi:[1,1,1]
    v_pk_fma_f32 v[44:45], v[42:43], v[234:235], v[44:45] op_sel:[0,1,0] op_sel_hi:[1,1,1] neg_lo:[0,1,0] neg_hi:[0,1,0]
    v_pk_fma_f32 v[46:47], v[40:41], v[234:235], v[46:47] op_sel:[0,1,0] op_sel_hi:[1,1,1]
    v_pk_fma_f32 v[40:41], v[44:45], v[232:233], v[148:149] op_sel:[0,1,0] op_sel_hi:[1,1,1]
    v_pk_fma_f32 v[42:43], v[46:47], v[232:233], v[180:181] op_sel:[0,1,0] op_sel_hi:[1,1,1]
    v_pk_fma_f32 v[40:41], v[46:47], v[234:235], v[40:41] op_sel:[0,1,0] op_sel_hi:[1,1,1] neg_lo:[0,1,0] neg_hi:[0,1,0]
    v_pk_fma_f32 v[42:43], v[44:45], v[234:235], v[42:43] op_sel:[0,1,0] op_sel_hi:[1,1,1]
    v_pk_fma_f32 v[44:45], v[40:41], v[232:233], v[150:151] op_sel:[0,1,0] op_sel_hi:[1,1,1]
    v_pk_fma_f32 v[46:47], v[42:43], v[232:233], v[182:183] op_sel:[0,1,0] op_sel_hi:[1,1,1]
    v_pk_fma_f32 v[44:45], v[42:43], v[234:235], v[44:45] op_sel:[0,1,0] op_sel_hi:[1,1,1] neg_lo:[0,1,0] neg_hi:[0,1,0]
    v_pk_fma_f32 v[46:47], v[40:41], v[234:235], v[46:47] op_sel:[0,1,0] op_sel_hi:[1,1,1]
    v_pk_fma_f32 v[40:41], v[44:45], v[232:233], v[152:153] op_sel:[0,1,0] op_sel_hi:[1,1,1]
    v_pk_fma_f32 v[42:43], v[46:47], v[232:233], v[184:185] op_sel:[0,1,0] op_sel_hi:[1,1,1]
    v_pk_fma_f32 v[40:41], v[46:47], v[234:235], v[40:41] op_sel:[0,1,0] op_sel_hi:[1,1,1] neg_lo:[0,1,0] neg_hi:[0,1,0]
    v_pk_fma_f32 v[42:43], v[44:45], v[234:235], v[42:43] op_sel:[0,1,0] op_sel_hi:[1,1,1]
    v_pk_fma_f32 v[44:45], v[40:41], v[232:233], v[154:155] op_sel:[0,1,0] op_sel_hi:[1,1,1]
    v_pk_fma_f32 v[46:47], v[42:43], v[232:233], v[186:187] op_sel:[0,1,0] op_sel_hi:[1,1,1]
    v_pk_fma_f32 v[44:45], v[42:43], v[234:235], v[44:45] op_sel:[0,1,0] op_sel_hi:[1,1,1] neg_lo:[0,1,0] neg_hi:[0,1,0]
    v_pk_fma_f32 v[46:47], v[40:41], v[234:235], v[46:47] op_sel:[0,1,0] op_sel_hi:[1,1,1]
    v_pk_fma_f32 v[40:41], v[44:45], v[232:233], v[156:157] op_sel:[0,1,0] op_sel_hi:[1,1,1]
    v_pk_fma_f32 v[42:43], v[46:47], v[232:233], v[188:189] op_sel:[0,1,0] op_sel_hi:[1,1,1]
    v_pk_fma_f32 v[40:41], v[46:47], v[234:235], v[40:41] op_sel:[0,1,0] op_sel_hi:[1,1,1] neg_lo:[0,1,0] neg_hi:[0,1,0]
    v_pk_fma_f32 v[42:43], v[44:45], v[234:235], v[42:43] op_sel:[0,1,0] op_sel_hi:[1,1,1]
    v_pk_fma_f32 v[44:45], v[40:41], v[232:233], v[158:159] op_sel:[0,1,0] op_sel_hi:[1,1,1]
    v_pk_fma_f32 v[46:47], v[42:43], v[232:233], v[190:191] op_sel:[0,1,0] op_sel_hi:[1,1,1]
    v_pk_fma_f32 v[44:45], v[42:43], v[234:235], v[44:45] op_sel:[0,1,0] op_sel_hi:[1,1,1] neg_lo:[0,1,0] neg_hi:[0,1,0]
    v_pk_fma_f32 v[46:47], v[40:41], v[234:235], v[46:47] op_sel:[0,1,0] op_sel_hi:[1,1,1]
    v_pk_fma_f32 v[40:41], v[44:45], v[232:233], v[160:161] op_sel:[0,1,0] op_sel_hi:[1,1,1]
    v_pk_fma_f32 v[42:43], v[46:47], v[232:233], v[192:193] op_sel:[0,1,0] op_sel_hi:[1,1,1]
    v_pk_fma_f32 v[40:41], v[46:47], v[234:235], v[40:41] op_sel:[0,1,0] op_sel_hi:[1,1,1] neg_lo:[0,1,0] neg_hi:[0,1,0]
    v_pk_fma_f32 v[42:43], v[44:45], v[234:235], v[42:43] op_sel:[0,1,0] op_sel_hi:[1,1,1]
    v_pk_fma_f32 v[44:45], v[40:41], v[232:233], v[162:163] op_sel:[0,1,0] op_sel_hi:[1,1,1]
    v_pk_fma_f32 v[46:47], v[42:43], v[232:233], v[194:195] op_sel:[0,1,0] op_sel_hi:[1,1,1]
    v_pk_fma_f32 v[44:45], v[42:43], v[234:235], v[44:45] op_sel:[0,1,0] op_sel_hi:[1,1,1] neg_lo:[0,1,0] neg_hi:[0,1,0]
    v_pk_fma_f32 v[46:47], v[40:41], v[234:235], v[46:47] op_sel:[0,1,0] op_sel_hi:[1,1,1]
    v_pk_fma_f32 v[40:41], v[44:45], v[232:233], v[164:165] op_sel:[0,1,0] op_sel_hi:[1,1,1]
    v_pk_fma_f32 v[42:43], v[46:47], v[232:233], v[196:197] op_sel:[0,1,0] op_sel_hi:[1,1,1]
    v_pk_fma_f32 v[40:41], v[46:47], v[234:235], v[40:41] op_sel:[0,1,0] op_sel_hi:[1,1,1] neg_lo:[0,1,0] neg_hi:[0,1,0]
    v_pk_fma_f32 v[42:43], v[44:45], v[234:235], v[42:43] op_sel:[0,1,0] op_sel_hi:[1,1,1]
    v_pk_fma_f32 v[44:45], v[40:41], v[232:233], v[166:167] op_sel:[0,1,0] op_sel_hi:[1,1,1]
    v_pk_fma_f32 v[46:47], v[42:43], v[232:233], v[198:199] op_sel:[0,1,0] op_sel_hi:[1,1,1]
    v_pk_fma_f32 v[44:45], v[42:43], v[234:235], v[44:45] op_sel:[0,1,0] op_sel_hi:[1,1,1] neg_lo:[0,1,0] neg_hi:[0,1,0]
    v_pk_fma_f32 v[46:47], v[40:41], v[234:235], v[46:47] op_sel:[0,1,0] op_sel_hi:[1,1,1]
    v_fma_f32 v45, v44, v232, v45
    v_fma_f32 v47, v44, v234, v47
    v_fma_f32 v45, -v46, v234, v45
    v_fmac_f32 v47, v46, v232
    v_mul_f32 v40, v45, v238
    v_mul_f32 v41, v45, v239
    v_fma_f32 v40, -v47, v239, v40
    v_fmac_f32 v41, v47, v238
    s_nop 1
    v_permlane16_swap_b32 v40, v41
    v_add_f32 v40, v40, v41
    v_mov_b32 v41, v40
    s_nop 1
    v_permlane32_swap_b32 v40, v41
    v_add_f32 v48, v40, v41
    v_mov_b32 v49, s88
    s_mov_b32 exec_hi, 0
    buffer_store_dwordx2 v[48:49], v50, s[72:75], s70 offen sc1
    s_mov_b32 exec_hi, -1
    s_mov_b32 s84, 0xbfb8aa3b
    s_mov_b32 s85, 0xbfb8aa3b
    v_pk_mul_f32 v[112:113], v[200:201], s[84:85]
    v_pk_mul_f32 v[114:115], v[202:203], s[84:85]
    buffer_load_dwordx4 v249, s[36:39], s62 offen offset:1024  lds
    s_add_u32 s71, s0, 0
    v_pk_mul_f32 v[116:117], v[216:217], s[84:85]
    v_pk_mul_f32 v[118:119], v[218:219], s[84:85]
    v_exp_f32 v112, v112
    buffer_load_dwordx4 v250, s[36:39], s62 offen offset:2048  lds
    v_exp_f32 v113, v113
    v_exp_f32 v114, v114
    v_exp_f32 v115, v115
    v_exp_f32 v116, v116
    s_add_u32 s62, s62, s53
    buffer_load_dwordx4 v251, s[36:39], s62 offen offset:3072  lds
    v_exp_f32 v117, v117
    v_exp_f32 v118, v118
    v_exp_f32 v119, v119
    v_pk_add_f32 v[112:113], v[112:113], 1.0 op_sel_hi:[1,0]
    s_add_u32 m0, s63, 50176
    s_nop 0
    s_cmp_eq_u32 s92, 1
    s_cbranch_scc1 L_s57
    buffer_load_dwordx4 v253, s[36:39], s62 offen offset:0  lds
L_s57:
    v_pk_add_f32 v[114:115], v[114:115], 1.0 op_sel_hi:[1,0]
    v_pk_add_f32 v[116:117], v[116:117], 1.0 op_sel_hi:[1,0]
    v_pk_add_f32 v[118:119], v[118:119], 1.0 op_sel_hi:[1,0]
    v_rcp_f32 v112, v112
    v_rcp_f32 v113, v113
    v_rcp_f32 v114, v114
    v_rcp_f32 v115, v115
    v_rcp_f32 v116, v116
    v_rcp_f32 v117, v117
    v_rcp_f32 v118, v118
    v_rcp_f32 v119, v119
    v_pk_mul_f32 v[112:113], v[112:113], v[200:201]
    v_pk_mul_f32 v[114:115], v[114:115], v[202:203]
    v_pk_mul_f32 v[116:117], v[116:117], v[216:217]
    v_pk_mul_f32 v[118:119], v[118:119], v[218:219]
    v_cvt_pk_bf16_f32 v120, v112, v113
    v_cvt_pk_bf16_f32 v121, v114, v115
    v_cvt_pk_bf16_f32 v122, v116, v117
    v_cvt_pk_bf16_f32 v123, v118, v119
    buffer_store_dwordx4 v[120:123], v1, s[20:23], s71 offen sc1
    v_pk_mul_f32 v[124:125], v[204:205], s[84:85]
    v_pk_mul_f32 v[126:127], v[206:207], s[84:85]
    s_add_u32 s91, s91, s65
    s_cmp_ge_u32 s91, s55
    s_cselect_b32 s96, 491520, 0
    s_sub_u32 s91, s91, s96
    s_mov_b32 s62, s91
    s_add_u32 m0, s63, 81920
    s_nop 0
    buffer_load_dwordx4 v248, s[28:31], s62 offen offset:0  lds
    s_add_u32 s71, s0, 49152
    v_pk_mul_f32 v[128:129], v[220:221], s[84:85]
    v_pk_mul_f32 v[130:131], v[222:223], s[84:85]
    v_exp_f32 v124, v124
    buffer_load_dwordx4 v249, s[28:31], s62 offen offset:1024  lds
    v_exp_f32 v125, v125
    v_exp_f32 v126, v126
    v_exp_f32 v127, v127
    v_exp_f32 v128, v128
    buffer_load_dwordx4 v250, s[28:31], s62 offen offset:2048  lds
    v_exp_f32 v129, v129
    v_exp_f32 v130, v130
    v_exp_f32 v131, v131
    v_pk_add_f32 v[124:125], v[124:125], 1.0 op_sel_hi:[1,0]
    buffer_load_dwordx4 v251, s[28:31], s62 offen offset:3072  lds
    v_pk_add_f32 v[126:127], v[126:127], 1.0 op_sel_hi:[1,0]
    v_pk_add_f32 v[128:129], v[128:129], 1.0 op_sel_hi:[1,0]
    v_pk_add_f32 v[130:131], v[130:131], 1.0 op_sel_hi:[1,0]
    v_rcp_f32 v124, v124
    v_rcp_f32 v125, v125
    v_rcp_f32 v126, v126
    v_rcp_f32 v127, v127
    v_rcp_f32 v128, v128
    v_rcp_f32 v129, v129
    v_rcp_f32 v130, v130
    v_rcp_f32 v131, v131
    v_pk_mul_f32 v[124:125], v[124:125], v[204:205]
    v_pk_mul_f32 v[126:127], v[126:127], v[206:207]
    v_pk_mul_f32 v[128:129], v[128:129], v[220:221]
    v_pk_mul_f32 v[130:131], v[130:131], v[222:223]
    v_cvt_pk_bf16_f32 v132, v124, v125
    v_cvt_pk_bf16_f32 v133, v126, v127
    v_cvt_pk_bf16_f32 v134, v128, v129
    v_cvt_pk_bf16_f32 v135, v130, v131
    buffer_store_dwordx4 v[132:135], v1, s[20:23], s71 offen sc1
    v_pk_mul_f32 v[112:113], v[208:209], s[84:85]
    v_pk_mul_f32 v[114:115], v[210:211], s[84:85]
    s_add_u32 m0, s63, 86016
    s_nop 0
    buffer_load_dwordx4 v253, s[28:31], s62 offen offset:0  lds
    s_add_u32 s71, s0, 98304
    v_pk_mul_f32 v[116:117], v[224:225], s[84:85]
    v_pk_mul_f32 v[118:119], v[226:227], s[84:85]
    v_exp_f32 v112, v112
    s_add_u32 s62, s62, s64
    s_add_u32 m0, s63, 87040
    s_nop 0
    buffer_load_dwordx4 v248, s[28:31], s62 offen offset:0  lds
    v_exp_f32 v113, v113
    v_exp_f32 v114, v114
    v_exp_f32 v115, v115
    v_exp_f32 v116, v116
    buffer_load_dwordx4 v249, s[28:31], s62 offen offset:1024  lds
    v_exp_f32 v117, v117
    v_exp_f32 v118, v118
    v_exp_f32 v119, v119
    v_pk_add_f32 v[112:113], v[112:113], 1.0 op_sel_hi:[1,0]
    buffer_load_dwordx4 v250, s[28:31], s62 offen offset:2048  lds
    v_pk_add_f32 v[114:115], v[114:115], 1.0 op_sel_hi:[1,0]
    v_pk_add_f32 v[116:117], v[116:117], 1.0 op_sel_hi:[1,0]
    v_pk_add_f32 v[118:119], v[118:119], 1.0 op_sel_hi:[1,0]
    v_rcp_f32 v112, v112
    v_rcp_f32 v113, v113
    v_rcp_f32 v114, v114
    v_rcp_f32 v115, v115
    v_rcp_f32 v116, v116
    v_rcp_f32 v117, v117
    v_rcp_f32 v118, v118
    v_rcp_f32 v119, v119
    v_pk_mul_f32 v[112:113], v[112:113], v[208:209]
    v_pk_mul_f32 v[114:115], v[114:115], v[210:211]
    v_pk_mul_f32 v[116:117], v[116:117], v[224:225]
    v_pk_mul_f32 v[118:119], v[118:119], v[226:227]
    v_cvt_pk_bf16_f32 v120, v112, v113
    v_cvt_pk_bf16_f32 v121, v114, v115
    v_cvt_pk_bf16_f32 v122, v116, v117
    v_cvt_pk_bf16_f32 v123, v118, v119
    buffer_store_dwordx4 v[120:123], v1, s[20:23], s71 offen sc1
    v_pk_mul_f32 v[124:125], v[212:213], s[84:85]
    v_pk_mul_f32 v[126:127], v[214:215], s[84:85]
    s_add_u32 s62, s62, s53
    buffer_load_dwordx4 v251, s[28:31], s62 offen offset:3072  lds
    s_add_u32 s71, s0, 147456
    v_pk_mul_f32 v[128:129], v[228:229], s[84:85]
    v_pk_mul_f32 v[130:131], v[230:231], s[84:85]
    v_exp_f32 v124, v124
    s_add_u32 m0, s63, 91136
    s_nop 0
    buffer_load_dwordx4 v253, s[28:31], s62 offen offset:0  lds
    v_exp_f32 v125, v125
    v_exp_f32 v126, v126
    v_exp_f32 v127, v127
    v_exp_f32 v128, v128
    v_exp_f32 v129, v129
    v_exp_f32 v130, v130
    v_exp_f32 v131, v131
    v_pk_add_f32 v[124:125], v[124:125], 1.0 op_sel_hi:[1,0]
    v_pk_add_f32 v[126:127], v[126:127], 1.0 op_sel_hi:[1,0]
    v_pk_add_f32 v[128:129], v[128:129], 1.0 op_sel_hi:[1,0]
    v_pk_add_f32 v[130:131], v[130:131], 1.0 op_sel_hi:[1,0]
    v_rcp_f32 v124, v124
    v_rcp_f32 v125, v125
    v_rcp_f32 v126, v126
    v_rcp_f32 v127, v127
    v_rcp_f32 v128, v128
    v_rcp_f32 v129, v129
    v_rcp_f32 v130, v130
    v_rcp_f32 v131, v131
    v_pk_mul_f32 v[124:125], v[124:125], v[212:213]
    v_pk_mul_f32 v[126:127], v[126:127], v[214:215]
    v_pk_mul_f32 v[128:129], v[128:129], v[228:229]
    v_pk_mul_f32 v[130:131], v[130:131], v[230:231]
    v_cvt_pk_bf16_f32 v132, v124, v125
    v_cvt_pk_bf16_f32 v133, v126, v127
    v_cvt_pk_bf16_f32 v134, v128, v129
    v_cvt_pk_bf16_f32 v135, v130, v131
    buffer_store_dwordx4 v[132:135], v1, s[20:23], s71 offen sc1
    v_lshrrev_b32 v52, 4, v0
    v_and_b32 v53, 15, v0
    s_sub_u32 s96, s76, 1
    v_sub_u32 v52, s96, v52
    v_lshlrev_b32 v52, 8, v52
    v_lshl_add_u32 v88, v53, 4, v52
    v_add_u32 v89, -1024, v88
    v_add_u32 v90, -2048, v88
    v_add_u32 v91, -3072, v88
    s_movk_i32 s96, 0x1000
    v_cmp_gt_u32 vcc, s96, v88
    s_nop 1
    v_cndmask_b32 v92, 0, v36, vcc
    v_cmp_gt_u32 vcc, s96, v89
    s_nop 1
    v_cndmask_b32 v93, 0, v36, vcc
    v_cmp_gt_u32 vcc, s96, v90
    s_nop 1
    v_cndmask_b32 v94, 0, v36, vcc
    v_cmp_gt_u32 vcc, s96, v91
    s_nop 1
    v_cndmask_b32 v95, 0, v36, vcc
    v_mov_b32 v56, v45
    v_mov_b32 v57, v45
    v_mov_b32 v60, v47
    v_mov_b32 v61, v47
    v_permlane16_swap_b32 v56, v57
    s_nop 0
    v_permlane16_swap_b32 v60, v61
    v_mov_b32 v58, v56
    v_mov_b32 v62, v60
    s_nop 0
    v_permlane32_swap_b32 v56, v58
    v_permlane32_swap_b32 v60, v62
    v_mov_b32 v59, v57
    v_mov_b32 v63, v61
    s_nop 0
    v_permlane32_swap_b32 v57, v59
    v_permlane32_swap_b32 v61, v63
    v_fma_f32 v57, v56, v240, v57
    v_fma_f32 v61, v56, v241, v61
    v_fma_f32 v57, -v60, v241, v57
    v_fmac_f32 v61, v60, v240
    v_fma_f32 v58, v57, v240, v58
    v_fma_f32 v62, v57, v241, v62
    v_fma_f32 v58, -v61, v241, v58
    v_fmac_f32 v62, v61, v240
    s_mov_b32 vcc_lo, 0xffff0000
    s_mov_b32 vcc_hi, 0
    v_cndmask_b32 v64, 0, v56, vcc
    v_cndmask_b32 v65, 0, v60, vcc
    s_mov_b32 vcc_lo, 0
    s_mov_b32 vcc_hi, 0xffff
    v_cndmask_b32 v64, v64, v57, vcc
    v_cndmask_b32 v65, v65, v61, vcc
    s_mov_b32 vcc_lo, 0
    s_mov_b32 vcc_hi, 0xffff0000
    v_cndmask_b32 v64, v64, v58, vcc
    v_cndmask_b32 v65, v65, v62, vcc
    v_mul_f32 v106, v236, v64
    v_mul_f32 v107, v237, v64
    v_fma_f32 v106, -v237, v65, v106
    v_fma_f32 v107, -v236, v65, -v107
    v_pk_mul_f32 v[68:69], v[136:137], v[236:237] op_sel:[0,1] op_sel_hi:[1,1]
    buffer_load_dwordx4 v[84:87], v91, s[72:75], 0 offen sc1
    v_pk_mul_f32 v[136:137], v[136:137], v[236:237] op_sel_hi:[1,0]
    v_pk_fma_f32 v[136:137], v[168:169], v[236:237], v[136:137] op_sel:[0,1,0] op_sel_hi:[1,1,1] neg_lo:[0,1,0] neg_hi:[0,1,0]
    v_pk_fma_f32 v[168:169], v[168:169], v[236:237], v[68:69] op_sel_hi:[1,0,1] neg_lo:[0,1,1] neg_hi:[0,1,1]
    v_pk_mul_f32 v[68:69], v[138:139], v[236:237] op_sel:[0,1] op_sel_hi:[1,1]
    buffer_load_dwordx4 v[80:83], v90, s[72:75], 0 offen sc1
    v_pk_mul_f32 v[138:139], v[138:139], v[236:237] op_sel_hi:[1,0]
    v_pk_fma_f32 v[138:139], v[170:171], v[236:237], v[138:139] op_sel:[0,1,0] op_sel_hi:[1,1,1] neg_lo:[0,1,0] neg_hi:[0,1,0]
    v_pk_fma_f32 v[170:171], v[170:171], v[236:237], v[68:69] op_sel_hi:[1,0,1] neg_lo:[0,1,1] neg_hi:[0,1,1]
    v_pk_mul_f32 v[68:69], v[140:141], v[236:237] op_sel:[0,1] op_sel_hi:[1,1]
    buffer_load_dwordx4 v[76:79], v89, s[72:75], 0 offen sc1
    v_pk_mul_f32 v[140:141], v[140:141], v[236:237] op_sel_hi:[1,0]
    v_pk_fma_f32 v[140:141], v[172:173], v[236:237], v[140:141] op_sel:[0,1,0] op_sel_hi:[1,1,1] neg_lo:[0,1,0] neg_hi:[0,1,0]
    v_pk_fma_f32 v[172:173], v[172:173], v[236:237], v[68:69] op_sel_hi:[1,0,1] neg_lo:[0,1,1] neg_hi:[0,1,1]
    v_pk_mul_f32 v[68:69], v[142:143], v[236:237] op_sel:[0,1] op_sel_hi:[1,1]
    buffer_load_dwordx4 v[72:75], v88, s[72:75], 0 offen sc1
    v_pk_mul_f32 v[142:143], v[142:143], v[236:237] op_sel_hi:[1,0]
    v_pk_fma_f32 v[142:143], v[174:175], v[236:237], v[142:143] op_sel:[0,1,0] op_sel_hi:[1,1,1] neg_lo:[0,1,0] neg_hi:[0,1,0]
    v_pk_fma_f32 v[174:175], v[174:175], v[236:237], v[68:69] op_sel_hi:[1,0,1] neg_lo:[0,1,1] neg_hi:[0,1,1]
    v_pk_mul_f32 v[68:69], v[144:145], v[236:237] op_sel:[0,1] op_sel_hi:[1,1]
    s_waitcnt vmcnt(27)
    v_pk_mul_f32 v[144:145], v[144:145], v[236:237] op_sel_hi:[1,0]
    v_pk_fma_f32 v[144:145], v[176:177], v[236:237], v[144:145] op_sel:[0,1,0] op_sel_hi:[1,1,1] neg_lo:[0,1,0] neg_hi:[0,1,0]
    v_pk_fma_f32 v[176:177], v[176:177], v[236:237], v[68:69] op_sel_hi:[1,0,1] neg_lo:[0,1,1] neg_hi:[0,1,1]
    v_pk_mul_f32 v[68:69], v[146:147], v[236:237] op_sel:[0,1] op_sel_hi:[1,1]
    v_add_u32 v254, 122880, v38
    v_pk_mul_f32 v[146:147], v[146:147], v[236:237] op_sel_hi:[1,0]
    v_pk_fma_f32 v[146:147], v[178:179], v[236:237], v[146:147] op_sel:[0,1,0] op_sel_hi:[1,1,1] neg_lo:[0,1,0] neg_hi:[0,1,0]
    v_pk_fma_f32 v[178:179], v[178:179], v[236:237], v[68:69] op_sel_hi:[1,0,1] neg_lo:[0,1,1] neg_hi:[0,1,1]
    v_pk_mul_f32 v[68:69], v[148:149], v[236:237] op_sel:[0,1] op_sel_hi:[1,1]
    v_xor_b32 v255, 64, v254
    v_pk_mul_f32 v[148:149], v[148:149], v[236:237] op_sel_hi:[1,0]
    v_pk_fma_f32 v[148:149], v[180:181], v[236:237], v[148:149] op_sel:[0,1,0] op_sel_hi:[1,1,1] neg_lo:[0,1,0] neg_hi:[0,1,0]
    v_pk_fma_f32 v[180:181], v[180:181], v[236:237], v[68:69] op_sel_hi:[1,0,1] neg_lo:[0,1,1] neg_hi:[0,1,1]
    v_pk_mul_f32 v[68:69], v[150:151], v[236:237] op_sel:[0,1] op_sel_hi:[1,1]
    ds_read_b64 a[0:1], v254 offset:0
    v_pk_mul_f32 v[150:151], v[150:151], v[236:237] op_sel_hi:[1,0]
    v_pk_fma_f32 v[150:151], v[182:183], v[236:237], v[150:151] op_sel:[0,1,0] op_sel_hi:[1,1,1] neg_lo:[0,1,0] neg_hi:[0,1,0]
    v_pk_fma_f32 v[182:183], v[182:183], v[236:237], v[68:69] op_sel_hi:[1,0,1] neg_lo:[0,1,1] neg_hi:[0,1,1]
    v_pk_mul_f32 v[68:69], v[152:153], v[236:237] op_sel:[0,1] op_sel_hi:[1,1]
    ds_read_b64 a[4:5], v254 offset:2048
    v_pk_mul_f32 v[152:153], v[152:153], v[236:237] op_sel_hi:[1,0]
    v_pk_fma_f32 v[152:153], v[184:185], v[236:237], v[152:153] op_sel:[0,1,0] op_sel_hi:[1,1,1] neg_lo:[0,1,0] neg_hi:[0,1,0]
    v_pk_fma_f32 v[184:185], v[184:185], v[236:237], v[68:69] op_sel_hi:[1,0,1] neg_lo:[0,1,1] neg_hi:[0,1,1]
    v_pk_mul_f32 v[68:69], v[154:155], v[236:237] op_sel:[0,1] op_sel_hi:[1,1]
    ds_read_b64 a[52:53], v254 offset:6144
    v_pk_mul_f32 v[154:155], v[154:155], v[236:237] op_sel_hi:[1,0]
    v_pk_fma_f32 v[154:155], v[186:187], v[236:237], v[154:155] op_sel:[0,1,0] op_sel_hi:[1,1,1] neg_lo:[0,1,0] neg_hi:[0,1,0]
    v_pk_fma_f32 v[186:187], v[186:187], v[236:237], v[68:69] op_sel_hi:[1,0,1] neg_lo:[0,1,1] neg_hi:[0,1,1]
    v_pk_mul_f32 v[68:69], v[156:157], v[236:237] op_sel:[0,1] op_sel_hi:[1,1]
    ds_read_b64 a[56:57], v254 offset:8192
    v_pk_mul_f32 v[156:157], v[156:157], v[236:237] op_sel_hi:[1,0]
    v_pk_fma_f32 v[156:157], v[188:189], v[236:237], v[156:157] op_sel:[0,1,0] op_sel_hi:[1,1,1] neg_lo:[0,1,0] neg_hi:[0,1,0]
    v_pk_fma_f32 v[188:189], v[188:189], v[236:237], v[68:69] op_sel_hi:[1,0,1] neg_lo:[0,1,1] neg_hi:[0,1,1]
    v_pk_mul_f32 v[68:69], v[158:159], v[236:237] op_sel:[0,1] op_sel_hi:[1,1]
    ds_read_b64 a[40:41], v255 offset:0
    v_pk_mul_f32 v[158:159], v[158:159], v[236:237] op_sel_hi:[1,0]
    v_pk_fma_f32 v[158:159], v[190:191], v[236:237], v[158:159] op_sel:[0,1,0] op_sel_hi:[1,1,1] neg_lo:[0,1,0] neg_hi:[0,1,0]
    v_pk_fma_f32 v[190:191], v[190:191], v[236:237], v[68:69] op_sel_hi:[1,0,1] neg_lo:[0,1,1] neg_hi:[0,1,1]
    v_pk_mul_f32 v[68:69], v[160:161], v[236:237] op_sel:[0,1] op_sel_hi:[1,1]
    ds_read_b64 a[44:45], v255 offset:2048
    v_pk_mul_f32 v[160:161], v[160:161], v[236:237] op_sel_hi:[1,0]
    v_pk_fma_f32 v[160:161], v[192:193], v[236:237], v[160:161] op_sel:[0,1,0] op_sel_hi:[1,1,1] neg_lo:[0,1,0] neg_hi:[0,1,0]
    v_pk_fma_f32 v[192:193], v[192:193], v[236:237], v[68:69] op_sel_hi:[1,0,1] neg_lo:[0,1,1] neg_hi:[0,1,1]
    v_pk_mul_f32 v[68:69], v[162:163], v[236:237] op_sel:[0,1] op_sel_hi:[1,1]
    ds_read_b64 a[12:13], v255 offset:6144
    v_pk_mul_f32 v[162:163], v[162:163], v[236:237] op_sel_hi:[1,0]
    v_pk_fma_f32 v[162:163], v[194:195], v[236:237], v[162:163] op_sel:[0,1,0] op_sel_hi:[1,1,1] neg_lo:[0,1,0] neg_hi:[0,1,0]
    v_pk_fma_f32 v[194:195], v[194:195], v[236:237], v[68:69] op_sel_hi:[1,0,1] neg_lo:[0,1,1] neg_hi:[0,1,1]
    v_pk_mul_f32 v[68:69], v[164:165], v[236:237] op_sel:[0,1] op_sel_hi:[1,1]
    ds_read_b64 a[16:17], v255 offset:8192
    v_pk_mul_f32 v[164:165], v[164:165], v[236:237] op_sel_hi:[1,0]
    v_pk_fma_f32 v[164:165], v[196:197], v[236:237], v[164:165] op_sel:[0,1,0] op_sel_hi:[1,1,1] neg_lo:[0,1,0] neg_hi:[0,1,0]
    v_pk_fma_f32 v[196:197], v[196:197], v[236:237], v[68:69] op_sel_hi:[1,0,1] neg_lo:[0,1,1] neg_hi:[0,1,1]
    v_pk_mul_f32 v[68:69], v[166:167], v[236:237] op_sel:[0,1] op_sel_hi:[1,1]
    v_xor_b32 v254, 32, v254
    v_pk_mul_f32 v[166:167], v[166:167], v[236:237] op_sel_hi:[1,0]
    v_pk_fma_f32 v[166:167], v[198:199], v[236:237], v[166:167] op_sel:[0,1,0] op_sel_hi:[1,1,1] neg_lo:[0,1,0] neg_hi:[0,1,0]
    v_pk_fma_f32 v[198:199], v[198:199], v[236:237], v[68:69] op_sel_hi:[1,0,1] neg_lo:[0,1,1] neg_hi:[0,1,1]
    v_xor_b32 v255, 32, v255
    ds_read_b64 a[20:21], v254 offset:0
    ds_read_b64 a[24:25], v254 offset:2048
    ds_read_b64 a[72:73], v254 offset:6144
    ds_read_b64 a[76:77], v254 offset:8192
    ds_read_b64 a[60:61], v255 offset:0
    ds_read_b64 a[64:65], v255 offset:2048
    ds_read_b64 a[32:33], v255 offset:6144
    ds_read_b64 a[36:37], v255 offset:8192
    v_lshlrev_b32 v255, 3, v0
    v_and_b32 v255, 64, v255
    v_xor_b32 v254, v254, v255
    v_xor_b32 v255, 32, v254
    ds_read_b64 a[28:29], v254 offset:4096
    ds_read_b64 a[8:9], v255 offset:4096
    v_xor_b32 v254, 64, v254
    v_xor_b32 v255, 64, v255
    ds_read_b64 a[68:69], v254 offset:4096
    ds_read_b64 a[48:49], v255 offset:4096
    s_waitcnt lgkmcnt(0)
    s_mul_i32 s96, s92, 81920
    s_add_u32 s91, s91, s96
    s_cmp_ge_u32 s91, s55
    s_cselect_b32 s96, 491520, 0
    s_sub_u32 s91, s91, s96
    s_mov_b32 s62, s91
    s_add_u32 m0, s63, 122880
    s_nop 0
    buffer_load_dwordx4 v248, s[36:39], s62 offen offset:0  lds
    buffer_load_dwordx4 v249, s[36:39], s62 offen offset:1024  lds
    buffer_load_dwordx4 v250, s[36:39], s62 offen offset:2048  lds
    buffer_load_dwordx4 v251, s[36:39], s62 offen offset:3072  lds
    s_add_u32 m0, s63, 126976
    s_nop 0
    buffer_load_dwordx4 v253, s[36:39], s62 offen offset:0  lds
    s_add_u32 s62, s62, s64
    s_add_u32 m0, s63, 128000
    s_nop 0
    buffer_load_dwordx4 v248, s[36:39], s62 offen offset:0  lds
    buffer_load_dwordx4 v249, s[36:39], s62 offen offset:1024  lds
    buffer_load_dwordx4 v250, s[36:39], s62 offen offset:2048  lds
    s_add_u32 s62, s62, s53
    buffer_load_dwordx4 v251, s[36:39], s62 offen offset:3072  lds
    s_add_u32 m0, s63, 132096
    s_nop 0
    buffer_load_dwordx4 v253, s[36:39], s62 offen offset:0  lds
    s_mul_i32 s96, s3, 8448
    v_lshrrev_b32 v52, 4, v0
    v_mul_u32_u24 v104, 264, v53
    v_lshl_add_u32 v104, v52, 6, v104
    v_add_u32 v104, s96, v104
    v_lshrrev_b32 v105, 2, v0
    v_mul_u32_u24 v105, 264, v105
    v_and_b32 v52, 3, v0
    v_lshl_add_u32 v105, v52, 6, v105
    v_add_u32 v105, s96, v105
    v_sub_f32 v108, 0, v234
    s_waitcnt vmcnt(10)
L_lb00:
    v_xor_b32 v70, v73, v92
    v_bitop3_b32 v70, v70, v75, v92 bitop3:0xf6
    v_bitop3_b32 v70, v70, v77, v93 bitop3:0xf6
    v_bitop3_b32 v70, v70, v79, v93 bitop3:0xf6
    v_bitop3_b32 v70, v70, v81, v94 bitop3:0xf6
    v_bitop3_b32 v70, v70, v83, v94 bitop3:0xf6
    v_bitop3_b32 v70, v70, v85, v95 bitop3:0xf6
    v_bitop3_b32 v70, v70, v87, v95 bitop3:0xf6
    s_mov_b64 exec, 1
    buffer_store_dwordx2 v[36:37], v34, s[20:23], s1 offen offset:0 sc1
    s_mov_b64 exec, -1
    v_cmp_ne_u32 vcc, 0, v70
    s_nop 1
    s_cmp_lg_u64 vcc, 0
    s_cbranch_scc1 L_lbslow00
    v_fma_f32 v80, v84, v244, v80
    v_fma_f32 v82, v84, v245, v82
    v_fma_f32 v80, -v86, v245, v80
    v_fmac_f32 v82, v86, v244
    v_fma_f32 v76, v80, v244, v76
    v_fma_f32 v78, v80, v245, v78
    v_fma_f32 v76, -v82, v245, v76
    v_fmac_f32 v78, v82, v244
    v_fma_f32 v72, v76, v244, v72
    v_fma_f32 v74, v76, v245, v74
    v_fma_f32 v72, -v78, v245, v72
    v_fmac_f32 v74, v78, v244
    v_mul_f32 v70, v72, v246
    v_mul_f32 v71, v72, v247
    v_fma_f32 v70, -v74, v247, v70
    v_fmac_f32 v71, v74, v246
    s_nop 1
    v_permlane16_swap_b32 v70, v71
    v_add_f32 v70, v70, v71
    v_mov_b32 v71, v70
    s_nop 1
    v_permlane32_swap_b32 v70, v71
    v_add_f32 v70, v70, v71
    v_mov_b32 v71, v70
    s_nop 1
    v_permlane16_swap_b32 v70, v71
    v_fmac_f32 v106, v242, v70
    v_fma_f32 v107, -v242, v71, v107
    v_fma_f32 v106, -v243, v71, v106
    v_fma_f32 v107, -v243, v70, v107
    v_fmac_f32 v136, v232, v106
    v_fmac_f32 v168, v232, v107
    v_fmac_f32 v136, v234, v107
    v_fmac_f32 v168, v108, v106
    v_fmac_f32 v137, v232, v136
    v_fmac_f32 v169, v232, v168
    v_fmac_f32 v137, v234, v168
    v_fmac_f32 v169, v108, v136
    v_cvt_pk_bf16_f32 v40, v136, v137
    v_cvt_pk_bf16_f32 v56, v168, v169
    v_fmac_f32 v138, v232, v137
    v_fmac_f32 v170, v232, v169
    v_fmac_f32 v138, v234, v169
    v_fmac_f32 v170, v108, v137
    v_fmac_f32 v139, v232, v138
    v_fmac_f32 v171, v232, v170
    v_fmac_f32 v139, v234, v170
    v_fmac_f32 v171, v108, v138
    v_cvt_pk_bf16_f32 v41, v138, v139
    v_cvt_pk_bf16_f32 v57, v170, v171
    ds_write_b64 v104, v[40:41] offset:0
    ds_write_b64 v104, v[56:57] offset:4224
    v_fmac_f32 v140, v232, v139
    v_fmac_f32 v172, v232, v171
    v_fmac_f32 v140, v234, v171
    v_fmac_f32 v172, v108, v139
    v_fmac_f32 v141, v232, v140
    v_fmac_f32 v173, v232, v172
    v_fmac_f32 v141, v234, v172
    v_fmac_f32 v173, v108, v140
    v_cvt_pk_bf16_f32 v42, v140, v141
    v_cvt_pk_bf16_f32 v58, v172, v173
    v_fmac_f32 v142, v232, v141
    v_fmac_f32 v174, v232, v173
    v_fmac_f32 v142, v234, v173
    v_fmac_f32 v174, v108, v141
    v_fmac_f32 v143, v232, v142
    v_fmac_f32 v175, v232, v174
    v_fmac_f32 v143, v234, v174
    v_fmac_f32 v175, v108, v142
    v_cvt_pk_bf16_f32 v43, v142, v143
    v_cvt_pk_bf16_f32 v59, v174, v175
    ds_write_b64 v104, v[42:43] offset:8
    ds_write_b64 v104, v[58:59] offset:4232
    v_fmac_f32 v144, v232, v143
    v_fmac_f32 v176, v232, v175
    v_fmac_f32 v144, v234, v175
    v_fmac_f32 v176, v108, v143
    v_fmac_f32 v145, v232, v144
    v_fmac_f32 v177, v232, v176
    v_fmac_f32 v145, v234, v176
    v_fmac_f32 v177, v108, v144
    v_cvt_pk_bf16_f32 v44, v144, v145
    v_cvt_pk_bf16_f32 v60, v176, v177
    ds_read_b64_tr_b16 v[72:73], v105 offset:0
    ds_read_b64_tr_b16 v[74:75], v105 offset:4224
    v_fmac_f32 v146, v232, v145
    v_fmac_f32 v178, v232, v177
    v_fmac_f32 v146, v234, v177
    v_fmac_f32 v178, v108, v145
    v_fmac_f32 v147, v232, v146
    v_fmac_f32 v179, v232, v178
    v_fmac_f32 v147, v234, v178
    v_fmac_f32 v179, v108, v146
    v_cvt_pk_bf16_f32 v45, v146, v147
    v_cvt_pk_bf16_f32 v61, v178, v179
    ds_write_b64 v104, v[44:45] offset:16
    ds_write_b64 v104, v[60:61] offset:4240
    v_fmac_f32 v148, v232, v147
    v_fmac_f32 v180, v232, v179
    v_fmac_f32 v148, v234, v179
    v_fmac_f32 v180, v108, v147
    v_fmac_f32 v149, v232, v148
    v_fmac_f32 v181, v232, v180
    v_fmac_f32 v149, v234, v180
    v_fmac_f32 v181, v108, v148
    v_cvt_pk_bf16_f32 v46, v148, v149
    v_cvt_pk_bf16_f32 v62, v180, v181
    ds_read_b64_tr_b16 v[76:77], v105 offset:8
    ds_read_b64_tr_b16 v[78:79], v105 offset:4232
    v_fmac_f32 v150, v232, v149
    v_fmac_f32 v182, v232, v181
    v_fmac_f32 v150, v234, v181
    v_fmac_f32 v182, v108, v149
    s_add_u32 s71, s34, 0
    s_waitcnt lgkmcnt(4)
    buffer_store_dwordx4 v[72:75], v1, s[20:23], s71 offen sc1
    v_fmac_f32 v151, v232, v150
    v_fmac_f32 v183, v232, v182
    v_fmac_f32 v151, v234, v182
    v_fmac_f32 v183, v108, v150
    v_cvt_pk_bf16_f32 v47, v150, v151
    v_cvt_pk_bf16_f32 v63, v182, v183
    ds_write_b64 v104, v[46:47] offset:24
    ds_write_b64 v104, v[62:63] offset:4248
    v_fmac_f32 v152, v232, v151
    v_fmac_f32 v184, v232, v183
    v_fmac_f32 v152, v234, v183
    v_fmac_f32 v184, v108, v151
    v_fmac_f32 v153, v232, v152
    v_fmac_f32 v185, v232, v184
    v_fmac_f32 v153, v234, v184
    v_fmac_f32 v185, v108, v152
    v_cvt_pk_bf16_f32 v48, v152, v153
    v_cvt_pk_bf16_f32 v64, v184, v185
    ds_read_b64_tr_b16 v[80:81], v105 offset:16
    ds_read_b64_tr_b16 v[82:83], v105 offset:4240
    v_fmac_f32 v154, v232, v153
    v_fmac_f32 v186, v232, v185
    v_fmac_f32 v154, v234, v185
    v_fmac_f32 v186, v108, v153
    s_add_u32 s71, s34, 40960
    s_waitcnt lgkmcnt(4)
    buffer_store_dwordx4 v[76:79], v1, s[20:23], s71 offen sc1
    v_fmac_f32 v155, v232, v154
    v_fmac_f32 v187, v232, v186
    v_fmac_f32 v155, v234, v186
    v_fmac_f32 v187, v108, v154
    v_cvt_pk_bf16_f32 v49, v154, v155
    v_cvt_pk_bf16_f32 v65, v186, v187
    ds_write_b64 v104, v[48:49] offset:32
    ds_write_b64 v104, v[64:65] offset:4256
    v_fmac_f32 v156, v232, v155
    v_fmac_f32 v188, v232, v187
    v_fmac_f32 v156, v234, v187
    v_fmac_f32 v188, v108, v155
    v_fmac_f32 v157, v232, v156
    v_fmac_f32 v189, v232, v188
    v_fmac_f32 v157, v234, v188
    v_fmac_f32 v189, v108, v156
    v_cvt_pk_bf16_f32 v50, v156, v157
    v_cvt_pk_bf16_f32 v66, v188, v189
    ds_read_b64_tr_b16 v[84:85], v105 offset:24
    ds_read_b64_tr_b16 v[86:87], v105 offset:4248
    v_fmac_f32 v158, v232, v157
    v_fmac_f32 v190, v232, v189
    v_fmac_f32 v158, v234, v189
    v_fmac_f32 v190, v108, v157
    s_add_u32 s71, s34, 81920
    s_waitcnt lgkmcnt(4)
    buffer_store_dwordx4 v[80:83], v1, s[20:23], s71 offen sc1
    v_fmac_f32 v159, v232, v158
    v_fmac_f32 v191, v232, v190
    v_fmac_f32 v159, v234, v190
    v_fmac_f32 v191, v108, v158
    v_cvt_pk_bf16_f32 v51, v158, v159
    v_cvt_pk_bf16_f32 v67, v190, v191
    ds_write_b64 v104, v[50:51] offset:40
    ds_write_b64 v104, v[66:67] offset:4264
    v_fmac_f32 v160, v232, v159
    v_fmac_f32 v192, v232, v191
    v_fmac_f32 v160, v234, v191
    v_fmac_f32 v192, v108, v159
    v_fmac_f32 v161, v232, v160
    v_fmac_f32 v193, v232, v192
    v_fmac_f32 v161, v234, v192
    v_fmac_f32 v193, v108, v160
    v_cvt_pk_bf16_f32 v52, v160, v161
    v_cvt_pk_bf16_f32 v68, v192, v193
    ds_read_b64_tr_b16 v[88:89], v105 offset:32
    ds_read_b64_tr_b16 v[90:91], v105 offset:4256
    v_fmac_f32 v162, v232, v161
    v_fmac_f32 v194, v232, v193
    v_fmac_f32 v162, v234, v193
    v_fmac_f32 v194, v108, v161
    s_add_u32 s71, s34, 122880
    s_waitcnt lgkmcnt(4)
    buffer_store_dwordx4 v[84:87], v1, s[20:23], s71 offen sc1
    v_fmac_f32 v163, v232, v162
    v_fmac_f32 v195, v232, v194
    v_fmac_f32 v163, v234, v194
    v_fmac_f32 v195, v108, v162
    v_cvt_pk_bf16_f32 v53, v162, v163
    v_cvt_pk_bf16_f32 v69, v194, v195
    ds_write_b64 v104, v[52:53] offset:48
    ds_write_b64 v104, v[68:69] offset:4272
    v_fmac_f32 v164, v232, v163
    v_fmac_f32 v196, v232, v195
    v_fmac_f32 v164, v234, v195
    v_fmac_f32 v196, v108, v163
    v_fmac_f32 v165, v232, v164
    v_fmac_f32 v197, v232, v196
    v_fmac_f32 v165, v234, v196
    v_fmac_f32 v197, v108, v164
    v_cvt_pk_bf16_f32 v54, v164, v165
    v_cvt_pk_bf16_f32 v70, v196, v197
    ds_read_b64_tr_b16 v[92:93], v105 offset:40
    ds_read_b64_tr_b16 v[94:95], v105 offset:4264
    v_fmac_f32 v166, v232, v165
    v_fmac_f32 v198, v232, v197
    v_fmac_f32 v166, v234, v197
    v_fmac_f32 v198, v108, v165
    s_add_u32 s71, s34, 163840
    s_waitcnt lgkmcnt(4)
    buffer_store_dwordx4 v[88:91], v1, s[20:23], s71 offen sc1
    v_fmac_f32 v167, v232, v166
    v_fmac_f32 v199, v232, v198
    v_fmac_f32 v167, v234, v198
    v_fmac_f32 v199, v108, v166
    v_cvt_pk_bf16_f32 v55, v166, v167
    v_cvt_pk_bf16_f32 v71, v198, v199
    ds_write_b64 v104, v[54:55] offset:56
    ds_write_b64 v104, v[70:71] offset:4280
    ds_read_b64_tr_b16 v[96:97], v105 offset:48
    ds_read_b64_tr_b16 v[98:99], v105 offset:4272
    ds_read_b64_tr_b16 v[100:101], v105 offset:56
    ds_read_b64_tr_b16 v[102:103], v105 offset:4280
    s_add_u32 s71, s34, 204800
    s_waitcnt lgkmcnt(6)
    buffer_store_dwordx4 v[92:95], v1, s[20:23], s71 offen sc1
    s_add_u32 s71, s34, 245760
    s_waitcnt lgkmcnt(2)
    buffer_store_dwordx4 v[96:99], v1, s[20:23], s71 offen sc1
    s_add_u32 s71, s34, 286720
    s_waitcnt lgkmcnt(0)
    buffer_store_dwordx4 v[100:103], v1, s[20:23], s71 offen sc1
    s_branch L_xep20
L_xep10:
    v_and_b32 v50, 15, v0
    v_bfe_u32 v51, v0, 4, 1
    v_lshlrev_b32 v50, 4, v50
    v_lshl_add_u32 v50, v51, 3, v50
    s_lshl_b32 s70, s76, 8
    v_pk_fma_f32 v[44:45], v[152:153], v[232:233], v[154:155] op_sel:[0,1,0] op_sel_hi:[1,1,1]
    v_pk_fma_f32 v[46:47], v[184:185], v[232:233], v[186:187] op_sel:[0,1,0] op_sel_hi:[1,1,1]
    v_pk_fma_f32 v[44:45], v[184:185], v[234:235], v[44:45] op_sel:[0,1,0] op_sel_hi:[1,1,1] neg_lo:[0,1,0] neg_hi:[0,1,0]
    v_pk_fma_f32 v[46:47], v[152:153], v[234:235], v[46:47] op_sel:[0,1,0] op_sel_hi:[1,1,1]
    v_pk_fma_f32 v[40:41], v[44:45], v[232:233], v[156:157] op_sel:[0,1,0] op_sel_hi:[1,1,1]
    v_pk_fma_f32 v[42:43], v[46:47], v[232:233], v[188:189] op_sel:[0,1,0] op_sel_hi:[1,1,1]
    v_pk_fma_f32 v[40:41], v[46:47], v[234:235], v[40:41] op_sel:[0,1,0] op_sel_hi:[1,1,1] neg_lo:[0,1,0] neg_hi:[0,1,0]
    v_pk_fma_f32 v[42:43], v[44:45], v[234:235], v[42:43] op_sel:[0,1,0] op_sel_hi:[1,1,1]
    v_pk_fma_f32 v[44:45], v[40:41], v[232:233], v[158:159] op_sel:[0,1,0] op_sel_hi:[1,1,1]
    v_pk_fma_f32 v[46:47], v[42:43], v[232:233], v[190:191] op_sel:[0,1,0] op_sel_hi:[1,1,1]
    v_pk_fma_f32 v[44:45], v[42:43], v[234:235], v[44:45] op_sel:[0,1,0] op_sel_hi:[1,1,1] neg_lo:[0,1,0] neg_hi:[0,1,0]
    v_pk_fma_f32 v[46:47], v[40:41], v[234:235], v[46:47] op_sel:[0,1,0] op_sel_hi:[1,1,1]
    v_pk_fma_f32 v[40:41], v[44:45], v[232:233], v[160:161] op_sel:[0,1,0] op_sel_hi:[1,1,1]
    v_pk_fma_f32 v[42:43], v[46:47], v[232:233], v[192:193] op_sel:[0,1,0] op_sel_hi:[1,1,1]
    v_pk_fma_f32 v[40:41], v[46:47], v[234:235], v[40:41] op_sel:[0,1,0] op_sel_hi:[1,1,1] neg_lo:[0,1,0] neg_hi:[0,1,0]
    v_pk_fma_f32 v[42:43], v[44:45], v[234:235], v[42:43] op_sel:[0,1,0] op_sel_hi:[1,1,1]
    v_pk_fma_f32 v[44:45], v[40:41], v[232:233], v[162:163] op_sel:[0,1,0] op_sel_hi:[1,1,1]
    v_pk_fma_f32 v[46:47], v[42:43], v[232:233], v[194:195] op_sel:[0,1,0] op_sel_hi:[1,1,1]
    v_pk_fma_f32 v[44:45], v[42:43], v[234:235], v[44:45] op_sel:[0,1,0] op_sel_hi:[1,1,1] neg_lo:[0,1,0] neg_hi:[0,1,0]
    v_pk_fma_f32 v[46:47], v[40:41], v[234:235], v[46:47] op_sel:[0,1,0] op_sel_hi:[1,1,1]
    v_pk_fma_f32 v[40:41], v[44:45], v[232:233], v[164:165] op_sel:[0,1,0] op_sel_hi:[1,1,1]
    v_pk_fma_f32 v[42:43], v[46:47], v[232:233], v[196:197] op_sel:[0,1,0] op_sel_hi:[1,1,1]
    v_pk_fma_f32 v[40:41], v[46:47], v[234:235], v[40:41] op_sel:[0,1,0] op_sel_hi:[1,1,1] neg_lo:[0,1,0] neg_hi:[0,1,0]
    v_pk_fma_f32 v[42:43], v[44:45], v[234:235], v[42:43] op_sel:[0,1,0] op_sel_hi:[1,1,1]
    v_pk_fma_f32 v[44:45], v[40:41], v[232:233], v[166:167] op_sel:[0,1,0] op_sel_hi:[1,1,1]
    v_pk_fma_f32 v[46:47], v[42:43], v[232:233], v[198:199] op_sel:[0,1,0] op_sel_hi:[1,1,1]
    v_pk_fma_f32 v[44:45], v[42:43], v[234:235], v[44:45] op_sel:[0,1,0] op_sel_hi:[1,1,1] neg_lo:[0,1,0] neg_hi:[0,1,0]
    v_pk_fma_f32 v[46:47], v[40:41], v[234:235], v[46:47] op_sel:[0,1,0] op_sel_hi:[1,1,1]
    v_pk_fma_f32 v[40:41], v[44:45], v[232:233], v[136:137] op_sel:[0,1,0] op_sel_hi:[1,1,1]
    v_pk_fma_f32 v[42:43], v[46:47], v[232:233], v[168:169] op_sel:[0,1,0] op_sel_hi:[1,1,1]
    v_pk_fma_f32 v[40:41], v[46:47], v[234:235], v[40:41] op_sel:[0,1,0] op_sel_hi:[1,1,1] neg_lo:[0,1,0] neg_hi:[0,1,0]
    v_pk_fma_f32 v[42:43], v[44:45], v[234:235], v[42:43] op_sel:[0,1,0] op_sel_hi:[1,1,1]
    v_pk_fma_f32 v[44:45], v[40:41], v[232:233], v[138:139] op_sel:[0,1,0] op_sel_hi:[1,1,1]
    v_pk_fma_f32 v[46:47], v[42:43], v[232:233], v[170:171] op_sel:[0,1,0] op_sel_hi:[1,1,1]
    v_pk_fma_f32 v[44:45], v[42:43], v[234:235], v[44:45] op_sel:[0,1,0] op_sel_hi:[1,1,1] neg_lo:[0,1,0] neg_hi:[0,1,0]
    v_pk_fma_f32 v[46:47], v[40:41], v[234:235], v[46:47] op_sel:[0,1,0] op_sel_hi:[1,1,1]
    v_pk_fma_f32 v[40:41], v[44:45], v[232:233], v[140:141] op_sel:[0,1,0] op_sel_hi:[1,1,1]
    v_pk_fma_f32 v[42:43], v[46:47], v[232:233], v[172:173] op_sel:[0,1,0] op_sel_hi:[1,1,1]
    v_pk_fma_f32 v[40:41], v[46:47], v[234:235], v[40:41] op_sel:[0,1,0] op_sel_hi:[1,1,1] neg_lo:[0,1,0] neg_hi:[0,1,0]
    v_pk_fma_f32 v[42:43], v[44:45], v[234:235], v[42:43] op_sel:[0,1,0] op_sel_hi:[1,1,1]
    v_pk_fma_f32 v[44:45], v[40:41], v[232:233], v[142:143] op_sel:[0,1,0] op_sel_hi:[1,1,1]
    v_pk_fma_f32 v[46:47], v[42:43], v[232:233], v[174:175] op_sel:[0,1,0] op_sel_hi:[1,1,1]
    v_pk_fma_f32 v[44:45], v[42:43], v[234:235], v[44:45] op_sel:[0,1,0] op_sel_hi:[1,1,1] neg_lo:[0,1,0] neg_hi:[0,1,0]
    v_pk_fma_f32 v[46:47], v[40:41], v[234:235], v[46:47] op_sel:[0,1,0] op_sel_hi:[1,1,1]
    v_pk_fma_f32 v[40:41], v[44:45], v[232:233], v[144:145] op_sel:[0,1,0] op_sel_hi:[1,1,1]
    v_pk_fma_f32 v[42:43], v[46:47], v[232:233], v[176:177] op_sel:[0,1,0] op_sel_hi:[1,1,1]
    v_pk_fma_f32 v[40:41], v[46:47], v[234:235], v[40:41] op_sel:[0,1,0] op_sel_hi:[1,1,1] neg_lo:[0,1,0] neg_hi:[0,1,0]
    v_pk_fma_f32 v[42:43], v[44:45], v[234:235], v[42:43] op_sel:[0,1,0] op_sel_hi:[1,1,1]
    v_pk_fma_f32 v[44:45], v[40:41], v[232:233], v[146:147] op_sel:[0,1,0] op_sel_hi:[1,1,1]
    v_pk_fma_f32 v[46:47], v[42:43], v[232:233], v[178:179] op_sel:[0,1,0] op_sel_hi:[1,1,1]
    v_pk_fma_f32 v[44:45], v[42:43], v[234:235], v[44:45] op_sel:[0,1,0] op_sel_hi:[1,1,1] neg_lo:[0,1,0] neg_hi:[0,1,0]
    v_pk_fma_f32 v[46:47], v[40:41], v[234:235], v[46:47] op_sel:[0,1,0] op_sel_hi:[1,1,1]
    v_pk_fma_f32 v[40:41], v[44:45], v[232:233], v[148:149] op_sel:[0,1,0] op_sel_hi:[1,1,1]
    v_pk_fma_f32 v[42:43], v[46:47], v[232:233], v[180:181] op_sel:[0,1,0] op_sel_hi:[1,1,1]
    v_pk_fma_f32 v[40:41], v[46:47], v[234:235], v[40:41] op_sel:[0,1,0] op_sel_hi:[1,1,1] neg_lo:[0,1,0] neg_hi:[0,1,0]
    v_pk_fma_f32 v[42:43], v[44:45], v[234:235], v[42:43] op_sel:[0,1,0] op_sel_hi:[1,1,1]
    v_pk_fma_f32 v[44:45], v[40:41], v[232:233], v[150:151] op_sel:[0,1,0] op_sel_hi:[1,1,1]
    v_pk_fma_f32 v[46:47], v[42:43], v[232:233], v[182:183] op_sel:[0,1,0] op_sel_hi:[1,1,1]
    v_pk_fma_f32 v[44:45], v[42:43], v[234:235], v[44:45] op_sel:[0,1,0] op_sel_hi:[1,1,1] neg_lo:[0,1,0] neg_hi:[0,1,0]
    v_pk_fma_f32 v[46:47], v[40:41], v[234:235], v[46:47] op_sel:[0,1,0] op_sel_hi:[1,1,1]
    v_fma_f32 v45, v44, v232, v45
    v_fma_f32 v47, v44, v234, v47
    v_fma_f32 v45, -v46, v234, v45
    v_fmac_f32 v47, v46, v232
    v_mul_f32 v40, v45, v238
    v_mul_f32 v41, v45, v239
    v_fma_f32 v40, -v47, v239, v40
    v_fmac_f32 v41, v47, v238
    s_nop 1
    v_permlane16_swap_b32 v40, v41
    v_add_f32 v40, v40, v41
    v_mov_b32 v41, v40
    s_nop 1
    v_permlane32_swap_b32 v40, v41
    v_add_f32 v48, v40, v41
    v_mov_b32 v49, s88
    s_mov_b32 exec_hi, 0
    buffer_store_dwordx2 v[48:49], v50, s[72:75], s70 offen sc1
    s_mov_b32 exec_hi, -1
    s_mov_b32 s84, 0xbfb8aa3b
    s_mov_b32 s85, 0xbfb8aa3b
    v_pk_mul_f32 v[112:113], v[200:201], s[84:85]
    v_pk_mul_f32 v[114:115], v[202:203], s[84:85]
    buffer_load_dwordx4 v249, s[36:39], s62 offen offset:1024  lds
    s_add_u32 s71, s0, 0
    v_pk_mul_f32 v[116:117], v[216:217], s[84:85]
    v_pk_mul_f32 v[118:119], v[218:219], s[84:85]
    v_exp_f32 v112, v112
    buffer_load_dwordx4 v250, s[36:39], s62 offen offset:2048  lds
    v_exp_f32 v113, v113
    v_exp_f32 v114, v114
    v_exp_f32 v115, v115
    v_exp_f32 v116, v116
    s_add_u32 s62, s62, s53
    buffer_load_dwordx4 v251, s[36:39], s62 offen offset:3072  lds
    v_exp_f32 v117, v117
    v_exp_f32 v118, v118
    v_exp_f32 v119, v119
    v_pk_add_f32 v[112:113], v[112:113], 1.0 op_sel_hi:[1,0]
    s_add_u32 m0, s63, 50176
    s_nop 0
    s_cmp_eq_u32 s92, 1
    s_cbranch_scc1 L_s58
    buffer_load_dwordx4 v253, s[36:39], s62 offen offset:0  lds
L_s58:
    v_pk_add_f32 v[114:115], v[114:115], 1.0 op_sel_hi:[1,0]
    v_pk_add_f32 v[116:117], v[116:117], 1.0 op_sel_hi:[1,0]
    v_pk_add_f32 v[118:119], v[118:119], 1.0 op_sel_hi:[1,0]
    v_rcp_f32 v112, v112
    v_rcp_f32 v113, v113
    v_rcp_f32 v114, v114
    v_rcp_f32 v115, v115
    v_rcp_f32 v116, v116
    v_rcp_f32 v117, v117
    v_rcp_f32 v118, v118
    v_rcp_f32 v119, v119
    v_pk_mul_f32 v[112:113], v[112:113], v[200:201]
    v_pk_mul_f32 v[114:115], v[114:115], v[202:203]
    v_pk_mul_f32 v[116:117], v[116:117], v[216:217]
    v_pk_mul_f32 v[118:119], v[118:119], v[218:219]
    v_cvt_pk_bf16_f32 v120, v112, v113
    v_cvt_pk_bf16_f32 v121, v114, v115
    v_cvt_pk_bf16_f32 v122, v116, v117
    v_cvt_pk_bf16_f32 v123, v118, v119
    buffer_store_dwordx4 v[120:123], v1, s[20:23], s71 offen sc1
    v_pk_mul_f32 v[124:125], v[204:205], s[84:85]
    v_pk_mul_f32 v[126:127], v[206:207], s[84:85]
    s_add_u32 s91, s91, s65
    s_cmp_ge_u32 s91, s55
    s_cselect_b32 s96, 491520, 0
    s_sub_u32 s91, s91, s96
    s_mov_b32 s62, s91
    s_add_u32 m0, s63, 81920
    s_nop 0
    buffer_load_dwordx4 v248, s[28:31], s62 offen offset:0  lds
    s_add_u32 s71, s0, 49152
    v_pk_mul_f32 v[128:129], v[220:221], s[84:85]
    v_pk_mul_f32 v[130:131], v[222:223], s[84:85]
    v_exp_f32 v124, v124
    buffer_load_dwordx4 v249, s[28:31], s62 offen offset:1024  lds
    v_exp_f32 v125, v125
    v_exp_f32 v126, v126
    v_exp_f32 v127, v127
    v_exp_f32 v128, v128
    buffer_load_dwordx4 v250, s[28:31], s62 offen offset:2048  lds
    v_exp_f32 v129, v129
    v_exp_f32 v130, v130
    v_exp_f32 v131, v131
    v_pk_add_f32 v[124:125], v[124:125], 1.0 op_sel_hi:[1,0]
    buffer_load_dwordx4 v251, s[28:31], s62 offen offset:3072  lds
    v_pk_add_f32 v[126:127], v[126:127], 1.0 op_sel_hi:[1,0]
    v_pk_add_f32 v[128:129], v[128:129], 1.0 op_sel_hi:[1,0]
    v_pk_add_f32 v[130:131], v[130:131], 1.0 op_sel_hi:[1,0]
    v_rcp_f32 v124, v124
    v_rcp_f32 v125, v125
    v_rcp_f32 v126, v126
    v_rcp_f32 v127, v127
    v_rcp_f32 v128, v128
    v_rcp_f32 v129, v129
    v_rcp_f32 v130, v130
    v_rcp_f32 v131, v131
    v_pk_mul_f32 v[124:125], v[124:125], v[204:205]
    v_pk_mul_f32 v[126:127], v[126:127], v[206:207]
    v_pk_mul_f32 v[128:129], v[128:129], v[220:221]
    v_pk_mul_f32 v[130:131], v[130:131], v[222:223]
    v_cvt_pk_bf16_f32 v132, v124, v125
    v_cvt_pk_bf16_f32 v133, v126, v127
    v_cvt_pk_bf16_f32 v134, v128, v129
    v_cvt_pk_bf16_f32 v135, v130, v131
    buffer_store_dwordx4 v[132:135], v1, s[20:23], s71 offen sc1
    v_pk_mul_f32 v[112:113], v[208:209], s[84:85]
    v_pk_mul_f32 v[114:115], v[210:211], s[84:85]
    s_add_u32 m0, s63, 86016
    s_nop 0
    buffer_load_dwordx4 v253, s[28:31], s62 offen offset:0  lds
    s_add_u32 s71, s0, 98304
    v_pk_mul_f32 v[116:117], v[224:225], s[84:85]
    v_pk_mul_f32 v[118:119], v[226:227], s[84:85]
    v_exp_f32 v112, v112
    s_add_u32 s62, s62, s64
    s_add_u32 m0, s63, 87040
    s_nop 0
    buffer_load_dwordx4 v248, s[28:31], s62 offen offset:0  lds
    v_exp_f32 v113, v113
    v_exp_f32 v114, v114
    v_exp_f32 v115, v115
    v_exp_f32 v116, v116
    buffer_load_dwordx4 v249, s[28:31], s62 offen offset:1024  lds
    v_exp_f32 v117, v117
    v_exp_f32 v118, v118
    v_exp_f32 v119, v119
    v_pk_add_f32 v[112:113], v[112:113], 1.0 op_sel_hi:[1,0]
    buffer_load_dwordx4 v250, s[28:31], s62 offen offset:2048  lds
    v_pk_add_f32 v[114:115], v[114:115], 1.0 op_sel_hi:[1,0]
    v_pk_add_f32 v[116:117], v[116:117], 1.0 op_sel_hi:[1,0]
    v_pk_add_f32 v[118:119], v[118:119], 1.0 op_sel_hi:[1,0]
    v_rcp_f32 v112, v112
    v_rcp_f32 v113, v113
    v_rcp_f32 v114, v114
    v_rcp_f32 v115, v115
    v_rcp_f32 v116, v116
    v_rcp_f32 v117, v117
    v_rcp_f32 v118, v118
    v_rcp_f32 v119, v119
    v_pk_mul_f32 v[112:113], v[112:113], v[208:209]
    v_pk_mul_f32 v[114:115], v[114:115], v[210:211]
    v_pk_mul_f32 v[116:117], v[116:117], v[224:225]
    v_pk_mul_f32 v[118:119], v[118:119], v[226:227]
    v_cvt_pk_bf16_f32 v120, v112, v113
    v_cvt_pk_bf16_f32 v121, v114, v115
    v_cvt_pk_bf16_f32 v122, v116, v117
    v_cvt_pk_bf16_f32 v123, v118, v119
    buffer_store_dwordx4 v[120:123], v1, s[20:23], s71 offen sc1
    v_pk_mul_f32 v[124:125], v[212:213], s[84:85]
    v_pk_mul_f32 v[126:127], v[214:215], s[84:85]
    s_add_u32 s62, s62, s53
    buffer_load_dwordx4 v251, s[28:31], s62 offen offset:3072  lds
    s_add_u32 s71, s0, 147456
    v_pk_mul_f32 v[128:129], v[228:229], s[84:85]
    v_pk_mul_f32 v[130:131], v[230:231], s[84:85]
    v_exp_f32 v124, v124
    s_add_u32 m0, s63, 91136
    s_nop 0
    buffer_load_dwordx4 v253, s[28:31], s62 offen offset:0  lds
    v_exp_f32 v125, v125
    v_exp_f32 v126, v126
    v_exp_f32 v127, v127
    v_exp_f32 v128, v128
    v_exp_f32 v129, v129
    v_exp_f32 v130, v130
    v_exp_f32 v131, v131
    v_pk_add_f32 v[124:125], v[124:125], 1.0 op_sel_hi:[1,0]
    v_pk_add_f32 v[126:127], v[126:127], 1.0 op_sel_hi:[1,0]
    v_pk_add_f32 v[128:129], v[128:129], 1.0 op_sel_hi:[1,0]
    v_pk_add_f32 v[130:131], v[130:131], 1.0 op_sel_hi:[1,0]
    v_rcp_f32 v124, v124
    v_rcp_f32 v125, v125
    v_rcp_f32 v126, v126
    v_rcp_f32 v127, v127
    v_rcp_f32 v128, v128
    v_rcp_f32 v129, v129
    v_rcp_f32 v130, v130
    v_rcp_f32 v131, v131
    v_pk_mul_f32 v[124:125], v[124:125], v[212:213]
    v_pk_mul_f32 v[126:127], v[126:127], v[214:215]
    v_pk_mul_f32 v[128:129], v[128:129], v[228:229]
    v_pk_mul_f32 v[130:131], v[130:131], v[230:231]
    v_cvt_pk_bf16_f32 v132, v124, v125
    v_cvt_pk_bf16_f32 v133, v126, v127
    v_cvt_pk_bf16_f32 v134, v128, v129
    v_cvt_pk_bf16_f32 v135, v130, v131
    buffer_store_dwordx4 v[132:135], v1, s[20:23], s71 offen sc1
    v_lshrrev_b32 v52, 4, v0
    v_and_b32 v53, 15, v0
    s_sub_u32 s96, s76, 1
    v_sub_u32 v52, s96, v52
    v_lshlrev_b32 v52, 8, v52
    v_lshl_add_u32 v88, v53, 4, v52
    v_add_u32 v89, -1024, v88
    v_add_u32 v90, -2048, v88
    v_add_u32 v91, -3072, v88
    s_movk_i32 s96, 0x1000
    v_cmp_gt_u32 vcc, s96, v88
    s_nop 1
    v_cndmask_b32 v92, 0, v36, vcc
    v_cmp_gt_u32 vcc, s96, v89
    s_nop 1
    v_cndmask_b32 v93, 0, v36, vcc
    v_cmp_gt_u32 vcc, s96, v90
    s_nop 1
    v_cndmask_b32 v94, 0, v36, vcc
    v_cmp_gt_u32 vcc, s96, v91
    s_nop 1
    v_cndmask_b32 v95, 0, v36, vcc
    v_mov_b32 v56, v45
    v_mov_b32 v57, v45
    v_mov_b32 v60, v47
    v_mov_b32 v61, v47
    v_permlane16_swap_b32 v56, v57
    s_nop 0
    v_permlane16_swap_b32 v60, v61
    v_mov_b32 v58, v56
    v_mov_b32 v62, v60
    s_nop 0
    v_permlane32_swap_b32 v56, v58
    v_permlane32_swap_b32 v60, v62
    v_mov_b32 v59, v57
    v_mov_b32 v63, v61
    s_nop 0
    v_permlane32_swap_b32 v57, v59
    v_permlane32_swap_b32 v61, v63
    v_fma_f32 v57, v56, v240, v57
    v_fma_f32 v61, v56, v241, v61
    v_fma_f32 v57, -v60, v241, v57
    v_fmac_f32 v61, v60, v240
    v_fma_f32 v58, v57, v240, v58
    v_fma_f32 v62, v57, v241, v62
    v_fma_f32 v58, -v61, v241, v58
    v_fmac_f32 v62, v61, v240
    s_mov_b32 vcc_lo, 0xffff0000
    s_mov_b32 vcc_hi, 0
    v_cndmask_b32 v64, 0, v56, vcc
    v_cndmask_b32 v65, 0, v60, vcc
    s_mov_b32 vcc_lo, 0
    s_mov_b32 vcc_hi, 0xffff
    v_cndmask_b32 v64, v64, v57, vcc
    v_cndmask_b32 v65, v65, v61, vcc
    s_mov_b32 vcc_lo, 0
    s_mov_b32 vcc_hi, 0xffff0000
    v_cndmask_b32 v64, v64, v58, vcc
    v_cndmask_b32 v65, v65, v62, vcc
    v_mul_f32 v106, v236, v64
    v_mul_f32 v107, v237, v64
    v_fma_f32 v106, -v237, v65, v106
    v_fma_f32 v107, -v236, v65, -v107
    v_pk_mul_f32 v[68:69], v[152:153], v[236:237] op_sel:[0,1] op_sel_hi:[1,1]
    buffer_load_dwordx4 v[84:87], v91, s[72:75], 0 offen sc1
    v_pk_mul_f32 v[152:153], v[152:153], v[236:237] op_sel_hi:[1,0]
    v_pk_fma_f32 v[152:153], v[184:185], v[236:237], v[152:153] op_sel:[0,1,0] op_sel_hi:[1,1,1] neg_lo:[0,1,0] neg_hi:[0,1,0]
    v_pk_fma_f32 v[184:185], v[184:185], v[236:237], v[68:69] op_sel_hi:[1,0,1] neg_lo:[0,1,1] neg_hi:[0,1,1]
    v_pk_mul_f32 v[68:69], v[154:155], v[236:237] op_sel:[0,1] op_sel_hi:[1,1]
    buffer_load_dwordx4 v[80:83], v90, s[72:75], 0 offen sc1
    v_pk_mul_f32 v[154:155], v[154:155], v[236:237] op_sel_hi:[1,0]
    v_pk_fma_f32 v[154:155], v[186:187], v[236:237], v[154:155] op_sel:[0,1,0] op_sel_hi:[1,1,1] neg_lo:[0,1,0] neg_hi:[0,1,0]
    v_pk_fma_f32 v[186:187], v[186:187], v[236:237], v[68:69] op_sel_hi:[1,0,1] neg_lo:[0,1,1] neg_hi:[0,1,1]
    v_pk_mul_f32 v[68:69], v[156:157], v[236:237] op_sel:[0,1] op_sel_hi:[1,1]
    buffer_load_dwordx4 v[76:79], v89, s[72:75], 0 offen sc1
    v_pk_mul_f32 v[156:157], v[156:157], v[236:237] op_sel_hi:[1,0]
    v_pk_fma_f32 v[156:157], v[188:189], v[236:237], v[156:157] op_sel:[0,1,0] op_sel_hi:[1,1,1] neg_lo:[0,1,0] neg_hi:[0,1,0]
    v_pk_fma_f32 v[188:189], v[188:189], v[236:237], v[68:69] op_sel_hi:[1,0,1] neg_lo:[0,1,1] neg_hi:[0,1,1]
    v_pk_mul_f32 v[68:69], v[158:159], v[236:237] op_sel:[0,1] op_sel_hi:[1,1]
    buffer_load_dwordx4 v[72:75], v88, s[72:75], 0 offen sc1
    v_pk_mul_f32 v[158:159], v[158:159], v[236:237] op_sel_hi:[1,0]
    v_pk_fma_f32 v[158:159], v[190:191], v[236:237], v[158:159] op_sel:[0,1,0] op_sel_hi:[1,1,1] neg_lo:[0,1,0] neg_hi:[0,1,0]
    v_pk_fma_f32 v[190:191], v[190:191], v[236:237], v[68:69] op_sel_hi:[1,0,1] neg_lo:[0,1,1] neg_hi:[0,1,1]
    v_pk_mul_f32 v[68:69], v[160:161], v[236:237] op_sel:[0,1] op_sel_hi:[1,1]
    s_waitcnt vmcnt(27)
    v_pk_mul_f32 v[160:161], v[160:161], v[236:237] op_sel_hi:[1,0]
    v_pk_fma_f32 v[160:161], v[192:193], v[236:237], v[160:161] op_sel:[0,1,0] op_sel_hi:[1,1,1] neg_lo:[0,1,0] neg_hi:[0,1,0]
    v_pk_fma_f32 v[192:193], v[192:193], v[236:237], v[68:69] op_sel_hi:[1,0,1] neg_lo:[0,1,1] neg_hi:[0,1,1]
    v_pk_mul_f32 v[68:69], v[162:163], v[236:237] op_sel:[0,1] op_sel_hi:[1,1]
    v_add_u32 v254, 122880, v38
    v_pk_mul_f32 v[162:163], v[162:163], v[236:237] op_sel_hi:[1,0]
    v_pk_fma_f32 v[162:163], v[194:195], v[236:237], v[162:163] op_sel:[0,1,0] op_sel_hi:[1,1,1] neg_lo:[0,1,0] neg_hi:[0,1,0]
    v_pk_fma_f32 v[194:195], v[194:195], v[236:237], v[68:69] op_sel_hi:[1,0,1] neg_lo:[0,1,1] neg_hi:[0,1,1]
    v_pk_mul_f32 v[68:69], v[164:165], v[236:237] op_sel:[0,1] op_sel_hi:[1,1]
    v_xor_b32 v255, 64, v254
    v_pk_mul_f32 v[164:165], v[164:165], v[236:237] op_sel_hi:[1,0]
    v_pk_fma_f32 v[164:165], v[196:197], v[236:237], v[164:165] op_sel:[0,1,0] op_sel_hi:[1,1,1] neg_lo:[0,1,0] neg_hi:[0,1,0]
    v_pk_fma_f32 v[196:197], v[196:197], v[236:237], v[68:69] op_sel_hi:[1,0,1] neg_lo:[0,1,1] neg_hi:[0,1,1]
    v_pk_mul_f32 v[68:69], v[166:167], v[236:237] op_sel:[0,1] op_sel_hi:[1,1]
    ds_read_b64 a[0:1], v254 offset:0
    v_pk_mul_f32 v[166:167], v[166:167], v[236:237] op_sel_hi:[1,0]
    v_pk_fma_f32 v[166:167], v[198:199], v[236:237], v[166:167] op_sel:[0,1,0] op_sel_hi:[1,1,1] neg_lo:[0,1,0] neg_hi:[0,1,0]
    v_pk_fma_f32 v[198:199], v[198:199], v[236:237], v[68:69] op_sel_hi:[1,0,1] neg_lo:[0,1,1] neg_hi:[0,1,1]
    v_pk_mul_f32 v[68:69], v[136:137], v[236:237] op_sel:[0,1] op_sel_hi:[1,1]
    ds_read_b64 a[4:5], v254 offset:2048
    v_pk_mul_f32 v[136:137], v[136:137], v[236:237] op_sel_hi:[1,0]
    v_pk_fma_f32 v[136:137], v[168:169], v[236:237], v[136:137] op_sel:[0,1,0] op_sel_hi:[1,1,1] neg_lo:[0,1,0] neg_hi:[0,1,0]
    v_pk_fma_f32 v[168:169], v[168:169], v[236:237], v[68:69] op_sel_hi:[1,0,1] neg_lo:[0,1,1] neg_hi:[0,1,1]
    v_pk_mul_f32 v[68:69], v[138:139], v[236:237] op_sel:[0,1] op_sel_hi:[1,1]
    ds_read_b64 a[52:53], v254 offset:6144
    v_pk_mul_f32 v[138:139], v[138:139], v[236:237] op_sel_hi:[1,0]
    v_pk_fma_f32 v[138:139], v[170:171], v[236:237], v[138:139] op_sel:[0,1,0] op_sel_hi:[1,1,1] neg_lo:[0,1,0] neg_hi:[0,1,0]
    v_pk_fma_f32 v[170:171], v[170:171], v[236:237], v[68:69] op_sel_hi:[1,0,1] neg_lo:[0,1,1] neg_hi:[0,1,1]
    v_pk_mul_f32 v[68:69], v[140:141], v[236:237] op_sel:[0,1] op_sel_hi:[1,1]
    ds_read_b64 a[56:57], v254 offset:8192
    v_pk_mul_f32 v[140:141], v[140:141], v[236:237] op_sel_hi:[1,0]
    v_pk_fma_f32 v[140:141], v[172:173], v[236:237], v[140:141] op_sel:[0,1,0] op_sel_hi:[1,1,1] neg_lo:[0,1,0] neg_hi:[0,1,0]
    v_pk_fma_f32 v[172:173], v[172:173], v[236:237], v[68:69] op_sel_hi:[1,0,1] neg_lo:[0,1,1] neg_hi:[0,1,1]
    v_pk_mul_f32 v[68:69], v[142:143], v[236:237] op_sel:[0,1] op_sel_hi:[1,1]
    ds_read_b64 a[40:41], v255 offset:0
    v_pk_mul_f32 v[142:143], v[142:143], v[236:237] op_sel_hi:[1,0]
    v_pk_fma_f32 v[142:143], v[174:175], v[236:237], v[142:143] op_sel:[0,1,0] op_sel_hi:[1,1,1] neg_lo:[0,1,0] neg_hi:[0,1,0]
    v_pk_fma_f32 v[174:175], v[174:175], v[236:237], v[68:69] op_sel_hi:[1,0,1] neg_lo:[0,1,1] neg_hi:[0,1,1]
    v_pk_mul_f32 v[68:69], v[144:145], v[236:237] op_sel:[0,1] op_sel_hi:[1,1]
    ds_read_b64 a[44:45], v255 offset:2048
    v_pk_mul_f32 v[144:145], v[144:145], v[236:237] op_sel_hi:[1,0]
    v_pk_fma_f32 v[144:145], v[176:177], v[236:237], v[144:145] op_sel:[0,1,0] op_sel_hi:[1,1,1] neg_lo:[0,1,0] neg_hi:[0,1,0]
    v_pk_fma_f32 v[176:177], v[176:177], v[236:237], v[68:69] op_sel_hi:[1,0,1] neg_lo:[0,1,1] neg_hi:[0,1,1]
    v_pk_mul_f32 v[68:69], v[146:147], v[236:237] op_sel:[0,1] op_sel_hi:[1,1]
    ds_read_b64 a[12:13], v255 offset:6144
    v_pk_mul_f32 v[146:147], v[146:147], v[236:237] op_sel_hi:[1,0]
    v_pk_fma_f32 v[146:147], v[178:179], v[236:237], v[146:147] op_sel:[0,1,0] op_sel_hi:[1,1,1] neg_lo:[0,1,0] neg_hi:[0,1,0]
    v_pk_fma_f32 v[178:179], v[178:179], v[236:237], v[68:69] op_sel_hi:[1,0,1] neg_lo:[0,1,1] neg_hi:[0,1,1]
    v_pk_mul_f32 v[68:69], v[148:149], v[236:237] op_sel:[0,1] op_sel_hi:[1,1]
    ds_read_b64 a[16:17], v255 offset:8192
    v_pk_mul_f32 v[148:149], v[148:149], v[236:237] op_sel_hi:[1,0]
    v_pk_fma_f32 v[148:149], v[180:181], v[236:237], v[148:149] op_sel:[0,1,0] op_sel_hi:[1,1,1] neg_lo:[0,1,0] neg_hi:[0,1,0]
    v_pk_fma_f32 v[180:181], v[180:181], v[236:237], v[68:69] op_sel_hi:[1,0,1] neg_lo:[0,1,1] neg_hi:[0,1,1]
    v_pk_mul_f32 v[68:69], v[150:151], v[236:237] op_sel:[0,1] op_sel_hi:[1,1]
    v_xor_b32 v254, 32, v254
    v_pk_mul_f32 v[150:151], v[150:151], v[236:237] op_sel_hi:[1,0]
    v_pk_fma_f32 v[150:151], v[182:183], v[236:237], v[150:151] op_sel:[0,1,0] op_sel_hi:[1,1,1] neg_lo:[0,1,0] neg_hi:[0,1,0]
    v_pk_fma_f32 v[182:183], v[182:183], v[236:237], v[68:69] op_sel_hi:[1,0,1] neg_lo:[0,1,1] neg_hi:[0,1,1]
    v_xor_b32 v255, 32, v255
    ds_read_b64 a[20:21], v254 offset:0
    ds_read_b64 a[24:25], v254 offset:2048
    ds_read_b64 a[72:73], v254 offset:6144
    ds_read_b64 a[76:77], v254 offset:8192
    ds_read_b64 a[60:61], v255 offset:0
    ds_read_b64 a[64:65], v255 offset:2048
    ds_read_b64 a[32:33], v255 offset:6144
    ds_read_b64 a[36:37], v255 offset:8192
    v_lshlrev_b32 v255, 3, v0
    v_and_b32 v255, 64, v255
    v_xor_b32 v254, v254, v255
    v_xor_b32 v255, 32, v254
    ds_read_b64 a[28:29], v254 offset:4096
    ds_read_b64 a[8:9], v255 offset:4096
    v_xor_b32 v254, 64, v254
    v_xor_b32 v255, 64, v255
    ds_read_b64 a[68:69], v254 offset:4096
    ds_read_b64 a[48:49], v255 offset:4096
    s_waitcnt lgkmcnt(0)
    s_mul_i32 s96, s92, 81920
    s_add_u32 s91, s91, s96
    s_cmp_ge_u32 s91, s55
    s_cselect_b32 s96, 491520, 0
    s_sub_u32 s91, s91, s96
    s_mov_b32 s62, s91
    s_add_u32 m0, s63, 122880
    s_nop 0
    buffer_load_dwordx4 v248, s[36:39], s62 offen offset:0  lds
    buffer_load_dwordx4 v249, s[36:39], s62 offen offset:1024  lds
    buffer_load_dwordx4 v250, s[36:39], s62 offen offset:2048  lds
    buffer_load_dwordx4 v251, s[36:39], s62 offen offset:3072  lds
    s_add_u32 m0, s63, 126976
    s_nop 0
    buffer_load_dwordx4 v253, s[36:39], s62 offen offset:0  lds
    s_add_u32 s62, s62, s64
    s_add_u32 m0, s63, 128000
    s_nop 0
    buffer_load_dwordx4 v248, s[36:39], s62 offen offset:0  lds
    buffer_load_dwordx4 v249, s[36:39], s62 offen offset:1024  lds
    buffer_load_dwordx4 v250, s[36:39], s62 offen offset:2048  lds
    s_add_u32 s62, s62, s53
    buffer_load_dwordx4 v251, s[36:39], s62 offen offset:3072  lds
    s_add_u32 m0, s63, 132096
    s_nop 0
    buffer_load_dwordx4 v253, s[36:39], s62 offen offset:0  lds
    s_mul_i32 s96, s3, 8448
    v_lshrrev_b32 v52, 4, v0
    v_mul_u32_u24 v104, 264, v53
    v_lshl_add_u32 v104, v52, 6, v104
    v_add_u32 v104, s96, v104
    v_lshrrev_b32 v105, 2, v0
    v_mul_u32_u24 v105, 264, v105
    v_and_b32 v52, 3, v0
    v_lshl_add_u32 v105, v52, 6, v105
    v_add_u32 v105, s96, v105
    v_sub_f32 v108, 0, v234
    s_waitcnt vmcnt(10)
L_lb10:
    v_xor_b32 v70, v73, v92
    v_bitop3_b32 v70, v70, v75, v92 bitop3:0xf6
    v_bitop3_b32 v70, v70, v77, v93 bitop3:0xf6
    v_bitop3_b32 v70, v70, v79, v93 bitop3:0xf6
    v_bitop3_b32 v70, v70, v81, v94 bitop3:0xf6
    v_bitop3_b32 v70, v70, v83, v94 bitop3:0xf6
    v_bitop3_b32 v70, v70, v85, v95 bitop3:0xf6
    v_bitop3_b32 v70, v70, v87, v95 bitop3:0xf6
    s_mov_b64 exec, 1
    buffer_store_dwordx2 v[36:37], v34, s[20:23], s1 offen offset:0 sc1
    s_mov_b64 exec, -1
    v_cmp_ne_u32 vcc, 0, v70
    s_nop 1
    s_cmp_lg_u64 vcc, 0
    s_cbranch_scc1 L_lbslow10
    v_fma_f32 v80, v84, v244, v80
    v_fma_f32 v82, v84, v245, v82
    v_fma_f32 v80, -v86, v245, v80
    v_fmac_f32 v82, v86, v244
    v_fma_f32 v76, v80, v244, v76
    v_fma_f32 v78, v80, v245, v78
    v_fma_f32 v76, -v82, v245, v76
    v_fmac_f32 v78, v82, v244
    v_fma_f32 v72, v76, v244, v72
    v_fma_f32 v74, v76, v245, v74
    v_fma_f32 v72, -v78, v245, v72
    v_fmac_f32 v74, v78, v244
    v_mul_f32 v70, v72, v246
    v_mul_f32 v71, v72, v247
    v_fma_f32 v70, -v74, v247, v70
    v_fmac_f32 v71, v74, v246
    s_nop 1
    v_permlane16_swap_b32 v70, v71
    v_add_f32 v70, v70, v71
    v_mov_b32 v71, v70
    s_nop 1
    v_permlane32_swap_b32 v70, v71
    v_add_f32 v70, v70, v71
    v_mov_b32 v71, v70
    s_nop 1
    v_permlane16_swap_b32 v70, v71
    v_fmac_f32 v106, v242, v70
    v_fma_f32 v107, -v242, v71, v107
    v_fma_f32 v106, -v243, v71, v106
    v_fma_f32 v107, -v243, v70, v107
    v_fmac_f32 v152, v232, v106
    v_fmac_f32 v184, v232, v107
    v_fmac_f32 v152, v234, v107
    v_fmac_f32 v184, v108, v106
    v_fmac_f32 v153, v232, v152
    v_fmac_f32 v185, v232, v184
    v_fmac_f32 v153, v234, v184
    v_fmac_f32 v185, v108, v152
    v_cvt_pk_bf16_f32 v40, v152, v153
    v_cvt_pk_bf16_f32 v56, v184, v185
    v_fmac_f32 v154, v232, v153
    v_fmac_f32 v186, v232, v185
    v_fmac_f32 v154, v234, v185
    v_fmac_f32 v186, v108, v153
    v_fmac_f32 v155, v232, v154
    v_fmac_f32 v187, v232, v186
    v_fmac_f32 v155, v234, v186
    v_fmac_f32 v187, v108, v154
    v_cvt_pk_bf16_f32 v41, v154, v155
    v_cvt_pk_bf16_f32 v57, v186, v187
    ds_write_b64 v104, v[40:41] offset:0
    ds_write_b64 v104, v[56:57] offset:4224
    v_fmac_f32 v156, v232, v155
    v_fmac_f32 v188, v232, v187
    v_fmac_f32 v156, v234, v187
    v_fmac_f32 v188, v108, v155
    v_fmac_f32 v157, v232, v156
    v_fmac_f32 v189, v232, v188
    v_fmac_f32 v157, v234, v188
    v_fmac_f32 v189, v108, v156
    v_cvt_pk_bf16_f32 v42, v156, v157
    v_cvt_pk_bf16_f32 v58, v188, v189
    v_fmac_f32 v158, v232, v157
    v_fmac_f32 v190, v232, v189
    v_fmac_f32 v158, v234, v189
    v_fmac_f32 v190, v108, v157
    v_fmac_f32 v159, v232, v158
    v_fmac_f32 v191, v232, v190
    v_fmac_f32 v159, v234, v190
    v_fmac_f32 v191, v108, v158
    v_cvt_pk_bf16_f32 v43, v158, v159
    v_cvt_pk_bf16_f32 v59, v190, v191
    ds_write_b64 v104, v[42:43] offset:8
    ds_write_b64 v104, v[58:59] offset:4232
    v_fmac_f32 v160, v232, v159
    v_fmac_f32 v192, v232, v191
    v_fmac_f32 v160, v234, v191
    v_fmac_f32 v192, v108, v159
    v_fmac_f32 v161, v232, v160
    v_fmac_f32 v193, v232, v192
    v_fmac_f32 v161, v234, v192
    v_fmac_f32 v193, v108, v160
    v_cvt_pk_bf16_f32 v44, v160, v161
    v_cvt_pk_bf16_f32 v60, v192, v193
    ds_read_b64_tr_b16 v[72:73], v105 offset:0
    ds_read_b64_tr_b16 v[74:75], v105 offset:4224
    v_fmac_f32 v162, v232, v161
    v_fmac_f32 v194, v232, v193
    v_fmac_f32 v162, v234, v193
    v_fmac_f32 v194, v108, v161
    v_fmac_f32 v163, v232, v162
    v_fmac_f32 v195, v232, v194
    v_fmac_f32 v163, v234, v194
    v_fmac_f32 v195, v108, v162
    v_cvt_pk_bf16_f32 v45, v162, v163
    v_cvt_pk_bf16_f32 v61, v194, v195
    ds_write_b64 v104, v[44:45] offset:16
    ds_write_b64 v104, v[60:61] offset:4240
    v_fmac_f32 v164, v232, v163
    v_fmac_f32 v196, v232, v195
    v_fmac_f32 v164, v234, v195
    v_fmac_f32 v196, v108, v163
    v_fmac_f32 v165, v232, v164
    v_fmac_f32 v197, v232, v196
    v_fmac_f32 v165, v234, v196
    v_fmac_f32 v197, v108, v164
    v_cvt_pk_bf16_f32 v46, v164, v165
    v_cvt_pk_bf16_f32 v62, v196, v197
    ds_read_b64_tr_b16 v[76:77], v105 offset:8
    ds_read_b64_tr_b16 v[78:79], v105 offset:4232
    v_fmac_f32 v166, v232, v165
    v_fmac_f32 v198, v232, v197
    v_fmac_f32 v166, v234, v197
    v_fmac_f32 v198, v108, v165
    s_add_u32 s71, s34, 0
    s_waitcnt lgkmcnt(4)
    buffer_store_dwordx4 v[72:75], v1, s[20:23], s71 offen sc1
    v_fmac_f32 v167, v232, v166
    v_fmac_f32 v199, v232, v198
    v_fmac_f32 v167, v234, v198
    v_fmac_f32 v199, v108, v166
    v_cvt_pk_bf16_f32 v47, v166, v167
    v_cvt_pk_bf16_f32 v63, v198, v199
    ds_write_b64 v104, v[46:47] offset:24
    ds_write_b64 v104, v[62:63] offset:4248
    v_fmac_f32 v136, v232, v167
    v_fmac_f32 v168, v232, v199
    v_fmac_f32 v136, v234, v199
    v_fmac_f32 v168, v108, v167
    v_fmac_f32 v137, v232, v136
    v_fmac_f32 v169, v232, v168
    v_fmac_f32 v137, v234, v168
    v_fmac_f32 v169, v108, v136
    v_cvt_pk_bf16_f32 v48, v136, v137
    v_cvt_pk_bf16_f32 v64, v168, v169
    ds_read_b64_tr_b16 v[80:81], v105 offset:16
    ds_read_b64_tr_b16 v[82:83], v105 offset:4240
    v_fmac_f32 v138, v232, v137
    v_fmac_f32 v170, v232, v169
    v_fmac_f32 v138, v234, v169
    v_fmac_f32 v170, v108, v137
    s_add_u32 s71, s34, 40960
    s_waitcnt lgkmcnt(4)
    buffer_store_dwordx4 v[76:79], v1, s[20:23], s71 offen sc1
    v_fmac_f32 v139, v232, v138
    v_fmac_f32 v171, v232, v170
    v_fmac_f32 v139, v234, v170
    v_fmac_f32 v171, v108, v138
    v_cvt_pk_bf16_f32 v49, v138, v139
    v_cvt_pk_bf16_f32 v65, v170, v171
    ds_write_b64 v104, v[48:49] offset:32
    ds_write_b64 v104, v[64:65] offset:4256
    v_fmac_f32 v140, v232, v139
    v_fmac_f32 v172, v232, v171
    v_fmac_f32 v140, v234, v171
    v_fmac_f32 v172, v108, v139
    v_fmac_f32 v141, v232, v140
    v_fmac_f32 v173, v232, v172
    v_fmac_f32 v141, v234, v172
    v_fmac_f32 v173, v108, v140
    v_cvt_pk_bf16_f32 v50, v140, v141
    v_cvt_pk_bf16_f32 v66, v172, v173
    ds_read_b64_tr_b16 v[84:85], v105 offset:24
    ds_read_b64_tr_b16 v[86:87], v105 offset:4248
    v_fmac_f32 v142, v232, v141
    v_fmac_f32 v174, v232, v173
    v_fmac_f32 v142, v234, v173
    v_fmac_f32 v174, v108, v141
    s_add_u32 s71, s34, 81920
    s_waitcnt lgkmcnt(4)
    buffer_store_dwordx4 v[80:83], v1, s[20:23], s71 offen sc1
    v_fmac_f32 v143, v232, v142
    v_fmac_f32 v175, v232, v174
    v_fmac_f32 v143, v234, v174
    v_fmac_f32 v175, v108, v142
    v_cvt_pk_bf16_f32 v51, v142, v143
    v_cvt_pk_bf16_f32 v67, v174, v175
    ds_write_b64 v104, v[50:51] offset:40
    ds_write_b64 v104, v[66:67] offset:4264
    v_fmac_f32 v144, v232, v143
    v_fmac_f32 v176, v232, v175
    v_fmac_f32 v144, v234, v175
    v_fmac_f32 v176, v108, v143
    v_fmac_f32 v145, v232, v144
    v_fmac_f32 v177, v232, v176
    v_fmac_f32 v145, v234, v176
    v_fmac_f32 v177, v108, v144
    v_cvt_pk_bf16_f32 v52, v144, v145
    v_cvt_pk_bf16_f32 v68, v176, v177
    ds_read_b64_tr_b16 v[88:89], v105 offset:32
    ds_read_b64_tr_b16 v[90:91], v105 offset:4256
    v_fmac_f32 v146, v232, v145
    v_fmac_f32 v178, v232, v177
    v_fmac_f32 v146, v234, v177
    v_fmac_f32 v178, v108, v145
    s_add_u32 s71, s34, 122880
    s_waitcnt lgkmcnt(4)
    buffer_store_dwordx4 v[84:87], v1, s[20:23], s71 offen sc1
    v_fmac_f32 v147, v232, v146
    v_fmac_f32 v179, v232, v178
    v_fmac_f32 v147, v234, v178
    v_fmac_f32 v179, v108, v146
    v_cvt_pk_bf16_f32 v53, v146, v147
    v_cvt_pk_bf16_f32 v69, v178, v179
    ds_write_b64 v104, v[52:53] offset:48
    ds_write_b64 v104, v[68:69] offset:4272
    v_fmac_f32 v148, v232, v147
    v_fmac_f32 v180, v232, v179
    v_fmac_f32 v148, v234, v179
    v_fmac_f32 v180, v108, v147
    v_fmac_f32 v149, v232, v148
    v_fmac_f32 v181, v232, v180
    v_fmac_f32 v149, v234, v180
    v_fmac_f32 v181, v108, v148
    v_cvt_pk_bf16_f32 v54, v148, v149
    v_cvt_pk_bf16_f32 v70, v180, v181
    ds_read_b64_tr_b16 v[92:93], v105 offset:40
    ds_read_b64_tr_b16 v[94:95], v105 offset:4264
    v_fmac_f32 v150, v232, v149
    v_fmac_f32 v182, v232, v181
    v_fmac_f32 v150, v234, v181
    v_fmac_f32 v182, v108, v149
    s_add_u32 s71, s34, 163840
    s_waitcnt lgkmcnt(4)
    buffer_store_dwordx4 v[88:91], v1, s[20:23], s71 offen sc1
    v_fmac_f32 v151, v232, v150
    v_fmac_f32 v183, v232, v182
    v_fmac_f32 v151, v234, v182
    v_fmac_f32 v183, v108, v150
    v_cvt_pk_bf16_f32 v55, v150, v151
    v_cvt_pk_bf16_f32 v71, v182, v183
    ds_write_b64 v104, v[54:55] offset:56
    ds_write_b64 v104, v[70:71] offset:4280
    ds_read_b64_tr_b16 v[96:97], v105 offset:48
    ds_read_b64_tr_b16 v[98:99], v105 offset:4272
    ds_read_b64_tr_b16 v[100:101], v105 offset:56
    ds_read_b64_tr_b16 v[102:103], v105 offset:4280
    s_add_u32 s71, s34, 204800
    s_waitcnt lgkmcnt(6)
    buffer_store_dwordx4 v[92:95], v1, s[20:23], s71 offen sc1
    s_add_u32 s71, s34, 245760
    s_waitcnt lgkmcnt(2)
    buffer_store_dwordx4 v[96:99], v1, s[20:23], s71 offen sc1
    s_add_u32 s71, s34, 286720
    s_waitcnt lgkmcnt(0)
    buffer_store_dwordx4 v[100:103], v1, s[20:23], s71 offen sc1
L_xep20:
    v_add_u32 v254, 40960, v38
    v_xor_b32 v255, 64, v254
    ds_read_b64 a[2:3], v254 offset:0
    ds_read_b64 a[6:7], v254 offset:2048
    ds_read_b64 a[54:55], v254 offset:6144
    ds_read_b64 a[58:59], v254 offset:8192
    ds_read_b64 a[42:43], v255 offset:0
    ds_read_b64 a[46:47], v255 offset:2048
    ds_read_b64 a[14:15], v255 offset:6144
    ds_read_b64 a[18:19], v255 offset:8192
    v_xor_b32 v254, 32, v254
    v_xor_b32 v255, 32, v255
    ds_read_b64 a[22:23], v254 offset:0
    ds_read_b64 a[26:27], v254 offset:2048
    ds_read_b64 a[74:75], v254 offset:6144
    ds_read_b64 a[78:79], v254 offset:8192
    ds_read_b64 a[62:63], v255 offset:0
    ds_read_b64 a[66:67], v255 offset:2048
    ds_read_b64 a[34:35], v255 offset:6144
    ds_read_b64 a[38:39], v255 offset:8192
    v_lshlrev_b32 v255, 3, v0
    v_and_b32 v255, 64, v255
    v_xor_b32 v254, v254, v255
    v_xor_b32 v255, 32, v254
    ds_read_b64 a[30:31], v254 offset:4096
    ds_read_b64 a[10:11], v255 offset:4096
    v_xor_b32 v254, 64, v254
    v_xor_b32 v255, 64, v255
    ds_read_b64 a[70:71], v254 offset:4096
    ds_read_b64 a[50:51], v255 offset:4096
    s_waitcnt lgkmcnt(0)
    s_mov_b32 s91, s54
    v_accvgpr_read_b32 v248, a254
    v_add_u32 v249, 19456, v248
    v_add_u32 v250, 38912, v248
    v_add_u32 v251, 58368, v248
    v_add_u32 v253, 81920, v248
    s_mul_i32 s96, s51, 1280
    v_add_u32 v253, s96, v253
    s_mov_b32 s62, s91
    s_add_u32 m0, s63, 40960
    s_nop 0
    buffer_load_dwordx4 v248, s[28:31], s62 offen offset:0  lds
    buffer_load_dwordx4 v249, s[28:31], s62 offen offset:1024  lds
    buffer_load_dwordx4 v250, s[28:31], s62 offen offset:2048  lds
    buffer_load_dwordx4 v251, s[28:31], s62 offen offset:3072  lds
    s_add_u32 m0, s63, 45056
    s_nop 0
    buffer_load_dwordx4 v253, s[28:31], s62 offen offset:0  lds
    s_mul_i32 s96, s92, 40960
    s_add_u32 s62, s62, s96
    s_add_u32 m0, s63, 46080
    s_nop 0
    buffer_load_dwordx4 v248, s[36:39], s62 offen offset:0  lds
    buffer_load_dwordx4 v249, s[36:39], s62 offen offset:1024  lds
    buffer_load_dwordx4 v250, s[36:39], s62 offen offset:2048  lds
    buffer_load_dwordx4 v251, s[36:39], s62 offen offset:3072  lds
    s_add_u32 m0, s63, 50176
    s_nop 0
    buffer_load_dwordx4 v253, s[36:39], s62 offen offset:0  lds
    buffer_load_dwordx2 v[26:27], v8, s[20:23], s32 offen sc1
    v_add_u32 v254, 81920, v38
    v_xor_b32 v255, 64, v254
    ds_read_b64 a[80:81], v254 offset:0
    ds_read_b64 a[84:85], v254 offset:2048
    ds_read_b64 a[132:133], v254 offset:6144
    ds_read_b64 a[136:137], v254 offset:8192
    ds_read_b64 a[120:121], v255 offset:0
    ds_read_b64 a[124:125], v255 offset:2048
    ds_read_b64 a[92:93], v255 offset:6144
    ds_read_b64 a[96:97], v255 offset:8192
    v_xor_b32 v254, 32, v254
    v_xor_b32 v255, 32, v255
    ds_read_b64 a[100:101], v254 offset:0
    ds_read_b64 a[104:105], v254 offset:2048
    ds_read_b64 a[152:153], v254 offset:6144
    ds_read_b64 a[156:157], v254 offset:8192
    ds_read_b64 a[140:141], v255 offset:0
    ds_read_b64 a[144:145], v255 offset:2048
    ds_read_b64 a[112:113], v255 offset:6144
    ds_read_b64 a[116:117], v255 offset:8192
    v_lshlrev_b32 v255, 3, v0
    v_and_b32 v255, 64, v255
    v_xor_b32 v254, v254, v255
    v_xor_b32 v255, 32, v254
    ds_read_b64 a[108:109], v254 offset:4096
    ds_read_b64 a[88:89], v255 offset:4096
    v_xor_b32 v254, 64, v254
    v_xor_b32 v255, 64, v255
    ds_read_b64 a[148:149], v254 offset:4096
    ds_read_b64 a[128:129], v255 offset:4096
    s_waitcnt vmcnt(20)
    v_add_u32 v254, 122880, v38
    v_xor_b32 v255, 64, v254
    ds_read_b64 a[82:83], v254 offset:0
    ds_read_b64 a[86:87], v254 offset:2048
    ds_read_b64 a[134:135], v254 offset:6144
    ds_read_b64 a[138:139], v254 offset:8192
    ds_read_b64 a[122:123], v255 offset:0
    ds_read_b64 a[126:127], v255 offset:2048
    ds_read_b64 a[94:95], v255 offset:6144
    ds_read_b64 a[98:99], v255 offset:8192
    v_xor_b32 v254, 32, v254
    v_xor_b32 v255, 32, v255
    ds_read_b64 a[102:103], v254 offset:0
    ds_read_b64 a[106:107], v254 offset:2048
    ds_read_b64 a[154:155], v254 offset:6144
    ds_read_b64 a[158:159], v254 offset:8192
    ds_read_b64 a[142:143], v255 offset:0
    ds_read_b64 a[146:147], v255 offset:2048
    ds_read_b64 a[114:115], v255 offset:6144
    ds_read_b64 a[118:119], v255 offset:8192
    v_lshlrev_b32 v255, 3, v0
    v_and_b32 v255, 64, v255
    v_xor_b32 v254, v254, v255
    v_xor_b32 v255, 32, v254
    ds_read_b64 a[110:111], v254 offset:4096
    ds_read_b64 a[90:91], v255 offset:4096
    v_xor_b32 v254, 64, v254
    v_xor_b32 v255, 64, v255
    ds_read_b64 a[150:151], v254 offset:4096
    ds_read_b64 a[130:131], v255 offset:4096
    s_mov_b32 s58, 0xffff
    s_add_u32 s83, s67, 12288
    s_lshl_b32 s87, s77, 11
    s_add_u32 s87, s87, s33
    s_lshl_b32 s86, s52, 12
    s_add_u32 s8, s87, s86
    s_add_u32 s9, s8, 2048
    s_xor_b32 s86, s86, 4096
    s_add_u32 s10, s87, s86
    s_add_u32 s11, s10, 2048
    s_add_u32 s12, s33, 8192
    s_cmp_eq_u32 s77, 1
    s_cselect_b32 s12, s33, s12
    s_waitcnt vmcnt(11)
    s_mov_b64 exec, 1
    buffer_store_dwordx2 v[36:37], v34, s[20:23], s35 offen offset:0 sc1
    s_mov_b64 exec, -1
    s_waitcnt vmcnt(2)
    v_add_u32 v254, 40960, v39
    v_xor_b32 v255, 32, v254
    ds_read_b64 a[160:161], v254 offset:0
    ds_read_b64 a[162:163], v254 offset:5120
    ds_read_b64 a[164:165], v254 offset:1024
    ds_read_b64 a[166:167], v254 offset:6144
    ds_read_b64 a[168:169], v254 offset:2048
    ds_read_b64 a[170:171], v254 offset:7168
    ds_read_b64 a[172:173], v254 offset:3072
    ds_read_b64 a[174:175], v254 offset:8192
    ds_read_b64 a[176:177], v254 offset:4096
    ds_read_b64 a[178:179], v254 offset:9216
    ds_read_b64 a[180:181], v255 offset:0
    ds_read_b64 a[182:183], v255 offset:5120
    ds_read_b64 a[184:185], v255 offset:1024
    ds_read_b64 a[186:187], v255 offset:6144
    ds_read_b64 a[188:189], v255 offset:2048
    ds_read_b64 a[190:191], v255 offset:7168
    ds_read_b64 a[192:193], v255 offset:3072
    ds_read_b64 a[194:195], v255 offset:8192
    ds_read_b64 a[196:197], v255 offset:4096
    ds_read_b64 a[198:199], v255 offset:9216
    s_nop 0
    s_waitcnt vmcnt(1)
    s_branch L_roleP
L_xq:
    s_cmp_eq_u32 s77, 1
    s_cbranch_scc1 L_xep11
    v_and_b32 v50, 15, v0
    v_bfe_u32 v51, v0, 4, 1
    v_lshlrev_b32 v50, 4, v50
    v_lshl_add_u32 v50, v51, 3, v50
    s_lshl_b32 s70, s76, 8
    v_pk_fma_f32 v[44:45], v[136:137], v[232:233], v[138:139] op_sel:[0,1,0] op_sel_hi:[1,1,1]
    v_pk_fma_f32 v[46:47], v[168:169], v[232:233], v[170:171] op_sel:[0,1,0] op_sel_hi:[1,1,1]
    v_pk_fma_f32 v[44:45], v[168:169], v[234:235], v[44:45] op_sel:[0,1,0] op_sel_hi:[1,1,1] neg_lo:[0,1,0] neg_hi:[0,1,0]
    v_pk_fma_f32 v[46:47], v[136:137], v[234:235], v[46:47] op_sel:[0,1,0] op_sel_hi:[1,1,1]
    v_pk_fma_f32 v[40:41], v[44:45], v[232:233], v[140:141] op_sel:[0,1,0] op_sel_hi:[1,1,1]
    v_pk_fma_f32 v[42:43], v[46:47], v[232:233], v[172:173] op_sel:[0,1,0] op_sel_hi:[1,1,1]
    v_pk_fma_f32 v[40:41], v[46:47], v[234:235], v[40:41] op_sel:[0,1,0] op_sel_hi:[1,1,1] neg_lo:[0,1,0] neg_hi:[0,1,0]
    v_pk_fma_f32 v[42:43], v[44:45], v[234:235], v[42:43] op_sel:[0,1,0] op_sel_hi:[1,1,1]
    v_pk_fma_f32 v[44:45], v[40:41], v[232:233], v[142:143] op_sel:[0,1,0] op_sel_hi:[1,1,1]
    v_pk_fma_f32 v[46:47], v[42:43], v[232:233], v[174:175] op_sel:[0,1,0] op_sel_hi:[1,1,1]
    v_pk_fma_f32 v[44:45], v[42:43], v[234:235], v[44:45] op_sel:[0,1,0] op_sel_hi:[1,1,1] neg_lo:[0,1,0] neg_hi:[0,1,0]
    v_pk_fma_f32 v[46:47], v[40:41], v[234:235], v[46:47] op_sel:[0,1,0] op_sel_hi:[1,1,1]
    v_pk_fma_f32 v[40:41], v[44:45], v[232:233], v[144:145] op_sel:[0,1,0] op_sel_hi:[1,1,1]
    v_pk_fma_f32 v[42:43], v[46:47], v[232:233], v[176:177] op_sel:[0,1,0] op_sel_hi:[1,1,1]
    v_pk_fma_f32 v[40:41], v[46:47], v[234:235], v[40:41] op_sel:[0,1,0] op_sel_hi:[1,1,1] neg_lo:[0,1,0] neg_hi:[0,1,0]
    v_pk_fma_f32 v[42:43], v[44:45], v[234:235], v[42:43] op_sel:[0,1,0] op_sel_hi:[1,1,1]
    v_pk_fma_f32 v[44:45], v[40:41], v[232:233], v[146:147] op_sel:[0,1,0] op_sel_hi:[1,1,1]
    v_pk_fma_f32 v[46:47], v[42:43], v[232:233], v[178:179] op_sel:[0,1,0] op_sel_hi:[1,1,1]
    v_pk_fma_f32 v[44:45], v[42:43], v[234:235], v[44:45] op_sel:[0,1,0] op_sel_hi:[1,1,1] neg_lo:[0,1,0] neg_hi:[0,1,0]
    v_pk_fma_f32 v[46:47], v[40:41], v[234:235], v[46:47] op_sel:[0,1,0] op_sel_hi:[1,1,1]
    v_pk_fma_f32 v[40:41], v[44:45], v[232:233], v[148:149] op_sel:[0,1,0] op_sel_hi:[1,1,1]
    v_pk_fma_f32 v[42:43], v[46:47], v[232:233], v[180:181] op_sel:[0,1,0] op_sel_hi:[1,1,1]
    v_pk_fma_f32 v[40:41], v[46:47], v[234:235], v[40:41] op_sel:[0,1,0] op_sel_hi:[1,1,1] neg_lo:[0,1,0] neg_hi:[0,1,0]
    v_pk_fma_f32 v[42:43], v[44:45], v[234:235], v[42:43] op_sel:[0,1,0] op_sel_hi:[1,1,1]
    v_pk_fma_f32 v[44:45], v[40:41], v[232:233], v[150:151] op_sel:[0,1,0] op_sel_hi:[1,1,1]
    v_pk_fma_f32 v[46:47], v[42:43], v[232:233], v[182:183] op_sel:[0,1,0] op_sel_hi:[1,1,1]
    v_pk_fma_f32 v[44:45], v[42:43], v[234:235], v[44:45] op_sel:[0,1,0] op_sel_hi:[1,1,1] neg_lo:[0,1,0] neg_hi:[0,1,0]
    v_pk_fma_f32 v[46:47], v[40:41], v[234:235], v[46:47] op_sel:[0,1,0] op_sel_hi:[1,1,1]
    v_pk_fma_f32 v[40:41], v[44:45], v[232:233], v[152:153] op_sel:[0,1,0] op_sel_hi:[1,1,1]
    v_pk_fma_f32 v[42:43], v[46:47], v[232:233], v[184:185] op_sel:[0,1,0] op_sel_hi:[1,1,1]
    v_pk_fma_f32 v[40:41], v[46:47], v[234:235], v[40:41] op_sel:[0,1,0] op_sel_hi:[1,1,1] neg_lo:[0,1,0] neg_hi:[0,1,0]
    v_pk_fma_f32 v[42:43], v[44:45], v[234:235], v[42:43] op_sel:[0,1,0] op_sel_hi:[1,1,1]
    v_pk_fma_f32 v[44:45], v[40:41], v[232:233], v[154:155] op_sel:[0,1,0] op_sel_hi:[1,1,1]
    v_pk_fma_f32 v[46:47], v[42:43], v[232:233], v[186:187] op_sel:[0,1,0] op_sel_hi:[1,1,1]
    v_pk_fma_f32 v[44:45], v[42:43], v[234:235], v[44:45] op_sel:[0,1,0] op_sel_hi:[1,1,1] neg_lo:[0,1,0] neg_hi:[0,1,0]
    v_pk_fma_f32 v[46:47], v[40:41], v[234:235], v[46:47] op_sel:[0,1,0] op_sel_hi:[1,1,1]
    v_pk_fma_f32 v[40:41], v[44:45], v[232:233], v[156:157] op_sel:[0,1,0] op_sel_hi:[1,1,1]
    v_pk_fma_f32 v[42:43], v[46:47], v[232:233], v[188:189] op_sel:[0,1,0] op_sel_hi:[1,1,1]
    v_pk_fma_f32 v[40:41], v[46:47], v[234:235], v[40:41] op_sel:[0,1,0] op_sel_hi:[1,1,1] neg_lo:[0,1,0] neg_hi:[0,1,0]
    v_pk_fma_f32 v[42:43], v[44:45], v[234:235], v[42:43] op_sel:[0,1,0] op_sel_hi:[1,1,1]
    v_pk_fma_f32 v[44:45], v[40:41], v[232:233], v[158:159] op_sel:[0,1,0] op_sel_hi:[1,1,1]
    v_pk_fma_f32 v[46:47], v[42:43], v[232:233], v[190:191] op_sel:[0,1,0] op_sel_hi:[1,1,1]
    v_pk_fma_f32 v[44:45], v[42:43], v[234:235], v[44:45] op_sel:[0,1,0] op_sel_hi:[1,1,1] neg_lo:[0,1,0] neg_hi:[0,1,0]
    v_pk_fma_f32 v[46:47], v[40:41], v[234:235], v[46:47] op_sel:[0,1,0] op_sel_hi:[1,1,1]
    v_pk_fma_f32 v[40:41], v[44:45], v[232:233], v[160:161] op_sel:[0,1,0] op_sel_hi:[1,1,1]
    v_pk_fma_f32 v[42:43], v[46:47], v[232:233], v[192:193] op_sel:[0,1,0] op_sel_hi:[1,1,1]
    v_pk_fma_f32 v[40:41], v[46:47], v[234:235], v[40:41] op_sel:[0,1,0] op_sel_hi:[1,1,1] neg_lo:[0,1,0] neg_hi:[0,1,0]
    v_pk_fma_f32 v[42:43], v[44:45], v[234:235], v[42:43] op_sel:[0,1,0] op_sel_hi:[1,1,1]
    v_pk_fma_f32 v[44:45], v[40:41], v[232:233], v[162:163] op_sel:[0,1,0] op_sel_hi:[1,1,1]
    v_pk_fma_f32 v[46:47], v[42:43], v[232:233], v[194:195] op_sel:[0,1,0] op_sel_hi:[1,1,1]
    v_pk_fma_f32 v[44:45], v[42:43], v[234:235], v[44:45] op_sel:[0,1,0] op_sel_hi:[1,1,1] neg_lo:[0,1,0] neg_hi:[0,1,0]
    v_pk_fma_f32 v[46:47], v[40:41], v[234:235], v[46:47] op_sel:[0,1,0] op_sel_hi:[1,1,1]
    v_pk_fma_f32 v[40:41], v[44:45], v[232:233], v[164:165] op_sel:[0,1,0] op_sel_hi:[1,1,1]
    v_pk_fma_f32 v[42:43], v[46:47], v[232:233], v[196:197] op_sel:[0,1,0] op_sel_hi:[1,1,1]
    v_pk_fma_f32 v[40:41], v[46:47], v[234:235], v[40:41] op_sel:[0,1,0] op_sel_hi:[1,1,1] neg_lo:[0,1,0] neg_hi:[0,1,0]
    v_pk_fma_f32 v[42:43], v[44:45], v[234:235], v[42:43] op_sel:[0,1,0] op_sel_hi:[1,1,1]
    v_pk_fma_f32 v[44:45], v[40:41], v[232:233], v[166:167] op_sel:[0,1,0] op_sel_hi:[1,1,1]
    v_pk_fma_f32 v[46:47], v[42:43], v[232:233], v[198:199] op_sel:[0,1,0] op_sel_hi:[1,1,1]
    v_pk_fma_f32 v[44:45], v[42:43], v[234:235], v[44:45] op_sel:[0,1,0] op_sel_hi:[1,1,1] neg_lo:[0,1,0] neg_hi:[0,1,0]
    v_pk_fma_f32 v[46:47], v[40:41], v[234:235], v[46:47] op_sel:[0,1,0] op_sel_hi:[1,1,1]
    v_fma_f32 v45, v44, v232, v45
    v_fma_f32 v47, v44, v234, v47
    v_fma_f32 v45, -v46, v234, v45
    v_fmac_f32 v47, v46, v232
    v_mul_f32 v40, v45, v238
    v_mul_f32 v41, v45, v239
    v_fma_f32 v40, -v47, v239, v40
    v_fmac_f32 v41, v47, v238
    s_nop 1
    v_permlane16_swap_b32 v40, v41
    v_add_f32 v40, v40, v41
    v_mov_b32 v41, v40
    s_nop 1
    v_permlane32_swap_b32 v40, v41
    v_add_f32 v48, v40, v41
    v_mov_b32 v49, s88
    s_mov_b32 exec_hi, 0
    buffer_store_dwordx2 v[48:49], v50, s[72:75], s70 offen sc1
    s_mov_b32 exec_hi, -1
    s_mov_b32 s84, 0xbfb8aa3b
    s_mov_b32 s85, 0xbfb8aa3b
    v_pk_mul_f32 v[112:113], v[200:201], s[84:85]
    v_pk_mul_f32 v[114:115], v[202:203], s[84:85]
    buffer_load_dwordx4 v249, s[36:39], s62 offen offset:1024  lds
    s_add_u32 s71, s0, 0
    v_pk_mul_f32 v[116:117], v[216:217], s[84:85]
    v_pk_mul_f32 v[118:119], v[218:219], s[84:85]
    v_exp_f32 v112, v112
    buffer_load_dwordx4 v250, s[36:39], s62 offen offset:2048  lds
    v_exp_f32 v113, v113
    v_exp_f32 v114, v114
    v_exp_f32 v115, v115
    v_exp_f32 v116, v116
    s_add_u32 s62, s62, s53
    buffer_load_dwordx4 v251, s[36:39], s62 offen offset:3072  lds
    v_exp_f32 v117, v117
    v_exp_f32 v118, v118
    v_exp_f32 v119, v119
    v_pk_add_f32 v[112:113], v[112:113], 1.0 op_sel_hi:[1,0]
    v_pk_add_f32 v[114:115], v[114:115], 1.0 op_sel_hi:[1,0]
    v_pk_add_f32 v[116:117], v[116:117], 1.0 op_sel_hi:[1,0]
    v_pk_add_f32 v[118:119], v[118:119], 1.0 op_sel_hi:[1,0]
    v_rcp_f32 v112, v112
    v_rcp_f32 v113, v113
    v_rcp_f32 v114, v114
    v_rcp_f32 v115, v115
    v_rcp_f32 v116, v116
    v_rcp_f32 v117, v117
    v_rcp_f32 v118, v118
    v_rcp_f32 v119, v119
    v_pk_mul_f32 v[112:113], v[112:113], v[200:201]
    v_pk_mul_f32 v[114:115], v[114:115], v[202:203]
    v_pk_mul_f32 v[116:117], v[116:117], v[216:217]
    v_pk_mul_f32 v[118:119], v[118:119], v[218:219]
    v_cvt_pk_bf16_f32 v120, v112, v113
    v_cvt_pk_bf16_f32 v121, v114, v115
    v_cvt_pk_bf16_f32 v122, v116, v117
    v_cvt_pk_bf16_f32 v123, v118, v119
    buffer_store_dwordx4 v[120:123], v1, s[20:23], s71 offen sc1
    v_pk_mul_f32 v[124:125], v[204:205], s[84:85]
    v_pk_mul_f32 v[126:127], v[206:207], s[84:85]
    s_add_u32 m0, s63, 50176
    s_nop 0
    s_cmp_eq_u32 s92, 1
    s_cbranch_scc1 L_s59
    buffer_load_dwordx4 v253, s[36:39], s62 offen offset:0  lds
L_s59:
    s_add_u32 s71, s0, 49152
    v_pk_mul_f32 v[128:129], v[220:221], s[84:85]
    v_pk_mul_f32 v[130:131], v[222:223], s[84:85]
    v_exp_f32 v124, v124
    s_add_u32 s91, s91, s65
    s_cmp_ge_u32 s91, s55
    s_cselect_b32 s96, 491520, 0
    s_sub_u32 s91, s91, s96
    s_mov_b32 s62, s91
    s_add_u32 m0, s63, 81920
    s_nop 0
    buffer_load_dwordx4 v248, s[28:31], s62 offen offset:0  lds
    v_exp_f32 v125, v125
    v_exp_f32 v126, v126
    v_exp_f32 v127, v127
    v_exp_f32 v128, v128
    buffer_load_dwordx4 v249, s[28:31], s62 offen offset:1024  lds
    v_exp_f32 v129, v129
    v_exp_f32 v130, v130
    v_exp_f32 v131, v131
    v_pk_add_f32 v[124:125], v[124:125], 1.0 op_sel_hi:[1,0]
    v_pk_add_f32 v[126:127], v[126:127], 1.0 op_sel_hi:[1,0]
    v_pk_add_f32 v[128:129], v[128:129], 1.0 op_sel_hi:[1,0]
    v_pk_add_f32 v[130:131], v[130:131], 1.0 op_sel_hi:[1,0]
    v_rcp_f32 v124, v124
    v_rcp_f32 v125, v125
    v_rcp_f32 v126, v126
    v_rcp_f32 v127, v127
    v_rcp_f32 v128, v128
    v_rcp_f32 v129, v129
    v_rcp_f32 v130, v130
    v_rcp_f32 v131, v131
    v_pk_mul_f32 v[124:125], v[124:125], v[204:205]
    v_pk_mul_f32 v[126:127], v[126:127], v[206:207]
    v_pk_mul_f32 v[128:129], v[128:129], v[220:221]
    v_pk_mul_f32 v[130:131], v[130:131], v[222:223]
    v_cvt_pk_bf16_f32 v132, v124, v125
    v_cvt_pk_bf16_f32 v133, v126, v127
    v_cvt_pk_bf16_f32 v134, v128, v129
    v_cvt_pk_bf16_f32 v135, v130, v131
    buffer_store_dwordx4 v[132:135], v1, s[20:23], s71 offen sc1
    v_pk_mul_f32 v[112:113], v[208:209], s[84:85]
    v_pk_mul_f32 v[114:115], v[210:211], s[84:85]
    buffer_load_dwordx4 v250, s[28:31], s62 offen offset:2048  lds
    s_add_u32 s71, s0, 98304
    v_pk_mul_f32 v[116:117], v[224:225], s[84:85]
    v_pk_mul_f32 v[118:119], v[226:227], s[84:85]
    v_exp_f32 v112, v112
    buffer_load_dwordx4 v251, s[28:31], s62 offen offset:3072  lds
    v_exp_f32 v113, v113
    v_exp_f32 v114, v114
    v_exp_f32 v115, v115
    v_exp_f32 v116, v116
    s_add_u32 s62, s62, s64
    s_add_u32 m0, s63, 87040
    s_nop 0
    buffer_load_dwordx4 v248, s[28:31], s62 offen offset:0  lds
    v_exp_f32 v117, v117
    v_exp_f32 v118, v118
    v_exp_f32 v119, v119
    v_pk_add_f32 v[112:113], v[112:113], 1.0 op_sel_hi:[1,0]
    v_pk_add_f32 v[114:115], v[114:115], 1.0 op_sel_hi:[1,0]
    v_pk_add_f32 v[116:117], v[116:117], 1.0 op_sel_hi:[1,0]
    v_pk_add_f32 v[118:119], v[118:119], 1.0 op_sel_hi:[1,0]
    v_rcp_f32 v112, v112
    v_rcp_f32 v113, v113
    v_rcp_f32 v114, v114
    v_rcp_f32 v115, v115
    v_rcp_f32 v116, v116
    v_rcp_f32 v117, v117
    v_rcp_f32 v118, v118
    v_rcp_f32 v119, v119
    v_pk_mul_f32 v[112:113], v[112:113], v[208:209]
    v_pk_mul_f32 v[114:115], v[114:115], v[210:211]
    v_pk_mul_f32 v[116:117], v[116:117], v[224:225]
    v_pk_mul_f32 v[118:119], v[118:119], v[226:227]
    v_cvt_pk_bf16_f32 v120, v112, v113
    v_cvt_pk_bf16_f32 v121, v114, v115
    v_cvt_pk_bf16_f32 v122, v116, v117
    v_cvt_pk_bf16_f32 v123, v118, v119
    buffer_store_dwordx4 v[120:123], v1, s[20:23], s71 offen sc1
    v_pk_mul_f32 v[124:125], v[212:213], s[84:85]
    v_pk_mul_f32 v[126:127], v[214:215], s[84:85]
    buffer_load_dwordx4 v249, s[28:31], s62 offen offset:1024  lds
    s_add_u32 s71, s0, 147456
    v_pk_mul_f32 v[128:129], v[228:229], s[84:85]
    v_pk_mul_f32 v[130:131], v[230:231], s[84:85]
    v_exp_f32 v124, v124
    buffer_load_dwordx4 v250, s[28:31], s62 offen offset:2048  lds
    v_exp_f32 v125, v125
    v_exp_f32 v126, v126
    v_exp_f32 v127, v127
    v_exp_f32 v128, v128
    s_add_u32 s62, s62, s53
    buffer_load_dwordx4 v251, s[28:31], s62 offen offset:3072  lds
    v_exp_f32 v129, v129
    v_exp_f32 v130, v130
    v_exp_f32 v131, v131
    v_pk_add_f32 v[124:125], v[124:125], 1.0 op_sel_hi:[1,0]
    v_pk_add_f32 v[126:127], v[126:127], 1.0 op_sel_hi:[1,0]
    v_pk_add_f32 v[128:129], v[128:129], 1.0 op_sel_hi:[1,0]
    v_pk_add_f32 v[130:131], v[130:131], 1.0 op_sel_hi:[1,0]
    v_rcp_f32 v124, v124
    v_rcp_f32 v125, v125
    v_rcp_f32 v126, v126
    v_rcp_f32 v127, v127
    v_rcp_f32 v128, v128
    v_rcp_f32 v129, v129
    v_rcp_f32 v130, v130
    v_rcp_f32 v131, v131
    v_pk_mul_f32 v[124:125], v[124:125], v[212:213]
    v_pk_mul_f32 v[126:127], v[126:127], v[214:215]
    v_pk_mul_f32 v[128:129], v[128:129], v[228:229]
    v_pk_mul_f32 v[130:131], v[130:131], v[230:231]
    v_cvt_pk_bf16_f32 v132, v124, v125
    v_cvt_pk_bf16_f32 v133, v126, v127
    v_cvt_pk_bf16_f32 v134, v128, v129
    v_cvt_pk_bf16_f32 v135, v130, v131
    buffer_store_dwordx4 v[132:135], v1, s[20:23], s71 offen sc1
    v_lshrrev_b32 v52, 4, v0
    v_and_b32 v53, 15, v0
    s_sub_u32 s96, s76, 1
    v_sub_u32 v52, s96, v52
    v_lshlrev_b32 v52, 8, v52
    v_lshl_add_u32 v88, v53, 4, v52
    v_add_u32 v89, -1024, v88
    v_add_u32 v90, -2048, v88
    v_add_u32 v91, -3072, v88
    s_movk_i32 s96, 0x1000
    v_cmp_gt_u32 vcc, s96, v88
    s_nop 1
    v_cndmask_b32 v92, 0, v36, vcc
    v_cmp_gt_u32 vcc, s96, v89
    s_nop 1
    v_cndmask_b32 v93, 0, v36, vcc
    v_cmp_gt_u32 vcc, s96, v90
    s_nop 1
    v_cndmask_b32 v94, 0, v36, vcc
    v_cmp_gt_u32 vcc, s96, v91
    s_nop 1
    v_cndmask_b32 v95, 0, v36, vcc
    v_mov_b32 v56, v45
    v_mov_b32 v57, v45
    v_mov_b32 v60, v47
    v_mov_b32 v61, v47
    v_permlane16_swap_b32 v56, v57
    s_nop 0
    v_permlane16_swap_b32 v60, v61
    v_mov_b32 v58, v56
    v_mov_b32 v62, v60
    s_nop 0
    v_permlane32_swap_b32 v56, v58
    v_permlane32_swap_b32 v60, v62
    v_mov_b32 v59, v57
    v_mov_b32 v63, v61
    s_nop 0
    v_permlane32_swap_b32 v57, v59
    v_permlane32_swap_b32 v61, v63
    v_fma_f32 v57, v56, v240, v57
    v_fma_f32 v61, v56, v241, v61
    v_fma_f32 v57, -v60, v241, v57
    v_fmac_f32 v61, v60, v240
    v_fma_f32 v58, v57, v240, v58
    v_fma_f32 v62, v57, v241, v62
    v_fma_f32 v58, -v61, v241, v58
    v_fmac_f32 v62, v61, v240
    s_mov_b32 vcc_lo, 0xffff0000
    s_mov_b32 vcc_hi, 0
    v_cndmask_b32 v64, 0, v56, vcc
    v_cndmask_b32 v65, 0, v60, vcc
    s_mov_b32 vcc_lo, 0
    s_mov_b32 vcc_hi, 0xffff
    v_cndmask_b32 v64, v64, v57, vcc
    v_cndmask_b32 v65, v65, v61, vcc
    s_mov_b32 vcc_lo, 0
    s_mov_b32 vcc_hi, 0xffff0000
    v_cndmask_b32 v64, v64, v58, vcc
    v_cndmask_b32 v65, v65, v62, vcc
    v_mul_f32 v106, v236, v64
    v_mul_f32 v107, v237, v64
    v_fma_f32 v106, -v237, v65, v106
    v_fma_f32 v107, -v236, v65, -v107
    v_pk_mul_f32 v[68:69], v[136:137], v[236:237] op_sel:[0,1] op_sel_hi:[1,1]
    buffer_load_dwordx4 v[84:87], v91, s[72:75], 0 offen sc1
    v_pk_mul_f32 v[136:137], v[136:137], v[236:237] op_sel_hi:[1,0]
    v_pk_fma_f32 v[136:137], v[168:169], v[236:237], v[136:137] op_sel:[0,1,0] op_sel_hi:[1,1,1] neg_lo:[0,1,0] neg_hi:[0,1,0]
    v_pk_fma_f32 v[168:169], v[168:169], v[236:237], v[68:69] op_sel_hi:[1,0,1] neg_lo:[0,1,1] neg_hi:[0,1,1]
    v_pk_mul_f32 v[68:69], v[138:139], v[236:237] op_sel:[0,1] op_sel_hi:[1,1]
    buffer_load_dwordx4 v[80:83], v90, s[72:75], 0 offen sc1
    v_pk_mul_f32 v[138:139], v[138:139], v[236:237] op_sel_hi:[1,0]
    v_pk_fma_f32 v[138:139], v[170:171], v[236:237], v[138:139] op_sel:[0,1,0] op_sel_hi:[1,1,1] neg_lo:[0,1,0] neg_hi:[0,1,0]
    v_pk_fma_f32 v[170:171], v[170:171], v[236:237], v[68:69] op_sel_hi:[1,0,1] neg_lo:[0,1,1] neg_hi:[0,1,1]
    v_pk_mul_f32 v[68:69], v[140:141], v[236:237] op_sel:[0,1] op_sel_hi:[1,1]
    buffer_load_dwordx4 v[76:79], v89, s[72:75], 0 offen sc1
    v_pk_mul_f32 v[140:141], v[140:141], v[236:237] op_sel_hi:[1,0]
    v_pk_fma_f32 v[140:141], v[172:173], v[236:237], v[140:141] op_sel:[0,1,0] op_sel_hi:[1,1,1] neg_lo:[0,1,0] neg_hi:[0,1,0]
    v_pk_fma_f32 v[172:173], v[172:173], v[236:237], v[68:69] op_sel_hi:[1,0,1] neg_lo:[0,1,1] neg_hi:[0,1,1]
    v_pk_mul_f32 v[68:69], v[142:143], v[236:237] op_sel:[0,1] op_sel_hi:[1,1]
    buffer_load_dwordx4 v[72:75], v88, s[72:75], 0 offen sc1
    v_pk_mul_f32 v[142:143], v[142:143], v[236:237] op_sel_hi:[1,0]
    v_pk_fma_f32 v[142:143], v[174:175], v[236:237], v[142:143] op_sel:[0,1,0] op_sel_hi:[1,1,1] neg_lo:[0,1,0] neg_hi:[0,1,0]
    v_pk_fma_f32 v[174:175], v[174:175], v[236:237], v[68:69] op_sel_hi:[1,0,1] neg_lo:[0,1,1] neg_hi:[0,1,1]
    v_pk_mul_f32 v[68:69], v[144:145], v[236:237] op_sel:[0,1] op_sel_hi:[1,1]
    s_waitcnt vmcnt(25)
    v_pk_mul_f32 v[144:145], v[144:145], v[236:237] op_sel_hi:[1,0]
    v_pk_fma_f32 v[144:145], v[176:177], v[236:237], v[144:145] op_sel:[0,1,0] op_sel_hi:[1,1,1] neg_lo:[0,1,0] neg_hi:[0,1,0]
    v_pk_fma_f32 v[176:177], v[176:177], v[236:237], v[68:69] op_sel_hi:[1,0,1] neg_lo:[0,1,1] neg_hi:[0,1,1]
    v_pk_mul_f32 v[68:69], v[146:147], v[236:237] op_sel:[0,1] op_sel_hi:[1,1]
    v_add_u32 v254, 122880, v38
    v_pk_mul_f32 v[146:147], v[146:147], v[236:237] op_sel_hi:[1,0]
    v_pk_fma_f32 v[146:147], v[178:179], v[236:237], v[146:147] op_sel:[0,1,0] op_sel_hi:[1,1,1] neg_lo:[0,1,0] neg_hi:[0,1,0]
    v_pk_fma_f32 v[178:179], v[178:179], v[236:237], v[68:69] op_sel_hi:[1,0,1] neg_lo:[0,1,1] neg_hi:[0,1,1]
    v_pk_mul_f32 v[68:69], v[148:149], v[236:237] op_sel:[0,1] op_sel_hi:[1,1]
    v_xor_b32 v255, 32, v254
    v_pk_mul_f32 v[148:149], v[148:149], v[236:237] op_sel_hi:[1,0]
    v_pk_fma_f32 v[148:149], v[180:181], v[236:237], v[148:149] op_sel:[0,1,0] op_sel_hi:[1,1,1] neg_lo:[0,1,0] neg_hi:[0,1,0]
    v_pk_fma_f32 v[180:181], v[180:181], v[236:237], v[68:69] op_sel_hi:[1,0,1] neg_lo:[0,1,1] neg_hi:[0,1,1]
    v_pk_mul_f32 v[68:69], v[150:151], v[236:237] op_sel:[0,1] op_sel_hi:[1,1]
    ds_read_b64_tr_b16 a[0:1], v254 offset:0
    v_pk_mul_f32 v[150:151], v[150:151], v[236:237] op_sel_hi:[1,0]
    v_pk_fma_f32 v[150:151], v[182:183], v[236:237], v[150:151] op_sel:[0,1,0] op_sel_hi:[1,1,1] neg_lo:[0,1,0] neg_hi:[0,1,0]
    v_pk_fma_f32 v[182:183], v[182:183], v[236:237], v[68:69] op_sel_hi:[1,0,1] neg_lo:[0,1,1] neg_hi:[0,1,1]
    v_pk_mul_f32 v[68:69], v[152:153], v[236:237] op_sel:[0,1] op_sel_hi:[1,1]
    ds_read_b64_tr_b16 a[2:3], v254 offset:2048
    v_pk_mul_f32 v[152:153], v[152:153], v[236:237] op_sel_hi:[1,0]
    v_pk_fma_f32 v[152:153], v[184:185], v[236:237], v[152:153] op_sel:[0,1,0] op_sel_hi:[1,1,1] neg_lo:[0,1,0] neg_hi:[0,1,0]
    v_pk_fma_f32 v[184:185], v[184:185], v[236:237], v[68:69] op_sel_hi:[1,0,1] neg_lo:[0,1,1] neg_hi:[0,1,1]
    v_pk_mul_f32 v[68:69], v[154:155], v[236:237] op_sel:[0,1] op_sel_hi:[1,1]
    ds_read_b64_tr_b16 a[4:5], v255 offset:0
    v_pk_mul_f32 v[154:155], v[154:155], v[236:237] op_sel_hi:[1,0]
    v_pk_fma_f32 v[154:155], v[186:187], v[236:237], v[154:155] op_sel:[0,1,0] op_sel_hi:[1,1,1] neg_lo:[0,1,0] neg_hi:[0,1,0]
    v_pk_fma_f32 v[186:187], v[186:187], v[236:237], v[68:69] op_sel_hi:[1,0,1] neg_lo:[0,1,1] neg_hi:[0,1,1]
    v_pk_mul_f32 v[68:69], v[156:157], v[236:237] op_sel:[0,1] op_sel_hi:[1,1]
    ds_read_b64_tr_b16 a[6:7], v255 offset:2048
    v_pk_mul_f32 v[156:157], v[156:157], v[236:237] op_sel_hi:[1,0]
    v_pk_fma_f32 v[156:157], v[188:189], v[236:237], v[156:157] op_sel:[0,1,0] op_sel_hi:[1,1,1] neg_lo:[0,1,0] neg_hi:[0,1,0]
    v_pk_fma_f32 v[188:189], v[188:189], v[236:237], v[68:69] op_sel_hi:[1,0,1] neg_lo:[0,1,1] neg_hi:[0,1,1]
    v_pk_mul_f32 v[68:69], v[158:159], v[236:237] op_sel:[0,1] op_sel_hi:[1,1]
    ds_read_b64_tr_b16 a[20:21], v254 offset:5120
    v_pk_mul_f32 v[158:159], v[158:159], v[236:237] op_sel_hi:[1,0]
    v_pk_fma_f32 v[158:159], v[190:191], v[236:237], v[158:159] op_sel:[0,1,0] op_sel_hi:[1,1,1] neg_lo:[0,1,0] neg_hi:[0,1,0]
    v_pk_fma_f32 v[190:191], v[190:191], v[236:237], v[68:69] op_sel_hi:[1,0,1] neg_lo:[0,1,1] neg_hi:[0,1,1]
    v_pk_mul_f32 v[68:69], v[160:161], v[236:237] op_sel:[0,1] op_sel_hi:[1,1]
    ds_read_b64_tr_b16 a[22:23], v254 offset:7168
    v_pk_mul_f32 v[160:161], v[160:161], v[236:237] op_sel_hi:[1,0]
    v_pk_fma_f32 v[160:161], v[192:193], v[236:237], v[160:161] op_sel:[0,1,0] op_sel_hi:[1,1,1] neg_lo:[0,1,0] neg_hi:[0,1,0]
    v_pk_fma_f32 v[192:193], v[192:193], v[236:237], v[68:69] op_sel_hi:[1,0,1] neg_lo:[0,1,1] neg_hi:[0,1,1]
    v_pk_mul_f32 v[68:69], v[162:163], v[236:237] op_sel:[0,1] op_sel_hi:[1,1]
    ds_read_b64_tr_b16 a[24:25], v255 offset:5120
    v_pk_mul_f32 v[162:163], v[162:163], v[236:237] op_sel_hi:[1,0]
    v_pk_fma_f32 v[162:163], v[194:195], v[236:237], v[162:163] op_sel:[0,1,0] op_sel_hi:[1,1,1] neg_lo:[0,1,0] neg_hi:[0,1,0]
    v_pk_fma_f32 v[194:195], v[194:195], v[236:237], v[68:69] op_sel_hi:[1,0,1] neg_lo:[0,1,1] neg_hi:[0,1,1]
    v_pk_mul_f32 v[68:69], v[164:165], v[236:237] op_sel:[0,1] op_sel_hi:[1,1]
    ds_read_b64_tr_b16 a[26:27], v255 offset:7168
    v_pk_mul_f32 v[164:165], v[164:165], v[236:237] op_sel_hi:[1,0]
    v_pk_fma_f32 v[164:165], v[196:197], v[236:237], v[164:165] op_sel:[0,1,0] op_sel_hi:[1,1,1] neg_lo:[0,1,0] neg_hi:[0,1,0]
    v_pk_fma_f32 v[196:197], v[196:197], v[236:237], v[68:69] op_sel_hi:[1,0,1] neg_lo:[0,1,1] neg_hi:[0,1,1]
    v_pk_mul_f32 v[68:69], v[166:167], v[236:237] op_sel:[0,1] op_sel_hi:[1,1]
    v_xor_b32 v254, 64, v254
    v_pk_mul_f32 v[166:167], v[166:167], v[236:237] op_sel_hi:[1,0]
    v_pk_fma_f32 v[166:167], v[198:199], v[236:237], v[166:167] op_sel:[0,1,0] op_sel_hi:[1,1,1] neg_lo:[0,1,0] neg_hi:[0,1,0]
    v_pk_fma_f32 v[198:199], v[198:199], v[236:237], v[68:69] op_sel_hi:[1,0,1] neg_lo:[0,1,1] neg_hi:[0,1,1]
    v_xor_b32 v255, 64, v255
    ds_read_b64_tr_b16 a[8:9], v254 offset:0
    ds_read_b64_tr_b16 a[10:11], v254 offset:2048
    ds_read_b64_tr_b16 a[12:13], v255 offset:0
    ds_read_b64_tr_b16 a[14:15], v255 offset:2048
    ds_read_b64_tr_b16 a[28:29], v254 offset:5120
    ds_read_b64_tr_b16 a[30:31], v254 offset:7168
    ds_read_b64_tr_b16 a[32:33], v255 offset:5120
    ds_read_b64_tr_b16 a[34:35], v255 offset:7168
    s_waitcnt lgkmcnt(0)
    s_mul_i32 s96, s92, 81920
    s_add_u32 s91, s91, s96
    s_cmp_ge_u32 s91, s55
    s_cselect_b32 s96, 491520, 0
    s_sub_u32 s91, s91, s96
    s_mov_b32 s62, s91
    s_add_u32 m0, s63, 122880
    s_nop 0
    buffer_load_dwordx4 v248, s[36:39], s62 offen offset:0  lds
    buffer_load_dwordx4 v249, s[36:39], s62 offen offset:1024  lds
    buffer_load_dwordx4 v250, s[36:39], s62 offen offset:2048  lds
    buffer_load_dwordx4 v251, s[36:39], s62 offen offset:3072  lds
    s_add_u32 s62, s62, s64
    s_add_u32 m0, s63, 128000
    s_nop 0
    buffer_load_dwordx4 v248, s[36:39], s62 offen offset:0  lds
    buffer_load_dwordx4 v249, s[36:39], s62 offen offset:1024  lds
    buffer_load_dwordx4 v250, s[36:39], s62 offen offset:2048  lds
    s_add_u32 s62, s62, s53
    buffer_load_dwordx4 v251, s[36:39], s62 offen offset:3072  lds
    s_lshr_b32 s70, s90, 2
    s_mul_i32 s70, s70, 6144
    s_mul_i32 s96, s3, 1536
    s_add_u32 s70, s70, s96
    s_add_u32 s70, s70, 24543232
    v_min_u32 v28, 11, v0
    v_lshlrev_b32 v28, 7, v28
    s_mov_b32 s79, s70
    buffer_load_dwordx2 v[30:31], v28, s[20:23], s79 offen sc1
    s_mul_i32 s96, s3, 8448
    v_lshrrev_b32 v52, 4, v0
    v_mul_u32_u24 v104, 264, v53
    v_lshl_add_u32 v104, v52, 6, v104
    v_add_u32 v104, s96, v104
    v_lshrrev_b32 v105, 2, v0
    v_mul_u32_u24 v105, 264, v105
    v_and_b32 v52, 3, v0
    v_lshl_add_u32 v105, v52, 6, v105
    v_add_u32 v105, s96, v105
    v_sub_f32 v108, 0, v234
    s_waitcnt vmcnt(9)
L_lb01:
    v_xor_b32 v70, v73, v92
    v_bitop3_b32 v70, v70, v75, v92 bitop3:0xf6
    v_bitop3_b32 v70, v70, v77, v93 bitop3:0xf6
    v_bitop3_b32 v70, v70, v79, v93 bitop3:0xf6
    v_bitop3_b32 v70, v70, v81, v94 bitop3:0xf6
    v_bitop3_b32 v70, v70, v83, v94 bitop3:0xf6
    v_bitop3_b32 v70, v70, v85, v95 bitop3:0xf6
    v_bitop3_b32 v70, v70, v87, v95 bitop3:0xf6
    s_mov_b64 exec, 1
    buffer_store_dwordx2 v[36:37], v34, s[20:23], s1 offen offset:0 sc1
    s_mov_b64 exec, -1
    v_cmp_ne_u32 vcc, 0, v70
    s_nop 1
    s_cmp_lg_u64 vcc, 0
    s_cbranch_scc1 L_lbslow01
    v_fma_f32 v80, v84, v244, v80
    v_fma_f32 v82, v84, v245, v82
    v_fma_f32 v80, -v86, v245, v80
    v_fmac_f32 v82, v86, v244
    v_fma_f32 v76, v80, v244, v76
    v_fma_f32 v78, v80, v245, v78
    v_fma_f32 v76, -v82, v245, v76
    v_fmac_f32 v78, v82, v244
    v_fma_f32 v72, v76, v244, v72
    v_fma_f32 v74, v76, v245, v74
    v_fma_f32 v72, -v78, v245, v72
    v_fmac_f32 v74, v78, v244
    v_mul_f32 v70, v72, v246
    v_mul_f32 v71, v72, v247
    v_fma_f32 v70, -v74, v247, v70
    v_fmac_f32 v71, v74, v246
    s_nop 1
    v_permlane16_swap_b32 v70, v71
    v_add_f32 v70, v70, v71
    v_mov_b32 v71, v70
    s_nop 1
    v_permlane32_swap_b32 v70, v71
    v_add_f32 v70, v70, v71
    v_mov_b32 v71, v70
    s_nop 1
    v_permlane16_swap_b32 v70, v71
    v_fmac_f32 v106, v242, v70
    v_fma_f32 v107, -v242, v71, v107
    v_fma_f32 v106, -v243, v71, v106
    v_fma_f32 v107, -v243, v70, v107
    v_fmac_f32 v136, v232, v106
    v_fmac_f32 v168, v232, v107
    v_fmac_f32 v136, v234, v107
    v_fmac_f32 v168, v108, v106
    v_fmac_f32 v137, v232, v136
    v_fmac_f32 v169, v232, v168
    v_fmac_f32 v137, v234, v168
    v_fmac_f32 v169, v108, v136
    v_cvt_pk_bf16_f32 v40, v136, v137
    v_cvt_pk_bf16_f32 v56, v168, v169
    v_fmac_f32 v138, v232, v137
    v_fmac_f32 v170, v232, v169
    v_fmac_f32 v138, v234, v169
    v_fmac_f32 v170, v108, v137
    v_fmac_f32 v139, v232, v138
    v_fmac_f32 v171, v232, v170
    v_fmac_f32 v139, v234, v170
    v_fmac_f32 v171, v108, v138
    v_cvt_pk_bf16_f32 v41, v138, v139
    v_cvt_pk_bf16_f32 v57, v170, v171
    ds_write_b64 v104, v[40:41] offset:0
    ds_write_b64 v104, v[56:57] offset:4224
    v_fmac_f32 v140, v232, v139
    v_fmac_f32 v172, v232, v171
    v_fmac_f32 v140, v234, v171
    v_fmac_f32 v172, v108, v139
    v_fmac_f32 v141, v232, v140
    v_fmac_f32 v173, v232, v172
    v_fmac_f32 v141, v234, v172
    v_fmac_f32 v173, v108, v140
    v_cvt_pk_bf16_f32 v42, v140, v141
    v_cvt_pk_bf16_f32 v58, v172, v173
    v_fmac_f32 v142, v232, v141
    v_fmac_f32 v174, v232, v173
    v_fmac_f32 v142, v234, v173
    v_fmac_f32 v174, v108, v141
    v_fmac_f32 v143, v232, v142
    v_fmac_f32 v175, v232, v174
    v_fmac_f32 v143, v234, v174
    v_fmac_f32 v175, v108, v142
    v_cvt_pk_bf16_f32 v43, v142, v143
    v_cvt_pk_bf16_f32 v59, v174, v175
    ds_write_b64 v104, v[42:43] offset:8
    ds_write_b64 v104, v[58:59] offset:4232
    v_fmac_f32 v144, v232, v143
    v_fmac_f32 v176, v232, v175
    v_fmac_f32 v144, v234, v175
    v_fmac_f32 v176, v108, v143
    v_fmac_f32 v145, v232, v144
    v_fmac_f32 v177, v232, v176
    v_fmac_f32 v145, v234, v176
    v_fmac_f32 v177, v108, v144
    v_cvt_pk_bf16_f32 v44, v144, v145
    v_cvt_pk_bf16_f32 v60, v176, v177
    ds_read_b64_tr_b16 v[72:73], v105 offset:0
    ds_read_b64_tr_b16 v[74:75], v105 offset:4224
    v_fmac_f32 v146, v232, v145
    v_fmac_f32 v178, v232, v177
    v_fmac_f32 v146, v234, v177
    v_fmac_f32 v178, v108, v145
    v_fmac_f32 v147, v232, v146
    v_fmac_f32 v179, v232, v178
    v_fmac_f32 v147, v234, v178
    v_fmac_f32 v179, v108, v146
    v_cvt_pk_bf16_f32 v45, v146, v147
    v_cvt_pk_bf16_f32 v61, v178, v179
    ds_write_b64 v104, v[44:45] offset:16
    ds_write_b64 v104, v[60:61] offset:4240
    v_fmac_f32 v148, v232, v147
    v_fmac_f32 v180, v232, v179
    v_fmac_f32 v148, v234, v179
    v_fmac_f32 v180, v108, v147
    v_fmac_f32 v149, v232, v148
    v_fmac_f32 v181, v232, v180
    v_fmac_f32 v149, v234, v180
    v_fmac_f32 v181, v108, v148
    v_cvt_pk_bf16_f32 v46, v148, v149
    v_cvt_pk_bf16_f32 v62, v180, v181
    ds_read_b64_tr_b16 v[76:77], v105 offset:8
    ds_read_b64_tr_b16 v[78:79], v105 offset:4232
    v_fmac_f32 v150, v232, v149
    v_fmac_f32 v182, v232, v181
    v_fmac_f32 v150, v234, v181
    v_fmac_f32 v182, v108, v149
    s_add_u32 s71, s34, 0
    s_waitcnt lgkmcnt(4)
    buffer_store_dwordx4 v[72:75], v1, s[20:23], s71 offen sc1
    v_fmac_f32 v151, v232, v150
    v_fmac_f32 v183, v232, v182
    v_fmac_f32 v151, v234, v182
    v_fmac_f32 v183, v108, v150
    v_cvt_pk_bf16_f32 v47, v150, v151
    v_cvt_pk_bf16_f32 v63, v182, v183
    ds_write_b64 v104, v[46:47] offset:24
    ds_write_b64 v104, v[62:63] offset:4248
    v_fmac_f32 v152, v232, v151
    v_fmac_f32 v184, v232, v183
    v_fmac_f32 v152, v234, v183
    v_fmac_f32 v184, v108, v151
    v_fmac_f32 v153, v232, v152
    v_fmac_f32 v185, v232, v184
    v_fmac_f32 v153, v234, v184
    v_fmac_f32 v185, v108, v152
    v_cvt_pk_bf16_f32 v48, v152, v153
    v_cvt_pk_bf16_f32 v64, v184, v185
    ds_read_b64_tr_b16 v[80:81], v105 offset:16
    ds_read_b64_tr_b16 v[82:83], v105 offset:4240
    v_fmac_f32 v154, v232, v153
    v_fmac_f32 v186, v232, v185
    v_fmac_f32 v154, v234, v185
    v_fmac_f32 v186, v108, v153
    s_add_u32 s71, s34, 40960
    s_waitcnt lgkmcnt(4)
    buffer_store_dwordx4 v[76:79], v1, s[20:23], s71 offen sc1
    v_fmac_f32 v155, v232, v154
    v_fmac_f32 v187, v232, v186
    v_fmac_f32 v155, v234, v186
    v_fmac_f32 v187, v108, v154
    v_cvt_pk_bf16_f32 v49, v154, v155
    v_cvt_pk_bf16_f32 v65, v186, v187
    ds_write_b64 v104, v[48:49] offset:32
    ds_write_b64 v104, v[64:65] offset:4256
    v_fmac_f32 v156, v232, v155
    v_fmac_f32 v188, v232, v187
    v_fmac_f32 v156, v234, v187
    v_fmac_f32 v188, v108, v155
    v_fmac_f32 v157, v232, v156
    v_fmac_f32 v189, v232, v188
    v_fmac_f32 v157, v234, v188
    v_fmac_f32 v189, v108, v156
    v_cvt_pk_bf16_f32 v50, v156, v157
    v_cvt_pk_bf16_f32 v66, v188, v189
    ds_read_b64_tr_b16 v[84:85], v105 offset:24
    ds_read_b64_tr_b16 v[86:87], v105 offset:4248
    v_fmac_f32 v158, v232, v157
    v_fmac_f32 v190, v232, v189
    v_fmac_f32 v158, v234, v189
    v_fmac_f32 v190, v108, v157
    s_add_u32 s71, s34, 81920
    s_waitcnt lgkmcnt(4)
    buffer_store_dwordx4 v[80:83], v1, s[20:23], s71 offen sc1
    v_fmac_f32 v159, v232, v158
    v_fmac_f32 v191, v232, v190
    v_fmac_f32 v159, v234, v190
    v_fmac_f32 v191, v108, v158
    v_cvt_pk_bf16_f32 v51, v158, v159
    v_cvt_pk_bf16_f32 v67, v190, v191
    ds_write_b64 v104, v[50:51] offset:40
    ds_write_b64 v104, v[66:67] offset:4264
    v_fmac_f32 v160, v232, v159
    v_fmac_f32 v192, v232, v191
    v_fmac_f32 v160, v234, v191
    v_fmac_f32 v192, v108, v159
    v_fmac_f32 v161, v232, v160
    v_fmac_f32 v193, v232, v192
    v_fmac_f32 v161, v234, v192
    v_fmac_f32 v193, v108, v160
    v_cvt_pk_bf16_f32 v52, v160, v161
    v_cvt_pk_bf16_f32 v68, v192, v193
    ds_read_b64_tr_b16 v[88:89], v105 offset:32
    ds_read_b64_tr_b16 v[90:91], v105 offset:4256
    v_fmac_f32 v162, v232, v161
    v_fmac_f32 v194, v232, v193
    v_fmac_f32 v162, v234, v193
    v_fmac_f32 v194, v108, v161
    s_add_u32 s71, s34, 122880
    s_waitcnt lgkmcnt(4)
    buffer_store_dwordx4 v[84:87], v1, s[20:23], s71 offen sc1
    v_fmac_f32 v163, v232, v162
    v_fmac_f32 v195, v232, v194
    v_fmac_f32 v163, v234, v194
    v_fmac_f32 v195, v108, v162
    v_cvt_pk_bf16_f32 v53, v162, v163
    v_cvt_pk_bf16_f32 v69, v194, v195
    ds_write_b64 v104, v[52:53] offset:48
    ds_write_b64 v104, v[68:69] offset:4272
    v_fmac_f32 v164, v232, v163
    v_fmac_f32 v196, v232, v195
    v_fmac_f32 v164, v234, v195
    v_fmac_f32 v196, v108, v163
    v_fmac_f32 v165, v232, v164
    v_fmac_f32 v197, v232, v196
    v_fmac_f32 v165, v234, v196
    v_fmac_f32 v197, v108, v164
    v_cvt_pk_bf16_f32 v54, v164, v165
    v_cvt_pk_bf16_f32 v70, v196, v197
    ds_read_b64_tr_b16 v[92:93], v105 offset:40
    ds_read_b64_tr_b16 v[94:95], v105 offset:4264
    v_fmac_f32 v166, v232, v165
    v_fmac_f32 v198, v232, v197
    v_fmac_f32 v166, v234, v197
    v_fmac_f32 v198, v108, v165
    s_add_u32 s71, s34, 163840
    s_waitcnt lgkmcnt(4)
    buffer_store_dwordx4 v[88:91], v1, s[20:23], s71 offen sc1
    v_fmac_f32 v167, v232, v166
    v_fmac_f32 v199, v232, v198
    v_fmac_f32 v167, v234, v198
    v_fmac_f32 v199, v108, v166
    v_cvt_pk_bf16_f32 v55, v166, v167
    v_cvt_pk_bf16_f32 v71, v198, v199
    ds_write_b64 v104, v[54:55] offset:56
    ds_write_b64 v104, v[70:71] offset:4280
    ds_read_b64_tr_b16 v[96:97], v105 offset:48
    ds_read_b64_tr_b16 v[98:99], v105 offset:4272
    ds_read_b64_tr_b16 v[100:101], v105 offset:56
    ds_read_b64_tr_b16 v[102:103], v105 offset:4280
    s_add_u32 s71, s34, 204800
    s_waitcnt lgkmcnt(6)
    buffer_store_dwordx4 v[92:95], v1, s[20:23], s71 offen sc1
    s_add_u32 s71, s34, 245760
    s_waitcnt lgkmcnt(2)
    buffer_store_dwordx4 v[96:99], v1, s[20:23], s71 offen sc1
    s_add_u32 s71, s34, 286720
    s_waitcnt lgkmcnt(0)
    buffer_store_dwordx4 v[100:103], v1, s[20:23], s71 offen sc1
    s_branch L_xep21
L_xep11:
    v_and_b32 v50, 15, v0
    v_bfe_u32 v51, v0, 4, 1
    v_lshlrev_b32 v50, 4, v50
    v_lshl_add_u32 v50, v51, 3, v50
    s_lshl_b32 s70, s76, 8
    v_pk_fma_f32 v[44:45], v[152:153], v[232:233], v[154:155] op_sel:[0,1,0] op_sel_hi:[1,1,1]
    v_pk_fma_f32 v[46:47], v[184:185], v[232:233], v[186:187] op_sel:[0,1,0] op_sel_hi:[1,1,1]
    v_pk_fma_f32 v[44:45], v[184:185], v[234:235], v[44:45] op_sel:[0,1,0] op_sel_hi:[1,1,1] neg_lo:[0,1,0] neg_hi:[0,1,0]
    v_pk_fma_f32 v[46:47], v[152:153], v[234:235], v[46:47] op_sel:[0,1,0] op_sel_hi:[1,1,1]
    v_pk_fma_f32 v[40:41], v[44:45], v[232:233], v[156:157] op_sel:[0,1,0] op_sel_hi:[1,1,1]
    v_pk_fma_f32 v[42:43], v[46:47], v[232:233], v[188:189] op_sel:[0,1,0] op_sel_hi:[1,1,1]
    v_pk_fma_f32 v[40:41], v[46:47], v[234:235], v[40:41] op_sel:[0,1,0] op_sel_hi:[1,1,1] neg_lo:[0,1,0] neg_hi:[0,1,0]
    v_pk_fma_f32 v[42:43], v[44:45], v[234:235], v[42:43] op_sel:[0,1,0] op_sel_hi:[1,1,1]
    v_pk_fma_f32 v[44:45], v[40:41], v[232:233], v[158:159] op_sel:[0,1,0] op_sel_hi:[1,1,1]
    v_pk_fma_f32 v[46:47], v[42:43], v[232:233], v[190:191] op_sel:[0,1,0] op_sel_hi:[1,1,1]
    v_pk_fma_f32 v[44:45], v[42:43], v[234:235], v[44:45] op_sel:[0,1,0] op_sel_hi:[1,1,1] neg_lo:[0,1,0] neg_hi:[0,1,0]
    v_pk_fma_f32 v[46:47], v[40:41], v[234:235], v[46:47] op_sel:[0,1,0] op_sel_hi:[1,1,1]
    v_pk_fma_f32 v[40:41], v[44:45], v[232:233], v[160:161] op_sel:[0,1,0] op_sel_hi:[1,1,1]
    v_pk_fma_f32 v[42:43], v[46:47], v[232:233], v[192:193] op_sel:[0,1,0] op_sel_hi:[1,1,1]
    v_pk_fma_f32 v[40:41], v[46:47], v[234:235], v[40:41] op_sel:[0,1,0] op_sel_hi:[1,1,1] neg_lo:[0,1,0] neg_hi:[0,1,0]
    v_pk_fma_f32 v[42:43], v[44:45], v[234:235], v[42:43] op_sel:[0,1,0] op_sel_hi:[1,1,1]
    v_pk_fma_f32 v[44:45], v[40:41], v[232:233], v[162:163] op_sel:[0,1,0] op_sel_hi:[1,1,1]
    v_pk_fma_f32 v[46:47], v[42:43], v[232:233], v[194:195] op_sel:[0,1,0] op_sel_hi:[1,1,1]
    v_pk_fma_f32 v[44:45], v[42:43], v[234:235], v[44:45] op_sel:[0,1,0] op_sel_hi:[1,1,1] neg_lo:[0,1,0] neg_hi:[0,1,0]
    v_pk_fma_f32 v[46:47], v[40:41], v[234:235], v[46:47] op_sel:[0,1,0] op_sel_hi:[1,1,1]
    v_pk_fma_f32 v[40:41], v[44:45], v[232:233], v[164:165] op_sel:[0,1,0] op_sel_hi:[1,1,1]
    v_pk_fma_f32 v[42:43], v[46:47], v[232:233], v[196:197] op_sel:[0,1,0] op_sel_hi:[1,1,1]
    v_pk_fma_f32 v[40:41], v[46:47], v[234:235], v[40:41] op_sel:[0,1,0] op_sel_hi:[1,1,1] neg_lo:[0,1,0] neg_hi:[0,1,0]
    v_pk_fma_f32 v[42:43], v[44:45], v[234:235], v[42:43] op_sel:[0,1,0] op_sel_hi:[1,1,1]
    v_pk_fma_f32 v[44:45], v[40:41], v[232:233], v[166:167] op_sel:[0,1,0] op_sel_hi:[1,1,1]
    v_pk_fma_f32 v[46:47], v[42:43], v[232:233], v[198:199] op_sel:[0,1,0] op_sel_hi:[1,1,1]
    v_pk_fma_f32 v[44:45], v[42:43], v[234:235], v[44:45] op_sel:[0,1,0] op_sel_hi:[1,1,1] neg_lo:[0,1,0] neg_hi:[0,1,0]
    v_pk_fma_f32 v[46:47], v[40:41], v[234:235], v[46:47] op_sel:[0,1,0] op_sel_hi:[1,1,1]
    v_pk_fma_f32 v[40:41], v[44:45], v[232:233], v[136:137] op_sel:[0,1,0] op_sel_hi:[1,1,1]
    v_pk_fma_f32 v[42:43], v[46:47], v[232:233], v[168:169] op_sel:[0,1,0] op_sel_hi:[1,1,1]
    v_pk_fma_f32 v[40:41], v[46:47], v[234:235], v[40:41] op_sel:[0,1,0] op_sel_hi:[1,1,1] neg_lo:[0,1,0] neg_hi:[0,1,0]
    v_pk_fma_f32 v[42:43], v[44:45], v[234:235], v[42:43] op_sel:[0,1,0] op_sel_hi:[1,1,1]
    v_pk_fma_f32 v[44:45], v[40:41], v[232:233], v[138:139] op_sel:[0,1,0] op_sel_hi:[1,1,1]
    v_pk_fma_f32 v[46:47], v[42:43], v[232:233], v[170:171] op_sel:[0,1,0] op_sel_hi:[1,1,1]
    v_pk_fma_f32 v[44:45], v[42:43], v[234:235], v[44:45] op_sel:[0,1,0] op_sel_hi:[1,1,1] neg_lo:[0,1,0] neg_hi:[0,1,0]
    v_pk_fma_f32 v[46:47], v[40:41], v[234:235], v[46:47] op_sel:[0,1,0] op_sel_hi:[1,1,1]
    v_pk_fma_f32 v[40:41], v[44:45], v[232:233], v[140:141] op_sel:[0,1,0] op_sel_hi:[1,1,1]
    v_pk_fma_f32 v[42:43], v[46:47], v[232:233], v[172:173] op_sel:[0,1,0] op_sel_hi:[1,1,1]
    v_pk_fma_f32 v[40:41], v[46:47], v[234:235], v[40:41] op_sel:[0,1,0] op_sel_hi:[1,1,1] neg_lo:[0,1,0] neg_hi:[0,1,0]
    v_pk_fma_f32 v[42:43], v[44:45], v[234:235], v[42:43] op_sel:[0,1,0] op_sel_hi:[1,1,1]
    v_pk_fma_f32 v[44:45], v[40:41], v[232:233], v[142:143] op_sel:[0,1,0] op_sel_hi:[1,1,1]
    v_pk_fma_f32 v[46:47], v[42:43], v[232:233], v[174:175] op_sel:[0,1,0] op_sel_hi:[1,1,1]
    v_pk_fma_f32 v[44:45], v[42:43], v[234:235], v[44:45] op_sel:[0,1,0] op_sel_hi:[1,1,1] neg_lo:[0,1,0] neg_hi:[0,1,0]
    v_pk_fma_f32 v[46:47], v[40:41], v[234:235], v[46:47] op_sel:[0,1,0] op_sel_hi:[1,1,1]
    v_pk_fma_f32 v[40:41], v[44:45], v[232:233], v[144:145] op_sel:[0,1,0] op_sel_hi:[1,1,1]
    v_pk_fma_f32 v[42:43], v[46:47], v[232:233], v[176:177] op_sel:[0,1,0] op_sel_hi:[1,1,1]
    v_pk_fma_f32 v[40:41], v[46:47], v[234:235], v[40:41] op_sel:[0,1,0] op_sel_hi:[1,1,1] neg_lo:[0,1,0] neg_hi:[0,1,0]
    v_pk_fma_f32 v[42:43], v[44:45], v[234:235], v[42:43] op_sel:[0,1,0] op_sel_hi:[1,1,1]
    v_pk_fma_f32 v[44:45], v[40:41], v[232:233], v[146:147] op_sel:[0,1,0] op_sel_hi:[1,1,1]
    v_pk_fma_f32 v[46:47], v[42:43], v[232:233], v[178:179] op_sel:[0,1,0] op_sel_hi:[1,1,1]
    v_pk_fma_f32 v[44:45], v[42:43], v[234:235], v[44:45] op_sel:[0,1,0] op_sel_hi:[1,1,1] neg_lo:[0,1,0] neg_hi:[0,1,0]
    v_pk_fma_f32 v[46:47], v[40:41], v[234:235], v[46:47] op_sel:[0,1,0] op_sel_hi:[1,1,1]
    v_pk_fma_f32 v[40:41], v[44:45], v[232:233], v[148:149] op_sel:[0,1,0] op_sel_hi:[1,1,1]
    v_pk_fma_f32 v[42:43], v[46:47], v[232:233], v[180:181] op_sel:[0,1,0] op_sel_hi:[1,1,1]
    v_pk_fma_f32 v[40:41], v[46:47], v[234:235], v[40:41] op_sel:[0,1,0] op_sel_hi:[1,1,1] neg_lo:[0,1,0] neg_hi:[0,1,0]
    v_pk_fma_f32 v[42:43], v[44:45], v[234:235], v[42:43] op_sel:[0,1,0] op_sel_hi:[1,1,1]
    v_pk_fma_f32 v[44:45], v[40:41], v[232:233], v[150:151] op_sel:[0,1,0] op_sel_hi:[1,1,1]
    v_pk_fma_f32 v[46:47], v[42:43], v[232:233], v[182:183] op_sel:[0,1,0] op_sel_hi:[1,1,1]
    v_pk_fma_f32 v[44:45], v[42:43], v[234:235], v[44:45] op_sel:[0,1,0] op_sel_hi:[1,1,1] neg_lo:[0,1,0] neg_hi:[0,1,0]
    v_pk_fma_f32 v[46:47], v[40:41], v[234:235], v[46:47] op_sel:[0,1,0] op_sel_hi:[1,1,1]
    v_fma_f32 v45, v44, v232, v45
    v_fma_f32 v47, v44, v234, v47
    v_fma_f32 v45, -v46, v234, v45
    v_fmac_f32 v47, v46, v232
    v_mul_f32 v40, v45, v238
    v_mul_f32 v41, v45, v239
    v_fma_f32 v40, -v47, v239, v40
    v_fmac_f32 v41, v47, v238
    s_nop 1
    v_permlane16_swap_b32 v40, v41
    v_add_f32 v40, v40, v41
    v_mov_b32 v41, v40
    s_nop 1
    v_permlane32_swap_b32 v40, v41
    v_add_f32 v48, v40, v41
    v_mov_b32 v49, s88
    s_mov_b32 exec_hi, 0
    buffer_store_dwordx2 v[48:49], v50, s[72:75], s70 offen sc1
    s_mov_b32 exec_hi, -1
    s_mov_b32 s84, 0xbfb8aa3b
    s_mov_b32 s85, 0xbfb8aa3b
    v_pk_mul_f32 v[112:113], v[200:201], s[84:85]
    v_pk_mul_f32 v[114:115], v[202:203], s[84:85]
    buffer_load_dwordx4 v249, s[36:39], s62 offen offset:1024  lds
    s_add_u32 s71, s0, 0
    v_pk_mul_f32 v[116:117], v[216:217], s[84:85]
    v_pk_mul_f32 v[118:119], v[218:219], s[84:85]
    v_exp_f32 v112, v112
    buffer_load_dwordx4 v250, s[36:39], s62 offen offset:2048  lds
    v_exp_f32 v113, v113
    v_exp_f32 v114, v114
    v_exp_f32 v115, v115
    v_exp_f32 v116, v116
    s_add_u32 s62, s62, s53
    buffer_load_dwordx4 v251, s[36:39], s62 offen offset:3072  lds
    v_exp_f32 v117, v117
    v_exp_f32 v118, v118
    v_exp_f32 v119, v119
    v_pk_add_f32 v[112:113], v[112:113], 1.0 op_sel_hi:[1,0]
    v_pk_add_f32 v[114:115], v[114:115], 1.0 op_sel_hi:[1,0]
    v_pk_add_f32 v[116:117], v[116:117], 1.0 op_sel_hi:[1,0]
    v_pk_add_f32 v[118:119], v[118:119], 1.0 op_sel_hi:[1,0]
    v_rcp_f32 v112, v112
    v_rcp_f32 v113, v113
    v_rcp_f32 v114, v114
    v_rcp_f32 v115, v115
    v_rcp_f32 v116, v116
    v_rcp_f32 v117, v117
    v_rcp_f32 v118, v118
    v_rcp_f32 v119, v119
    v_pk_mul_f32 v[112:113], v[112:113], v[200:201]
    v_pk_mul_f32 v[114:115], v[114:115], v[202:203]
    v_pk_mul_f32 v[116:117], v[116:117], v[216:217]
    v_pk_mul_f32 v[118:119], v[118:119], v[218:219]
    v_cvt_pk_bf16_f32 v120, v112, v113
    v_cvt_pk_bf16_f32 v121, v114, v115
    v_cvt_pk_bf16_f32 v122, v116, v117
    v_cvt_pk_bf16_f32 v123, v118, v119
    buffer_store_dwordx4 v[120:123], v1, s[20:23], s71 offen sc1
    v_pk_mul_f32 v[124:125], v[204:205], s[84:85]
    v_pk_mul_f32 v[126:127], v[206:207], s[84:85]
    s_add_u32 m0, s63, 50176
    s_nop 0
    s_cmp_eq_u32 s92, 1
    s_cbranch_scc1 L_s510
    buffer_load_dwordx4 v253, s[36:39], s62 offen offset:0  lds
L_s510:
    s_add_u32 s71, s0, 49152
    v_pk_mul_f32 v[128:129], v[220:221], s[84:85]
    v_pk_mul_f32 v[130:131], v[222:223], s[84:85]
    v_exp_f32 v124, v124
    s_add_u32 s91, s91, s65
    s_cmp_ge_u32 s91, s55
    s_cselect_b32 s96, 491520, 0
    s_sub_u32 s91, s91, s96
    s_mov_b32 s62, s91
    s_add_u32 m0, s63, 81920
    s_nop 0
    buffer_load_dwordx4 v248, s[28:31], s62 offen offset:0  lds
    v_exp_f32 v125, v125
    v_exp_f32 v126, v126
    v_exp_f32 v127, v127
    v_exp_f32 v128, v128
    buffer_load_dwordx4 v249, s[28:31], s62 offen offset:1024  lds
    v_exp_f32 v129, v129
    v_exp_f32 v130, v130
    v_exp_f32 v131, v131
    v_pk_add_f32 v[124:125], v[124:125], 1.0 op_sel_hi:[1,0]
    v_pk_add_f32 v[126:127], v[126:127], 1.0 op_sel_hi:[1,0]
    v_pk_add_f32 v[128:129], v[128:129], 1.0 op_sel_hi:[1,0]
    v_pk_add_f32 v[130:131], v[130:131], 1.0 op_sel_hi:[1,0]
    v_rcp_f32 v124, v124
    v_rcp_f32 v125, v125
    v_rcp_f32 v126, v126
    v_rcp_f32 v127, v127
    v_rcp_f32 v128, v128
    v_rcp_f32 v129, v129
    v_rcp_f32 v130, v130
    v_rcp_f32 v131, v131
    v_pk_mul_f32 v[124:125], v[124:125], v[204:205]
    v_pk_mul_f32 v[126:127], v[126:127], v[206:207]
    v_pk_mul_f32 v[128:129], v[128:129], v[220:221]
    v_pk_mul_f32 v[130:131], v[130:131], v[222:223]
    v_cvt_pk_bf16_f32 v132, v124, v125
    v_cvt_pk_bf16_f32 v133, v126, v127
    v_cvt_pk_bf16_f32 v134, v128, v129
    v_cvt_pk_bf16_f32 v135, v130, v131
    buffer_store_dwordx4 v[132:135], v1, s[20:23], s71 offen sc1
    v_pk_mul_f32 v[112:113], v[208:209], s[84:85]
    v_pk_mul_f32 v[114:115], v[210:211], s[84:85]
    buffer_load_dwordx4 v250, s[28:31], s62 offen offset:2048  lds
    s_add_u32 s71, s0, 98304
    v_pk_mul_f32 v[116:117], v[224:225], s[84:85]
    v_pk_mul_f32 v[118:119], v[226:227], s[84:85]
    v_exp_f32 v112, v112
    buffer_load_dwordx4 v251, s[28:31], s62 offen offset:3072  lds
    v_exp_f32 v113, v113
    v_exp_f32 v114, v114
    v_exp_f32 v115, v115
    v_exp_f32 v116, v116
    s_add_u32 s62, s62, s64
    s_add_u32 m0, s63, 87040
    s_nop 0
    buffer_load_dwordx4 v248, s[28:31], s62 offen offset:0  lds
    v_exp_f32 v117, v117
    v_exp_f32 v118, v118
    v_exp_f32 v119, v119
    v_pk_add_f32 v[112:113], v[112:113], 1.0 op_sel_hi:[1,0]
    v_pk_add_f32 v[114:115], v[114:115], 1.0 op_sel_hi:[1,0]
    v_pk_add_f32 v[116:117], v[116:117], 1.0 op_sel_hi:[1,0]
    v_pk_add_f32 v[118:119], v[118:119], 1.0 op_sel_hi:[1,0]
    v_rcp_f32 v112, v112
    v_rcp_f32 v113, v113
    v_rcp_f32 v114, v114
    v_rcp_f32 v115, v115
    v_rcp_f32 v116, v116
    v_rcp_f32 v117, v117
    v_rcp_f32 v118, v118
    v_rcp_f32 v119, v119
    v_pk_mul_f32 v[112:113], v[112:113], v[208:209]
    v_pk_mul_f32 v[114:115], v[114:115], v[210:211]
    v_pk_mul_f32 v[116:117], v[116:117], v[224:225]
    v_pk_mul_f32 v[118:119], v[118:119], v[226:227]
    v_cvt_pk_bf16_f32 v120, v112, v113
    v_cvt_pk_bf16_f32 v121, v114, v115
    v_cvt_pk_bf16_f32 v122, v116, v117
    v_cvt_pk_bf16_f32 v123, v118, v119
    buffer_store_dwordx4 v[120:123], v1, s[20:23], s71 offen sc1
    v_pk_mul_f32 v[124:125], v[212:213], s[84:85]
    v_pk_mul_f32 v[126:127], v[214:215], s[84:85]
    buffer_load_dwordx4 v249, s[28:31], s62 offen offset:1024  lds
    s_add_u32 s71, s0, 147456
    v_pk_mul_f32 v[128:129], v[228:229], s[84:85]
    v_pk_mul_f32 v[130:131], v[230:231], s[84:85]
    v_exp_f32 v124, v124
    buffer_load_dwordx4 v250, s[28:31], s62 offen offset:2048  lds
    v_exp_f32 v125, v125
    v_exp_f32 v126, v126
    v_exp_f32 v127, v127
    v_exp_f32 v128, v128
    s_add_u32 s62, s62, s53
    buffer_load_dwordx4 v251, s[28:31], s62 offen offset:3072  lds
    v_exp_f32 v129, v129
    v_exp_f32 v130, v130
    v_exp_f32 v131, v131
    v_pk_add_f32 v[124:125], v[124:125], 1.0 op_sel_hi:[1,0]
    v_pk_add_f32 v[126:127], v[126:127], 1.0 op_sel_hi:[1,0]
    v_pk_add_f32 v[128:129], v[128:129], 1.0 op_sel_hi:[1,0]
    v_pk_add_f32 v[130:131], v[130:131], 1.0 op_sel_hi:[1,0]
    v_rcp_f32 v124, v124
    v_rcp_f32 v125, v125
    v_rcp_f32 v126, v126
    v_rcp_f32 v127, v127
    v_rcp_f32 v128, v128
    v_rcp_f32 v129, v129
    v_rcp_f32 v130, v130
    v_rcp_f32 v131, v131
    v_pk_mul_f32 v[124:125], v[124:125], v[212:213]
    v_pk_mul_f32 v[126:127], v[126:127], v[214:215]
    v_pk_mul_f32 v[128:129], v[128:129], v[228:229]
    v_pk_mul_f32 v[130:131], v[130:131], v[230:231]
    v_cvt_pk_bf16_f32 v132, v124, v125
    v_cvt_pk_bf16_f32 v133, v126, v127
    v_cvt_pk_bf16_f32 v134, v128, v129
    v_cvt_pk_bf16_f32 v135, v130, v131
    buffer_store_dwordx4 v[132:135], v1, s[20:23], s71 offen sc1
    v_lshrrev_b32 v52, 4, v0
    v_and_b32 v53, 15, v0
    s_sub_u32 s96, s76, 1
    v_sub_u32 v52, s96, v52
    v_lshlrev_b32 v52, 8, v52
    v_lshl_add_u32 v88, v53, 4, v52
    v_add_u32 v89, -1024, v88
    v_add_u32 v90, -2048, v88
    v_add_u32 v91, -3072, v88
    s_movk_i32 s96, 0x1000
    v_cmp_gt_u32 vcc, s96, v88
    s_nop 1
    v_cndmask_b32 v92, 0, v36, vcc
    v_cmp_gt_u32 vcc, s96, v89
    s_nop 1
    v_cndmask_b32 v93, 0, v36, vcc
    v_cmp_gt_u32 vcc, s96, v90
    s_nop 1
    v_cndmask_b32 v94, 0, v36, vcc
    v_cmp_gt_u32 vcc, s96, v91
    s_nop 1
    v_cndmask_b32 v95, 0, v36, vcc
    v_mov_b32 v56, v45
    v_mov_b32 v57, v45
    v_mov_b32 v60, v47
    v_mov_b32 v61, v47
    v_permlane16_swap_b32 v56, v57
    s_nop 0
    v_permlane16_swap_b32 v60, v61
    v_mov_b32 v58, v56
    v_mov_b32 v62, v60
    s_nop 0
    v_permlane32_swap_b32 v56, v58
    v_permlane32_swap_b32 v60, v62
    v_mov_b32 v59, v57
    v_mov_b32 v63, v61
    s_nop 0
    v_permlane32_swap_b32 v57, v59
    v_permlane32_swap_b32 v61, v63
    v_fma_f32 v57, v56, v240, v57
    v_fma_f32 v61, v56, v241, v61
    v_fma_f32 v57, -v60, v241, v57
    v_fmac_f32 v61, v60, v240
    v_fma_f32 v58, v57, v240, v58
    v_fma_f32 v62, v57, v241, v62
    v_fma_f32 v58, -v61, v241, v58
    v_fmac_f32 v62, v61, v240
    s_mov_b32 vcc_lo, 0xffff0000
    s_mov_b32 vcc_hi, 0
    v_cndmask_b32 v64, 0, v56, vcc
    v_cndmask_b32 v65, 0, v60, vcc
    s_mov_b32 vcc_lo, 0
    s_mov_b32 vcc_hi, 0xffff
    v_cndmask_b32 v64, v64, v57, vcc
    v_cndmask_b32 v65, v65, v61, vcc
    s_mov_b32 vcc_lo, 0
    s_mov_b32 vcc_hi, 0xffff0000
    v_cndmask_b32 v64, v64, v58, vcc
    v_cndmask_b32 v65, v65, v62, vcc
    v_mul_f32 v106, v236, v64
    v_mul_f32 v107, v237, v64
    v_fma_f32 v106, -v237, v65, v106
    v_fma_f32 v107, -v236, v65, -v107
    v_pk_mul_f32 v[68:69], v[152:153], v[236:237] op_sel:[0,1] op_sel_hi:[1,1]
    buffer_load_dwordx4 v[84:87], v91, s[72:75], 0 offen sc1
    v_pk_mul_f32 v[152:153], v[152:153], v[236:237] op_sel_hi:[1,0]
    v_pk_fma_f32 v[152:153], v[184:185], v[236:237], v[152:153] op_sel:[0,1,0] op_sel_hi:[1,1,1] neg_lo:[0,1,0] neg_hi:[0,1,0]
    v_pk_fma_f32 v[184:185], v[184:185], v[236:237], v[68:69] op_sel_hi:[1,0,1] neg_lo:[0,1,1] neg_hi:[0,1,1]
    v_pk_mul_f32 v[68:69], v[154:155], v[236:237] op_sel:[0,1] op_sel_hi:[1,1]
    buffer_load_dwordx4 v[80:83], v90, s[72:75], 0 offen sc1
    v_pk_mul_f32 v[154:155], v[154:155], v[236:237] op_sel_hi:[1,0]
    v_pk_fma_f32 v[154:155], v[186:187], v[236:237], v[154:155] op_sel:[0,1,0] op_sel_hi:[1,1,1] neg_lo:[0,1,0] neg_hi:[0,1,0]
    v_pk_fma_f32 v[186:187], v[186:187], v[236:237], v[68:69] op_sel_hi:[1,0,1] neg_lo:[0,1,1] neg_hi:[0,1,1]
    v_pk_mul_f32 v[68:69], v[156:157], v[236:237] op_sel:[0,1] op_sel_hi:[1,1]
    buffer_load_dwordx4 v[76:79], v89, s[72:75], 0 offen sc1
    v_pk_mul_f32 v[156:157], v[156:157], v[236:237] op_sel_hi:[1,0]
    v_pk_fma_f32 v[156:157], v[188:189], v[236:237], v[156:157] op_sel:[0,1,0] op_sel_hi:[1,1,1] neg_lo:[0,1,0] neg_hi:[0,1,0]
    v_pk_fma_f32 v[188:189], v[188:189], v[236:237], v[68:69] op_sel_hi:[1,0,1] neg_lo:[0,1,1] neg_hi:[0,1,1]
    v_pk_mul_f32 v[68:69], v[158:159], v[236:237] op_sel:[0,1] op_sel_hi:[1,1]
    buffer_load_dwordx4 v[72:75], v88, s[72:75], 0 offen sc1
    v_pk_mul_f32 v[158:159], v[158:159], v[236:237] op_sel_hi:[1,0]
    v_pk_fma_f32 v[158:159], v[190:191], v[236:237], v[158:159] op_sel:[0,1,0] op_sel_hi:[1,1,1] neg_lo:[0,1,0] neg_hi:[0,1,0]
    v_pk_fma_f32 v[190:191], v[190:191], v[236:237], v[68:69] op_sel_hi:[1,0,1] neg_lo:[0,1,1] neg_hi:[0,1,1]
    v_pk_mul_f32 v[68:69], v[160:161], v[236:237] op_sel:[0,1] op_sel_hi:[1,1]
    s_waitcnt vmcnt(25)
    v_pk_mul_f32 v[160:161], v[160:161], v[236:237] op_sel_hi:[1,0]
    v_pk_fma_f32 v[160:161], v[192:193], v[236:237], v[160:161] op_sel:[0,1,0] op_sel_hi:[1,1,1] neg_lo:[0,1,0] neg_hi:[0,1,0]
    v_pk_fma_f32 v[192:193], v[192:193], v[236:237], v[68:69] op_sel_hi:[1,0,1] neg_lo:[0,1,1] neg_hi:[0,1,1]
    v_pk_mul_f32 v[68:69], v[162:163], v[236:237] op_sel:[0,1] op_sel_hi:[1,1]
    v_add_u32 v254, 122880, v38
    v_pk_mul_f32 v[162:163], v[162:163], v[236:237] op_sel_hi:[1,0]
    v_pk_fma_f32 v[162:163], v[194:195], v[236:237], v[162:163] op_sel:[0,1,0] op_sel_hi:[1,1,1] neg_lo:[0,1,0] neg_hi:[0,1,0]
    v_pk_fma_f32 v[194:195], v[194:195], v[236:237], v[68:69] op_sel_hi:[1,0,1] neg_lo:[0,1,1] neg_hi:[0,1,1]
    v_pk_mul_f32 v[68:69], v[164:165], v[236:237] op_sel:[0,1] op_sel_hi:[1,1]
    v_xor_b32 v255, 32, v254
    v_pk_mul_f32 v[164:165], v[164:165], v[236:237] op_sel_hi:[1,0]
    v_pk_fma_f32 v[164:165], v[196:197], v[236:237], v[164:165] op_sel:[0,1,0] op_sel_hi:[1,1,1] neg_lo:[0,1,0] neg_hi:[0,1,0]
    v_pk_fma_f32 v[196:197], v[196:197], v[236:237], v[68:69] op_sel_hi:[1,0,1] neg_lo:[0,1,1] neg_hi:[0,1,1]
    v_pk_mul_f32 v[68:69], v[166:167], v[236:237] op_sel:[0,1] op_sel_hi:[1,1]
    ds_read_b64_tr_b16 a[0:1], v254 offset:0
    v_pk_mul_f32 v[166:167], v[166:167], v[236:237] op_sel_hi:[1,0]
    v_pk_fma_f32 v[166:167], v[198:199], v[236:237], v[166:167] op_sel:[0,1,0] op_sel_hi:[1,1,1] neg_lo:[0,1,0] neg_hi:[0,1,0]
    v_pk_fma_f32 v[198:199], v[198:199], v[236:237], v[68:69] op_sel_hi:[1,0,1] neg_lo:[0,1,1] neg_hi:[0,1,1]
    v_pk_mul_f32 v[68:69], v[136:137], v[236:237] op_sel:[0,1] op_sel_hi:[1,1]
    ds_read_b64_tr_b16 a[2:3], v254 offset:2048
    v_pk_mul_f32 v[136:137], v[136:137], v[236:237] op_sel_hi:[1,0]
    v_pk_fma_f32 v[136:137], v[168:169], v[236:237], v[136:137] op_sel:[0,1,0] op_sel_hi:[1,1,1] neg_lo:[0,1,0] neg_hi:[0,1,0]
    v_pk_fma_f32 v[168:169], v[168:169], v[236:237], v[68:69] op_sel_hi:[1,0,1] neg_lo:[0,1,1] neg_hi:[0,1,1]
    v_pk_mul_f32 v[68:69], v[138:139], v[236:237] op_sel:[0,1] op_sel_hi:[1,1]
    ds_read_b64_tr_b16 a[4:5], v255 offset:0
    v_pk_mul_f32 v[138:139], v[138:139], v[236:237] op_sel_hi:[1,0]
    v_pk_fma_f32 v[138:139], v[170:171], v[236:237], v[138:139] op_sel:[0,1,0] op_sel_hi:[1,1,1] neg_lo:[0,1,0] neg_hi:[0,1,0]
    v_pk_fma_f32 v[170:171], v[170:171], v[236:237], v[68:69] op_sel_hi:[1,0,1] neg_lo:[0,1,1] neg_hi:[0,1,1]
    v_pk_mul_f32 v[68:69], v[140:141], v[236:237] op_sel:[0,1] op_sel_hi:[1,1]
    ds_read_b64_tr_b16 a[6:7], v255 offset:2048
    v_pk_mul_f32 v[140:141], v[140:141], v[236:237] op_sel_hi:[1,0]
    v_pk_fma_f32 v[140:141], v[172:173], v[236:237], v[140:141] op_sel:[0,1,0] op_sel_hi:[1,1,1] neg_lo:[0,1,0] neg_hi:[0,1,0]
    v_pk_fma_f32 v[172:173], v[172:173], v[236:237], v[68:69] op_sel_hi:[1,0,1] neg_lo:[0,1,1] neg_hi:[0,1,1]
    v_pk_mul_f32 v[68:69], v[142:143], v[236:237] op_sel:[0,1] op_sel_hi:[1,1]
    ds_read_b64_tr_b16 a[20:21], v254 offset:5120
    v_pk_mul_f32 v[142:143], v[142:143], v[236:237] op_sel_hi:[1,0]
    v_pk_fma_f32 v[142:143], v[174:175], v[236:237], v[142:143] op_sel:[0,1,0] op_sel_hi:[1,1,1] neg_lo:[0,1,0] neg_hi:[0,1,0]
    v_pk_fma_f32 v[174:175], v[174:175], v[236:237], v[68:69] op_sel_hi:[1,0,1] neg_lo:[0,1,1] neg_hi:[0,1,1]
    v_pk_mul_f32 v[68:69], v[144:145], v[236:237] op_sel:[0,1] op_sel_hi:[1,1]
    ds_read_b64_tr_b16 a[22:23], v254 offset:7168
    v_pk_mul_f32 v[144:145], v[144:145], v[236:237] op_sel_hi:[1,0]
    v_pk_fma_f32 v[144:145], v[176:177], v[236:237], v[144:145] op_sel:[0,1,0] op_sel_hi:[1,1,1] neg_lo:[0,1,0] neg_hi:[0,1,0]
    v_pk_fma_f32 v[176:177], v[176:177], v[236:237], v[68:69] op_sel_hi:[1,0,1] neg_lo:[0,1,1] neg_hi:[0,1,1]
    v_pk_mul_f32 v[68:69], v[146:147], v[236:237] op_sel:[0,1] op_sel_hi:[1,1]
    ds_read_b64_tr_b16 a[24:25], v255 offset:5120
    v_pk_mul_f32 v[146:147], v[146:147], v[236:237] op_sel_hi:[1,0]
    v_pk_fma_f32 v[146:147], v[178:179], v[236:237], v[146:147] op_sel:[0,1,0] op_sel_hi:[1,1,1] neg_lo:[0,1,0] neg_hi:[0,1,0]
    v_pk_fma_f32 v[178:179], v[178:179], v[236:237], v[68:69] op_sel_hi:[1,0,1] neg_lo:[0,1,1] neg_hi:[0,1,1]
    v_pk_mul_f32 v[68:69], v[148:149], v[236:237] op_sel:[0,1] op_sel_hi:[1,1]
    ds_read_b64_tr_b16 a[26:27], v255 offset:7168
    v_pk_mul_f32 v[148:149], v[148:149], v[236:237] op_sel_hi:[1,0]
    v_pk_fma_f32 v[148:149], v[180:181], v[236:237], v[148:149] op_sel:[0,1,0] op_sel_hi:[1,1,1] neg_lo:[0,1,0] neg_hi:[0,1,0]
    v_pk_fma_f32 v[180:181], v[180:181], v[236:237], v[68:69] op_sel_hi:[1,0,1] neg_lo:[0,1,1] neg_hi:[0,1,1]
    v_pk_mul_f32 v[68:69], v[150:151], v[236:237] op_sel:[0,1] op_sel_hi:[1,1]
    v_xor_b32 v254, 64, v254
    v_pk_mul_f32 v[150:151], v[150:151], v[236:237] op_sel_hi:[1,0]
    v_pk_fma_f32 v[150:151], v[182:183], v[236:237], v[150:151] op_sel:[0,1,0] op_sel_hi:[1,1,1] neg_lo:[0,1,0] neg_hi:[0,1,0]
    v_pk_fma_f32 v[182:183], v[182:183], v[236:237], v[68:69] op_sel_hi:[1,0,1] neg_lo:[0,1,1] neg_hi:[0,1,1]
    v_xor_b32 v255, 64, v255
    ds_read_b64_tr_b16 a[8:9], v254 offset:0
    ds_read_b64_tr_b16 a[10:11], v254 offset:2048
    ds_read_b64_tr_b16 a[12:13], v255 offset:0
    ds_read_b64_tr_b16 a[14:15], v255 offset:2048
    ds_read_b64_tr_b16 a[28:29], v254 offset:5120
    ds_read_b64_tr_b16 a[30:31], v254 offset:7168
    ds_read_b64_tr_b16 a[32:33], v255 offset:5120
    ds_read_b64_tr_b16 a[34:35], v255 offset:7168
    s_waitcnt lgkmcnt(0)
    s_mul_i32 s96, s92, 81920
    s_add_u32 s91, s91, s96
    s_cmp_ge_u32 s91, s55
    s_cselect_b32 s96, 491520, 0
    s_sub_u32 s91, s91, s96
    s_mov_b32 s62, s91
    s_add_u32 m0, s63, 122880
    s_nop 0
    buffer_load_dwordx4 v248, s[36:39], s62 offen offset:0  lds
    buffer_load_dwordx4 v249, s[36:39], s62 offen offset:1024  lds
    buffer_load_dwordx4 v250, s[36:39], s62 offen offset:2048  lds
    buffer_load_dwordx4 v251, s[36:39], s62 offen offset:3072  lds
    s_add_u32 s62, s62, s64
    s_add_u32 m0, s63, 128000
    s_nop 0
    buffer_load_dwordx4 v248, s[36:39], s62 offen offset:0  lds
    buffer_load_dwordx4 v249, s[36:39], s62 offen offset:1024  lds
    buffer_load_dwordx4 v250, s[36:39], s62 offen offset:2048  lds
    s_add_u32 s62, s62, s53
    buffer_load_dwordx4 v251, s[36:39], s62 offen offset:3072  lds
    s_lshr_b32 s70, s90, 2
    s_mul_i32 s70, s70, 6144
    s_mul_i32 s96, s3, 1536
    s_add_u32 s70, s70, s96
    s_add_u32 s70, s70, 24543232
    v_min_u32 v28, 11, v0
    v_lshlrev_b32 v28, 7, v28
    s_mov_b32 s79, s70
    buffer_load_dwordx2 v[30:31], v28, s[20:23], s79 offen sc1
    s_mul_i32 s96, s3, 8448
    v_lshrrev_b32 v52, 4, v0
    v_mul_u32_u24 v104, 264, v53
    v_lshl_add_u32 v104, v52, 6, v104
    v_add_u32 v104, s96, v104
    v_lshrrev_b32 v105, 2, v0
    v_mul_u32_u24 v105, 264, v105
    v_and_b32 v52, 3, v0
    v_lshl_add_u32 v105, v52, 6, v105
    v_add_u32 v105, s96, v105
    v_sub_f32 v108, 0, v234
    s_waitcnt vmcnt(9)
L_lb11:
    v_xor_b32 v70, v73, v92
    v_bitop3_b32 v70, v70, v75, v92 bitop3:0xf6
    v_bitop3_b32 v70, v70, v77, v93 bitop3:0xf6
    v_bitop3_b32 v70, v70, v79, v93 bitop3:0xf6
    v_bitop3_b32 v70, v70, v81, v94 bitop3:0xf6
    v_bitop3_b32 v70, v70, v83, v94 bitop3:0xf6
    v_bitop3_b32 v70, v70, v85, v95 bitop3:0xf6
    v_bitop3_b32 v70, v70, v87, v95 bitop3:0xf6
    s_mov_b64 exec, 1
    buffer_store_dwordx2 v[36:37], v34, s[20:23], s1 offen offset:0 sc1
    s_mov_b64 exec, -1
    v_cmp_ne_u32 vcc, 0, v70
    s_nop 1
    s_cmp_lg_u64 vcc, 0
    s_cbranch_scc1 L_lbslow11
    v_fma_f32 v80, v84, v244, v80
    v_fma_f32 v82, v84, v245, v82
    v_fma_f32 v80, -v86, v245, v80
    v_fmac_f32 v82, v86, v244
    v_fma_f32 v76, v80, v244, v76
    v_fma_f32 v78, v80, v245, v78
    v_fma_f32 v76, -v82, v245, v76
    v_fmac_f32 v78, v82, v244
    v_fma_f32 v72, v76, v244, v72
    v_fma_f32 v74, v76, v245, v74
    v_fma_f32 v72, -v78, v245, v72
    v_fmac_f32 v74, v78, v244
    v_mul_f32 v70, v72, v246
    v_mul_f32 v71, v72, v247
    v_fma_f32 v70, -v74, v247, v70
    v_fmac_f32 v71, v74, v246
    s_nop 1
    v_permlane16_swap_b32 v70, v71
    v_add_f32 v70, v70, v71
    v_mov_b32 v71, v70
    s_nop 1
    v_permlane32_swap_b32 v70, v71
    v_add_f32 v70, v70, v71
    v_mov_b32 v71, v70
    s_nop 1
    v_permlane16_swap_b32 v70, v71
    v_fmac_f32 v106, v242, v70
    v_fma_f32 v107, -v242, v71, v107
    v_fma_f32 v106, -v243, v71, v106
    v_fma_f32 v107, -v243, v70, v107
    v_fmac_f32 v152, v232, v106
    v_fmac_f32 v184, v232, v107
    v_fmac_f32 v152, v234, v107
    v_fmac_f32 v184, v108, v106
    v_fmac_f32 v153, v232, v152
    v_fmac_f32 v185, v232, v184
    v_fmac_f32 v153, v234, v184
    v_fmac_f32 v185, v108, v152
    v_cvt_pk_bf16_f32 v40, v152, v153
    v_cvt_pk_bf16_f32 v56, v184, v185
    v_fmac_f32 v154, v232, v153
    v_fmac_f32 v186, v232, v185
    v_fmac_f32 v154, v234, v185
    v_fmac_f32 v186, v108, v153
    v_fmac_f32 v155, v232, v154
    v_fmac_f32 v187, v232, v186
    v_fmac_f32 v155, v234, v186
    v_fmac_f32 v187, v108, v154
    v_cvt_pk_bf16_f32 v41, v154, v155
    v_cvt_pk_bf16_f32 v57, v186, v187
    ds_write_b64 v104, v[40:41] offset:0
    ds_write_b64 v104, v[56:57] offset:4224
    v_fmac_f32 v156, v232, v155
    v_fmac_f32 v188, v232, v187
    v_fmac_f32 v156, v234, v187
    v_fmac_f32 v188, v108, v155
    v_fmac_f32 v157, v232, v156
    v_fmac_f32 v189, v232, v188
    v_fmac_f32 v157, v234, v188
    v_fmac_f32 v189, v108, v156
    v_cvt_pk_bf16_f32 v42, v156, v157
    v_cvt_pk_bf16_f32 v58, v188, v189
    v_fmac_f32 v158, v232, v157
    v_fmac_f32 v190, v232, v189
    v_fmac_f32 v158, v234, v189
    v_fmac_f32 v190, v108, v157
    v_fmac_f32 v159, v232, v158
    v_fmac_f32 v191, v232, v190
    v_fmac_f32 v159, v234, v190
    v_fmac_f32 v191, v108, v158
    v_cvt_pk_bf16_f32 v43, v158, v159
    v_cvt_pk_bf16_f32 v59, v190, v191
    ds_write_b64 v104, v[42:43] offset:8
    ds_write_b64 v104, v[58:59] offset:4232
    v_fmac_f32 v160, v232, v159
    v_fmac_f32 v192, v232, v191
    v_fmac_f32 v160, v234, v191
    v_fmac_f32 v192, v108, v159
    v_fmac_f32 v161, v232, v160
    v_fmac_f32 v193, v232, v192
    v_fmac_f32 v161, v234, v192
    v_fmac_f32 v193, v108, v160
    v_cvt_pk_bf16_f32 v44, v160, v161
    v_cvt_pk_bf16_f32 v60, v192, v193
    ds_read_b64_tr_b16 v[72:73], v105 offset:0
    ds_read_b64_tr_b16 v[74:75], v105 offset:4224
    v_fmac_f32 v162, v232, v161
    v_fmac_f32 v194, v232, v193
    v_fmac_f32 v162, v234, v193
    v_fmac_f32 v194, v108, v161
    v_fmac_f32 v163, v232, v162
    v_fmac_f32 v195, v232, v194
    v_fmac_f32 v163, v234, v194
    v_fmac_f32 v195, v108, v162
    v_cvt_pk_bf16_f32 v45, v162, v163
    v_cvt_pk_bf16_f32 v61, v194, v195
    ds_write_b64 v104, v[44:45] offset:16
    ds_write_b64 v104, v[60:61] offset:4240
    v_fmac_f32 v164, v232, v163
    v_fmac_f32 v196, v232, v195
    v_fmac_f32 v164, v234, v195
    v_fmac_f32 v196, v108, v163
    v_fmac_f32 v165, v232, v164
    v_fmac_f32 v197, v232, v196
    v_fmac_f32 v165, v234, v196
    v_fmac_f32 v197, v108, v164
    v_cvt_pk_bf16_f32 v46, v164, v165
    v_cvt_pk_bf16_f32 v62, v196, v197
    ds_read_b64_tr_b16 v[76:77], v105 offset:8
    ds_read_b64_tr_b16 v[78:79], v105 offset:4232
    v_fmac_f32 v166, v232, v165
    v_fmac_f32 v198, v232, v197
    v_fmac_f32 v166, v234, v197
    v_fmac_f32 v198, v108, v165
    s_add_u32 s71, s34, 0
    s_waitcnt lgkmcnt(4)
    buffer_store_dwordx4 v[72:75], v1, s[20:23], s71 offen sc1
    v_fmac_f32 v167, v232, v166
    v_fmac_f32 v199, v232, v198
    v_fmac_f32 v167, v234, v198
    v_fmac_f32 v199, v108, v166
    v_cvt_pk_bf16_f32 v47, v166, v167
    v_cvt_pk_bf16_f32 v63, v198, v199
    ds_write_b64 v104, v[46:47] offset:24
    ds_write_b64 v104, v[62:63] offset:4248
    v_fmac_f32 v136, v232, v167
    v_fmac_f32 v168, v232, v199
    v_fmac_f32 v136, v234, v199
    v_fmac_f32 v168, v108, v167
    v_fmac_f32 v137, v232, v136
    v_fmac_f32 v169, v232, v168
    v_fmac_f32 v137, v234, v168
    v_fmac_f32 v169, v108, v136
    v_cvt_pk_bf16_f32 v48, v136, v137
    v_cvt_pk_bf16_f32 v64, v168, v169
    ds_read_b64_tr_b16 v[80:81], v105 offset:16
    ds_read_b64_tr_b16 v[82:83], v105 offset:4240
    v_fmac_f32 v138, v232, v137
    v_fmac_f32 v170, v232, v169
    v_fmac_f32 v138, v234, v169
    v_fmac_f32 v170, v108, v137
    s_add_u32 s71, s34, 40960
    s_waitcnt lgkmcnt(4)
    buffer_store_dwordx4 v[76:79], v1, s[20:23], s71 offen sc1
    v_fmac_f32 v139, v232, v138
    v_fmac_f32 v171, v232, v170
    v_fmac_f32 v139, v234, v170
    v_fmac_f32 v171, v108, v138
    v_cvt_pk_bf16_f32 v49, v138, v139
    v_cvt_pk_bf16_f32 v65, v170, v171
    ds_write_b64 v104, v[48:49] offset:32
    ds_write_b64 v104, v[64:65] offset:4256
    v_fmac_f32 v140, v232, v139
    v_fmac_f32 v172, v232, v171
    v_fmac_f32 v140, v234, v171
    v_fmac_f32 v172, v108, v139
    v_fmac_f32 v141, v232, v140
    v_fmac_f32 v173, v232, v172
    v_fmac_f32 v141, v234, v172
    v_fmac_f32 v173, v108, v140
    v_cvt_pk_bf16_f32 v50, v140, v141
    v_cvt_pk_bf16_f32 v66, v172, v173
    ds_read_b64_tr_b16 v[84:85], v105 offset:24
    ds_read_b64_tr_b16 v[86:87], v105 offset:4248
    v_fmac_f32 v142, v232, v141
    v_fmac_f32 v174, v232, v173
    v_fmac_f32 v142, v234, v173
    v_fmac_f32 v174, v108, v141
    s_add_u32 s71, s34, 81920
    s_waitcnt lgkmcnt(4)
    buffer_store_dwordx4 v[80:83], v1, s[20:23], s71 offen sc1
    v_fmac_f32 v143, v232, v142
    v_fmac_f32 v175, v232, v174
    v_fmac_f32 v143, v234, v174
    v_fmac_f32 v175, v108, v142
    v_cvt_pk_bf16_f32 v51, v142, v143
    v_cvt_pk_bf16_f32 v67, v174, v175
    ds_write_b64 v104, v[50:51] offset:40
    ds_write_b64 v104, v[66:67] offset:4264
    v_fmac_f32 v144, v232, v143
    v_fmac_f32 v176, v232, v175
    v_fmac_f32 v144, v234, v175
    v_fmac_f32 v176, v108, v143
    v_fmac_f32 v145, v232, v144
    v_fmac_f32 v177, v232, v176
    v_fmac_f32 v145, v234, v176
    v_fmac_f32 v177, v108, v144
    v_cvt_pk_bf16_f32 v52, v144, v145
    v_cvt_pk_bf16_f32 v68, v176, v177
    ds_read_b64_tr_b16 v[88:89], v105 offset:32
    ds_read_b64_tr_b16 v[90:91], v105 offset:4256
    v_fmac_f32 v146, v232, v145
    v_fmac_f32 v178, v232, v177
    v_fmac_f32 v146, v234, v177
    v_fmac_f32 v178, v108, v145
    s_add_u32 s71, s34, 122880
    s_waitcnt lgkmcnt(4)
    buffer_store_dwordx4 v[84:87], v1, s[20:23], s71 offen sc1
    v_fmac_f32 v147, v232, v146
    v_fmac_f32 v179, v232, v178
    v_fmac_f32 v147, v234, v178
    v_fmac_f32 v179, v108, v146
    v_cvt_pk_bf16_f32 v53, v146, v147
    v_cvt_pk_bf16_f32 v69, v178, v179
    ds_write_b64 v104, v[52:53] offset:48
    ds_write_b64 v104, v[68:69] offset:4272
    v_fmac_f32 v148, v232, v147
    v_fmac_f32 v180, v232, v179
    v_fmac_f32 v148, v234, v179
    v_fmac_f32 v180, v108, v147
    v_fmac_f32 v149, v232, v148
    v_fmac_f32 v181, v232, v180
    v_fmac_f32 v149, v234, v180
    v_fmac_f32 v181, v108, v148
    v_cvt_pk_bf16_f32 v54, v148, v149
    v_cvt_pk_bf16_f32 v70, v180, v181
    ds_read_b64_tr_b16 v[92:93], v105 offset:40
    ds_read_b64_tr_b16 v[94:95], v105 offset:4264
    v_fmac_f32 v150, v232, v149
    v_fmac_f32 v182, v232, v181
    v_fmac_f32 v150, v234, v181
    v_fmac_f32 v182, v108, v149
    s_add_u32 s71, s34, 163840
    s_waitcnt lgkmcnt(4)
    buffer_store_dwordx4 v[88:91], v1, s[20:23], s71 offen sc1
    v_fmac_f32 v151, v232, v150
    v_fmac_f32 v183, v232, v182
    v_fmac_f32 v151, v234, v182
    v_fmac_f32 v183, v108, v150
    v_cvt_pk_bf16_f32 v55, v150, v151
    v_cvt_pk_bf16_f32 v71, v182, v183
    ds_write_b64 v104, v[54:55] offset:56
    ds_write_b64 v104, v[70:71] offset:4280
    ds_read_b64_tr_b16 v[96:97], v105 offset:48
    ds_read_b64_tr_b16 v[98:99], v105 offset:4272
    ds_read_b64_tr_b16 v[100:101], v105 offset:56
    ds_read_b64_tr_b16 v[102:103], v105 offset:4280
    s_add_u32 s71, s34, 204800
    s_waitcnt lgkmcnt(6)
    buffer_store_dwordx4 v[92:95], v1, s[20:23], s71 offen sc1
    s_add_u32 s71, s34, 245760
    s_waitcnt lgkmcnt(2)
    buffer_store_dwordx4 v[96:99], v1, s[20:23], s71 offen sc1
    s_add_u32 s71, s34, 286720
    s_waitcnt lgkmcnt(0)
    buffer_store_dwordx4 v[100:103], v1, s[20:23], s71 offen sc1
L_xep21:
    v_add_u32 v254, 40960, v38
    v_xor_b32 v255, 32, v254
    ds_read_b64_tr_b16 a[40:41], v254 offset:0
    ds_read_b64_tr_b16 a[42:43], v254 offset:2048
    ds_read_b64_tr_b16 a[44:45], v255 offset:0
    ds_read_b64_tr_b16 a[46:47], v255 offset:2048
    ds_read_b64_tr_b16 a[60:61], v254 offset:5120
    ds_read_b64_tr_b16 a[62:63], v254 offset:7168
    ds_read_b64_tr_b16 a[64:65], v255 offset:5120
    ds_read_b64_tr_b16 a[66:67], v255 offset:7168
    v_xor_b32 v254, 64, v254
    v_xor_b32 v255, 64, v255
    ds_read_b64_tr_b16 a[48:49], v254 offset:0
    ds_read_b64_tr_b16 a[50:51], v254 offset:2048
    ds_read_b64_tr_b16 a[52:53], v255 offset:0
    ds_read_b64_tr_b16 a[54:55], v255 offset:2048
    ds_read_b64_tr_b16 a[68:69], v254 offset:5120
    ds_read_b64_tr_b16 a[70:71], v254 offset:7168
    ds_read_b64_tr_b16 a[72:73], v255 offset:5120
    ds_read_b64_tr_b16 a[74:75], v255 offset:7168
    s_waitcnt lgkmcnt(0)
    s_add_u32 s91, s91, s65
    s_cmp_ge_u32 s91, s55
    s_cselect_b32 s96, 491520, 0
    s_sub_u32 s91, s91, s96
    s_mov_b32 s62, s91
    s_add_u32 m0, s63, 40960
    s_nop 0
    buffer_load_dwordx4 v248, s[28:31], s62 offen offset:0  lds
    buffer_load_dwordx4 v249, s[28:31], s62 offen offset:1024  lds
    buffer_load_dwordx4 v250, s[28:31], s62 offen offset:2048  lds
    buffer_load_dwordx4 v251, s[28:31], s62 offen offset:3072  lds
    s_mul_i32 s96, s92, 40960
    s_add_u32 s62, s62, s96
    s_add_u32 m0, s63, 46080
    s_nop 0
    buffer_load_dwordx4 v248, s[36:39], s62 offen offset:0  lds
    buffer_load_dwordx4 v249, s[36:39], s62 offen offset:1024  lds
    buffer_load_dwordx4 v250, s[36:39], s62 offen offset:2048  lds
    buffer_load_dwordx4 v251, s[36:39], s62 offen offset:3072  lds
    v_add_u32 v254, 81920, v38
    v_xor_b32 v255, 32, v254
    ds_read_b64_tr_b16 a[80:81], v254 offset:0
    ds_read_b64_tr_b16 a[82:83], v254 offset:2048
    ds_read_b64_tr_b16 a[84:85], v255 offset:0
    ds_read_b64_tr_b16 a[86:87], v255 offset:2048
    ds_read_b64_tr_b16 a[100:101], v254 offset:5120
    ds_read_b64_tr_b16 a[102:103], v254 offset:7168
    ds_read_b64_tr_b16 a[104:105], v255 offset:5120
    ds_read_b64_tr_b16 a[106:107], v255 offset:7168
    v_xor_b32 v254, 64, v254
    v_xor_b32 v255, 64, v255
    ds_read_b64_tr_b16 a[88:89], v254 offset:0
    ds_read_b64_tr_b16 a[90:91], v254 offset:2048
    ds_read_b64_tr_b16 a[92:93], v255 offset:0
    ds_read_b64_tr_b16 a[94:95], v255 offset:2048
    ds_read_b64_tr_b16 a[108:109], v254 offset:5120
    ds_read_b64_tr_b16 a[110:111], v254 offset:7168
    ds_read_b64_tr_b16 a[112:113], v255 offset:5120
    ds_read_b64_tr_b16 a[114:115], v255 offset:7168
    s_waitcnt lgkmcnt(0)
    s_mul_i32 s96, s92, 81920
    s_add_u32 s91, s91, s96
    s_cmp_ge_u32 s91, s55
    s_cselect_b32 s96, 491520, 0
    s_sub_u32 s91, s91, s96
    s_mov_b32 s62, s91
    s_add_u32 m0, s63, 81920
    s_nop 0
    buffer_load_dwordx4 v248, s[28:31], s62 offen offset:0  lds
    buffer_load_dwordx4 v249, s[28:31], s62 offen offset:1024  lds
    buffer_load_dwordx4 v250, s[28:31], s62 offen offset:2048  lds
    buffer_load_dwordx4 v251, s[28:31], s62 offen offset:3072  lds
    s_mul_i32 s96, s92, 40960
    s_add_u32 s62, s62, s96
    s_add_u32 m0, s63, 87040
    s_nop 0
    buffer_load_dwordx4 v248, s[36:39], s62 offen offset:0  lds
    buffer_load_dwordx4 v249, s[36:39], s62 offen offset:1024  lds
    buffer_load_dwordx4 v250, s[36:39], s62 offen offset:2048  lds
    buffer_load_dwordx4 v251, s[36:39], s62 offen offset:3072  lds
    s_mov_b32 s58, 0xffff
    s_sub_u32 s83, s67, 12288
    s_lshl_b32 s87, s52, 11
    s_add_u32 s8, s87, s33
    s_add_u32 s87, s33, 12288
    s_add_u32 s9, s8, 2048
    s_cmp_eq_u32 s9, s87
    s_cselect_b32 s9, s33, s9
    s_add_u32 s10, s9, 2048
    s_cmp_eq_u32 s10, s87
    s_cselect_b32 s10, s33, s10
    s_add_u32 s11, s10, 2048
    s_cmp_eq_u32 s11, s87
    s_cselect_b32 s11, s33, s11
    s_add_u32 s12, s11, 2048
    s_cmp_eq_u32 s12, s87
    s_cselect_b32 s12, s33, s12
    s_add_u32 s13, s12, 2048
    s_cmp_eq_u32 s13, s87
    s_cselect_b32 s13, s33, s13
    s_waitcnt vmcnt(25)
    v_cmp_ne_u32 vcc, s88, v30
    v_cmp_ne_u32 s[96:97], s88, v31
    s_nop 1
    s_or_b64 vcc, vcc, s[96:97]
    s_cbranch_scc1 L_pslow11
L_pok11:
    s_mul_i32 s70, s90, 49152
    s_mul_i32 s96, s3, 12288
    s_add_u32 s70, s70, s96
    s_add_u32 s70, s70, 12582912
    s_sub_u32 s70, s70, s33
    s_add_u32 s86, s8, s70
    buffer_load_dwordx4 a[16:19], v1, s[20:23], s86 offen offset:0 sc1
    buffer_load_dwordx4 a[36:39], v1, s[20:23], s86 offen offset:1024 sc1
    s_add_u32 s86, s9, s70
    buffer_load_dwordx4 a[56:59], v1, s[20:23], s86 offen offset:0 sc1
    buffer_load_dwordx4 a[76:79], v1, s[20:23], s86 offen offset:1024 sc1
    s_add_u32 s86, s10, s70
    buffer_load_dwordx4 a[96:99], v1, s[20:23], s86 offen offset:0 sc1
    buffer_load_dwordx4 a[116:119], v1, s[20:23], s86 offen offset:1024 sc1
    s_add_u32 s86, s11, s70
    buffer_load_dwordx4 a[136:139], v1, s[20:23], s86 offen offset:0 sc1
    buffer_load_dwordx4 a[156:159], v1, s[20:23], s86 offen offset:1024 sc1
    s_add_u32 s86, s12, s70
    buffer_load_dwordx4 a[176:179], v1, s[20:23], s86 offen offset:0 sc1
    buffer_load_dwordx4 a[196:199], v1, s[20:23], s86 offen offset:1024 sc1
    s_add_u32 s86, s13, s70
    buffer_load_dwordx4 a[216:219], v1, s[20:23], s86 offen offset:0 sc1
    buffer_load_dwordx4 a[236:239], v1, s[20:23], s86 offen offset:1024 sc1
    buffer_load_dwordx2 v[26:27], v8, s[20:23], s32 offen sc1
    v_add_u32 v254, 122880, v38
    v_xor_b32 v255, 32, v254
    ds_read_b64_tr_b16 a[120:121], v254 offset:0
    ds_read_b64_tr_b16 a[122:123], v254 offset:2048
    ds_read_b64_tr_b16 a[124:125], v255 offset:0
    ds_read_b64_tr_b16 a[126:127], v255 offset:2048
    ds_read_b64_tr_b16 a[140:141], v254 offset:5120
    ds_read_b64_tr_b16 a[142:143], v254 offset:7168
    ds_read_b64_tr_b16 a[144:145], v255 offset:5120
    ds_read_b64_tr_b16 a[146:147], v255 offset:7168
    v_xor_b32 v254, 64, v254
    v_xor_b32 v255, 64, v255
    ds_read_b64_tr_b16 a[128:129], v254 offset:0
    ds_read_b64_tr_b16 a[130:131], v254 offset:2048
    ds_read_b64_tr_b16 a[132:133], v255 offset:0
    ds_read_b64_tr_b16 a[134:135], v255 offset:2048
    ds_read_b64_tr_b16 a[148:149], v254 offset:5120
    ds_read_b64_tr_b16 a[150:151], v254 offset:7168
    ds_read_b64_tr_b16 a[152:153], v255 offset:5120
    ds_read_b64_tr_b16 a[154:155], v255 offset:7168
    s_waitcnt vmcnt(29)
    s_mov_b64 exec, 1
    buffer_store_dwordx2 v[36:37], v34, s[20:23], s35 offen offset:0 sc1
    s_mov_b64 exec, -1
    s_waitcnt vmcnt(22)
    v_add_u32 v254, 40960, v38
    v_xor_b32 v255, 32, v254
    ds_read_b64_tr_b16 a[160:161], v254 offset:0
    ds_read_b64_tr_b16 a[162:163], v254 offset:2048
    ds_read_b64_tr_b16 a[164:165], v255 offset:0
    ds_read_b64_tr_b16 a[166:167], v255 offset:2048
    ds_read_b64_tr_b16 a[180:181], v254 offset:5120
    ds_read_b64_tr_b16 a[182:183], v254 offset:7168
    ds_read_b64_tr_b16 a[184:185], v255 offset:5120
    ds_read_b64_tr_b16 a[186:187], v255 offset:7168
    v_xor_b32 v254, 64, v254
    v_xor_b32 v255, 64, v255
    ds_read_b64_tr_b16 a[168:169], v254 offset:0
    ds_read_b64_tr_b16 a[170:171], v254 offset:2048
    ds_read_b64_tr_b16 a[172:173], v255 offset:0
    ds_read_b64_tr_b16 a[174:175], v255 offset:2048
    ds_read_b64_tr_b16 a[188:189], v254 offset:5120
    ds_read_b64_tr_b16 a[190:191], v254 offset:7168
    ds_read_b64_tr_b16 a[192:193], v255 offset:5120
    ds_read_b64_tr_b16 a[194:195], v255 offset:7168
    s_waitcnt vmcnt(14)
    v_add_u32 v254, 81920, v38
    v_xor_b32 v255, 32, v254
    ds_read_b64_tr_b16 a[200:201], v254 offset:0
    ds_read_b64_tr_b16 a[202:203], v254 offset:2048
    ds_read_b64_tr_b16 a[204:205], v255 offset:0
    ds_read_b64_tr_b16 a[206:207], v255 offset:2048
    ds_read_b64_tr_b16 a[220:221], v254 offset:5120
    ds_read_b64_tr_b16 a[222:223], v254 offset:7168
    ds_read_b64_tr_b16 a[224:225], v255 offset:5120
    ds_read_b64_tr_b16 a[226:227], v255 offset:7168
    v_xor_b32 v254, 64, v254
    v_xor_b32 v255, 64, v255
    ds_read_b64_tr_b16 a[208:209], v254 offset:0
    ds_read_b64_tr_b16 a[210:211], v254 offset:2048
    ds_read_b64_tr_b16 a[212:213], v255 offset:0
    ds_read_b64_tr_b16 a[214:215], v255 offset:2048
    ds_read_b64_tr_b16 a[228:229], v254 offset:5120
    ds_read_b64_tr_b16 a[230:231], v254 offset:7168
    ds_read_b64_tr_b16 a[232:233], v255 offset:5120
    ds_read_b64_tr_b16 a[234:235], v255 offset:7168
    s_nop 0
    s_waitcnt vmcnt(1)
    s_branch L_roleQ
L_typeY:
    s_mul_i32 s79, s60, 3
    s_add_u32 s79, s79, 4
    s_lshl_b32 s79, s79, 7
    s_lshl_b32 s84, s80, 7
    s_add_u32 s81, s61, s84
    s_add_u32 m0, s58, 0
    s_nop 0
    buffer_load_dwordx4 v2, s[4:7], s81 offen offset:0  lds
    s_mul_i32 s83, s80, 196608
    buffer_load_dwordx4 v3, s[4:7], s81 offen offset:1024  lds
    s_add_u32 s83, s83, s79
    s_add_u32 s80, s80, 1
    buffer_load_dwordx4 v4, s[4:7], s81 offen offset:2048  lds
    s_cmp_eq_u32 s80, 10
    s_cselect_b32 s80, 0, s80
    buffer_load_dwordx4 v5, s[4:7], s81 offen offset:3072  lds
    s_add_u32 m0, s59, 0
    s_nop 0
    buffer_load_dwordx4 v8, s[16:19], s83 offen offset:0  lds
    buffer_load_dwordx4 v9, s[16:19], s83 offen offset:1024  lds
    s_add_u32 s83, s83, 128
    s_add_u32 m0, s59, 8192
    s_nop 0
    buffer_load_dwordx4 v8, s[16:19], s83 offen offset:0  lds
    buffer_load_dwordx4 v9, s[16:19], s83 offen offset:1024  lds
    s_add_u32 s83, s83, 128
    s_add_u32 m0, s59, 16384
    s_nop 0
    buffer_load_dwordx4 v8, s[16:19], s83 offen offset:0  lds
    buffer_load_dwordx4 v9, s[16:19], s83 offen offset:1024  lds
    s_or_b32 s96, s2, s3
    s_cmp_lg_u32 s96, 0
    s_cbranch_scc1 L_notag12
    s_or_b32 s96, s100, 1
    v_mov_b32 v35, s96
    s_mov_b64 exec, 1
    global_store_dword v34, v35, s[68:69] sc1
    s_mov_b64 exec, -1
L_notag12:
    s_mov_b32 s101, 400000
    s_bfe_u32 s92, s2, 0x10002
    s_and_b32 s89, s76, 8
    s_and_b32 s90, s2, 2
    s_lshl_b32 s90, s90, 1
    s_add_u32 s89, s89, s90
    s_add_u32 s89, s89, s87
    s_mov_b32 s90, s86
    s_mul_i32 s0, s76, 393216
    s_mul_i32 s96, s77, 196608
    s_add_u32 s0, s0, s96
    s_lshl_b32 s96, s79, 4
    s_add_u32 s0, s0, s96
    s_lshl_b32 s96, s78, 10
    s_add_u32 s0, s0, s96
    s_add_u32 s0, s0, 6291456
    s_mul_i32 s1, s76, 12288
    s_lshl_b32 s96, s79, 2
    s_add_u32 s1, s1, s96
    s_lshl_b32 s96, s3, 7
    s_add_u32 s1, s1, s96
    s_add_u32 s1, s1, 24248320
    s_lshl_b32 s95, s89, 9
    s_lshl_b32 s96, s92, 8
    s_add_u32 s95, s95, s96
    s_lshl_b32 s96, s3, 6
    s_add_u32 s95, s95, s96
    s_add_u32 s95, s95, 17301504
    s_lshr_b32 s70, s90, 2
    s_and_b32 s71, s90, 3
    s_cmp_eq_u32 s92, 0
    s_cbranch_scc1 L_wsP13
    s_mov_b32 s28, s62
    s_mov_b32 s29, s63
    s_mov_b32 s30, 1966080
    s_mov_b32 s31, 0x20000
    s_mov_b32 s36, s62
    s_mov_b32 s37, s63
    s_mov_b32 s38, 1966080
    s_mov_b32 s39, 0x20000
    s_mul_i32 s50, s70, 320
    s_lshl_b32 s96, s71, 6
    s_add_u32 s50, s50, s96
    s_mul_i32 s51, s71, -48
    s_add_u32 s51, s51, 192
    s_lshr_b32 s96, s87, 1
    s_add_u32 s52, s96, s87
    s_mul_i32 s91, s3, 491520
    s_lshl_b32 s96, s50, 1
    s_add_u32 s91, s91, s96
    s_add_u32 s55, s91, 491520
    s_mul_i32 s96, s52, 81920
    s_add_u32 s91, s91, s96
    s_mov_b32 s64, 40960
    s_mov_b32 s65, 81920
    s_mov_b32 s54, 0
    v_mul_u32_u24 v121, 1280, v129
    v_lshlrev_b32 v120, 1, v131
    v_xor_b32 v120, v120, v128
    v_lshl_add_u32 v248, v120, 4, v121
    v_add_u32 v249, 9216, v248
    v_add_u32 v250, 18432, v248
    v_add_u32 v251, 27648, v248
    v_add_u32 v253, 0, v248
    v_lshrrev_b32 v120, 3, v0
    v_and_b32 v120, 3, v120
    v_lshlrev_b32 v120, 5, v120
    v_lshrrev_b32 v121, 2, v0
    v_lshl_add_u32 v120, v121, 7, v120
    v_and_b32 v121, 3, v0
    v_lshl_add_u32 v38, v121, 3, v120
    v_mov_b32 v39, v38
    s_branch L_wsE13
L_wsP13:
    s_mov_b32 s28, s50
    s_mov_b32 s29, s51
    s_mov_b32 s30, 819200
    s_mov_b32 s31, 0x20000
    s_mov_b32 s36, s52
    s_mov_b32 s37, s53
    s_mov_b32 s38, 819200
    s_mov_b32 s39, 0x20000
    s_mul_i32 s50, s70, 320
    s_lshl_b32 s96, s71, 6
    s_add_u32 s50, s50, s96
    s_mul_i32 s51, s71, -48
    s_add_u32 s51, s51, 192
    s_mul_i32 s54, s3, 5
    s_add_u32 s54, s54, 1
    s_lshr_b32 s54, s54, 1
    s_and_b32 s52, s87, 1
    s_mul_i32 s91, s50, 1280
    s_lshl_b32 s96, s54, 7
    s_add_u32 s91, s91, s96
    s_mov_b32 s64, 51200
    s_mul_i32 s54, s77, -320
    s_add_u32 s54, s54, 256
    s_add_u32 s54, s54, s91
    s_lshl_b32 s96, s52, 7
    s_add_u32 s91, s91, s96
    s_mul_i32 s65, s52, -256
    s_add_u32 s65, s65, 128
    s_mov_b32 s55, -1
    v_mul_u32_u24 v120, 1280, v129
    v_add_u32 v248, v120, v126
    v_add_u32 v249, v120, v127
    v_add_u32 v249, 9216, v249
    v_add_u32 v250, v120, v126
    v_add_u32 v250, 18432, v250
    v_add_u32 v251, v120, v127
    v_add_u32 v251, 27648, v251
    v_add_u32 v253, v120, v126
    v_add_u32 v253, 40960, v253
    v_lshrrev_b32 v120, 2, v0
    v_mul_u32_u24 v120, 1280, v120
    v_and_b32 v121, 3, v0
    v_xor_b32 v121, v121, v131
    v_lshl_add_u32 v120, v121, 4, v120
    v_accvgpr_write_b32 a254, v120
    v_lshrrev_b32 v121, 1, v131
    v_and_b32 v122, 1, v131
    v_lshrrev_b32 v120, 1, v130
    v_xor_b32 v120, v120, v121
    v_lshlrev_b32 v120, 4, v120
    v_lshl_add_u32 v120, v130, 7, v120
    v_lshl_add_u32 v38, v122, 3, v120
    v_lshrrev_b32 v120, 2, v130
    v_xor_b32 v120, v120, v121
    v_lshlrev_b32 v120, 4, v120
    v_lshl_add_u32 v120, v130, 6, v120
    v_lshl_add_u32 v39, v122, 3, v120
L_wsE13:
    s_xor_b32 s53, s92, 1
    s_mul_i32 s53, s53, s51
    s_mul_i32 s53, s53, 1280
    s_mul_i32 s94, s89, 163840
    s_mul_i32 s96, s3, 40960
    s_add_u32 s94, s94, s96
    s_mul_i32 s96, s92, 20480
    s_add_u32 s94, s94, s96
    s_lshl_b32 s96, s50, 1
    s_add_u32 s94, s94, s96
    s_mul_i32 s63, s3, 10240
    v_add_u32 v38, s63, v38
    v_add_u32 v39, s63, v39
    s_lshl_b32 s96, s51, 1
    v_mov_b32 v124, s96
    v_mul_u32_u24 v120, 205, v0
    v_lshrrev_b32 v120, 12, v120
    v_mul_u32_u24 v122, 20, v120
    v_sub_u32 v122, v0, v122
    v_cmp_le_u32 vcc, 16, v122
    v_lshlrev_b32 v122, 3, v122
    s_nop 0
    v_cndmask_b32 v121, 0, v124, vcc
    v_add_u32 v122, v122, v121
    v_mul_u32_u24 v120, 1280, v120
    v_add_u32 v120, v120, v122
    v_cmp_le_u32 vcc, 12, v130
    v_lshl_add_u32 v123, v130, 3, 32
    s_nop 0
    v_cndmask_b32 v121, 0, v124, vcc
    v_add_u32 v123, v123, v121
    v_mul_u32_u24 v121, 5120, v131
    v_add_u32 v121, v121, v123
    v_add_u32 v121, 3840, v121
    s_lshl_b32 s96, s50, 1
    v_add_u32 v122, s96, v122
    v_add_u32 v123, s96, v123
    v_accvgpr_write_b32 a240, v120
    v_accvgpr_write_b32 a241, v121
    v_accvgpr_write_b32 a242, v122
    v_accvgpr_write_b32 a243, v123
    s_lshl_b32 s67, s89, 6
    s_lshl_b32 s96, s90, 3
    s_add_u32 s67, s67, s96
    s_lshl_b32 s96, s92, 2
    s_add_u32 s67, s67, s96
    s_add_u32 s67, s67, s3
    s_mul_i32 s67, s67, 3072
    s_add_u32 s67, s67, 17825792
    s_mul_i32 s71, s92, 14
    s_add_u32 s71, s71, 10
    s_lshl_b32 s70, s89, 2
    s_add_u32 s70, s70, s3
    s_mul_i32 s32, s70, s71
    s_lshl_b32 s32, s32, 7
    s_mul_i32 s71, s92, 131072
    s_add_u32 s32, s32, s71
    s_add_u32 s32, s32, 24117248
    s_lshl_b32 s70, s89, 5
    s_add_u32 s70, s70, s3
    s_lshl_b32 s71, s92, 11
    s_add_u32 s71, s71, 10240
    s_mul_i32 s33, s70, s71
    s_mul_i32 s71, s92, 6291456
    s_add_u32 s33, s33, s71
    v_lshrrev_b32 v120, 1, v130
    v_xor_b32 v120, v120, v131
    v_lshlrev_b32 v120, 4, v120
    v_lshl_add_u32 v120, v130, 7, v120
    v_xor_b32 v121, 64, v120
    s_lshl_b32 s96, s77, 13
    v_add_u32 v10, s96, v120
    v_add_u32 v11, s96, v121
    v_lshrrev_b32 v122, 2, v130
    v_lshl_add_u32 v123, v131, 3, v122
    v_lshlrev_b32 v123, 7, v123
    v_and_b32 v124, 3, v0
    v_lshl_add_u32 v123, v124, 3, v123
    v_lshrrev_b32 v122, 1, v122
    v_and_b32 v124, 1, v131
    v_lshl_add_u32 v122, v124, 1, v122
    s_lshl_b32 s96, s78, 1
    v_xor_b32 v122, s96, v122
    v_lshl_add_u32 v14, v122, 5, v123
    v_add_u32 v14, 16384, v14
    v_xor_b32 v122, 1, v122
    v_lshl_add_u32 v15, v122, 5, v123
    v_add_u32 v15, 16384, v15
    v_add_u32 v18, 40960, v10
    v_add_u32 v19, 40960, v11
    v_add_u32 v22, 40960, v14
    v_add_u32 v23, 40960, v15
    v_add_u32 v26, 81920, v10
    v_add_u32 v27, 81920, v11
    v_add_u32 v30, 81920, v14
    v_add_u32 v31, 81920, v15
    s_lshl_b32 s84, s80, 7
    s_add_u32 s81, s61, s84
    s_add_u32 m0, s58, 40960
    s_nop 0
    buffer_load_dwordx4 v2, s[4:7], s81 offen offset:0  lds
    s_mul_i32 s83, s80, 196608
    buffer_load_dwordx4 v3, s[4:7], s81 offen offset:1024  lds
    s_add_u32 s83, s83, s79
    s_add_u32 s80, s80, 1
    buffer_load_dwordx4 v4, s[4:7], s81 offen offset:2048  lds
    s_cmp_eq_u32 s80, 10
    s_cselect_b32 s80, 0, s80
    buffer_load_dwordx4 v5, s[4:7], s81 offen offset:3072  lds
    s_add_u32 m0, s59, 40960
    s_nop 0
    buffer_load_dwordx4 v8, s[16:19], s83 offen offset:0  lds
    buffer_load_dwordx4 v9, s[16:19], s83 offen offset:1024  lds
    s_add_u32 s83, s83, 128
    s_add_u32 m0, s59, 49152
    s_nop 0
    buffer_load_dwordx4 v8, s[16:19], s83 offen offset:0  lds
    buffer_load_dwordx4 v9, s[16:19], s83 offen offset:1024  lds
    s_add_u32 s83, s83, 128
    s_add_u32 m0, s59, 57344
    s_nop 0
    buffer_load_dwordx4 v8, s[16:19], s83 offen offset:0  lds
    buffer_load_dwordx4 v9, s[16:19], s83 offen offset:1024  lds
    v_min_u32 v120, 9, v0
    v_lshlrev_b32 v120, 7, v120
    global_load_dword a255, v120, s[56:57]
    s_waitcnt vmcnt(11)
    s_barrier
    ds_read_b128 v[40:43], v10 offset:0
    ds_read_b64_tr_b16 v[56:57], v14 offset:0
    ds_read_b64_tr_b16 v[58:59], v14 offset:512
    ds_read_b128 v[44:47], v10 offset:2048
    ds_read_b128 v[48:51], v10 offset:4096
    ds_read_b128 v[52:55], v10 offset:6144
    ds_read_b64_tr_b16 v[60:61], v15 offset:0
    ds_read_b64_tr_b16 v[62:63], v15 offset:512
    ds_read_b64_tr_b16 v[64:65], v14 offset:8192
    ds_read_b64_tr_b16 v[66:67], v14 offset:8704
    ds_read_b64_tr_b16 v[68:69], v15 offset:8192
    ds_read_b64_tr_b16 v[70:71], v15 offset:8704
    ds_read_b64_tr_b16 v[72:73], v14 offset:16384
    ds_read_b64_tr_b16 v[74:75], v14 offset:16896
    ds_read_b64_tr_b16 v[76:77], v15 offset:16384
    ds_read_b64_tr_b16 v[78:79], v15 offset:16896
    s_waitcnt lgkmcnt(0)
    v_mfma_f32_16x16x32_bf16 v[136:139], v[56:59], v[40:43], 0
    ds_read_b128 v[88:91], v11 offset:0
    v_mfma_f32_16x16x32_bf16 v[140:143], v[56:59], v[44:47], 0
    ds_read_b64_tr_b16 v[104:105], v14 offset:4096
    v_mfma_f32_16x16x32_bf16 v[144:147], v[56:59], v[48:51], 0
    ds_read_b64_tr_b16 v[106:107], v14 offset:4608
    s_lshl_b32 s84, s80, 7
    s_add_u32 s81, s61, s84
    s_add_u32 m0, s58, 81920
    v_mfma_f32_16x16x32_bf16 v[148:151], v[56:59], v[52:55], 0
    buffer_load_dwordx4 v2, s[4:7], s81 offen offset:0  lds
    v_mfma_f32_16x16x32_bf16 v[152:155], v[60:63], v[40:43], 0
    ds_read_b128 v[92:95], v11 offset:2048
    v_mfma_f32_16x16x32_bf16 v[156:159], v[60:63], v[44:47], 0
    ds_read_b128 v[96:99], v11 offset:4096
    v_mfma_f32_16x16x32_bf16 v[160:163], v[60:63], v[48:51], 0
    ds_read_b128 v[100:103], v11 offset:6144
    s_mul_i32 s83, s80, 196608
    v_mfma_f32_16x16x32_bf16 v[164:167], v[60:63], v[52:55], 0
    buffer_load_dwordx4 v3, s[4:7], s81 offen offset:1024  lds
    v_mfma_f32_16x16x32_bf16 v[168:171], v[64:67], v[40:43], 0
    ds_read_b64_tr_b16 v[108:109], v15 offset:4096
    v_mfma_f32_16x16x32_bf16 v[172:175], v[64:67], v[44:47], 0
    ds_read_b64_tr_b16 v[110:111], v15 offset:4608
    v_mfma_f32_16x16x32_bf16 v[176:179], v[64:67], v[48:51], 0
    ds_read_b64_tr_b16 v[112:113], v14 offset:12288
    s_add_u32 s83, s83, s79
    s_add_u32 s80, s80, 1
    v_mfma_f32_16x16x32_bf16 v[180:183], v[64:67], v[52:55], 0
    buffer_load_dwordx4 v4, s[4:7], s81 offen offset:2048  lds
    v_mfma_f32_16x16x32_bf16 v[184:187], v[68:71], v[40:43], 0
    ds_read_b64_tr_b16 v[114:115], v14 offset:12800
    v_mfma_f32_16x16x32_bf16 v[188:191], v[68:71], v[44:47], 0
    ds_read_b64_tr_b16 v[116:117], v15 offset:12288
    v_mfma_f32_16x16x32_bf16 v[192:195], v[68:71], v[48:51], 0
    ds_read_b64_tr_b16 v[118:119], v15 offset:12800
    s_cmp_eq_u32 s80, 10
    s_cselect_b32 s80, 0, s80
    v_mfma_f32_16x16x32_bf16 v[196:199], v[68:71], v[52:55], 0
    buffer_load_dwordx4 v5, s[4:7], s81 offen offset:3072  lds
    v_mfma_f32_16x16x32_bf16 v[200:203], v[72:75], v[40:43], 0
    ds_read_b64_tr_b16 v[120:121], v14 offset:20480
    v_mfma_f32_16x16x32_bf16 v[204:207], v[72:75], v[44:47], 0
    ds_read_b64_tr_b16 v[122:123], v14 offset:20992
    v_mfma_f32_16x16x32_bf16 v[208:211], v[72:75], v[48:51], 0
    ds_read_b64_tr_b16 v[124:125], v15 offset:20480
    s_add_u32 m0, s59, 81920
    v_mfma_f32_16x16x32_bf16 v[212:215], v[72:75], v[52:55], 0
    buffer_load_dwordx4 v8, s[16:19], s83 offen offset:0  lds
    v_mfma_f32_16x16x32_bf16 v[216:219], v[76:79], v[40:43], 0
    ds_read_b64_tr_b16 v[126:127], v15 offset:20992
    v_mfma_f32_16x16x32_bf16 v[220:223], v[76:79], v[44:47], 0
    v_mfma_f32_16x16x32_bf16 v[224:227], v[76:79], v[48:51], 0
    v_mfma_f32_16x16x32_bf16 v[228:231], v[76:79], v[52:55], 0
    buffer_load_dwordx4 v9, s[16:19], s83 offen offset:1024  lds
    s_waitcnt lgkmcnt(0)
    s_waitcnt vmcnt(7)
    s_barrier
    v_mfma_f32_16x16x32_bf16 v[136:139], v[104:107], v[88:91], v[136:139]
    ds_read_b128 v[40:43], v18 offset:0
    v_mfma_f32_16x16x32_bf16 v[140:143], v[104:107], v[92:95], v[140:143]
    ds_read_b64_tr_b16 v[56:57], v22 offset:0
    v_mfma_f32_16x16x32_bf16 v[144:147], v[104:107], v[96:99], v[144:147]
    ds_read_b64_tr_b16 v[58:59], v22 offset:512
    s_add_u32 s83, s83, 128
    s_add_u32 m0, s59, 90112
    v_mfma_f32_16x16x32_bf16 v[148:151], v[104:107], v[100:103], v[148:151]
    buffer_load_dwordx4 v8, s[16:19], s83 offen offset:0  lds
    v_mfma_f32_16x16x32_bf16 v[152:155], v[108:111], v[88:91], v[152:155]
    ds_read_b128 v[44:47], v18 offset:2048
    v_mfma_f32_16x16x32_bf16 v[156:159], v[108:111], v[92:95], v[156:159]
    ds_read_b128 v[48:51], v18 offset:4096
    v_mfma_f32_16x16x32_bf16 v[160:163], v[108:111], v[96:99], v[160:163]
    ds_read_b128 v[52:55], v18 offset:6144
    v_mfma_f32_16x16x32_bf16 v[164:167], v[108:111], v[100:103], v[164:167]
    buffer_load_dwordx4 v9, s[16:19], s83 offen offset:1024  lds
    v_mfma_f32_16x16x32_bf16 v[168:171], v[112:115], v[88:91], v[168:171]
    ds_read_b64_tr_b16 v[60:61], v23 offset:0
    v_mfma_f32_16x16x32_bf16 v[172:175], v[112:115], v[92:95], v[172:175]
    ds_read_b64_tr_b16 v[62:63], v23 offset:512
    v_mfma_f32_16x16x32_bf16 v[176:179], v[112:115], v[96:99], v[176:179]
    ds_read_b64_tr_b16 v[64:65], v22 offset:8192
    s_add_u32 s83, s83, 128
    s_add_u32 m0, s59, 98304
    v_mfma_f32_16x16x32_bf16 v[180:183], v[112:115], v[100:103], v[180:183]
    buffer_load_dwordx4 v8, s[16:19], s83 offen offset:0  lds
    v_mfma_f32_16x16x32_bf16 v[184:187], v[116:119], v[88:91], v[184:187]
    ds_read_b64_tr_b16 v[66:67], v22 offset:8704
    v_mfma_f32_16x16x32_bf16 v[188:191], v[116:119], v[92:95], v[188:191]
    ds_read_b64_tr_b16 v[68:69], v23 offset:8192
    v_mfma_f32_16x16x32_bf16 v[192:195], v[116:119], v[96:99], v[192:195]
    ds_read_b64_tr_b16 v[70:71], v23 offset:8704
    v_mfma_f32_16x16x32_bf16 v[196:199], v[116:119], v[100:103], v[196:199]
    buffer_load_dwordx4 v9, s[16:19], s83 offen offset:1024  lds
    v_mfma_f32_16x16x32_bf16 v[200:203], v[120:123], v[88:91], v[200:203]
    ds_read_b64_tr_b16 v[72:73], v22 offset:16384
    global_load_dword v35, v34, s[68:69] sc1
    v_mfma_f32_16x16x32_bf16 v[204:207], v[120:123], v[92:95], v[204:207]
    ds_read_b64_tr_b16 v[74:75], v22 offset:16896
    v_mfma_f32_16x16x32_bf16 v[208:211], v[120:123], v[96:99], v[208:211]
    ds_read_b64_tr_b16 v[76:77], v23 offset:16384
    s_lshl_b32 s84, s80, 7
    s_add_u32 s81, s61, s84
    s_add_u32 m0, s58, 0
    v_mfma_f32_16x16x32_bf16 v[212:215], v[120:123], v[100:103], v[212:215]
    buffer_load_dwordx4 v2, s[4:7], s81 offen offset:0  lds
    v_mfma_f32_16x16x32_bf16 v[216:219], v[124:127], v[88:91], v[216:219]
    ds_read_b64_tr_b16 v[78:79], v23 offset:16896
    v_mfma_f32_16x16x32_bf16 v[220:223], v[124:127], v[92:95], v[220:223]
    v_mfma_f32_16x16x32_bf16 v[224:227], v[124:127], v[96:99], v[224:227]
    s_mul_i32 s83, s80, 196608
    v_mfma_f32_16x16x32_bf16 v[228:231], v[124:127], v[100:103], v[228:231]
    buffer_load_dwordx4 v3, s[4:7], s81 offen offset:1024  lds
    s_waitcnt lgkmcnt(0)
    v_mfma_f32_16x16x32_bf16 v[136:139], v[56:59], v[40:43], v[136:139]
    ds_read_b128 v[88:91], v19 offset:0
    v_mfma_f32_16x16x32_bf16 v[140:143], v[56:59], v[44:47], v[140:143]
    ds_read_b64_tr_b16 v[104:105], v22 offset:4096
    v_mfma_f32_16x16x32_bf16 v[144:147], v[56:59], v[48:51], v[144:147]
    ds_read_b64_tr_b16 v[106:107], v22 offset:4608
    s_add_u32 s83, s83, s79
    s_add_u32 s80, s80, 1
    v_mfma_f32_16x16x32_bf16 v[148:151], v[56:59], v[52:55], v[148:151]
    buffer_load_dwordx4 v4, s[4:7], s81 offen offset:2048  lds
    v_mfma_f32_16x16x32_bf16 v[152:155], v[60:63], v[40:43], v[152:155]
    ds_read_b128 v[92:95], v19 offset:2048
    v_mfma_f32_16x16x32_bf16 v[156:159], v[60:63], v[44:47], v[156:159]
    ds_read_b128 v[96:99], v19 offset:4096
    v_mfma_f32_16x16x32_bf16 v[160:163], v[60:63], v[48:51], v[160:163]
    ds_read_b128 v[100:103], v19 offset:6144
    s_cmp_eq_u32 s80, 10
    s_cselect_b32 s80, 0, s80
    v_mfma_f32_16x16x32_bf16 v[164:167], v[60:63], v[52:55], v[164:167]
    buffer_load_dwordx4 v5, s[4:7], s81 offen offset:3072  lds
    v_mfma_f32_16x16x32_bf16 v[168:171], v[64:67], v[40:43], v[168:171]
    ds_read_b64_tr_b16 v[108:109], v23 offset:4096
    v_mfma_f32_16x16x32_bf16 v[172:175], v[64:67], v[44:47], v[172:175]
    ds_read_b64_tr_b16 v[110:111], v23 offset:4608
    v_mfma_f32_16x16x32_bf16 v[176:179], v[64:67], v[48:51], v[176:179]
    ds_read_b64_tr_b16 v[112:113], v22 offset:12288
    s_add_u32 m0, s59, 0
    v_mfma_f32_16x16x32_bf16 v[180:183], v[64:67], v[52:55], v[180:183]
    buffer_load_dwordx4 v8, s[16:19], s83 offen offset:0  lds
    v_mfma_f32_16x16x32_bf16 v[184:187], v[68:71], v[40:43], v[184:187]
    ds_read_b64_tr_b16 v[114:115], v22 offset:12800
    v_mfma_f32_16x16x32_bf16 v[188:191], v[68:71], v[44:47], v[188:191]
    ds_read_b64_tr_b16 v[116:117], v23 offset:12288
    v_mfma_f32_16x16x32_bf16 v[192:195], v[68:71], v[48:51], v[192:195]
    ds_read_b64_tr_b16 v[118:119], v23 offset:12800
    v_mfma_f32_16x16x32_bf16 v[196:199], v[68:71], v[52:55], v[196:199]
    buffer_load_dwordx4 v9, s[16:19], s83 offen offset:1024  lds
    v_mfma_f32_16x16x32_bf16 v[200:203], v[72:75], v[40:43], v[200:203]
    ds_read_b64_tr_b16 v[120:121], v22 offset:20480
    v_mfma_f32_16x16x32_bf16 v[204:207], v[72:75], v[44:47], v[204:207]
    ds_read_b64_tr_b16 v[122:123], v22 offset:20992
    v_mfma_f32_16x16x32_bf16 v[208:211], v[72:75], v[48:51], v[208:211]
    ds_read_b64_tr_b16 v[124:125], v23 offset:20480
    s_add_u32 s83, s83, 128
    s_add_u32 m0, s59, 8192
    v_mfma_f32_16x16x32_bf16 v[212:215], v[72:75], v[52:55], v[212:215]
    buffer_load_dwordx4 v8, s[16:19], s83 offen offset:0  lds
    v_mfma_f32_16x16x32_bf16 v[216:219], v[76:79], v[40:43], v[216:219]
    ds_read_b64_tr_b16 v[126:127], v23 offset:20992
    v_mfma_f32_16x16x32_bf16 v[220:223], v[76:79], v[44:47], v[220:223]
    v_mfma_f32_16x16x32_bf16 v[224:227], v[76:79], v[48:51], v[224:227]
    v_mfma_f32_16x16x32_bf16 v[228:231], v[76:79], v[52:55], v[228:231]
    buffer_load_dwordx4 v9, s[16:19], s83 offen offset:1024  lds
    s_waitcnt lgkmcnt(0)
    s_waitcnt vmcnt(9)
    s_barrier
    v_mfma_f32_16x16x32_bf16 v[136:139], v[104:107], v[88:91], v[136:139]
    ds_read_b128 v[40:43], v26 offset:0
    v_mfma_f32_16x16x32_bf16 v[140:143], v[104:107], v[92:95], v[140:143]
    ds_read_b64_tr_b16 v[56:57], v30 offset:0
    v_mfma_f32_16x16x32_bf16 v[144:147], v[104:107], v[96:99], v[144:147]
    ds_read_b64_tr_b16 v[58:59], v30 offset:512
    s_add_u32 s83, s83, 128
    s_add_u32 m0, s59, 16384
    v_mfma_f32_16x16x32_bf16 v[148:151], v[104:107], v[100:103], v[148:151]
    buffer_load_dwordx4 v8, s[16:19], s83 offen offset:0  lds
    v_mfma_f32_16x16x32_bf16 v[152:155], v[108:111], v[88:91], v[152:155]
    ds_read_b128 v[44:47], v26 offset:2048
    v_mfma_f32_16x16x32_bf16 v[156:159], v[108:111], v[92:95], v[156:159]
    ds_read_b128 v[48:51], v26 offset:4096
    v_mfma_f32_16x16x32_bf16 v[160:163], v[108:111], v[96:99], v[160:163]
    ds_read_b128 v[52:55], v26 offset:6144
    v_mfma_f32_16x16x32_bf16 v[164:167], v[108:111], v[100:103], v[164:167]
    buffer_load_dwordx4 v9, s[16:19], s83 offen offset:1024  lds
    v_mfma_f32_16x16x32_bf16 v[168:171], v[112:115], v[88:91], v[168:171]
    ds_read_b64_tr_b16 v[60:61], v31 offset:0
    v_mfma_f32_16x16x32_bf16 v[172:175], v[112:115], v[92:95], v[172:175]
    ds_read_b64_tr_b16 v[62:63], v31 offset:512
    v_mfma_f32_16x16x32_bf16 v[176:179], v[112:115], v[96:99], v[176:179]
    ds_read_b64_tr_b16 v[64:65], v30 offset:8192
    s_lshl_b32 s84, s80, 7
    s_add_u32 s81, s61, s84
    s_add_u32 m0, s58, 40960
    v_mfma_f32_16x16x32_bf16 v[180:183], v[112:115], v[100:103], v[180:183]
    buffer_load_dwordx4 v2, s[4:7], s81 offen offset:0  lds
    v_mfma_f32_16x16x32_bf16 v[184:187], v[116:119], v[88:91], v[184:187]
    ds_read_b64_tr_b16 v[66:67], v30 offset:8704
    v_mfma_f32_16x16x32_bf16 v[188:191], v[116:119], v[92:95], v[188:191]
    ds_read_b64_tr_b16 v[68:69], v31 offset:8192
    v_mfma_f32_16x16x32_bf16 v[192:195], v[116:119], v[96:99], v[192:195]
    ds_read_b64_tr_b16 v[70:71], v31 offset:8704
    s_mul_i32 s83, s80, 196608
    v_mfma_f32_16x16x32_bf16 v[196:199], v[116:119], v[100:103], v[196:199]
    buffer_load_dwordx4 v3, s[4:7], s81 offen offset:1024  lds
    v_mfma_f32_16x16x32_bf16 v[200:203], v[120:123], v[88:91], v[200:203]
    ds_read_b64_tr_b16 v[72:73], v30 offset:16384
    v_mfma_f32_16x16x32_bf16 v[204:207], v[120:123], v[92:95], v[204:207]
    ds_read_b64_tr_b16 v[74:75], v30 offset:16896
    v_mfma_f32_16x16x32_bf16 v[208:211], v[120:123], v[96:99], v[208:211]
    ds_read_b64_tr_b16 v[76:77], v31 offset:16384
    s_add_u32 s83, s83, s79
    s_add_u32 s80, s80, 1
    v_mfma_f32_16x16x32_bf16 v[212:215], v[120:123], v[100:103], v[212:215]
    buffer_load_dwordx4 v4, s[4:7], s81 offen offset:2048  lds
    v_mfma_f32_16x16x32_bf16 v[216:219], v[124:127], v[88:91], v[216:219]
    ds_read_b64_tr_b16 v[78:79], v31 offset:16896
    v_mfma_f32_16x16x32_bf16 v[220:223], v[124:127], v[92:95], v[220:223]
    v_mfma_f32_16x16x32_bf16 v[224:227], v[124:127], v[96:99], v[224:227]
    s_cmp_eq_u32 s80, 10
    s_cselect_b32 s80, 0, s80
    v_mfma_f32_16x16x32_bf16 v[228:231], v[124:127], v[100:103], v[228:231]
    buffer_load_dwordx4 v5, s[4:7], s81 offen offset:3072  lds
    s_waitcnt lgkmcnt(0)
    v_mfma_f32_16x16x32_bf16 v[136:139], v[56:59], v[40:43], v[136:139]
    ds_read_b128 v[88:91], v27 offset:0
    v_mfma_f32_16x16x32_bf16 v[140:143], v[56:59], v[44:47], v[140:143]
    ds_read_b64_tr_b16 v[104:105], v30 offset:4096
    v_mfma_f32_16x16x32_bf16 v[144:147], v[56:59], v[48:51], v[144:147]
    ds_read_b64_tr_b16 v[106:107], v30 offset:4608
    s_add_u32 m0, s59, 40960
    v_mfma_f32_16x16x32_bf16 v[148:151], v[56:59], v[52:55], v[148:151]
    buffer_load_dwordx4 v8, s[16:19], s83 offen offset:0  lds
    v_mfma_f32_16x16x32_bf16 v[152:155], v[60:63], v[40:43], v[152:155]
    ds_read_b128 v[92:95], v27 offset:2048
    v_mfma_f32_16x16x32_bf16 v[156:159], v[60:63], v[44:47], v[156:159]
    ds_read_b128 v[96:99], v27 offset:4096
    v_mfma_f32_16x16x32_bf16 v[160:163], v[60:63], v[48:51], v[160:163]
    ds_read_b128 v[100:103], v27 offset:6144
    v_mfma_f32_16x16x32_bf16 v[164:167], v[60:63], v[52:55], v[164:167]
    buffer_load_dwordx4 v9, s[16:19], s83 offen offset:1024  lds
    v_mfma_f32_16x16x32_bf16 v[168:171], v[64:67], v[40:43], v[168:171]
    ds_read_b64_tr_b16 v[108:109], v31 offset:4096
    v_mfma_f32_16x16x32_bf16 v[172:175], v[64:67], v[44:47], v[172:175]
    ds_read_b64_tr_b16 v[110:111], v31 offset:4608
    v_mfma_f32_16x16x32_bf16 v[176:179], v[64:67], v[48:51], v[176:179]
    ds_read_b64_tr_b16 v[112:113], v30 offset:12288
    s_add_u32 s83, s83, 128
    s_add_u32 m0, s59, 49152
    v_mfma_f32_16x16x32_bf16 v[180:183], v[64:67], v[52:55], v[180:183]
    buffer_load_dwordx4 v8, s[16:19], s83 offen offset:0  lds
    v_mfma_f32_16x16x32_bf16 v[184:187], v[68:71], v[40:43], v[184:187]
    ds_read_b64_tr_b16 v[114:115], v30 offset:12800
    v_mfma_f32_16x16x32_bf16 v[188:191], v[68:71], v[44:47], v[188:191]
    ds_read_b64_tr_b16 v[116:117], v31 offset:12288
    v_mfma_f32_16x16x32_bf16 v[192:195], v[68:71], v[48:51], v[192:195]
    ds_read_b64_tr_b16 v[118:119], v31 offset:12800
    v_mfma_f32_16x16x32_bf16 v[196:199], v[68:71], v[52:55], v[196:199]
    buffer_load_dwordx4 v9, s[16:19], s83 offen offset:1024  lds
    v_mfma_f32_16x16x32_bf16 v[200:203], v[72:75], v[40:43], v[200:203]
    ds_read_b64_tr_b16 v[120:121], v30 offset:20480
    v_mfma_f32_16x16x32_bf16 v[204:207], v[72:75], v[44:47], v[204:207]
    ds_read_b64_tr_b16 v[122:123], v30 offset:20992
    v_mfma_f32_16x16x32_bf16 v[208:211], v[72:75], v[48:51], v[208:211]
    ds_read_b64_tr_b16 v[124:125], v31 offset:20480
    s_add_u32 s83, s83, 128
    s_add_u32 m0, s59, 57344
    v_mfma_f32_16x16x32_bf16 v[212:215], v[72:75], v[52:55], v[212:215]
    buffer_load_dwordx4 v8, s[16:19], s83 offen offset:0  lds
    v_mfma_f32_16x16x32_bf16 v[216:219], v[76:79], v[40:43], v[216:219]
    ds_read_b64_tr_b16 v[126:127], v31 offset:20992
    v_mfma_f32_16x16x32_bf16 v[220:223], v[76:79], v[44:47], v[220:223]
    v_mfma_f32_16x16x32_bf16 v[224:227], v[76:79], v[48:51], v[224:227]
    v_mfma_f32_16x16x32_bf16 v[228:231], v[76:79], v[52:55], v[228:231]
    buffer_load_dwordx4 v9, s[16:19], s83 offen offset:1024  lds
    s_waitcnt lgkmcnt(0)
    s_waitcnt vmcnt(10)
    s_barrier
    v_mfma_f32_16x16x32_bf16 v[136:139], v[104:107], v[88:91], v[136:139]
    ds_read_b128 v[40:43], v10 offset:0
    v_mfma_f32_16x16x32_bf16 v[140:143], v[104:107], v[92:95], v[140:143]
    ds_read_b64_tr_b16 v[56:57], v14 offset:0
    v_mfma_f32_16x16x32_bf16 v[144:147], v[104:107], v[96:99], v[144:147]
    ds_read_b64_tr_b16 v[58:59], v14 offset:512
    s_lshl_b32 s84, s80, 7
    s_add_u32 s81, s61, s84
    s_add_u32 m0, s58, 81920
    v_mfma_f32_16x16x32_bf16 v[148:151], v[104:107], v[100:103], v[148:151]
    buffer_load_dwordx4 v2, s[4:7], s81 offen offset:0  lds
    v_mfma_f32_16x16x32_bf16 v[152:155], v[108:111], v[88:91], v[152:155]
    ds_read_b128 v[44:47], v10 offset:2048
    v_mfma_f32_16x16x32_bf16 v[156:159], v[108:111], v[92:95], v[156:159]
    ds_read_b128 v[48:51], v10 offset:4096
    v_mfma_f32_16x16x32_bf16 v[160:163], v[108:111], v[96:99], v[160:163]
    ds_read_b128 v[52:55], v10 offset:6144
    s_mul_i32 s83, s80, 196608
    v_mfma_f32_16x16x32_bf16 v[164:167], v[108:111], v[100:103], v[164:167]
    buffer_load_dwordx4 v3, s[4:7], s81 offen offset:1024  lds
    v_mfma_f32_16x16x32_bf16 v[168:171], v[112:115], v[88:91], v[168:171]
    ds_read_b64_tr_b16 v[60:61], v15 offset:0
    v_mfma_f32_16x16x32_bf16 v[172:175], v[112:115], v[92:95], v[172:175]
    ds_read_b64_tr_b16 v[62:63], v15 offset:512
    v_mfma_f32_16x16x32_bf16 v[176:179], v[112:115], v[96:99], v[176:179]
    ds_read_b64_tr_b16 v[64:65], v14 offset:8192
    s_add_u32 s83, s83, s79
    s_add_u32 s80, s80, 1
    v_mfma_f32_16x16x32_bf16 v[180:183], v[112:115], v[100:103], v[180:183]
    buffer_load_dwordx4 v4, s[4:7], s81 offen offset:2048  lds
    v_mfma_f32_16x16x32_bf16 v[184:187], v[116:119], v[88:91], v[184:187]
    ds_read_b64_tr_b16 v[66:67], v14 offset:8704
    v_mfma_f32_16x16x32_bf16 v[188:191], v[116:119], v[92:95], v[188:191]
    ds_read_b64_tr_b16 v[68:69], v15 offset:8192
    v_mfma_f32_16x16x32_bf16 v[192:195], v[116:119], v[96:99], v[192:195]
    ds_read_b64_tr_b16 v[70:71], v15 offset:8704
    s_cmp_eq_u32 s80, 10
    s_cselect_b32 s80, 0, s80
    v_mfma_f32_16x16x32_bf16 v[196:199], v[116:119], v[100:103], v[196:199]
    buffer_load_dwordx4 v5, s[4:7], s81 offen offset:3072  lds
    v_mfma_f32_16x16x32_bf16 v[200:203], v[120:123], v[88:91], v[200:203]
    ds_read_b64_tr_b16 v[72:73], v14 offset:16384
    v_mfma_f32_16x16x32_bf16 v[204:207], v[120:123], v[92:95], v[204:207]
    ds_read_b64_tr_b16 v[74:75], v14 offset:16896
    v_mfma_f32_16x16x32_bf16 v[208:211], v[120:123], v[96:99], v[208:211]
    ds_read_b64_tr_b16 v[76:77], v15 offset:16384
    s_add_u32 m0, s59, 81920
    v_mfma_f32_16x16x32_bf16 v[212:215], v[120:123], v[100:103], v[212:215]
    buffer_load_dwordx4 v8, s[16:19], s83 offen offset:0  lds
    v_mfma_f32_16x16x32_bf16 v[216:219], v[124:127], v[88:91], v[216:219]
    ds_read_b64_tr_b16 v[78:79], v15 offset:16896
    v_mfma_f32_16x16x32_bf16 v[220:223], v[124:127], v[92:95], v[220:223]
    v_mfma_f32_16x16x32_bf16 v[224:227], v[124:127], v[96:99], v[224:227]
    v_mfma_f32_16x16x32_bf16 v[228:231], v[124:127], v[100:103], v[228:231]
    s_waitcnt lgkmcnt(0)
    v_mfma_f32_16x16x32_bf16 v[136:139], v[56:59], v[40:43], v[136:139]
    ds_read_b128 v[88:91], v11 offset:0
    v_mfma_f32_16x16x32_bf16 v[140:143], v[56:59], v[44:47], v[140:143]
    ds_read_b64_tr_b16 v[104:105], v14 offset:4096
    v_mfma_f32_16x16x32_bf16 v[144:147], v[56:59], v[48:51], v[144:147]
    ds_read_b64_tr_b16 v[106:107], v14 offset:4608
    v_mfma_f32_16x16x32_bf16 v[148:151], v[56:59], v[52:55], v[148:151]
    buffer_load_dwordx4 v9, s[16:19], s83 offen offset:1024  lds
    v_mfma_f32_16x16x32_bf16 v[152:155], v[60:63], v[40:43], v[152:155]
    ds_read_b128 v[92:95], v11 offset:2048
    v_mfma_f32_16x16x32_bf16 v[156:159], v[60:63], v[44:47], v[156:159]
    ds_read_b128 v[96:99], v11 offset:4096
    v_mfma_f32_16x16x32_bf16 v[160:163], v[60:63], v[48:51], v[160:163]
    ds_read_b128 v[100:103], v11 offset:6144
    s_add_u32 s83, s83, 128
    s_add_u32 m0, s59, 90112
    v_mfma_f32_16x16x32_bf16 v[164:167], v[60:63], v[52:55], v[164:167]
    buffer_load_dwordx4 v8, s[16:19], s83 offen offset:0  lds
    v_mfma_f32_16x16x32_bf16 v[168:171], v[64:67], v[40:43], v[168:171]
    ds_read_b64_tr_b16 v[108:109], v15 offset:4096
    v_mfma_f32_16x16x32_bf16 v[172:175], v[64:67], v[44:47], v[172:175]
    ds_read_b64_tr_b16 v[110:111], v15 offset:4608
    v_mfma_f32_16x16x32_bf16 v[176:179], v[64:67], v[48:51], v[176:179]
    ds_read_b64_tr_b16 v[112:113], v14 offset:12288
    v_mfma_f32_16x16x32_bf16 v[180:183], v[64:67], v[52:55], v[180:183]
    buffer_load_dwordx4 v9, s[16:19], s83 offen offset:1024  lds
    v_mfma_f32_16x16x32_bf16 v[184:187], v[68:71], v[40:43], v[184:187]
    ds_read_b64_tr_b16 v[114:115], v14 offset:12800
    v_mfma_f32_16x16x32_bf16 v[188:191], v[68:71], v[44:47], v[188:191]
    ds_read_b64_tr_b16 v[116:117], v15 offset:12288
    v_mfma_f32_16x16x32_bf16 v[192:195], v[68:71], v[48:51], v[192:195]
    ds_read_b64_tr_b16 v[118:119], v15 offset:12800
    s_add_u32 s83, s83, 128
    s_add_u32 m0, s59, 98304
    v_mfma_f32_16x16x32_bf16 v[196:199], v[68:71], v[52:55], v[196:199]
    buffer_load_dwordx4 v8, s[16:19], s83 offen offset:0  lds
    v_mfma_f32_16x16x32_bf16 v[200:203], v[72:75], v[40:43], v[200:203]
    ds_read_b64_tr_b16 v[120:121], v14 offset:20480
    v_readfirstlane_b32 s88, v35
    s_nop 1
    s_cmp_eq_u32 s88, 0
    s_cbranch_scc1 L_tagslow14
L_tagok14:
    v_mov_b32 v36, s88
    v_mov_b32 v37, s88
    v_mfma_f32_16x16x32_bf16 v[204:207], v[72:75], v[44:47], v[204:207]
    ds_read_b64_tr_b16 v[122:123], v14 offset:20992
    v_mfma_f32_16x16x32_bf16 v[208:211], v[72:75], v[48:51], v[208:211]
    ds_read_b64_tr_b16 v[124:125], v15 offset:20480
    v_mfma_f32_16x16x32_bf16 v[212:215], v[72:75], v[52:55], v[212:215]
    buffer_load_dwordx4 v9, s[16:19], s83 offen offset:1024  lds
    v_mfma_f32_16x16x32_bf16 v[216:219], v[76:79], v[40:43], v[216:219]
    ds_read_b64_tr_b16 v[126:127], v15 offset:20992
    v_mfma_f32_16x16x32_bf16 v[220:223], v[76:79], v[44:47], v[220:223]
    v_mfma_f32_16x16x32_bf16 v[224:227], v[76:79], v[48:51], v[224:227]
    v_mfma_f32_16x16x32_bf16 v[228:231], v[76:79], v[52:55], v[228:231]
    s_waitcnt lgkmcnt(0)
    s_waitcnt vmcnt(10)
    s_barrier
    v_mfma_f32_16x16x32_bf16 v[136:139], v[104:107], v[88:91], v[136:139]
    ds_read_b128 v[40:43], v18 offset:0
    v_mfma_f32_16x16x32_bf16 v[140:143], v[104:107], v[92:95], v[140:143]
    ds_read_b64_tr_b16 v[56:57], v22 offset:0
    v_mfma_f32_16x16x32_bf16 v[144:147], v[104:107], v[96:99], v[144:147]
    ds_read_b64_tr_b16 v[58:59], v22 offset:512
    s_lshl_b32 s84, s80, 7
    s_add_u32 s81, s61, s84
    s_add_u32 m0, s58, 0
    v_mfma_f32_16x16x32_bf16 v[148:151], v[104:107], v[100:103], v[148:151]
    buffer_load_dwordx4 v2, s[4:7], s81 offen offset:0  lds
    v_mfma_f32_16x16x32_bf16 v[152:155], v[108:111], v[88:91], v[152:155]
    ds_read_b128 v[44:47], v18 offset:2048
    v_mfma_f32_16x16x32_bf16 v[156:159], v[108:111], v[92:95], v[156:159]
    ds_read_b128 v[48:51], v18 offset:4096
    v_mfma_f32_16x16x32_bf16 v[160:163], v[108:111], v[96:99], v[160:163]
    ds_read_b128 v[52:55], v18 offset:6144
    s_mul_i32 s83, s80, 196608
    v_mfma_f32_16x16x32_bf16 v[164:167], v[108:111], v[100:103], v[164:167]
    buffer_load_dwordx4 v3, s[4:7], s81 offen offset:1024  lds
    v_mfma_f32_16x16x32_bf16 v[168:171], v[112:115], v[88:91], v[168:171]
    ds_read_b64_tr_b16 v[60:61], v23 offset:0
    v_mfma_f32_16x16x32_bf16 v[172:175], v[112:115], v[92:95], v[172:175]
    ds_read_b64_tr_b16 v[62:63], v23 offset:512
    v_mfma_f32_16x16x32_bf16 v[176:179], v[112:115], v[96:99], v[176:179]
    ds_read_b64_tr_b16 v[64:65], v22 offset:8192
    s_add_u32 s83, s83, s79
    s_add_u32 s80, s80, 1
    v_mfma_f32_16x16x32_bf16 v[180:183], v[112:115], v[100:103], v[180:183]
    buffer_load_dwordx4 v4, s[4:7], s81 offen offset:2048  lds
    v_mfma_f32_16x16x32_bf16 v[184:187], v[116:119], v[88:91], v[184:187]
    ds_read_b64_tr_b16 v[66:67], v22 offset:8704
    v_mfma_f32_16x16x32_bf16 v[188:191], v[116:119], v[92:95], v[188:191]
    ds_read_b64_tr_b16 v[68:69], v23 offset:8192
    v_mfma_f32_16x16x32_bf16 v[192:195], v[116:119], v[96:99], v[192:195]
    ds_read_b64_tr_b16 v[70:71], v23 offset:8704
    s_cmp_eq_u32 s80, 10
    s_cselect_b32 s80, 0, s80
    v_mfma_f32_16x16x32_bf16 v[196:199], v[116:119], v[100:103], v[196:199]
    buffer_load_dwordx4 v5, s[4:7], s81 offen offset:3072  lds
    v_mfma_f32_16x16x32_bf16 v[200:203], v[120:123], v[88:91], v[200:203]
    ds_read_b64_tr_b16 v[72:73], v22 offset:16384
    v_mfma_f32_16x16x32_bf16 v[204:207], v[120:123], v[92:95], v[204:207]
    ds_read_b64_tr_b16 v[74:75], v22 offset:16896
    v_mfma_f32_16x16x32_bf16 v[208:211], v[120:123], v[96:99], v[208:211]
    ds_read_b64_tr_b16 v[76:77], v23 offset:16384
    s_add_u32 m0, s59, 0
    v_mfma_f32_16x16x32_bf16 v[212:215], v[120:123], v[100:103], v[212:215]
    buffer_load_dwordx4 v8, s[16:19], s83 offen offset:0  lds
    v_mfma_f32_16x16x32_bf16 v[216:219], v[124:127], v[88:91], v[216:219]
    ds_read_b64_tr_b16 v[78:79], v23 offset:16896
    v_mfma_f32_16x16x32_bf16 v[220:223], v[124:127], v[92:95], v[220:223]
    v_mfma_f32_16x16x32_bf16 v[224:227], v[124:127], v[96:99], v[224:227]
    v_mfma_f32_16x16x32_bf16 v[228:231], v[124:127], v[100:103], v[228:231]
    s_waitcnt lgkmcnt(0)
    v_mfma_f32_16x16x32_bf16 v[136:139], v[56:59], v[40:43], v[136:139]
    ds_read_b128 v[88:91], v19 offset:0
    v_mfma_f32_16x16x32_bf16 v[140:143], v[56:59], v[44:47], v[140:143]
    ds_read_b64_tr_b16 v[104:105], v22 offset:4096
    v_mfma_f32_16x16x32_bf16 v[144:147], v[56:59], v[48:51], v[144:147]
    ds_read_b64_tr_b16 v[106:107], v22 offset:4608
    v_mfma_f32_16x16x32_bf16 v[148:151], v[56:59], v[52:55], v[148:151]
    buffer_load_dwordx4 v9, s[16:19], s83 offen offset:1024  lds
    v_mfma_f32_16x16x32_bf16 v[152:155], v[60:63], v[40:43], v[152:155]
    ds_read_b128 v[92:95], v19 offset:2048
    v_mfma_f32_16x16x32_bf16 v[156:159], v[60:63], v[44:47], v[156:159]
    ds_read_b128 v[96:99], v19 offset:4096
    v_mfma_f32_16x16x32_bf16 v[160:163], v[60:63], v[48:51], v[160:163]
    ds_read_b128 v[100:103], v19 offset:6144
    s_add_u32 s83, s83, 128
    s_add_u32 m0, s59, 8192
    v_mfma_f32_16x16x32_bf16 v[164:167], v[60:63], v[52:55], v[164:167]
    buffer_load_dwordx4 v8, s[16:19], s83 offen offset:0  lds
    v_mfma_f32_16x16x32_bf16 v[168:171], v[64:67], v[40:43], v[168:171]
    ds_read_b64_tr_b16 v[108:109], v23 offset:4096
    v_mfma_f32_16x16x32_bf16 v[172:175], v[64:67], v[44:47], v[172:175]
    ds_read_b64_tr_b16 v[110:111], v23 offset:4608
    v_mfma_f32_16x16x32_bf16 v[176:179], v[64:67], v[48:51], v[176:179]
    ds_read_b64_tr_b16 v[112:113], v22 offset:12288
    v_mfma_f32_16x16x32_bf16 v[180:183], v[64:67], v[52:55], v[180:183]
    buffer_load_dwordx4 v9, s[16:19], s83 offen offset:1024  lds
    v_mfma_f32_16x16x32_bf16 v[184:187], v[68:71], v[40:43], v[184:187]
    ds_read_b64_tr_b16 v[114:115], v22 offset:12800
    v_mfma_f32_16x16x32_bf16 v[188:191], v[68:71], v[44:47], v[188:191]
    ds_read_b64_tr_b16 v[116:117], v23 offset:12288
    v_mfma_f32_16x16x32_bf16 v[192:195], v[68:71], v[48:51], v[192:195]
    ds_read_b64_tr_b16 v[118:119], v23 offset:12800
    s_add_u32 s83, s83, 128
    s_add_u32 m0, s59, 16384
    v_mfma_f32_16x16x32_bf16 v[196:199], v[68:71], v[52:55], v[196:199]
    buffer_load_dwordx4 v8, s[16:19], s83 offen offset:0  lds
    v_mfma_f32_16x16x32_bf16 v[200:203], v[72:75], v[40:43], v[200:203]
    ds_read_b64_tr_b16 v[120:121], v22 offset:20480
    v_mfma_f32_16x16x32_bf16 v[204:207], v[72:75], v[44:47], v[204:207]
    ds_read_b64_tr_b16 v[122:123], v22 offset:20992
    v_mfma_f32_16x16x32_bf16 v[208:211], v[72:75], v[48:51], v[208:211]
    ds_read_b64_tr_b16 v[124:125], v23 offset:20480
    v_mfma_f32_16x16x32_bf16 v[212:215], v[72:75], v[52:55], v[212:215]
    buffer_load_dwordx4 v9, s[16:19], s83 offen offset:1024  lds
    v_mfma_f32_16x16x32_bf16 v[216:219], v[76:79], v[40:43], v[216:219]
    ds_read_b64_tr_b16 v[126:127], v23 offset:20992
    v_mfma_f32_16x16x32_bf16 v[220:223], v[76:79], v[44:47], v[220:223]
    v_mfma_f32_16x16x32_bf16 v[224:227], v[76:79], v[48:51], v[224:227]
    v_mfma_f32_16x16x32_bf16 v[228:231], v[76:79], v[52:55], v[228:231]
    s_waitcnt lgkmcnt(0)
    s_waitcnt vmcnt(10)
    s_barrier
    v_mfma_f32_16x16x32_bf16 v[136:139], v[104:107], v[88:91], v[136:139]
    ds_read_b128 v[40:43], v26 offset:0
    v_mfma_f32_16x16x32_bf16 v[140:143], v[104:107], v[92:95], v[140:143]
    ds_read_b64_tr_b16 v[56:57], v30 offset:0
    v_mfma_f32_16x16x32_bf16 v[144:147], v[104:107], v[96:99], v[144:147]
    ds_read_b64_tr_b16 v[58:59], v30 offset:512
    s_lshl_b32 s84, s80, 7
    s_add_u32 s81, s61, s84
    s_add_u32 m0, s58, 40960
    v_mfma_f32_16x16x32_bf16 v[148:151], v[104:107], v[100:103], v[148:151]
    buffer_load_dwordx4 v2, s[4:7], s81 offen offset:0  lds
    v_mfma_f32_16x16x32_bf16 v[152:155], v[108:111], v[88:91], v[152:155]
    ds_read_b128 v[44:47], v26 offset:2048
    v_mfma_f32_16x16x32_bf16 v[156:159], v[108:111], v[92:95], v[156:159]
    ds_read_b128 v[48:51], v26 offset:4096
    v_mfma_f32_16x16x32_bf16 v[160:163], v[108:111], v[96:99], v[160:163]
    ds_read_b128 v[52:55], v26 offset:6144
    s_mul_i32 s83, s80, 196608
    v_mfma_f32_16x16x32_bf16 v[164:167], v[108:111], v[100:103], v[164:167]
    buffer_load_dwordx4 v3, s[4:7], s81 offen offset:1024  lds
    v_mfma_f32_16x16x32_bf16 v[168:171], v[112:115], v[88:91], v[168:171]
    ds_read_b64_tr_b16 v[60:61], v31 offset:0
    v_mfma_f32_16x16x32_bf16 v[172:175], v[112:115], v[92:95], v[172:175]
    ds_read_b64_tr_b16 v[62:63], v31 offset:512
    v_mfma_f32_16x16x32_bf16 v[176:179], v[112:115], v[96:99], v[176:179]
    ds_read_b64_tr_b16 v[64:65], v30 offset:8192
    s_add_u32 s83, s83, s79
    s_add_u32 s80, s80, 1
    v_mfma_f32_16x16x32_bf16 v[180:183], v[112:115], v[100:103], v[180:183]
    buffer_load_dwordx4 v4, s[4:7], s81 offen offset:2048  lds
    v_mfma_f32_16x16x32_bf16 v[184:187], v[116:119], v[88:91], v[184:187]
    ds_read_b64_tr_b16 v[66:67], v30 offset:8704
    v_mfma_f32_16x16x32_bf16 v[188:191], v[116:119], v[92:95], v[188:191]
    ds_read_b64_tr_b16 v[68:69], v31 offset:8192
    v_mfma_f32_16x16x32_bf16 v[192:195], v[116:119], v[96:99], v[192:195]
    ds_read_b64_tr_b16 v[70:71], v31 offset:8704
    s_cmp_eq_u32 s80, 10
    s_cselect_b32 s80, 0, s80
    v_mfma_f32_16x16x32_bf16 v[196:199], v[116:119], v[100:103], v[196:199]
    buffer_load_dwordx4 v5, s[4:7], s81 offen offset:3072  lds
    v_mfma_f32_16x16x32_bf16 v[200:203], v[120:123], v[88:91], v[200:203]
    ds_read_b64_tr_b16 v[72:73], v30 offset:16384
    v_mfma_f32_16x16x32_bf16 v[204:207], v[120:123], v[92:95], v[204:207]
    ds_read_b64_tr_b16 v[74:75], v30 offset:16896
    v_mfma_f32_16x16x32_bf16 v[208:211], v[120:123], v[96:99], v[208:211]
    ds_read_b64_tr_b16 v[76:77], v31 offset:16384
    s_add_u32 m0, s59, 40960
    v_mfma_f32_16x16x32_bf16 v[212:215], v[120:123], v[100:103], v[212:215]
    buffer_load_dwordx4 v8, s[16:19], s83 offen offset:0  lds
    v_mfma_f32_16x16x32_bf16 v[216:219], v[124:127], v[88:91], v[216:219]
    ds_read_b64_tr_b16 v[78:79], v31 offset:16896
    v_mfma_f32_16x16x32_bf16 v[220:223], v[124:127], v[92:95], v[220:223]
    v_mfma_f32_16x16x32_bf16 v[224:227], v[124:127], v[96:99], v[224:227]
    v_mfma_f32_16x16x32_bf16 v[228:231], v[124:127], v[100:103], v[228:231]
    s_waitcnt lgkmcnt(0)
    v_mfma_f32_16x16x32_bf16 v[136:139], v[56:59], v[40:43], v[136:139]
    ds_read_b128 v[88:91], v27 offset:0
    v_mfma_f32_16x16x32_bf16 v[140:143], v[56:59], v[44:47], v[140:143]
    ds_read_b64_tr_b16 v[104:105], v30 offset:4096
    v_mfma_f32_16x16x32_bf16 v[144:147], v[56:59], v[48:51], v[144:147]
    ds_read_b64_tr_b16 v[106:107], v30 offset:4608
    v_mfma_f32_16x16x32_bf16 v[148:151], v[56:59], v[52:55], v[148:151]
    buffer_load_dwordx4 v9, s[16:19], s83 offen offset:1024  lds
    v_mfma_f32_16x16x32_bf16 v[152:155], v[60:63], v[40:43], v[152:155]
    ds_read_b128 v[92:95], v27 offset:2048
    v_mfma_f32_16x16x32_bf16 v[156:159], v[60:63], v[44:47], v[156:159]
    ds_read_b128 v[96:99], v27 offset:4096
    v_mfma_f32_16x16x32_bf16 v[160:163], v[60:63], v[48:51], v[160:163]
    ds_read_b128 v[100:103], v27 offset:6144
    s_add_u32 s83, s83, 128
    s_add_u32 m0, s59, 49152
    v_mfma_f32_16x16x32_bf16 v[164:167], v[60:63], v[52:55], v[164:167]
    buffer_load_dwordx4 v8, s[16:19], s83 offen offset:0  lds
    v_mfma_f32_16x16x32_bf16 v[168:171], v[64:67], v[40:43], v[168:171]
    ds_read_b64_tr_b16 v[108:109], v31 offset:4096
    v_mfma_f32_16x16x32_bf16 v[172:175], v[64:67], v[44:47], v[172:175]
    ds_read_b64_tr_b16 v[110:111], v31 offset:4608
    v_mfma_f32_16x16x32_bf16 v[176:179], v[64:67], v[48:51], v[176:179]
    ds_read_b64_tr_b16 v[112:113], v30 offset:12288
    v_mfma_f32_16x16x32_bf16 v[180:183], v[64:67], v[52:55], v[180:183]
    buffer_load_dwordx4 v9, s[16:19], s83 offen offset:1024  lds
    v_mfma_f32_16x16x32_bf16 v[184:187], v[68:71], v[40:43], v[184:187]
    ds_read_b64_tr_b16 v[114:115], v30 offset:12800
    v_mfma_f32_16x16x32_bf16 v[188:191], v[68:71], v[44:47], v[188:191]
    ds_read_b64_tr_b16 v[116:117], v31 offset:12288
    v_mfma_f32_16x16x32_bf16 v[192:195], v[68:71], v[48:51], v[192:195]
    ds_read_b64_tr_b16 v[118:119], v31 offset:12800
    s_add_u32 s83, s83, 128
    s_add_u32 m0, s59, 57344
    v_mfma_f32_16x16x32_bf16 v[196:199], v[68:71], v[52:55], v[196:199]
    buffer_load_dwordx4 v8, s[16:19], s83 offen offset:0  lds
    v_mfma_f32_16x16x32_bf16 v[200:203], v[72:75], v[40:43], v[200:203]
    ds_read_b64_tr_b16 v[120:121], v30 offset:20480
    v_mfma_f32_16x16x32_bf16 v[204:207], v[72:75], v[44:47], v[204:207]
    ds_read_b64_tr_b16 v[122:123], v30 offset:20992
    v_mfma_f32_16x16x32_bf16 v[208:211], v[72:75], v[48:51], v[208:211]
    ds_read_b64_tr_b16 v[124:125], v31 offset:20480
    v_mfma_f32_16x16x32_bf16 v[212:215], v[72:75], v[52:55], v[212:215]
    buffer_load_dwordx4 v9, s[16:19], s83 offen offset:1024  lds
    v_mfma_f32_16x16x32_bf16 v[216:219], v[76:79], v[40:43], v[216:219]
    ds_read_b64_tr_b16 v[126:127], v31 offset:20992
    v_mfma_f32_16x16x32_bf16 v[220:223], v[76:79], v[44:47], v[220:223]
    v_mfma_f32_16x16x32_bf16 v[224:227], v[76:79], v[48:51], v[224:227]
    v_mfma_f32_16x16x32_bf16 v[228:231], v[76:79], v[52:55], v[228:231]
    s_waitcnt lgkmcnt(0)
    s_waitcnt vmcnt(10)
    s_barrier
    v_mfma_f32_16x16x32_bf16 v[136:139], v[104:107], v[88:91], v[136:139]
    ds_read_b128 v[40:43], v10 offset:0
    v_mfma_f32_16x16x32_bf16 v[140:143], v[104:107], v[92:95], v[140:143]
    ds_read_b64_tr_b16 v[56:57], v14 offset:0
    v_mfma_f32_16x16x32_bf16 v[144:147], v[104:107], v[96:99], v[144:147]
    ds_read_b64_tr_b16 v[58:59], v14 offset:512
    s_lshl_b32 s84, s80, 7
    s_add_u32 s81, s61, s84
    s_add_u32 m0, s58, 81920
    v_mfma_f32_16x16x32_bf16 v[148:151], v[104:107], v[100:103], v[148:151]
    buffer_load_dwordx4 v2, s[4:7], s81 offen offset:0  lds
    v_mfma_f32_16x16x32_bf16 v[152:155], v[108:111], v[88:91], v[152:155]
    ds_read_b128 v[44:47], v10 offset:2048
    v_mfma_f32_16x16x32_bf16 v[156:159], v[108:111], v[92:95], v[156:159]
    ds_read_b128 v[48:51], v10 offset:4096
    v_mfma_f32_16x16x32_bf16 v[160:163], v[108:111], v[96:99], v[160:163]
    ds_read_b128 v[52:55], v10 offset:6144
    s_mul_i32 s83, s80, 196608
    v_mfma_f32_16x16x32_bf16 v[164:167], v[108:111], v[100:103], v[164:167]
    buffer_load_dwordx4 v3, s[4:7], s81 offen offset:1024  lds
    v_mfma_f32_16x16x32_bf16 v[168:171], v[112:115], v[88:91], v[168:171]
    ds_read_b64_tr_b16 v[60:61], v15 offset:0
    v_mfma_f32_16x16x32_bf16 v[172:175], v[112:115], v[92:95], v[172:175]
    ds_read_b64_tr_b16 v[62:63], v15 offset:512
    v_mfma_f32_16x16x32_bf16 v[176:179], v[112:115], v[96:99], v[176:179]
    ds_read_b64_tr_b16 v[64:65], v14 offset:8192
    s_add_u32 s83, s83, s79
    s_add_u32 s80, s80, 1
    v_mfma_f32_16x16x32_bf16 v[180:183], v[112:115], v[100:103], v[180:183]
    buffer_load_dwordx4 v4, s[4:7], s81 offen offset:2048  lds
    v_mfma_f32_16x16x32_bf16 v[184:187], v[116:119], v[88:91], v[184:187]
    ds_read_b64_tr_b16 v[66:67], v14 offset:8704
    v_mfma_f32_16x16x32_bf16 v[188:191], v[116:119], v[92:95], v[188:191]
    ds_read_b64_tr_b16 v[68:69], v15 offset:8192
    v_mfma_f32_16x16x32_bf16 v[192:195], v[116:119], v[96:99], v[192:195]
    ds_read_b64_tr_b16 v[70:71], v15 offset:8704
    s_cmp_eq_u32 s80, 10
    s_cselect_b32 s80, 0, s80
    v_mfma_f32_16x16x32_bf16 v[196:199], v[116:119], v[100:103], v[196:199]
    buffer_load_dwordx4 v5, s[4:7], s81 offen offset:3072  lds
    v_mfma_f32_16x16x32_bf16 v[200:203], v[120:123], v[88:91], v[200:203]
    ds_read_b64_tr_b16 v[72:73], v14 offset:16384
    v_mfma_f32_16x16x32_bf16 v[204:207], v[120:123], v[92:95], v[204:207]
    ds_read_b64_tr_b16 v[74:75], v14 offset:16896
    v_mfma_f32_16x16x32_bf16 v[208:211], v[120:123], v[96:99], v[208:211]
    ds_read_b64_tr_b16 v[76:77], v15 offset:16384
    s_add_u32 m0, s59, 81920
    v_mfma_f32_16x16x32_bf16 v[212:215], v[120:123], v[100:103], v[212:215]
    buffer_load_dwordx4 v8, s[16:19], s83 offen offset:0  lds
    v_mfma_f32_16x16x32_bf16 v[216:219], v[124:127], v[88:91], v[216:219]
    ds_read_b64_tr_b16 v[78:79], v15 offset:16896
    v_mfma_f32_16x16x32_bf16 v[220:223], v[124:127], v[92:95], v[220:223]
    v_mfma_f32_16x16x32_bf16 v[224:227], v[124:127], v[96:99], v[224:227]
    v_mfma_f32_16x16x32_bf16 v[228:231], v[124:127], v[100:103], v[228:231]
    s_waitcnt lgkmcnt(0)
    v_mfma_f32_16x16x32_bf16 v[136:139], v[56:59], v[40:43], v[136:139]
    ds_read_b128 v[88:91], v11 offset:0
    v_mfma_f32_16x16x32_bf16 v[140:143], v[56:59], v[44:47], v[140:143]
    ds_read_b64_tr_b16 v[104:105], v14 offset:4096
    v_mfma_f32_16x16x32_bf16 v[144:147], v[56:59], v[48:51], v[144:147]
    ds_read_b64_tr_b16 v[106:107], v14 offset:4608
    v_mfma_f32_16x16x32_bf16 v[148:151], v[56:59], v[52:55], v[148:151]
    buffer_load_dwordx4 v9, s[16:19], s83 offen offset:1024  lds
    v_mfma_f32_16x16x32_bf16 v[152:155], v[60:63], v[40:43], v[152:155]
    ds_read_b128 v[92:95], v11 offset:2048
    v_mfma_f32_16x16x32_bf16 v[156:159], v[60:63], v[44:47], v[156:159]
    ds_read_b128 v[96:99], v11 offset:4096
    v_mfma_f32_16x16x32_bf16 v[160:163], v[60:63], v[48:51], v[160:163]
    ds_read_b128 v[100:103], v11 offset:6144
    s_add_u32 s83, s83, 128
    s_add_u32 m0, s59, 90112
    v_mfma_f32_16x16x32_bf16 v[164:167], v[60:63], v[52:55], v[164:167]
    buffer_load_dwordx4 v8, s[16:19], s83 offen offset:0  lds
    v_mfma_f32_16x16x32_bf16 v[168:171], v[64:67], v[40:43], v[168:171]
    ds_read_b64_tr_b16 v[108:109], v15 offset:4096
    v_mfma_f32_16x16x32_bf16 v[172:175], v[64:67], v[44:47], v[172:175]
    ds_read_b64_tr_b16 v[110:111], v15 offset:4608
    v_mfma_f32_16x16x32_bf16 v[176:179], v[64:67], v[48:51], v[176:179]
    ds_read_b64_tr_b16 v[112:113], v14 offset:12288
    v_mfma_f32_16x16x32_bf16 v[180:183], v[64:67], v[52:55], v[180:183]
    buffer_load_dwordx4 v9, s[16:19], s83 offen offset:1024  lds
    v_mfma_f32_16x16x32_bf16 v[184:187], v[68:71], v[40:43], v[184:187]
    ds_read_b64_tr_b16 v[114:115], v14 offset:12800
    v_mfma_f32_16x16x32_bf16 v[188:191], v[68:71], v[44:47], v[188:191]
    ds_read_b64_tr_b16 v[116:117], v15 offset:12288
    v_mfma_f32_16x16x32_bf16 v[192:195], v[68:71], v[48:51], v[192:195]
    ds_read_b64_tr_b16 v[118:119], v15 offset:12800
    s_add_u32 s83, s83, 128
    s_add_u32 m0, s59, 98304
    v_mfma_f32_16x16x32_bf16 v[196:199], v[68:71], v[52:55], v[196:199]
    buffer_load_dwordx4 v8, s[16:19], s83 offen offset:0  lds
    v_mfma_f32_16x16x32_bf16 v[200:203], v[72:75], v[40:43], v[200:203]
    ds_read_b64_tr_b16 v[120:121], v14 offset:20480
    v_mfma_f32_16x16x32_bf16 v[204:207], v[72:75], v[44:47], v[204:207]
    ds_read_b64_tr_b16 v[122:123], v14 offset:20992
    v_mfma_f32_16x16x32_bf16 v[208:211], v[72:75], v[48:51], v[208:211]
    ds_read_b64_tr_b16 v[124:125], v15 offset:20480
    v_mfma_f32_16x16x32_bf16 v[212:215], v[72:75], v[52:55], v[212:215]
    buffer_load_dwordx4 v9, s[16:19], s83 offen offset:1024  lds
    v_mfma_f32_16x16x32_bf16 v[216:219], v[76:79], v[40:43], v[216:219]
    ds_read_b64_tr_b16 v[126:127], v15 offset:20992
    v_mfma_f32_16x16x32_bf16 v[220:223], v[76:79], v[44:47], v[220:223]
    v_mfma_f32_16x16x32_bf16 v[224:227], v[76:79], v[48:51], v[224:227]
    v_accvgpr_read_b32 v254, a242
    v_accvgpr_read_b32 v255, a243
    v_mfma_f32_16x16x32_bf16 v[228:231], v[76:79], v[52:55], v[228:231]
    global_load_dwordx2 a[250:251], v254, s[56:57]
    s_waitcnt lgkmcnt(0)
    s_waitcnt vmcnt(11)
    s_barrier
    v_mfma_f32_16x16x32_bf16 v[136:139], v[104:107], v[88:91], v[136:139]
    ds_read_b128 v[40:43], v18 offset:0
    v_mfma_f32_16x16x32_bf16 v[140:143], v[104:107], v[92:95], v[140:143]
    ds_read_b64_tr_b16 v[56:57], v22 offset:0
    v_mfma_f32_16x16x32_bf16 v[144:147], v[104:107], v[96:99], v[144:147]
    ds_read_b64_tr_b16 v[58:59], v22 offset:512
    v_mfma_f32_16x16x32_bf16 v[148:151], v[104:107], v[100:103], v[148:151]
    global_load_dwordx2 a[252:253], v255, s[56:57]
    v_mfma_f32_16x16x32_bf16 v[152:155], v[108:111], v[88:91], v[152:155]
    ds_read_b128 v[44:47], v18 offset:2048
    v_mfma_f32_16x16x32_bf16 v[156:159], v[108:111], v[92:95], v[156:159]
    ds_read_b128 v[48:51], v18 offset:4096
    v_mfma_f32_16x16x32_bf16 v[160:163], v[108:111], v[96:99], v[160:163]
    ds_read_b128 v[52:55], v18 offset:6144
    v_accvgpr_read_b32 v254, a240
    v_accvgpr_read_b32 v255, a241
    v_mfma_f32_16x16x32_bf16 v[164:167], v[108:111], v[100:103], v[164:167]
    buffer_load_dwordx2 a[248:249], v255, s[4:7], s94 offen
    v_mfma_f32_16x16x32_bf16 v[168:171], v[112:115], v[88:91], v[168:171]
    ds_read_b64_tr_b16 v[60:61], v23 offset:0
    v_mfma_f32_16x16x32_bf16 v[172:175], v[112:115], v[92:95], v[172:175]
    ds_read_b64_tr_b16 v[62:63], v23 offset:512
    v_mfma_f32_16x16x32_bf16 v[176:179], v[112:115], v[96:99], v[176:179]
    ds_read_b64_tr_b16 v[64:65], v22 offset:8192
    s_add_u32 s85, s94, 0
    v_mfma_f32_16x16x32_bf16 v[180:183], v[112:115], v[100:103], v[180:183]
    buffer_load_dwordx2 a[240:241], v254, s[4:7], s85 offen
    v_mfma_f32_16x16x32_bf16 v[184:187], v[116:119], v[88:91], v[184:187]
    ds_read_b64_tr_b16 v[66:67], v22 offset:8704
    v_mfma_f32_16x16x32_bf16 v[188:191], v[116:119], v[92:95], v[188:191]
    ds_read_b64_tr_b16 v[68:69], v23 offset:8192
    v_mfma_f32_16x16x32_bf16 v[192:195], v[116:119], v[96:99], v[192:195]
    ds_read_b64_tr_b16 v[70:71], v23 offset:8704
    s_add_u32 s85, s94, 5120
    v_mfma_f32_16x16x32_bf16 v[196:199], v[116:119], v[100:103], v[196:199]
    buffer_load_dwordx2 a[242:243], v254, s[4:7], s85 offen
    v_mfma_f32_16x16x32_bf16 v[200:203], v[120:123], v[88:91], v[200:203]
    ds_read_b64_tr_b16 v[72:73], v22 offset:16384
    v_mfma_f32_16x16x32_bf16 v[204:207], v[120:123], v[92:95], v[204:207]
    ds_read_b64_tr_b16 v[74:75], v22 offset:16896
    v_mfma_f32_16x16x32_bf16 v[208:211], v[120:123], v[96:99], v[208:211]
    ds_read_b64_tr_b16 v[76:77], v23 offset:16384
    s_add_u32 s85, s94, 10240
    v_mfma_f32_16x16x32_bf16 v[212:215], v[120:123], v[100:103], v[212:215]
    buffer_load_dwordx2 a[244:245], v254, s[4:7], s85 offen
    v_mfma_f32_16x16x32_bf16 v[216:219], v[124:127], v[88:91], v[216:219]
    ds_read_b64_tr_b16 v[78:79], v23 offset:16896
    v_mfma_f32_16x16x32_bf16 v[220:223], v[124:127], v[92:95], v[220:223]
    v_mfma_f32_16x16x32_bf16 v[224:227], v[124:127], v[96:99], v[224:227]
    s_add_u32 s85, s94, 15360
    s_lshl_b32 s94, s94, 1
    v_mfma_f32_16x16x32_bf16 v[228:231], v[124:127], v[100:103], v[228:231]
    buffer_load_dwordx2 a[246:247], v254, s[4:7], s85 offen
    s_waitcnt lgkmcnt(0)
    v_mfma_f32_16x16x32_bf16 v[136:139], v[56:59], v[40:43], v[136:139]
    ds_read_b128 v[88:91], v19 offset:0
    v_mfma_f32_16x16x32_bf16 v[140:143], v[56:59], v[44:47], v[140:143]
    ds_read_b64_tr_b16 v[104:105], v22 offset:4096
    v_mfma_f32_16x16x32_bf16 v[144:147], v[56:59], v[48:51], v[144:147]
    ds_read_b64_tr_b16 v[106:107], v22 offset:4608
    s_lshl_b32 s84, s80, 7
    s_add_u32 s81, s61, s84
    s_add_u32 m0, s58, 0
    v_mfma_f32_16x16x32_bf16 v[148:151], v[56:59], v[52:55], v[148:151]
    buffer_load_dwordx4 v2, s[4:7], s81 offen offset:0  lds
    v_mfma_f32_16x16x32_bf16 v[152:155], v[60:63], v[40:43], v[152:155]
    ds_read_b128 v[92:95], v19 offset:2048
    v_mfma_f32_16x16x32_bf16 v[156:159], v[60:63], v[44:47], v[156:159]
    ds_read_b128 v[96:99], v19 offset:4096
    v_mfma_f32_16x16x32_bf16 v[160:163], v[60:63], v[48:51], v[160:163]
    ds_read_b128 v[100:103], v19 offset:6144
    s_mul_i32 s83, s80, 196608
    v_mfma_f32_16x16x32_bf16 v[164:167], v[60:63], v[52:55], v[164:167]
    buffer_load_dwordx4 v3, s[4:7], s81 offen offset:1024  lds
    v_mfma_f32_16x16x32_bf16 v[168:171], v[64:67], v[40:43], v[168:171]
    ds_read_b64_tr_b16 v[108:109], v23 offset:4096
    v_mfma_f32_16x16x32_bf16 v[172:175], v[64:67], v[44:47], v[172:175]
    ds_read_b64_tr_b16 v[110:111], v23 offset:4608
    v_mfma_f32_16x16x32_bf16 v[176:179], v[64:67], v[48:51], v[176:179]
    ds_read_b64_tr_b16 v[112:113], v22 offset:12288
    s_add_u32 s83, s83, s79
    s_add_u32 s80, s80, 1
    v_mfma_f32_16x16x32_bf16 v[180:183], v[64:67], v[52:55], v[180:183]
    buffer_load_dwordx4 v4, s[4:7], s81 offen offset:2048  lds
    v_mfma_f32_16x16x32_bf16 v[184:187], v[68:71], v[40:43], v[184:187]
    ds_read_b64_tr_b16 v[114:115], v22 offset:12800
    v_mfma_f32_16x16x32_bf16 v[188:191], v[68:71], v[44:47], v[188:191]
    ds_read_b64_tr_b16 v[116:117], v23 offset:12288
    v_mfma_f32_16x16x32_bf16 v[192:195], v[68:71], v[48:51], v[192:195]
    ds_read_b64_tr_b16 v[118:119], v23 offset:12800
    s_cmp_eq_u32 s80, 10
    s_cselect_b32 s80, 0, s80
    v_mfma_f32_16x16x32_bf16 v[196:199], v[68:71], v[52:55], v[196:199]
    buffer_load_dwordx4 v5, s[4:7], s81 offen offset:3072  lds
    v_mfma_f32_16x16x32_bf16 v[200:203], v[72:75], v[40:43], v[200:203]
    ds_read_b64_tr_b16 v[120:121], v22 offset:20480
    v_mfma_f32_16x16x32_bf16 v[204:207], v[72:75], v[44:47], v[204:207]
    ds_read_b64_tr_b16 v[122:123], v22 offset:20992
    v_mfma_f32_16x16x32_bf16 v[208:211], v[72:75], v[48:51], v[208:211]
    ds_read_b64_tr_b16 v[124:125], v23 offset:20480
    s_add_u32 m0, s59, 0
    v_mfma_f32_16x16x32_bf16 v[212:215], v[72:75], v[52:55], v[212:215]
    buffer_load_dwordx4 v8, s[16:19], s83 offen offset:0  lds
    v_mfma_f32_16x16x32_bf16 v[216:219], v[76:79], v[40:43], v[216:219]
    ds_read_b64_tr_b16 v[126:127], v23 offset:20992
    v_mfma_f32_16x16x32_bf16 v[220:223], v[76:79], v[44:47], v[220:223]
    v_mfma_f32_16x16x32_bf16 v[224:227], v[76:79], v[48:51], v[224:227]
    v_mfma_f32_16x16x32_bf16 v[228:231], v[76:79], v[52:55], v[228:231]
    buffer_load_dwordx4 v9, s[16:19], s83 offen offset:1024  lds
    s_waitcnt lgkmcnt(0)
    s_waitcnt vmcnt(13)
    s_barrier
    v_mfma_f32_16x16x32_bf16 v[136:139], v[104:107], v[88:91], v[136:139]
    ds_read_b128 v[40:43], v26 offset:0
    v_mfma_f32_16x16x32_bf16 v[140:143], v[104:107], v[92:95], v[140:143]
    ds_read_b64_tr_b16 v[56:57], v30 offset:0
    v_mfma_f32_16x16x32_bf16 v[144:147], v[104:107], v[96:99], v[144:147]
    ds_read_b64_tr_b16 v[58:59], v30 offset:512
    s_add_u32 s83, s83, 128
    s_add_u32 m0, s59, 8192
    v_mfma_f32_16x16x32_bf16 v[148:151], v[104:107], v[100:103], v[148:151]
    buffer_load_dwordx4 v8, s[16:19], s83 offen offset:0  lds
    v_mfma_f32_16x16x32_bf16 v[152:155], v[108:111], v[88:91], v[152:155]
    ds_read_b128 v[44:47], v26 offset:2048
    v_mfma_f32_16x16x32_bf16 v[156:159], v[108:111], v[92:95], v[156:159]
    ds_read_b128 v[48:51], v26 offset:4096
    v_mfma_f32_16x16x32_bf16 v[160:163], v[108:111], v[96:99], v[160:163]
    ds_read_b128 v[52:55], v26 offset:6144
    v_mfma_f32_16x16x32_bf16 v[164:167], v[108:111], v[100:103], v[164:167]
    buffer_load_dwordx4 v9, s[16:19], s83 offen offset:1024  lds
    v_mfma_f32_16x16x32_bf16 v[168:171], v[112:115], v[88:91], v[168:171]
    ds_read_b64_tr_b16 v[60:61], v31 offset:0
    v_mfma_f32_16x16x32_bf16 v[172:175], v[112:115], v[92:95], v[172:175]
    ds_read_b64_tr_b16 v[62:63], v31 offset:512
    v_mfma_f32_16x16x32_bf16 v[176:179], v[112:115], v[96:99], v[176:179]
    ds_read_b64_tr_b16 v[64:65], v30 offset:8192
    s_add_u32 s83, s83, 128
    s_add_u32 m0, s59, 16384
    v_mfma_f32_16x16x32_bf16 v[180:183], v[112:115], v[100:103], v[180:183]
    buffer_load_dwordx4 v8, s[16:19], s83 offen offset:0  lds
    v_mfma_f32_16x16x32_bf16 v[184:187], v[116:119], v[88:91], v[184:187]
    ds_read_b64_tr_b16 v[66:67], v30 offset:8704
    v_mfma_f32_16x16x32_bf16 v[188:191], v[116:119], v[92:95], v[188:191]
    ds_read_b64_tr_b16 v[68:69], v31 offset:8192
    v_mfma_f32_16x16x32_bf16 v[192:195], v[116:119], v[96:99], v[192:195]
    ds_read_b64_tr_b16 v[70:71], v31 offset:8704
    v_mfma_f32_16x16x32_bf16 v[196:199], v[116:119], v[100:103], v[196:199]
    buffer_load_dwordx4 v9, s[16:19], s83 offen offset:1024  lds
    v_mfma_f32_16x16x32_bf16 v[200:203], v[120:123], v[88:91], v[200:203]
    ds_read_b64_tr_b16 v[72:73], v30 offset:16384
    v_mfma_f32_16x16x32_bf16 v[204:207], v[120:123], v[92:95], v[204:207]
    ds_read_b64_tr_b16 v[74:75], v30 offset:16896
    v_mfma_f32_16x16x32_bf16 v[208:211], v[120:123], v[96:99], v[208:211]
    ds_read_b64_tr_b16 v[76:77], v31 offset:16384
    v_mfma_f32_16x16x32_bf16 v[212:215], v[120:123], v[100:103], v[212:215]
    ds_read_b64_tr_b16 v[78:79], v31 offset:16896
    v_mfma_f32_16x16x32_bf16 v[216:219], v[124:127], v[88:91], v[216:219]
    v_mfma_f32_16x16x32_bf16 v[220:223], v[124:127], v[92:95], v[220:223]
    v_mfma_f32_16x16x32_bf16 v[224:227], v[124:127], v[96:99], v[224:227]
    v_mfma_f32_16x16x32_bf16 v[228:231], v[124:127], v[100:103], v[228:231]
    s_waitcnt lgkmcnt(0)
    v_mfma_f32_16x16x32_bf16 v[136:139], v[56:59], v[40:43], v[136:139]
    ds_read_b128 v[88:91], v27 offset:0
    v_mfma_f32_16x16x32_bf16 v[140:143], v[56:59], v[44:47], v[140:143]
    ds_read_b64_tr_b16 v[104:105], v30 offset:4096
    v_mfma_f32_16x16x32_bf16 v[144:147], v[56:59], v[48:51], v[144:147]
    ds_read_b64_tr_b16 v[106:107], v30 offset:4608
    s_mov_b32 s62, s91
    s_add_u32 m0, s63, 122880
    v_mfma_f32_16x16x32_bf16 v[148:151], v[56:59], v[52:55], v[148:151]
    buffer_load_dwordx4 v248, s[28:31], s62 offen offset:0  lds
    v_mfma_f32_16x16x32_bf16 v[152:155], v[60:63], v[40:43], v[152:155]
    ds_read_b128 v[92:95], v27 offset:2048
    v_mfma_f32_16x16x32_bf16 v[156:159], v[60:63], v[44:47], v[156:159]
    ds_read_b128 v[96:99], v27 offset:4096
    v_mfma_f32_16x16x32_bf16 v[160:163], v[60:63], v[48:51], v[160:163]
    ds_read_b128 v[100:103], v27 offset:6144
    v_mfma_f32_16x16x32_bf16 v[164:167], v[60:63], v[52:55], v[164:167]
    buffer_load_dwordx4 v249, s[28:31], s62 offen offset:1024  lds
    v_mfma_f32_16x16x32_bf16 v[168:171], v[64:67], v[40:43], v[168:171]
    ds_read_b64_tr_b16 v[108:109], v31 offset:4096
    v_mfma_f32_16x16x32_bf16 v[172:175], v[64:67], v[44:47], v[172:175]
    ds_read_b64_tr_b16 v[110:111], v31 offset:4608
    v_mfma_f32_16x16x32_bf16 v[176:179], v[64:67], v[48:51], v[176:179]
    ds_read_b64_tr_b16 v[112:113], v30 offset:12288
    v_mfma_f32_16x16x32_bf16 v[180:183], v[64:67], v[52:55], v[180:183]
    buffer_load_dwordx4 v250, s[28:31], s62 offen offset:2048  lds
    v_mfma_f32_16x16x32_bf16 v[184:187], v[68:71], v[40:43], v[184:187]
    ds_read_b64_tr_b16 v[114:115], v30 offset:12800
    v_mfma_f32_16x16x32_bf16 v[188:191], v[68:71], v[44:47], v[188:191]
    ds_read_b64_tr_b16 v[116:117], v31 offset:12288
    v_mfma_f32_16x16x32_bf16 v[192:195], v[68:71], v[48:51], v[192:195]
    ds_read_b64_tr_b16 v[118:119], v31 offset:12800
    v_mfma_f32_16x16x32_bf16 v[196:199], v[68:71], v[52:55], v[196:199]
    buffer_load_dwordx4 v251, s[28:31], s62 offen offset:3072  lds
    v_mfma_f32_16x16x32_bf16 v[200:203], v[72:75], v[40:43], v[200:203]
    ds_read_b64_tr_b16 v[120:121], v30 offset:20480
    v_mfma_f32_16x16x32_bf16 v[204:207], v[72:75], v[44:47], v[204:207]
    ds_read_b64_tr_b16 v[122:123], v30 offset:20992
    v_mfma_f32_16x16x32_bf16 v[208:211], v[72:75], v[48:51], v[208:211]
    ds_read_b64_tr_b16 v[124:125], v31 offset:20480
    v_mfma_f32_16x16x32_bf16 v[212:215], v[72:75], v[52:55], v[212:215]
    ds_read_b64_tr_b16 v[126:127], v31 offset:20992
    v_mfma_f32_16x16x32_bf16 v[216:219], v[76:79], v[40:43], v[216:219]
    v_mfma_f32_16x16x32_bf16 v[220:223], v[76:79], v[44:47], v[220:223]
    v_mfma_f32_16x16x32_bf16 v[224:227], v[76:79], v[48:51], v[224:227]
    v_mfma_f32_16x16x32_bf16 v[228:231], v[76:79], v[52:55], v[228:231]
    s_waitcnt lgkmcnt(0)
    s_waitcnt vmcnt(4)
    s_barrier
    v_mfma_f32_16x16x32_bf16 v[136:139], v[104:107], v[88:91], v[136:139]
    ds_read_b128 v[40:43], v10 offset:0
    v_mfma_f32_16x16x32_bf16 v[140:143], v[104:107], v[92:95], v[140:143]
    ds_read_b64_tr_b16 v[56:57], v14 offset:0
    v_mfma_f32_16x16x32_bf16 v[144:147], v[104:107], v[96:99], v[144:147]
    ds_read_b64_tr_b16 v[58:59], v14 offset:512
    s_add_u32 m0, s63, 126976
    v_mfma_f32_16x16x32_bf16 v[148:151], v[104:107], v[100:103], v[148:151]
    s_cmp_eq_u32 s92, 1
    s_cbranch_scc1 L_s515
    buffer_load_dwordx4 v253, s[28:31], s62 offen offset:0  lds
L_s515:
    v_mfma_f32_16x16x32_bf16 v[152:155], v[108:111], v[88:91], v[152:155]
    ds_read_b128 v[44:47], v10 offset:2048
    v_mfma_f32_16x16x32_bf16 v[156:159], v[108:111], v[92:95], v[156:159]
    ds_read_b128 v[48:51], v10 offset:4096
    v_mfma_f32_16x16x32_bf16 v[160:163], v[108:111], v[96:99], v[160:163]
    ds_read_b128 v[52:55], v10 offset:6144
    s_add_u32 s62, s62, s64
    s_add_u32 m0, s63, 128000
    v_mfma_f32_16x16x32_bf16 v[164:167], v[108:111], v[100:103], v[164:167]
    buffer_load_dwordx4 v248, s[28:31], s62 offen offset:0  lds
    v_mfma_f32_16x16x32_bf16 v[168:171], v[112:115], v[88:91], v[168:171]
    ds_read_b64_tr_b16 v[60:61], v15 offset:0
    v_mfma_f32_16x16x32_bf16 v[172:175], v[112:115], v[92:95], v[172:175]
    ds_read_b64_tr_b16 v[62:63], v15 offset:512
    v_mfma_f32_16x16x32_bf16 v[176:179], v[112:115], v[96:99], v[176:179]
    ds_read_b64_tr_b16 v[64:65], v14 offset:8192
    v_mfma_f32_16x16x32_bf16 v[180:183], v[112:115], v[100:103], v[180:183]
    buffer_load_dwordx4 v249, s[28:31], s62 offen offset:1024  lds
    v_mfma_f32_16x16x32_bf16 v[184:187], v[116:119], v[88:91], v[184:187]
    ds_read_b64_tr_b16 v[66:67], v14 offset:8704
    v_mfma_f32_16x16x32_bf16 v[188:191], v[116:119], v[92:95], v[188:191]
    ds_read_b64_tr_b16 v[68:69], v15 offset:8192
    v_mfma_f32_16x16x32_bf16 v[192:195], v[116:119], v[96:99], v[192:195]
    ds_read_b64_tr_b16 v[70:71], v15 offset:8704
    v_mfma_f32_16x16x32_bf16 v[196:199], v[116:119], v[100:103], v[196:199]
    buffer_load_dwordx4 v250, s[28:31], s62 offen offset:2048  lds
    v_mfma_f32_16x16x32_bf16 v[200:203], v[120:123], v[88:91], v[200:203]
    ds_read_b64_tr_b16 v[72:73], v14 offset:16384
    v_mfma_f32_16x16x32_bf16 v[204:207], v[120:123], v[92:95], v[204:207]
    ds_read_b64_tr_b16 v[74:75], v14 offset:16896
    v_mfma_f32_16x16x32_bf16 v[208:211], v[120:123], v[96:99], v[208:211]
    ds_read_b64_tr_b16 v[76:77], v15 offset:16384
    v_mfma_f32_16x16x32_bf16 v[212:215], v[120:123], v[100:103], v[212:215]
    ds_read_b64_tr_b16 v[78:79], v15 offset:16896
    v_mfma_f32_16x16x32_bf16 v[216:219], v[124:127], v[88:91], v[216:219]
    v_mfma_f32_16x16x32_bf16 v[220:223], v[124:127], v[92:95], v[220:223]
    v_mfma_f32_16x16x32_bf16 v[224:227], v[124:127], v[96:99], v[224:227]
    v_mfma_f32_16x16x32_bf16 v[228:231], v[124:127], v[100:103], v[228:231]
    s_waitcnt lgkmcnt(0)
    v_mfma_f32_16x16x32_bf16 v[136:139], v[56:59], v[40:43], v[136:139]
    ds_read_b128 v[88:91], v11 offset:0
    v_mfma_f32_16x16x32_bf16 v[140:143], v[56:59], v[44:47], v[140:143]
    ds_read_b64_tr_b16 v[104:105], v14 offset:4096
    v_mfma_f32_16x16x32_bf16 v[144:147], v[56:59], v[48:51], v[144:147]
    ds_read_b64_tr_b16 v[106:107], v14 offset:4608
    s_add_u32 s62, s62, s53
    v_mfma_f32_16x16x32_bf16 v[148:151], v[56:59], v[52:55], v[148:151]
    buffer_load_dwordx4 v251, s[28:31], s62 offen offset:3072  lds
    v_mfma_f32_16x16x32_bf16 v[152:155], v[60:63], v[40:43], v[152:155]
    ds_read_b128 v[92:95], v11 offset:2048
    v_mfma_f32_16x16x32_bf16 v[156:159], v[60:63], v[44:47], v[156:159]
    ds_read_b128 v[96:99], v11 offset:4096
    v_mfma_f32_16x16x32_bf16 v[160:163], v[60:63], v[48:51], v[160:163]
    ds_read_b128 v[100:103], v11 offset:6144
    s_add_u32 m0, s63, 132096
    v_mfma_f32_16x16x32_bf16 v[164:167], v[60:63], v[52:55], v[164:167]
    s_cmp_eq_u32 s92, 1
    s_cbranch_scc1 L_s516
    buffer_load_dwordx4 v253, s[28:31], s62 offen offset:0  lds
L_s516:
    v_mfma_f32_16x16x32_bf16 v[168:171], v[64:67], v[40:43], v[168:171]
    ds_read_b64_tr_b16 v[108:109], v15 offset:4096
    v_mfma_f32_16x16x32_bf16 v[172:175], v[64:67], v[44:47], v[172:175]
    ds_read_b64_tr_b16 v[110:111], v15 offset:4608
    v_mfma_f32_16x16x32_bf16 v[176:179], v[64:67], v[48:51], v[176:179]
    ds_read_b64_tr_b16 v[112:113], v14 offset:12288
    s_mul_i32 s96, s92, 81920
    s_add_u32 s91, s91, s96
    s_cmp_ge_u32 s91, s55
    s_cselect_b32 s96, 491520, 0
    s_sub_u32 s91, s91, s96
    s_mov_b32 s62, s91
    s_add_u32 m0, s63, 40960
    v_mfma_f32_16x16x32_bf16 v[180:183], v[64:67], v[52:55], v[180:183]
    buffer_load_dwordx4 v248, s[36:39], s62 offen offset:0  lds
    v_mfma_f32_16x16x32_bf16 v[184:187], v[68:71], v[40:43], v[184:187]
    ds_read_b64_tr_b16 v[114:115], v14 offset:12800
    v_mfma_f32_16x16x32_bf16 v[188:191], v[68:71], v[44:47], v[188:191]
    ds_read_b64_tr_b16 v[116:117], v15 offset:12288
    v_mfma_f32_16x16x32_bf16 v[192:195], v[68:71], v[48:51], v[192:195]
    ds_read_b64_tr_b16 v[118:119], v15 offset:12800
    v_mfma_f32_16x16x32_bf16 v[196:199], v[68:71], v[52:55], v[196:199]
    buffer_load_dwordx4 v249, s[36:39], s62 offen offset:1024  lds
    v_mfma_f32_16x16x32_bf16 v[200:203], v[72:75], v[40:43], v[200:203]
    ds_read_b64_tr_b16 v[120:121], v14 offset:20480
    v_mfma_f32_16x16x32_bf16 v[204:207], v[72:75], v[44:47], v[204:207]
    ds_read_b64_tr_b16 v[122:123], v14 offset:20992
    v_mfma_f32_16x16x32_bf16 v[208:211], v[72:75], v[48:51], v[208:211]
    ds_read_b64_tr_b16 v[124:125], v15 offset:20480
    v_mfma_f32_16x16x32_bf16 v[212:215], v[72:75], v[52:55], v[212:215]
    ds_read_b64_tr_b16 v[126:127], v15 offset:20992
    v_mfma_f32_16x16x32_bf16 v[216:219], v[76:79], v[40:43], v[216:219]
    v_mfma_f32_16x16x32_bf16 v[220:223], v[76:79], v[44:47], v[220:223]
    v_mfma_f32_16x16x32_bf16 v[224:227], v[76:79], v[48:51], v[224:227]
    v_mfma_f32_16x16x32_bf16 v[228:231], v[76:79], v[52:55], v[228:231]
    s_waitcnt lgkmcnt(0)
    s_barrier
    v_mfma_f32_16x16x32_bf16 v[136:139], v[104:107], v[88:91], v[136:139]
    v_and_b32 v254, 15, v0
    v_mfma_f32_16x16x32_bf16 v[140:143], v[104:107], v[92:95], v[140:143]
    v_lshrrev_b32 v255, 4, v0
    v_mfma_f32_16x16x32_bf16 v[144:147], v[104:107], v[96:99], v[144:147]
    s_mul_i32 s85, s3, 5376
    v_mfma_f32_16x16x32_bf16 v[148:151], v[104:107], v[100:103], v[148:151]
    buffer_load_dwordx4 v250, s[36:39], s62 offen offset:2048  lds
    s_add_u32 s85, s85, 33792
    v_mfma_f32_16x16x32_bf16 v[152:155], v[108:111], v[88:91], v[152:155]
    v_mul_u32_u24 v2, 336, v254
    v_mfma_f32_16x16x32_bf16 v[156:159], v[108:111], v[92:95], v[156:159]
    v_lshl_add_u32 v2, v255, 4, v2
    v_mfma_f32_16x16x32_bf16 v[160:163], v[108:111], v[96:99], v[160:163]
    v_add_u32 v2, s85, v2
    v_mfma_f32_16x16x32_bf16 v[164:167], v[108:111], v[100:103], v[164:167]
    buffer_load_dwordx4 v251, s[36:39], s62 offen offset:3072  lds
    v_mul_u32_u24 v8, 205, v0
    v_mfma_f32_16x16x32_bf16 v[168:171], v[112:115], v[88:91], v[168:171]
    v_lshrrev_b32 v8, 12, v8
    v_mfma_f32_16x16x32_bf16 v[172:175], v[112:115], v[92:95], v[172:175]
    v_mul_u32_u24 v9, 20, v8
    v_mfma_f32_16x16x32_bf16 v[176:179], v[112:115], v[96:99], v[176:179]
    s_add_u32 m0, s63, 45056
    v_sub_u32 v9, v0, v9
    v_mfma_f32_16x16x32_bf16 v[180:183], v[112:115], v[100:103], v[180:183]
    s_cmp_eq_u32 s92, 1
    s_cbranch_scc1 L_s517
    buffer_load_dwordx4 v253, s[36:39], s62 offen offset:0  lds
L_s517:
    s_mul_i32 s85, s3, 1344
    v_mfma_f32_16x16x32_bf16 v[184:187], v[116:119], v[88:91], v[184:187]
    s_add_u32 s85, s85, 33792
    v_mfma_f32_16x16x32_bf16 v[188:191], v[116:119], v[92:95], v[188:191]
    v_mul_u32_u24 v3, 336, v8
    v_mfma_f32_16x16x32_bf16 v[192:195], v[116:119], v[96:99], v[192:195]
    s_add_u32 s62, s62, s64
    s_add_u32 m0, s63, 46080
    v_lshl_add_u32 v3, v9, 4, v3
    v_mfma_f32_16x16x32_bf16 v[196:199], v[116:119], v[100:103], v[196:199]
    buffer_load_dwordx4 v248, s[36:39], s62 offen offset:0  lds
    v_add_u32 v3, s85, v3
    v_mfma_f32_16x16x32_bf16 v[200:203], v[120:123], v[88:91], v[200:203]
    s_add_u32 s85, s85, 1072
    v_mfma_f32_16x16x32_bf16 v[204:207], v[120:123], v[92:95], v[204:207]
    v_lshl_add_u32 v4, v254, 4, s85
    v_mfma_f32_16x16x32_bf16 v[208:211], v[120:123], v[96:99], v[208:211]
    v_xor_b32 v5, 2, v255
    v_mfma_f32_16x16x32_bf16 v[212:215], v[120:123], v[100:103], v[212:215]
    v_and_b32 v6, 2, v5
    v_mfma_f32_16x16x32_bf16 v[216:219], v[124:127], v[88:91], v[216:219]
    v_add_u32 v5, v5, v6
    v_mfma_f32_16x16x32_bf16 v[220:223], v[124:127], v[92:95], v[220:223]
    s_movk_i32 s85, 21504
    v_mfma_f32_16x16x32_bf16 v[224:227], v[124:127], v[96:99], v[224:227]
    v_mad_u32_u24 v5, v5, s85, v4
    v_mfma_f32_16x16x32_bf16 v[228:231], v[124:127], v[100:103], v[228:231]
    v_mad_u32_u24 v4, v255, s85, v4
    s_lshl_b32 s85, s51, 2
    v_lshrrev_b32 v6, 4, v9
    v_mul_u32_u24 v6, s85, v6
    v_lshl_add_u32 v6, v9, 4, v6
    s_movk_i32 s86, 2560
    v_mad_u32_u24 v6, v8, s86, v6
    v_add_u32 v7, 4, v254
    v_lshrrev_b32 v7, 4, v7
    v_mul_u32_u24 v7, s85, v7
    v_lshl_add_u32 v7, v254, 4, v7
    s_movk_i32 s86, 10240
    v_mad_u32_u24 v7, v255, s86, v7
    v_add_u32 v7, 7744, v7
    v_lshl_add_u32 v9, v8, 8, v9
    s_mul_i32 s86, s92, 14
    s_add_u32 s86, s86, 9
    v_min_u32 v8, s86, v0
    v_lshlrev_b32 v8, 7, v8
    s_lshl_b32 s86, s89, 1
    s_add_u32 s86, s86, s92
    s_lshl_b32 s86, s86, 7
    s_add_u32 s86, s86, 24510464
    s_sub_u32 s86, s86, s32
    v_writelane_b32 v8, s86, 63
    s_mov_b32 s84, 0xbfb8aa3b
    s_mov_b32 s85, 0xbfb8aa3b
    v_pk_mul_f32 v[40:41], v[136:137], s[84:85]
    v_pk_mul_f32 v[42:43], v[138:139], s[84:85]
    s_add_u32 s71, s0, 0
    v_pk_mul_f32 v[44:45], v[152:153], s[84:85]
    v_pk_mul_f32 v[46:47], v[154:155], s[84:85]
    v_exp_f32 v40, v40
    v_exp_f32 v41, v41
    v_exp_f32 v42, v42
    v_exp_f32 v43, v43
    v_exp_f32 v44, v44
    v_exp_f32 v45, v45
    v_exp_f32 v46, v46
    v_exp_f32 v47, v47
    v_pk_add_f32 v[40:41], v[40:41], 1.0 op_sel_hi:[1,0]
    v_pk_add_f32 v[42:43], v[42:43], 1.0 op_sel_hi:[1,0]
    v_pk_add_f32 v[44:45], v[44:45], 1.0 op_sel_hi:[1,0]
    v_pk_add_f32 v[46:47], v[46:47], 1.0 op_sel_hi:[1,0]
    v_rcp_f32 v40, v40
    v_rcp_f32 v41, v41
    v_rcp_f32 v42, v42
    v_rcp_f32 v43, v43
    v_rcp_f32 v44, v44
    v_rcp_f32 v45, v45
    v_rcp_f32 v46, v46
    v_rcp_f32 v47, v47
    v_pk_mul_f32 v[40:41], v[40:41], v[136:137]
    v_pk_mul_f32 v[42:43], v[42:43], v[138:139]
    v_pk_mul_f32 v[44:45], v[44:45], v[152:153]
    v_pk_mul_f32 v[46:47], v[46:47], v[154:155]
    v_cvt_pk_bf16_f32 v48, v40, v41
    v_cvt_pk_bf16_f32 v49, v42, v43
    v_cvt_pk_bf16_f32 v50, v44, v45
    v_cvt_pk_bf16_f32 v51, v46, v47
    buffer_store_dwordx4 v[48:51], v1, s[20:23], s71 offen sc1
    v_pk_mul_f32 v[52:53], v[140:141], s[84:85]
    v_pk_mul_f32 v[54:55], v[142:143], s[84:85]
    s_add_u32 s71, s0, 49152
    v_pk_mul_f32 v[56:57], v[156:157], s[84:85]
    v_pk_mul_f32 v[58:59], v[158:159], s[84:85]
    v_exp_f32 v52, v52
    v_exp_f32 v53, v53
    v_exp_f32 v54, v54
    v_exp_f32 v55, v55
    v_exp_f32 v56, v56
    v_exp_f32 v57, v57
    v_exp_f32 v58, v58
    v_exp_f32 v59, v59
    v_pk_add_f32 v[52:53], v[52:53], 1.0 op_sel_hi:[1,0]
    v_pk_add_f32 v[54:55], v[54:55], 1.0 op_sel_hi:[1,0]
    v_pk_add_f32 v[56:57], v[56:57], 1.0 op_sel_hi:[1,0]
    v_pk_add_f32 v[58:59], v[58:59], 1.0 op_sel_hi:[1,0]
    v_rcp_f32 v52, v52
    v_rcp_f32 v53, v53
    v_rcp_f32 v54, v54
    v_rcp_f32 v55, v55
    v_rcp_f32 v56, v56
    v_rcp_f32 v57, v57
    v_rcp_f32 v58, v58
    v_rcp_f32 v59, v59
    v_pk_mul_f32 v[52:53], v[52:53], v[140:141]
    v_pk_mul_f32 v[54:55], v[54:55], v[142:143]
    v_pk_mul_f32 v[56:57], v[56:57], v[156:157]
    v_pk_mul_f32 v[58:59], v[58:59], v[158:159]
    v_cvt_pk_bf16_f32 v60, v52, v53
    v_cvt_pk_bf16_f32 v61, v54, v55
    v_cvt_pk_bf16_f32 v62, v56, v57
    v_cvt_pk_bf16_f32 v63, v58, v59
    buffer_store_dwordx4 v[60:63], v1, s[20:23], s71 offen sc1
    v_pk_mul_f32 v[40:41], v[144:145], s[84:85]
    v_pk_mul_f32 v[42:43], v[146:147], s[84:85]
    s_add_u32 s71, s0, 98304
    v_pk_mul_f32 v[44:45], v[160:161], s[84:85]
    v_pk_mul_f32 v[46:47], v[162:163], s[84:85]
    v_exp_f32 v40, v40
    v_exp_f32 v41, v41
    v_exp_f32 v42, v42
    v_exp_f32 v43, v43
    v_exp_f32 v44, v44
    v_exp_f32 v45, v45
    v_exp_f32 v46, v46
    v_exp_f32 v47, v47
    v_pk_add_f32 v[40:41], v[40:41], 1.0 op_sel_hi:[1,0]
    v_pk_add_f32 v[42:43], v[42:43], 1.0 op_sel_hi:[1,0]
    v_pk_add_f32 v[44:45], v[44:45], 1.0 op_sel_hi:[1,0]
    v_pk_add_f32 v[46:47], v[46:47], 1.0 op_sel_hi:[1,0]
    v_rcp_f32 v40, v40
    v_rcp_f32 v41, v41
    v_rcp_f32 v42, v42
    v_rcp_f32 v43, v43
    v_rcp_f32 v44, v44
    v_rcp_f32 v45, v45
    v_rcp_f32 v46, v46
    v_rcp_f32 v47, v47
    v_pk_mul_f32 v[40:41], v[40:41], v[144:145]
    v_pk_mul_f32 v[42:43], v[42:43], v[146:147]
    v_pk_mul_f32 v[44:45], v[44:45], v[160:161]
    v_pk_mul_f32 v[46:47], v[46:47], v[162:163]
    v_cvt_pk_bf16_f32 v48, v40, v41
    v_cvt_pk_bf16_f32 v49, v42, v43
    v_cvt_pk_bf16_f32 v50, v44, v45
    v_cvt_pk_bf16_f32 v51, v46, v47
    buffer_store_dwordx4 v[48:51], v1, s[20:23], s71 offen sc1
    v_pk_mul_f32 v[52:53], v[148:149], s[84:85]
    v_pk_mul_f32 v[54:55], v[150:151], s[84:85]
    s_add_u32 s71, s0, 147456
    v_pk_mul_f32 v[56:57], v[164:165], s[84:85]
    v_pk_mul_f32 v[58:59], v[166:167], s[84:85]
    v_exp_f32 v52, v52
    v_exp_f32 v53, v53
    v_exp_f32 v54, v54
    v_exp_f32 v55, v55
    v_exp_f32 v56, v56
    v_exp_f32 v57, v57
    v_exp_f32 v58, v58
    v_exp_f32 v59, v59
    v_pk_add_f32 v[52:53], v[52:53], 1.0 op_sel_hi:[1,0]
    v_pk_add_f32 v[54:55], v[54:55], 1.0 op_sel_hi:[1,0]
    v_pk_add_f32 v[56:57], v[56:57], 1.0 op_sel_hi:[1,0]
    v_pk_add_f32 v[58:59], v[58:59], 1.0 op_sel_hi:[1,0]
    v_rcp_f32 v52, v52
    v_rcp_f32 v53, v53
    v_rcp_f32 v54, v54
    v_rcp_f32 v55, v55
    v_rcp_f32 v56, v56
    v_rcp_f32 v57, v57
    v_rcp_f32 v58, v58
    v_rcp_f32 v59, v59
    v_pk_mul_f32 v[52:53], v[52:53], v[148:149]
    v_pk_mul_f32 v[54:55], v[54:55], v[150:151]
    v_pk_mul_f32 v[56:57], v[56:57], v[164:165]
    v_pk_mul_f32 v[58:59], v[58:59], v[166:167]
    v_cvt_pk_bf16_f32 v60, v52, v53
    v_cvt_pk_bf16_f32 v61, v54, v55
    v_cvt_pk_bf16_f32 v62, v56, v57
    v_cvt_pk_bf16_f32 v63, v58, v59
    buffer_store_dwordx4 v[60:63], v1, s[20:23], s71 offen sc1
    v_pk_mul_f32 v[40:41], v[168:169], s[84:85]
    v_pk_mul_f32 v[42:43], v[170:171], s[84:85]
    s_add_u32 s71, s0, 2048
    v_pk_mul_f32 v[44:45], v[184:185], s[84:85]
    v_pk_mul_f32 v[46:47], v[186:187], s[84:85]
    v_exp_f32 v40, v40
    v_exp_f32 v41, v41
    v_exp_f32 v42, v42
    v_exp_f32 v43, v43
    v_exp_f32 v44, v44
    v_exp_f32 v45, v45
    v_exp_f32 v46, v46
    v_exp_f32 v47, v47
    v_pk_add_f32 v[40:41], v[40:41], 1.0 op_sel_hi:[1,0]
    v_pk_add_f32 v[42:43], v[42:43], 1.0 op_sel_hi:[1,0]
    v_pk_add_f32 v[44:45], v[44:45], 1.0 op_sel_hi:[1,0]
    v_pk_add_f32 v[46:47], v[46:47], 1.0 op_sel_hi:[1,0]
    v_rcp_f32 v40, v40
    v_rcp_f32 v41, v41
    v_rcp_f32 v42, v42
    v_rcp_f32 v43, v43
    v_rcp_f32 v44, v44
    v_rcp_f32 v45, v45
    v_rcp_f32 v46, v46
    v_rcp_f32 v47, v47
    v_pk_mul_f32 v[40:41], v[40:41], v[168:169]
    v_pk_mul_f32 v[42:43], v[42:43], v[170:171]
    v_pk_mul_f32 v[44:45], v[44:45], v[184:185]
    v_pk_mul_f32 v[46:47], v[46:47], v[186:187]
    v_cvt_pk_bf16_f32 v48, v40, v41
    v_cvt_pk_bf16_f32 v49, v42, v43
    v_cvt_pk_bf16_f32 v50, v44, v45
    v_cvt_pk_bf16_f32 v51, v46, v47
    buffer_store_dwordx4 v[48:51], v1, s[20:23], s71 offen sc1
    v_pk_mul_f32 v[52:53], v[172:173], s[84:85]
    v_pk_mul_f32 v[54:55], v[174:175], s[84:85]
    s_add_u32 s71, s0, 51200
    v_pk_mul_f32 v[56:57], v[188:189], s[84:85]
    v_pk_mul_f32 v[58:59], v[190:191], s[84:85]
    v_exp_f32 v52, v52
    v_exp_f32 v53, v53
    v_exp_f32 v54, v54
    v_exp_f32 v55, v55
    v_exp_f32 v56, v56
    v_exp_f32 v57, v57
    v_exp_f32 v58, v58
    v_exp_f32 v59, v59
    v_pk_add_f32 v[52:53], v[52:53], 1.0 op_sel_hi:[1,0]
    v_pk_add_f32 v[54:55], v[54:55], 1.0 op_sel_hi:[1,0]
    v_pk_add_f32 v[56:57], v[56:57], 1.0 op_sel_hi:[1,0]
    v_pk_add_f32 v[58:59], v[58:59], 1.0 op_sel_hi:[1,0]
    v_rcp_f32 v52, v52
    v_rcp_f32 v53, v53
    v_rcp_f32 v54, v54
    v_rcp_f32 v55, v55
    v_rcp_f32 v56, v56
    v_rcp_f32 v57, v57
    v_rcp_f32 v58, v58
    v_rcp_f32 v59, v59
    v_pk_mul_f32 v[52:53], v[52:53], v[172:173]
    v_pk_mul_f32 v[54:55], v[54:55], v[174:175]
    v_pk_mul_f32 v[56:57], v[56:57], v[188:189]
    v_pk_mul_f32 v[58:59], v[58:59], v[190:191]
    v_cvt_pk_bf16_f32 v60, v52, v53
    v_cvt_pk_bf16_f32 v61, v54, v55
    v_cvt_pk_bf16_f32 v62, v56, v57
    v_cvt_pk_bf16_f32 v63, v58, v59
    buffer_store_dwordx4 v[60:63], v1, s[20:23], s71 offen sc1
    v_pk_mul_f32 v[40:41], v[176:177], s[84:85]
    v_pk_mul_f32 v[42:43], v[178:179], s[84:85]
    s_add_u32 s71, s0, 100352
    v_pk_mul_f32 v[44:45], v[192:193], s[84:85]
    v_pk_mul_f32 v[46:47], v[194:195], s[84:85]
    v_exp_f32 v40, v40
    v_exp_f32 v41, v41
    v_exp_f32 v42, v42
    v_exp_f32 v43, v43
    v_exp_f32 v44, v44
    v_exp_f32 v45, v45
    v_exp_f32 v46, v46
    v_exp_f32 v47, v47
    v_pk_add_f32 v[40:41], v[40:41], 1.0 op_sel_hi:[1,0]
    v_pk_add_f32 v[42:43], v[42:43], 1.0 op_sel_hi:[1,0]
    v_pk_add_f32 v[44:45], v[44:45], 1.0 op_sel_hi:[1,0]
    v_pk_add_f32 v[46:47], v[46:47], 1.0 op_sel_hi:[1,0]
    v_rcp_f32 v40, v40
    v_rcp_f32 v41, v41
    v_rcp_f32 v42, v42
    v_rcp_f32 v43, v43
    v_rcp_f32 v44, v44
    v_rcp_f32 v45, v45
    v_rcp_f32 v46, v46
    v_rcp_f32 v47, v47
    v_pk_mul_f32 v[40:41], v[40:41], v[176:177]
    v_pk_mul_f32 v[42:43], v[42:43], v[178:179]
    v_pk_mul_f32 v[44:45], v[44:45], v[192:193]
    v_pk_mul_f32 v[46:47], v[46:47], v[194:195]
    v_cvt_pk_bf16_f32 v48, v40, v41
    v_cvt_pk_bf16_f32 v49, v42, v43
    v_cvt_pk_bf16_f32 v50, v44, v45
    v_cvt_pk_bf16_f32 v51, v46, v47
    buffer_store_dwordx4 v[48:51], v1, s[20:23], s71 offen sc1
    v_pk_mul_f32 v[52:53], v[180:181], s[84:85]
    v_pk_mul_f32 v[54:55], v[182:183], s[84:85]
    s_add_u32 s71, s0, 149504
    v_pk_mul_f32 v[56:57], v[196:197], s[84:85]
    v_pk_mul_f32 v[58:59], v[198:199], s[84:85]
    v_exp_f32 v52, v52
    v_exp_f32 v53, v53
    v_exp_f32 v54, v54
    v_exp_f32 v55, v55
    v_exp_f32 v56, v56
    v_exp_f32 v57, v57
    v_exp_f32 v58, v58
    v_exp_f32 v59, v59
    v_pk_add_f32 v[52:53], v[52:53], 1.0 op_sel_hi:[1,0]
    v_pk_add_f32 v[54:55], v[54:55], 1.0 op_sel_hi:[1,0]
    v_pk_add_f32 v[56:57], v[56:57], 1.0 op_sel_hi:[1,0]
    v_pk_add_f32 v[58:59], v[58:59], 1.0 op_sel_hi:[1,0]
    v_rcp_f32 v52, v52
    v_rcp_f32 v53, v53
    v_rcp_f32 v54, v54
    v_rcp_f32 v55, v55
    v_rcp_f32 v56, v56
    v_rcp_f32 v57, v57
    v_rcp_f32 v58, v58
    v_rcp_f32 v59, v59
    v_pk_mul_f32 v[52:53], v[52:53], v[180:181]
    v_pk_mul_f32 v[54:55], v[54:55], v[182:183]
    v_pk_mul_f32 v[56:57], v[56:57], v[196:197]
    v_pk_mul_f32 v[58:59], v[58:59], v[198:199]
    v_cvt_pk_bf16_f32 v60, v52, v53
    v_cvt_pk_bf16_f32 v61, v54, v55
    v_cvt_pk_bf16_f32 v62, v56, v57
    v_cvt_pk_bf16_f32 v63, v58, v59
    buffer_store_dwordx4 v[60:63], v1, s[20:23], s71 offen sc1
    s_waitcnt vmcnt(4)
    s_mov_b64 exec, 1
    buffer_store_dwordx2 v[36:37], v34, s[20:23], s1 offen offset:0 sc1
    s_mov_b64 exec, -1
    v_pk_mul_f32 v[40:41], v[200:201], s[84:85]
    v_pk_mul_f32 v[42:43], v[202:203], s[84:85]
    s_add_u32 s71, s0, 4096
    v_pk_mul_f32 v[44:45], v[216:217], s[84:85]
    v_pk_mul_f32 v[46:47], v[218:219], s[84:85]
    v_exp_f32 v40, v40
    v_exp_f32 v41, v41
    v_exp_f32 v42, v42
    v_exp_f32 v43, v43
    v_exp_f32 v44, v44
    v_exp_f32 v45, v45
    v_exp_f32 v46, v46
    v_exp_f32 v47, v47
    v_pk_add_f32 v[40:41], v[40:41], 1.0 op_sel_hi:[1,0]
    v_pk_add_f32 v[42:43], v[42:43], 1.0 op_sel_hi:[1,0]
    v_pk_add_f32 v[44:45], v[44:45], 1.0 op_sel_hi:[1,0]
    v_pk_add_f32 v[46:47], v[46:47], 1.0 op_sel_hi:[1,0]
    v_rcp_f32 v40, v40
    v_rcp_f32 v41, v41
    v_rcp_f32 v42, v42
    v_rcp_f32 v43, v43
    v_rcp_f32 v44, v44
    v_rcp_f32 v45, v45
    v_rcp_f32 v46, v46
    v_rcp_f32 v47, v47
    v_pk_mul_f32 v[40:41], v[40:41], v[200:201]
    v_pk_mul_f32 v[42:43], v[42:43], v[202:203]
    v_pk_mul_f32 v[44:45], v[44:45], v[216:217]
    v_pk_mul_f32 v[46:47], v[46:47], v[218:219]
    v_cvt_pk_bf16_f32 v48, v40, v41
    v_cvt_pk_bf16_f32 v49, v42, v43
    v_cvt_pk_bf16_f32 v50, v44, v45
    v_cvt_pk_bf16_f32 v51, v46, v47
    buffer_store_dwordx4 v[48:51], v1, s[20:23], s71 offen sc1
    v_pk_mul_f32 v[52:53], v[204:205], s[84:85]
    v_pk_mul_f32 v[54:55], v[206:207], s[84:85]
    s_add_u32 s71, s0, 53248
    v_pk_mul_f32 v[56:57], v[220:221], s[84:85]
    v_pk_mul_f32 v[58:59], v[222:223], s[84:85]
    v_exp_f32 v52, v52
    v_exp_f32 v53, v53
    v_exp_f32 v54, v54
    v_exp_f32 v55, v55
    v_exp_f32 v56, v56
    v_exp_f32 v57, v57
    v_exp_f32 v58, v58
    v_exp_f32 v59, v59
    v_pk_add_f32 v[52:53], v[52:53], 1.0 op_sel_hi:[1,0]
    v_pk_add_f32 v[54:55], v[54:55], 1.0 op_sel_hi:[1,0]
    v_pk_add_f32 v[56:57], v[56:57], 1.0 op_sel_hi:[1,0]
    v_pk_add_f32 v[58:59], v[58:59], 1.0 op_sel_hi:[1,0]
    v_rcp_f32 v52, v52
    v_rcp_f32 v53, v53
    v_rcp_f32 v54, v54
    v_rcp_f32 v55, v55
    v_rcp_f32 v56, v56
    v_rcp_f32 v57, v57
    v_rcp_f32 v58, v58
    v_rcp_f32 v59, v59
    v_pk_mul_f32 v[52:53], v[52:53], v[204:205]
    v_pk_mul_f32 v[54:55], v[54:55], v[206:207]
    v_pk_mul_f32 v[56:57], v[56:57], v[220:221]
    v_pk_mul_f32 v[58:59], v[58:59], v[222:223]
    v_cvt_pk_bf16_f32 v60, v52, v53
    v_cvt_pk_bf16_f32 v61, v54, v55
    v_cvt_pk_bf16_f32 v62, v56, v57
    v_cvt_pk_bf16_f32 v63, v58, v59
    buffer_store_dwordx4 v[60:63], v1, s[20:23], s71 offen sc1
    v_pk_mul_f32 v[40:41], v[208:209], s[84:85]
    v_pk_mul_f32 v[42:43], v[210:211], s[84:85]
    s_add_u32 s71, s0, 102400
    v_pk_mul_f32 v[44:45], v[224:225], s[84:85]
    v_pk_mul_f32 v[46:47], v[226:227], s[84:85]
    v_exp_f32 v40, v40
    v_exp_f32 v41, v41
    v_exp_f32 v42, v42
    v_exp_f32 v43, v43
    v_exp_f32 v44, v44
    v_exp_f32 v45, v45
    v_exp_f32 v46, v46
    v_exp_f32 v47, v47
    v_pk_add_f32 v[40:41], v[40:41], 1.0 op_sel_hi:[1,0]
    v_pk_add_f32 v[42:43], v[42:43], 1.0 op_sel_hi:[1,0]
    v_pk_add_f32 v[44:45], v[44:45], 1.0 op_sel_hi:[1,0]
    v_pk_add_f32 v[46:47], v[46:47], 1.0 op_sel_hi:[1,0]
    v_rcp_f32 v40, v40
    v_rcp_f32 v41, v41
    v_rcp_f32 v42, v42
    v_rcp_f32 v43, v43
    v_rcp_f32 v44, v44
    v_rcp_f32 v45, v45
    v_rcp_f32 v46, v46
    v_rcp_f32 v47, v47
    v_pk_mul_f32 v[40:41], v[40:41], v[208:209]
    v_pk_mul_f32 v[42:43], v[42:43], v[210:211]
    v_pk_mul_f32 v[44:45], v[44:45], v[224:225]
    v_pk_mul_f32 v[46:47], v[46:47], v[226:227]
    v_cvt_pk_bf16_f32 v48, v40, v41
    v_cvt_pk_bf16_f32 v49, v42, v43
    v_cvt_pk_bf16_f32 v50, v44, v45
    v_cvt_pk_bf16_f32 v51, v46, v47
    buffer_store_dwordx4 v[48:51], v1, s[20:23], s71 offen sc1
    v_pk_mul_f32 v[52:53], v[212:213], s[84:85]
    v_pk_mul_f32 v[54:55], v[214:215], s[84:85]
    s_add_u32 s71, s0, 151552
    v_pk_mul_f32 v[56:57], v[228:229], s[84:85]
    v_pk_mul_f32 v[58:59], v[230:231], s[84:85]
    v_exp_f32 v52, v52
    v_exp_f32 v53, v53
    v_exp_f32 v54, v54
    v_exp_f32 v55, v55
    v_exp_f32 v56, v56
    v_exp_f32 v57, v57
    v_exp_f32 v58, v58
    v_exp_f32 v59, v59
    v_pk_add_f32 v[52:53], v[52:53], 1.0 op_sel_hi:[1,0]
    v_pk_add_f32 v[54:55], v[54:55], 1.0 op_sel_hi:[1,0]
    v_pk_add_f32 v[56:57], v[56:57], 1.0 op_sel_hi:[1,0]
    v_pk_add_f32 v[58:59], v[58:59], 1.0 op_sel_hi:[1,0]
    v_rcp_f32 v52, v52
    v_rcp_f32 v53, v53
    v_rcp_f32 v54, v54
    v_rcp_f32 v55, v55
    v_rcp_f32 v56, v56
    v_rcp_f32 v57, v57
    v_rcp_f32 v58, v58
    v_rcp_f32 v59, v59
    v_pk_mul_f32 v[52:53], v[52:53], v[212:213]
    v_pk_mul_f32 v[54:55], v[54:55], v[214:215]
    v_pk_mul_f32 v[56:57], v[56:57], v[228:229]
    v_pk_mul_f32 v[58:59], v[58:59], v[230:231]
    v_cvt_pk_bf16_f32 v60, v52, v53
    v_cvt_pk_bf16_f32 v61, v54, v55
    v_cvt_pk_bf16_f32 v62, v56, v57
    v_cvt_pk_bf16_f32 v63, v58, v59
    buffer_store_dwordx4 v[60:63], v1, s[20:23], s71 offen sc1
    s_waitcnt vmcnt(5)
    s_mov_b64 exec, 1
    buffer_store_dwordx2 v[36:37], v34, s[20:23], s1 offen offset:512 sc1
    s_mov_b64 exec, -1
    buffer_load_dwordx4 v249, s[36:39], s62 offen offset:1024  lds
    buffer_load_dwordx4 v250, s[36:39], s62 offen offset:2048  lds
    s_add_u32 s62, s62, s53
    buffer_load_dwordx4 v251, s[36:39], s62 offen offset:3072  lds
    s_add_u32 m0, s63, 50176
    s_nop 0
    s_cmp_eq_u32 s92, 1
    s_cbranch_scc1 L_s518
    buffer_load_dwordx4 v253, s[36:39], s62 offen offset:0  lds
L_s518:
    s_add_u32 s91, s91, s65
    s_cmp_ge_u32 s91, s55
    s_cselect_b32 s96, 491520, 0
    s_sub_u32 s91, s91, s96
    s_mov_b32 s62, s91
    s_add_u32 m0, s63, 81920
    s_nop 0
    buffer_load_dwordx4 v248, s[28:31], s62 offen offset:0  lds
    buffer_load_dwordx4 v249, s[28:31], s62 offen offset:1024  lds
    buffer_load_dwordx4 v250, s[28:31], s62 offen offset:2048  lds
    buffer_load_dwordx4 v251, s[28:31], s62 offen offset:3072  lds
    s_add_u32 s62, s62, s64
    s_add_u32 m0, s63, 87040
    s_nop 0
    buffer_load_dwordx4 v248, s[28:31], s62 offen offset:0  lds
    buffer_load_dwordx4 v249, s[28:31], s62 offen offset:1024  lds
    buffer_load_dwordx4 v250, s[28:31], s62 offen offset:2048  lds
    s_add_u32 s62, s62, s53
    buffer_load_dwordx4 v251, s[28:31], s62 offen offset:3072  lds
    s_lshr_b32 s70, s90, 2
    s_mul_i32 s70, s70, 6144
    s_mul_i32 s96, s3, 1536
    s_add_u32 s70, s70, s96
    s_add_u32 s70, s70, 24543232
    v_min_u32 v28, 11, v0
    v_lshlrev_b32 v28, 7, v28
    s_mov_b32 s79, s70
    buffer_load_dwordx2 v[30:31], v28, s[20:23], s79 offen sc1
    s_mov_b32 s58, 0xffff
    s_sub_u32 s83, s67, 12288
    s_lshl_b32 s87, s52, 11
    s_add_u32 s8, s87, s33
    s_add_u32 s87, s33, 12288
    s_add_u32 s9, s8, 2048
    s_cmp_eq_u32 s9, s87
    s_cselect_b32 s9, s33, s9
    s_add_u32 s10, s9, 2048
    s_cmp_eq_u32 s10, s87
    s_cselect_b32 s10, s33, s10
    s_add_u32 s11, s10, 2048
    s_cmp_eq_u32 s11, s87
    s_cselect_b32 s11, s33, s11
    s_add_u32 s12, s11, 2048
    s_cmp_eq_u32 s12, s87
    s_cselect_b32 s12, s33, s12
    s_add_u32 s13, s12, 2048
    s_cmp_eq_u32 s13, s87
    s_cselect_b32 s13, s33, s13
    s_waitcnt vmcnt(13)
    s_mov_b64 exec, 1
    buffer_store_dwordx2 v[36:37], v34, s[20:23], s1 offen offset:1024 sc1
    s_mov_b64 exec, -1
    v_add_u32 v254, 122880, v38
    v_xor_b32 v255, 32, v254
    ds_read_b64_tr_b16 a[0:1], v254 offset:0
    ds_read_b64_tr_b16 a[2:3], v254 offset:2048
    ds_read_b64_tr_b16 a[4:5], v255 offset:0
    ds_read_b64_tr_b16 a[6:7], v255 offset:2048
    ds_read_b64_tr_b16 a[20:21], v254 offset:5120
    ds_read_b64_tr_b16 a[22:23], v254 offset:7168
    ds_read_b64_tr_b16 a[24:25], v255 offset:5120
    ds_read_b64_tr_b16 a[26:27], v255 offset:7168
    v_xor_b32 v254, 64, v254
    v_xor_b32 v255, 64, v255
    ds_read_b64_tr_b16 a[8:9], v254 offset:0
    ds_read_b64_tr_b16 a[10:11], v254 offset:2048
    ds_read_b64_tr_b16 a[12:13], v255 offset:0
    ds_read_b64_tr_b16 a[14:15], v255 offset:2048
    ds_read_b64_tr_b16 a[28:29], v254 offset:5120
    ds_read_b64_tr_b16 a[30:31], v254 offset:7168
    ds_read_b64_tr_b16 a[32:33], v255 offset:5120
    ds_read_b64_tr_b16 a[34:35], v255 offset:7168
    s_waitcnt lgkmcnt(0)
    s_mul_i32 s96, s92, 81920
    s_add_u32 s91, s91, s96
    s_cmp_ge_u32 s91, s55
    s_cselect_b32 s96, 491520, 0
    s_sub_u32 s91, s91, s96
    s_mov_b32 s62, s91
    s_add_u32 m0, s63, 122880
    s_nop 0
    buffer_load_dwordx4 v248, s[36:39], s62 offen offset:0  lds
    buffer_load_dwordx4 v249, s[36:39], s62 offen offset:1024  lds
    buffer_load_dwordx4 v250, s[36:39], s62 offen offset:2048  lds
    buffer_load_dwordx4 v251, s[36:39], s62 offen offset:3072  lds
    s_add_u32 s62, s62, s64
    s_add_u32 m0, s63, 128000
    s_nop 0
    buffer_load_dwordx4 v248, s[36:39], s62 offen offset:0  lds
    buffer_load_dwordx4 v249, s[36:39], s62 offen offset:1024  lds
    buffer_load_dwordx4 v250, s[36:39], s62 offen offset:2048  lds
    s_add_u32 s62, s62, s53
    buffer_load_dwordx4 v251, s[36:39], s62 offen offset:3072  lds
    s_waitcnt vmcnt(18)
    v_add_u32 v254, 40960, v38
    v_xor_b32 v255, 32, v254
    ds_read_b64_tr_b16 a[40:41], v254 offset:0
    ds_read_b64_tr_b16 a[42:43], v254 offset:2048
    ds_read_b64_tr_b16 a[44:45], v255 offset:0
    ds_read_b64_tr_b16 a[46:47], v255 offset:2048
    ds_read_b64_tr_b16 a[60:61], v254 offset:5120
    ds_read_b64_tr_b16 a[62:63], v254 offset:7168
    ds_read_b64_tr_b16 a[64:65], v255 offset:5120
    ds_read_b64_tr_b16 a[66:67], v255 offset:7168
    v_xor_b32 v254, 64, v254
    v_xor_b32 v255, 64, v255
    ds_read_b64_tr_b16 a[48:49], v254 offset:0
    ds_read_b64_tr_b16 a[50:51], v254 offset:2048
    ds_read_b64_tr_b16 a[52:53], v255 offset:0
    ds_read_b64_tr_b16 a[54:55], v255 offset:2048
    ds_read_b64_tr_b16 a[68:69], v254 offset:5120
    ds_read_b64_tr_b16 a[70:71], v254 offset:7168
    ds_read_b64_tr_b16 a[72:73], v255 offset:5120
    ds_read_b64_tr_b16 a[74:75], v255 offset:7168
    s_waitcnt lgkmcnt(0)
    s_add_u32 s91, s91, s65
    s_cmp_ge_u32 s91, s55
    s_cselect_b32 s96, 491520, 0
    s_sub_u32 s91, s91, s96
    s_mov_b32 s62, s91
    s_add_u32 m0, s63, 40960
    s_nop 0
    buffer_load_dwordx4 v248, s[28:31], s62 offen offset:0  lds
    buffer_load_dwordx4 v249, s[28:31], s62 offen offset:1024  lds
    buffer_load_dwordx4 v250, s[28:31], s62 offen offset:2048  lds
    buffer_load_dwordx4 v251, s[28:31], s62 offen offset:3072  lds
    s_mul_i32 s96, s92, 40960
    s_add_u32 s62, s62, s96
    s_add_u32 m0, s63, 46080
    s_nop 0
    buffer_load_dwordx4 v248, s[36:39], s62 offen offset:0  lds
    buffer_load_dwordx4 v249, s[36:39], s62 offen offset:1024  lds
    buffer_load_dwordx4 v250, s[36:39], s62 offen offset:2048  lds
    buffer_load_dwordx4 v251, s[36:39], s62 offen offset:3072  lds
    s_waitcnt vmcnt(17)
    v_cmp_ne_u32 vcc, s88, v30
    v_cmp_ne_u32 s[96:97], s88, v31
    s_nop 1
    s_or_b64 vcc, vcc, s[96:97]
    s_cbranch_scc1 L_pslow19
L_pok19:
    s_mul_i32 s70, s90, 49152
    s_mul_i32 s96, s3, 12288
    s_add_u32 s70, s70, s96
    s_add_u32 s70, s70, 12582912
    s_sub_u32 s70, s70, s33
    s_add_u32 s86, s8, s70
    buffer_load_dwordx4 a[16:19], v1, s[20:23], s86 offen offset:0 sc1
    buffer_load_dwordx4 a[36:39], v1, s[20:23], s86 offen offset:1024 sc1
    s_add_u32 s86, s9, s70
    buffer_load_dwordx4 a[56:59], v1, s[20:23], s86 offen offset:0 sc1
    buffer_load_dwordx4 a[76:79], v1, s[20:23], s86 offen offset:1024 sc1
    s_add_u32 s86, s10, s70
    buffer_load_dwordx4 a[96:99], v1, s[20:23], s86 offen offset:0 sc1
    buffer_load_dwordx4 a[116:119], v1, s[20:23], s86 offen offset:1024 sc1
    s_add_u32 s86, s11, s70
    buffer_load_dwordx4 a[136:139], v1, s[20:23], s86 offen offset:0 sc1
    buffer_load_dwordx4 a[156:159], v1, s[20:23], s86 offen offset:1024 sc1
    s_add_u32 s86, s12, s70
    buffer_load_dwordx4 a[176:179], v1, s[20:23], s86 offen offset:0 sc1
    buffer_load_dwordx4 a[196:199], v1, s[20:23], s86 offen offset:1024 sc1
    s_add_u32 s86, s13, s70
    buffer_load_dwordx4 a[216:219], v1, s[20:23], s86 offen offset:0 sc1
    buffer_load_dwordx4 a[236:239], v1, s[20:23], s86 offen offset:1024 sc1
    v_add_u32 v254, 81920, v38
    v_xor_b32 v255, 32, v254
    ds_read_b64_tr_b16 a[80:81], v254 offset:0
    ds_read_b64_tr_b16 a[82:83], v254 offset:2048
    ds_read_b64_tr_b16 a[84:85], v255 offset:0
    ds_read_b64_tr_b16 a[86:87], v255 offset:2048
    ds_read_b64_tr_b16 a[100:101], v254 offset:5120
    ds_read_b64_tr_b16 a[102:103], v254 offset:7168
    ds_read_b64_tr_b16 a[104:105], v255 offset:5120
    ds_read_b64_tr_b16 a[106:107], v255 offset:7168
    v_xor_b32 v254, 64, v254
    v_xor_b32 v255, 64, v255
    ds_read_b64_tr_b16 a[88:89], v254 offset:0
    ds_read_b64_tr_b16 a[90:91], v254 offset:2048
    ds_read_b64_tr_b16 a[92:93], v255 offset:0
    ds_read_b64_tr_b16 a[94:95], v255 offset:2048
    ds_read_b64_tr_b16 a[108:109], v254 offset:5120
    ds_read_b64_tr_b16 a[110:111], v254 offset:7168
    ds_read_b64_tr_b16 a[112:113], v255 offset:5120
    ds_read_b64_tr_b16 a[114:115], v255 offset:7168
    s_waitcnt lgkmcnt(0)
    s_mul_i32 s96, s92, 81920
    s_add_u32 s91, s91, s96
    s_cmp_ge_u32 s91, s55
    s_cselect_b32 s96, 491520, 0
    s_sub_u32 s91, s91, s96
    s_mov_b32 s62, s91
    s_add_u32 m0, s63, 81920
    s_nop 0
    buffer_load_dwordx4 v248, s[28:31], s62 offen offset:0  lds
    buffer_load_dwordx4 v249, s[28:31], s62 offen offset:1024  lds
    buffer_load_dwordx4 v250, s[28:31], s62 offen offset:2048  lds
    buffer_load_dwordx4 v251, s[28:31], s62 offen offset:3072  lds
    s_mul_i32 s96, s92, 40960
    s_add_u32 s62, s62, s96
    s_add_u32 m0, s63, 87040
    s_nop 0
    buffer_load_dwordx4 v248, s[36:39], s62 offen offset:0  lds
    buffer_load_dwordx4 v249, s[36:39], s62 offen offset:1024  lds
    buffer_load_dwordx4 v250, s[36:39], s62 offen offset:2048  lds
    buffer_load_dwordx4 v251, s[36:39], s62 offen offset:3072  lds
    buffer_load_dwordx2 v[26:27], v8, s[20:23], s32 offen sc1
    s_waitcnt vmcnt(29)
    v_add_u32 v254, 122880, v38
    v_xor_b32 v255, 32, v254
    ds_read_b64_tr_b16 a[120:121], v254 offset:0
    ds_read_b64_tr_b16 a[122:123], v254 offset:2048
    ds_read_b64_tr_b16 a[124:125], v255 offset:0
    ds_read_b64_tr_b16 a[126:127], v255 offset:2048
    ds_read_b64_tr_b16 a[140:141], v254 offset:5120
    ds_read_b64_tr_b16 a[142:143], v254 offset:7168
    ds_read_b64_tr_b16 a[144:145], v255 offset:5120
    ds_read_b64_tr_b16 a[146:147], v255 offset:7168
    v_xor_b32 v254, 64, v254
    v_xor_b32 v255, 64, v255
    ds_read_b64_tr_b16 a[128:129], v254 offset:0
    ds_read_b64_tr_b16 a[130:131], v254 offset:2048
    ds_read_b64_tr_b16 a[132:133], v255 offset:0
    ds_read_b64_tr_b16 a[134:135], v255 offset:2048
    ds_read_b64_tr_b16 a[148:149], v254 offset:5120
    ds_read_b64_tr_b16 a[150:151], v254 offset:7168
    ds_read_b64_tr_b16 a[152:153], v255 offset:5120
    ds_read_b64_tr_b16 a[154:155], v255 offset:7168
    s_waitcnt vmcnt(21)
    v_add_u32 v254, 40960, v38
    v_xor_b32 v255, 32, v254
    ds_read_b64_tr_b16 a[160:161], v254 offset:0
    ds_read_b64_tr_b16 a[162:163], v254 offset:2048
    ds_read_b64_tr_b16 a[164:165], v255 offset:0
    ds_read_b64_tr_b16 a[166:167], v255 offset:2048
    ds_read_b64_tr_b16 a[180:181], v254 offset:5120
    ds_read_b64_tr_b16 a[182:183], v254 offset:7168
    ds_read_b64_tr_b16 a[184:185], v255 offset:5120
    ds_read_b64_tr_b16 a[186:187], v255 offset:7168
    v_xor_b32 v254, 64, v254
    v_xor_b32 v255, 64, v255
    ds_read_b64_tr_b16 a[168:169], v254 offset:0
    ds_read_b64_tr_b16 a[170:171], v254 offset:2048
    ds_read_b64_tr_b16 a[172:173], v255 offset:0
    ds_read_b64_tr_b16 a[174:175], v255 offset:2048
    ds_read_b64_tr_b16 a[188:189], v254 offset:5120
    ds_read_b64_tr_b16 a[190:191], v254 offset:7168
    ds_read_b64_tr_b16 a[192:193], v255 offset:5120
    ds_read_b64_tr_b16 a[194:195], v255 offset:7168
    s_waitcnt vmcnt(1)
    v_add_u32 v254, 81920, v38
    v_xor_b32 v255, 32, v254
    ds_read_b64_tr_b16 a[200:201], v254 offset:0
    ds_read_b64_tr_b16 a[202:203], v254 offset:2048
    ds_read_b64_tr_b16 a[204:205], v255 offset:0
    ds_read_b64_tr_b16 a[206:207], v255 offset:2048
    ds_read_b64_tr_b16 a[220:221], v254 offset:5120
    ds_read_b64_tr_b16 a[222:223], v254 offset:7168
    ds_read_b64_tr_b16 a[224:225], v255 offset:5120
    ds_read_b64_tr_b16 a[226:227], v255 offset:7168
    v_xor_b32 v254, 64, v254
    v_xor_b32 v255, 64, v255
    ds_read_b64_tr_b16 a[208:209], v254 offset:0
    ds_read_b64_tr_b16 a[210:211], v254 offset:2048
    ds_read_b64_tr_b16 a[212:213], v255 offset:0
    ds_read_b64_tr_b16 a[214:215], v255 offset:2048
    ds_read_b64_tr_b16 a[228:229], v254 offset:5120
    ds_read_b64_tr_b16 a[230:231], v254 offset:7168
    ds_read_b64_tr_b16 a[232:233], v255 offset:5120
    ds_read_b64_tr_b16 a[234:235], v255 offset:7168
    s_waitcnt vmcnt(0)
    s_branch L_roleQ
L_typeZ:
    s_lshl_b32 s79, s60, 1
    s_add_u32 s79, s79, 16
    s_lshl_b32 s79, s79, 7
    s_lshl_b32 s84, s80, 7
    s_add_u32 s81, s61, s84
    s_add_u32 m0, s58, 0
    s_nop 0
    buffer_load_dwordx4 v2, s[4:7], s81 offen offset:0  lds
    s_mul_i32 s83, s80, 196608
    buffer_load_dwordx4 v3, s[4:7], s81 offen offset:1024  lds
    s_add_u32 s83, s83, s79
    s_add_u32 s80, s80, 1
    buffer_load_dwordx4 v4, s[4:7], s81 offen offset:2048  lds
    s_cmp_eq_u32 s80, 10
    s_cselect_b32 s80, 0, s80
    buffer_load_dwordx4 v5, s[4:7], s81 offen offset:3072  lds
    s_add_u32 m0, s59, 0
    s_nop 0
    buffer_load_dwordx4 v8, s[16:19], s83 offen offset:0  lds
    buffer_load_dwordx4 v9, s[16:19], s83 offen offset:1024  lds
    s_add_u32 s83, s83, 128
    s_add_u32 m0, s59, 8192
    s_nop 0
    buffer_load_dwordx4 v8, s[16:19], s83 offen offset:0  lds
    buffer_load_dwordx4 v9, s[16:19], s83 offen offset:1024  lds
    s_or_b32 s96, s2, s3
    s_cmp_lg_u32 s96, 0
    s_cbranch_scc1 L_notag20
    s_or_b32 s96, s100, 1
    v_mov_b32 v35, s96
    s_mov_b64 exec, 1
    global_store_dword v34, v35, s[68:69] sc1
    s_mov_b64 exec, -1
L_notag20:
    s_mov_b32 s101, 400000
    s_bfe_u32 s92, s2, 0x10002
    s_and_b32 s89, s76, 8
    s_and_b32 s90, s2, 2
    s_lshl_b32 s90, s90, 1
    s_add_u32 s89, s89, s90
    s_add_u32 s89, s89, s87
    s_mov_b32 s90, s86
    s_xor_b32 s96, s79, 2048
    s_or_b32 s96, s96, s78
    s_cmp_eq_u32 s96, 0
    s_cselect_b32 s93, 1, 0
    s_cbranch_scc0 L_nogateld
    v_lshlrev_b32 v120, 4, v131
    s_sub_u32 s85, s80, 1
    s_cmp_eq_u32 s80, 0
    s_cselect_b32 s85, 9, s85
    s_lshl_b32 s96, s85, 7
    v_add_u32 v121, s96, v120
    global_load_dwordx4 a[0:3], v121, s[64:65] offset:0
    global_load_dwordx4 a[4:7], v121, s[64:65] offset:64
    s_add_u32 s85, s85, 1
    s_cmp_eq_u32 s85, 10
    s_cselect_b32 s85, 0, s85
    s_lshl_b32 s96, s85, 7
    v_add_u32 v121, s96, v120
    global_load_dwordx4 a[8:11], v121, s[64:65] offset:0
    global_load_dwordx4 a[12:15], v121, s[64:65] offset:64
    s_add_u32 s85, s85, 1
    s_cmp_eq_u32 s85, 10
    s_cselect_b32 s85, 0, s85
    s_lshl_b32 s96, s85, 7
    v_add_u32 v121, s96, v120
    global_load_dwordx4 a[16:19], v121, s[64:65] offset:0
    global_load_dwordx4 a[20:23], v121, s[64:65] offset:64
    s_add_u32 s85, s85, 1
    s_cmp_eq_u32 s85, 10
    s_cselect_b32 s85, 0, s85
    s_lshl_b32 s96, s85, 7
    v_add_u32 v121, s96, v120
    global_load_dwordx4 a[24:27], v121, s[64:65] offset:0
    global_load_dwordx4 a[28:31], v121, s[64:65] offset:64
    s_add_u32 s85, s85, 1
    s_cmp_eq_u32 s85, 10
    s_cselect_b32 s85, 0, s85
    s_lshl_b32 s96, s85, 7
    v_add_u32 v121, s96, v120
    global_load_dwordx4 a[32:35], v121, s[64:65] offset:0
    global_load_dwordx4 a[36:39], v121, s[64:65] offset:64
    s_add_u32 s85, s85, 1
    s_cmp_eq_u32 s85, 10
    s_cselect_b32 s85, 0, s85
    s_lshl_b32 s96, s85, 7
    v_add_u32 v121, s96, v120
    global_load_dwordx4 a[40:43], v121, s[64:65] offset:0
    global_load_dwordx4 a[44:47], v121, s[64:65] offset:64
    s_add_u32 s85, s85, 1
    s_cmp_eq_u32 s85, 10
    s_cselect_b32 s85, 0, s85
    s_lshl_b32 s96, s85, 7
    v_add_u32 v121, s96, v120
    global_load_dwordx4 a[48:51], v121, s[64:65] offset:0
    global_load_dwordx4 a[52:55], v121, s[64:65] offset:64
    s_add_u32 s85, s85, 1
    s_cmp_eq_u32 s85, 10
    s_cselect_b32 s85, 0, s85
    s_lshl_b32 s96, s85, 7
    v_add_u32 v121, s96, v120
    global_load_dwordx4 a[56:59], v121, s[64:65] offset:0
    global_load_dwordx4 a[60:63], v121, s[64:65] offset:64
    s_add_u32 s85, s85, 1
    s_cmp_eq_u32 s85, 10
    s_cselect_b32 s85, 0, s85
    s_lshl_b32 s96, s85, 7
    v_add_u32 v121, s96, v120
    global_load_dwordx4 a[64:67], v121, s[64:65] offset:0
    global_load_dwordx4 a[68:71], v121, s[64:65] offset:64
    s_add_u32 s85, s85, 1
    s_cmp_eq_u32 s85, 10
    s_cselect_b32 s85, 0, s85
    s_lshl_b32 s96, s85, 7
    v_add_u32 v121, s96, v120
    global_load_dwordx4 a[72:75], v121, s[64:65] offset:0
    global_load_dwordx4 a[76:79], v121, s[64:65] offset:64
    s_add_u32 s85, s85, 1
    s_cmp_eq_u32 s85, 10
    s_cselect_b32 s85, 0, s85
L_nogateld:
    s_and_b32 s70, s2, 63
    s_lshl_b32 s70, s70, 2
    s_add_u32 s70, s70, s3
    v_min_u32 v120, 24, v0
    s_mul_i32 s96, s70, 3200
    v_lshl_add_u32 v200, v120, 7, s96
    v_min_u32 v121, 59, v0
    s_mul_i32 s96, s70, 7680
    v_lshl_add_u32 v201, v121, 7, s96
    s_mov_b64 s[8:9], s[50:51]
    s_mov_b64 s[10:11], s[52:53]
    s_mov_b64 s[12:13], s[62:63]
    s_and_b32 s70, s2, 63
    s_cmp_ge_u32 s70, 12
    s_cselect_b32 s71, 1, 0
    s_lshl_b32 s74, s70, 9
    s_lshl_b32 s96, s3, 7
    s_add_u32 s74, s74, s96
    s_add_u32 s74, s74, 24543232
    s_mul_i32 s97, s71, 12
    s_sub_u32 s97, s70, s97
    s_lshl_b32 s97, s97, 2
    s_add_u32 s97, s97, s3
    s_mul_i32 s72, s97, 40960
    s_mul_i32 s96, s71, 640
    s_add_u32 s72, s72, s96
    s_add_u32 s72, s72, 512
    s_lshl_b32 s73, s97, 10
    s_mul_i32 s96, s71, 196608
    s_add_u32 s73, s73, s96
    s_add_u32 s73, s73, 12582912
    s_cmp_ge_u32 s70, 24
    s_cselect_b32 s72, 0x40000000, s72
    s_cselect_b32 s73, 2147483648, s73
    s_mov_b32 s12, s62
    s_mov_b32 s13, s63
    s_mov_b32 s14, 1966080
    s_mov_b32 s15, 0x20000
    v_mul_u32_u24 v121, 1280, v129
    v_lshlrev_b32 v120, 1, v131
    v_xor_b32 v120, v120, v128
    v_lshl_add_u32 v202, v120, 4, v121
    v_add_u32 v203, 9216, v202
    v_add_u32 v204, 18432, v202
    v_add_u32 v205, 27648, v202
    v_lshrrev_b32 v120, 3, v0
    v_and_b32 v120, 3, v120
    v_lshlrev_b32 v120, 5, v120
    v_lshrrev_b32 v121, 2, v0
    v_lshl_add_u32 v120, v121, 7, v120
    v_and_b32 v121, 3, v0
    v_lshl_add_u32 v120, v121, 3, v120
    s_mul_i32 s70, s3, 10240
    s_add_u32 s70, s70, 122880
    v_add_u32 v206, s70, v120
    s_mul_i32 s0, s76, 393216
    s_mul_i32 s96, s77, 196608
    s_add_u32 s0, s0, s96
    s_lshl_b32 s96, s79, 4
    s_add_u32 s0, s0, s96
    s_lshl_b32 s96, s78, 10
    s_add_u32 s0, s0, s96
    s_add_u32 s0, s0, 6291456
    s_mul_i32 s1, s76, 12288
    s_lshl_b32 s96, s79, 2
    s_add_u32 s1, s1, s96
    s_lshl_b32 s96, s3, 7
    s_add_u32 s1, s1, s96
    s_add_u32 s1, s1, 24248320
    s_lshl_b32 s95, s89, 9
    s_lshl_b32 s96, s92, 8
    s_add_u32 s95, s95, s96
    s_lshl_b32 s96, s3, 6
    s_add_u32 s95, s95, s96
    s_add_u32 s95, s95, 17301504
    s_lshr_b32 s70, s90, 2
    s_and_b32 s71, s90, 3
    s_cmp_eq_u32 s92, 0
    s_cbranch_scc1 L_wsP21
    s_mov_b32 s28, s62
    s_mov_b32 s29, s63
    s_mov_b32 s30, 1966080
    s_mov_b32 s31, 0x20000
    s_mov_b32 s36, s62
    s_mov_b32 s37, s63
    s_mov_b32 s38, 1966080
    s_mov_b32 s39, 0x20000
    s_mul_i32 s50, s70, 320
    s_lshl_b32 s96, s71, 6
    s_add_u32 s50, s50, s96
    s_mul_i32 s51, s71, -48
    s_add_u32 s51, s51, 192
    s_lshr_b32 s96, s87, 1
    s_add_u32 s52, s96, s87
    s_mul_i32 s91, s3, 491520
    s_lshl_b32 s96, s50, 1
    s_add_u32 s91, s91, s96
    s_add_u32 s55, s91, 491520
    s_mul_i32 s96, s52, 81920
    s_add_u32 s91, s91, s96
    s_mov_b32 s64, 40960
    s_mov_b32 s65, 81920
    s_mov_b32 s54, 0
    v_mul_u32_u24 v121, 1280, v129
    v_lshlrev_b32 v120, 1, v131
    v_xor_b32 v120, v120, v128
    v_lshl_add_u32 v248, v120, 4, v121
    v_add_u32 v249, 9216, v248
    v_add_u32 v250, 18432, v248
    v_add_u32 v251, 27648, v248
    v_add_u32 v253, 0, v248
    v_lshrrev_b32 v120, 3, v0
    v_and_b32 v120, 3, v120
    v_lshlrev_b32 v120, 5, v120
    v_lshrrev_b32 v121, 2, v0
    v_lshl_add_u32 v120, v121, 7, v120
    v_and_b32 v121, 3, v0
    v_lshl_add_u32 v38, v121, 3, v120
    v_mov_b32 v39, v38
    s_branch L_wsE21
L_wsP21:
    s_mov_b32 s28, s50
    s_mov_b32 s29, s51
    s_mov_b32 s30, 819200
    s_mov_b32 s31, 0x20000
    s_mov_b32 s36, s52
    s_mov_b32 s37, s53
    s_mov_b32 s38, 819200
    s_mov_b32 s39, 0x20000
    s_mul_i32 s50, s70, 320
    s_lshl_b32 s96, s71, 6
    s_add_u32 s50, s50, s96
    s_mul_i32 s51, s71, -48
    s_add_u32 s51, s51, 192
    s_mul_i32 s54, s3, 5
    s_add_u32 s54, s54, 1
    s_lshr_b32 s54, s54, 1
    s_and_b32 s52, s87, 1
    s_mul_i32 s91, s50, 1280
    s_lshl_b32 s96, s54, 7
    s_add_u32 s91, s91, s96
    s_mov_b32 s64, 51200
    s_mul_i32 s54, s77, -320
    s_add_u32 s54, s54, 256
    s_add_u32 s54, s54, s91
    s_lshl_b32 s96, s52, 7
    s_add_u32 s91, s91, s96
    s_mul_i32 s65, s52, -256
    s_add_u32 s65, s65, 128
    s_mov_b32 s55, -1
    v_mul_u32_u24 v120, 1280, v129
    v_add_u32 v248, v120, v126
    v_add_u32 v249, v120, v127
    v_add_u32 v249, 9216, v249
    v_add_u32 v250, v120, v126
    v_add_u32 v250, 18432, v250
    v_add_u32 v251, v120, v127
    v_add_u32 v251, 27648, v251
    v_add_u32 v253, v120, v126
    v_add_u32 v253, 40960, v253
    v_lshrrev_b32 v120, 2, v0
    v_mul_u32_u24 v120, 1280, v120
    v_and_b32 v121, 3, v0
    v_xor_b32 v121, v121, v131
    v_lshl_add_u32 v120, v121, 4, v120
    v_accvgpr_write_b32 a254, v120
    v_lshrrev_b32 v121, 1, v131
    v_and_b32 v122, 1, v131
    v_lshrrev_b32 v120, 1, v130
    v_xor_b32 v120, v120, v121
    v_lshlrev_b32 v120, 4, v120
    v_lshl_add_u32 v120, v130, 7, v120
    v_lshl_add_u32 v38, v122, 3, v120
    v_lshrrev_b32 v120, 2, v130
    v_xor_b32 v120, v120, v121
    v_lshlrev_b32 v120, 4, v120
    v_lshl_add_u32 v120, v130, 6, v120
    v_lshl_add_u32 v39, v122, 3, v120
L_wsE21:
    s_xor_b32 s53, s92, 1
    s_mul_i32 s53, s53, s51
    s_mul_i32 s53, s53, 1280
    s_mul_i32 s94, s89, 163840
    s_mul_i32 s96, s3, 40960
    s_add_u32 s94, s94, s96
    s_mul_i32 s96, s92, 20480
    s_add_u32 s94, s94, s96
    s_lshl_b32 s96, s50, 1
    s_add_u32 s94, s94, s96
    s_mul_i32 s63, s3, 10240
    v_add_u32 v38, s63, v38
    v_add_u32 v39, s63, v39
    s_lshl_b32 s96, s51, 1
    v_mov_b32 v124, s96
    v_mul_u32_u24 v120, 205, v0
    v_lshrrev_b32 v120, 12, v120
    v_mul_u32_u24 v122, 20, v120
    v_sub_u32 v122, v0, v122
    v_cmp_le_u32 vcc, 16, v122
    v_lshlrev_b32 v122, 3, v122
    s_nop 0
    v_cndmask_b32 v121, 0, v124, vcc
    v_add_u32 v122, v122, v121
    v_mul_u32_u24 v120, 1280, v120
    v_add_u32 v120, v120, v122
    v_cmp_le_u32 vcc, 12, v130
    v_lshl_add_u32 v123, v130, 3, 32
    s_nop 0
    v_cndmask_b32 v121, 0, v124, vcc
    v_add_u32 v123, v123, v121
    v_mul_u32_u24 v121, 5120, v131
    v_add_u32 v121, v121, v123
    v_add_u32 v121, 3840, v121
    s_lshl_b32 s96, s50, 1
    v_add_u32 v122, s96, v122
    v_add_u32 v123, s96, v123
    v_accvgpr_write_b32 a240, v120
    v_accvgpr_write_b32 a241, v121
    v_accvgpr_write_b32 a242, v122
    v_accvgpr_write_b32 a243, v123
    s_lshl_b32 s67, s89, 6
    s_lshl_b32 s96, s90, 3
    s_add_u32 s67, s67, s96
    s_lshl_b32 s96, s92, 2
    s_add_u32 s67, s67, s96
    s_add_u32 s67, s67, s3
    s_mul_i32 s67, s67, 3072
    s_add_u32 s67, s67, 17825792
    s_mul_i32 s71, s92, 14
    s_add_u32 s71, s71, 10
    s_lshl_b32 s70, s89, 2
    s_add_u32 s70, s70, s3
    s_mul_i32 s32, s70, s71
    s_lshl_b32 s32, s32, 7
    s_mul_i32 s71, s92, 131072
    s_add_u32 s32, s32, s71
    s_add_u32 s32, s32, 24117248
    s_lshl_b32 s70, s89, 5
    s_add_u32 s70, s70, s3
    s_lshl_b32 s71, s92, 11
    s_add_u32 s71, s71, 10240
    s_mul_i32 s33, s70, s71
    s_mul_i32 s71, s92, 6291456
    s_add_u32 s33, s33, s71
    v_lshrrev_b32 v120, 1, v130
    v_xor_b32 v120, v120, v131
    v_lshlrev_b32 v120, 4, v120
    v_lshl_add_u32 v120, v130, 7, v120
    v_xor_b32 v121, 64, v120
    s_lshl_b32 s96, s77, 13
    v_add_u32 v10, s96, v120
    v_add_u32 v11, s96, v121
    v_lshrrev_b32 v122, 2, v130
    v_lshl_add_u32 v123, v131, 3, v122
    v_lshlrev_b32 v123, 7, v123
    v_and_b32 v124, 3, v0
    v_lshl_add_u32 v123, v124, 3, v123
    v_lshrrev_b32 v122, 1, v122
    v_and_b32 v124, 1, v131
    v_lshl_add_u32 v122, v124, 1, v122
    s_lshl_b32 s96, s78, 1
    v_xor_b32 v122, s96, v122
    v_lshl_add_u32 v14, v122, 5, v123
    v_add_u32 v14, 16384, v14
    v_xor_b32 v122, 1, v122
    v_lshl_add_u32 v15, v122, 5, v123
    v_add_u32 v15, 16384, v15
    v_add_u32 v18, 40960, v10
    v_add_u32 v19, 40960, v11
    v_add_u32 v22, 40960, v14
    v_add_u32 v23, 40960, v15
    v_add_u32 v26, 81920, v10
    v_add_u32 v27, 81920, v11
    v_add_u32 v30, 81920, v14
    v_add_u32 v31, 81920, v15
    s_lshl_b32 s84, s80, 7
    s_add_u32 s81, s61, s84
    s_add_u32 m0, s58, 40960
    s_nop 0
    buffer_load_dwordx4 v2, s[4:7], s81 offen offset:0  lds
    s_mul_i32 s83, s80, 196608
    buffer_load_dwordx4 v3, s[4:7], s81 offen offset:1024  lds
    s_add_u32 s83, s83, s79
    s_add_u32 s80, s80, 1
    buffer_load_dwordx4 v4, s[4:7], s81 offen offset:2048  lds
    s_cmp_eq_u32 s80, 10
    s_cselect_b32 s80, 0, s80
    buffer_load_dwordx4 v5, s[4:7], s81 offen offset:3072  lds
    s_add_u32 m0, s59, 40960
    s_nop 0
    buffer_load_dwordx4 v8, s[16:19], s83 offen offset:0  lds
    buffer_load_dwordx4 v9, s[16:19], s83 offen offset:1024  lds
    s_add_u32 s83, s83, 128
    s_add_u32 m0, s59, 49152
    s_nop 0
    buffer_load_dwordx4 v8, s[16:19], s83 offen offset:0  lds
    buffer_load_dwordx4 v9, s[16:19], s83 offen offset:1024  lds
    v_min_u32 v120, 9, v0
    v_lshlrev_b32 v120, 7, v120
    global_load_dword a255, v120, s[56:57]
    s_waitcnt vmcnt(9)
    s_barrier
    ds_read_b128 v[40:43], v10 offset:0
    ds_read_b64_tr_b16 v[56:57], v14 offset:0
    ds_read_b64_tr_b16 v[58:59], v14 offset:512
    ds_read_b128 v[44:47], v10 offset:2048
    ds_read_b128 v[48:51], v10 offset:4096
    ds_read_b128 v[52:55], v10 offset:6144
    ds_read_b64_tr_b16 v[60:61], v15 offset:0
    ds_read_b64_tr_b16 v[62:63], v15 offset:512
    ds_read_b64_tr_b16 v[64:65], v14 offset:8192
    ds_read_b64_tr_b16 v[66:67], v14 offset:8704
    ds_read_b64_tr_b16 v[68:69], v15 offset:8192
    ds_read_b64_tr_b16 v[70:71], v15 offset:8704
    s_waitcnt lgkmcnt(0)
    v_mfma_f32_16x16x32_bf16 v[136:139], v[56:59], v[40:43], 0
    ds_read_b128 v[88:91], v11 offset:0
    s_lshl_b32 s84, s80, 7
    s_add_u32 s81, s61, s84
    s_add_u32 m0, s58, 81920
    v_mfma_f32_16x16x32_bf16 v[140:143], v[56:59], v[44:47], 0
    ds_read_b64_tr_b16 v[104:105], v14 offset:4096
    buffer_load_dwordx4 v2, s[4:7], s81 offen offset:0  lds
    v_mfma_f32_16x16x32_bf16 v[144:147], v[56:59], v[48:51], 0
    ds_read_b64_tr_b16 v[106:107], v14 offset:4608
    s_mul_i32 s83, s80, 196608
    v_mfma_f32_16x16x32_bf16 v[148:151], v[56:59], v[52:55], 0
    ds_read_b128 v[92:95], v11 offset:2048
    buffer_load_dwordx4 v3, s[4:7], s81 offen offset:1024  lds
    v_mfma_f32_16x16x32_bf16 v[152:155], v[60:63], v[40:43], 0
    ds_read_b128 v[96:99], v11 offset:4096
    s_add_u32 s83, s83, s79
    s_add_u32 s80, s80, 1
    v_mfma_f32_16x16x32_bf16 v[156:159], v[60:63], v[44:47], 0
    ds_read_b128 v[100:103], v11 offset:6144
    buffer_load_dwordx4 v4, s[4:7], s81 offen offset:2048  lds
    v_mfma_f32_16x16x32_bf16 v[160:163], v[60:63], v[48:51], 0
    ds_read_b64_tr_b16 v[108:109], v15 offset:4096
    v_mfma_f32_16x16x32_bf16 v[164:167], v[60:63], v[52:55], 0
    ds_read_b64_tr_b16 v[110:111], v15 offset:4608
    s_cmp_eq_u32 s80, 10
    s_cselect_b32 s80, 0, s80
    v_mfma_f32_16x16x32_bf16 v[168:171], v[64:67], v[40:43], 0
    ds_read_b64_tr_b16 v[112:113], v14 offset:12288
    buffer_load_dwordx4 v5, s[4:7], s81 offen offset:3072  lds
    v_mfma_f32_16x16x32_bf16 v[172:175], v[64:67], v[44:47], 0
    ds_read_b64_tr_b16 v[114:115], v14 offset:12800
    s_add_u32 m0, s59, 81920
    v_mfma_f32_16x16x32_bf16 v[176:179], v[64:67], v[48:51], 0
    ds_read_b64_tr_b16 v[116:117], v15 offset:12288
    buffer_load_dwordx4 v8, s[16:19], s83 offen offset:0  lds
    v_mfma_f32_16x16x32_bf16 v[180:183], v[64:67], v[52:55], 0
    ds_read_b64_tr_b16 v[118:119], v15 offset:12800
    v_mfma_f32_16x16x32_bf16 v[184:187], v[68:71], v[40:43], 0
    buffer_load_dwordx4 v9, s[16:19], s83 offen offset:1024  lds
    v_mfma_f32_16x16x32_bf16 v[188:191], v[68:71], v[44:47], 0
    v_mfma_f32_16x16x32_bf16 v[192:195], v[68:71], v[48:51], 0
    v_mfma_f32_16x16x32_bf16 v[196:199], v[68:71], v[52:55], 0
    s_cmp_eq_u32 s93, 0
    s_cbranch_scc1 L_ng0
    v_mfma_f32_16x16x32_bf16 v[232:235], a[0:3], v[40:43], 0
    v_mfma_f32_16x16x32_bf16 v[236:239], a[0:3], v[44:47], 0
    v_mfma_f32_16x16x32_bf16 v[240:243], a[0:3], v[48:51], 0
    v_mfma_f32_16x16x32_bf16 v[244:247], a[0:3], v[52:55], 0
L_ng0:
    s_waitcnt lgkmcnt(0)
    s_waitcnt vmcnt(7)
    s_barrier
    v_mfma_f32_16x16x32_bf16 v[136:139], v[104:107], v[88:91], v[136:139]
    ds_read_b128 v[40:43], v18 offset:0
    s_add_u32 s83, s83, 128
    s_add_u32 m0, s59, 90112
    v_mfma_f32_16x16x32_bf16 v[140:143], v[104:107], v[92:95], v[140:143]
    ds_read_b64_tr_b16 v[56:57], v22 offset:0
    buffer_load_dwordx4 v8, s[16:19], s83 offen offset:0  lds
    v_mfma_f32_16x16x32_bf16 v[144:147], v[104:107], v[96:99], v[144:147]
    ds_read_b64_tr_b16 v[58:59], v22 offset:512
    v_mfma_f32_16x16x32_bf16 v[148:151], v[104:107], v[100:103], v[148:151]
    ds_read_b128 v[44:47], v18 offset:2048
    buffer_load_dwordx4 v9, s[16:19], s83 offen offset:1024  lds
    v_mfma_f32_16x16x32_bf16 v[152:155], v[108:111], v[88:91], v[152:155]
    ds_read_b128 v[48:51], v18 offset:4096
    s_lshl_b32 s84, s80, 7
    s_add_u32 s81, s61, s84
    s_add_u32 m0, s58, 0
    v_mfma_f32_16x16x32_bf16 v[156:159], v[108:111], v[92:95], v[156:159]
    ds_read_b128 v[52:55], v18 offset:6144
    buffer_load_dwordx4 v2, s[4:7], s81 offen offset:0  lds
    v_mfma_f32_16x16x32_bf16 v[160:163], v[108:111], v[96:99], v[160:163]
    ds_read_b64_tr_b16 v[60:61], v23 offset:0
    v_mfma_f32_16x16x32_bf16 v[164:167], v[108:111], v[100:103], v[164:167]
    ds_read_b64_tr_b16 v[62:63], v23 offset:512
    s_mul_i32 s83, s80, 196608
    v_mfma_f32_16x16x32_bf16 v[168:171], v[112:115], v[88:91], v[168:171]
    ds_read_b64_tr_b16 v[64:65], v22 offset:8192
    buffer_load_dwordx4 v3, s[4:7], s81 offen offset:1024  lds
    v_mfma_f32_16x16x32_bf16 v[172:175], v[112:115], v[92:95], v[172:175]
    ds_read_b64_tr_b16 v[66:67], v22 offset:8704
    s_add_u32 s83, s83, s79
    s_add_u32 s80, s80, 1
    v_mfma_f32_16x16x32_bf16 v[176:179], v[112:115], v[96:99], v[176:179]
    ds_read_b64_tr_b16 v[68:69], v23 offset:8192
    buffer_load_dwordx4 v4, s[4:7], s81 offen offset:2048  lds
    v_mfma_f32_16x16x32_bf16 v[180:183], v[112:115], v[100:103], v[180:183]
    ds_read_b64_tr_b16 v[70:71], v23 offset:8704
    s_cmp_eq_u32 s80, 10
    s_cselect_b32 s80, 0, s80
    v_mfma_f32_16x16x32_bf16 v[184:187], v[116:119], v[88:91], v[184:187]
    buffer_load_dwordx4 v5, s[4:7], s81 offen offset:3072  lds
    global_load_dword v35, v34, s[68:69] sc1
    v_mfma_f32_16x16x32_bf16 v[188:191], v[116:119], v[92:95], v[188:191]
    v_mfma_f32_16x16x32_bf16 v[192:195], v[116:119], v[96:99], v[192:195]
    v_mfma_f32_16x16x32_bf16 v[196:199], v[116:119], v[100:103], v[196:199]
    s_cmp_eq_u32 s93, 0
    s_cbranch_scc1 L_ng1
    v_mfma_f32_16x16x32_bf16 v[232:235], a[4:7], v[88:91], v[232:235]
    v_mfma_f32_16x16x32_bf16 v[236:239], a[4:7], v[92:95], v[236:239]
    v_mfma_f32_16x16x32_bf16 v[240:243], a[4:7], v[96:99], v[240:243]
    v_mfma_f32_16x16x32_bf16 v[244:247], a[4:7], v[100:103], v[244:247]
L_ng1:
    s_waitcnt lgkmcnt(0)
    v_mfma_f32_16x16x32_bf16 v[136:139], v[56:59], v[40:43], v[136:139]
    ds_read_b128 v[88:91], v19 offset:0
    s_add_u32 m0, s59, 0
    v_mfma_f32_16x16x32_bf16 v[140:143], v[56:59], v[44:47], v[140:143]
    ds_read_b64_tr_b16 v[104:105], v22 offset:4096
    buffer_load_dwordx4 v8, s[16:19], s83 offen offset:0  lds
    v_mfma_f32_16x16x32_bf16 v[144:147], v[56:59], v[48:51], v[144:147]
    ds_read_b64_tr_b16 v[106:107], v22 offset:4608
    v_mfma_f32_16x16x32_bf16 v[148:151], v[56:59], v[52:55], v[148:151]
    ds_read_b128 v[92:95], v19 offset:2048
    v_mfma_f32_16x16x32_bf16 v[152:155], v[60:63], v[40:43], v[152:155]
    ds_read_b128 v[96:99], v19 offset:4096
    buffer_load_dwordx4 v9, s[16:19], s83 offen offset:1024  lds
    v_mfma_f32_16x16x32_bf16 v[156:159], v[60:63], v[44:47], v[156:159]
    ds_read_b128 v[100:103], v19 offset:6144
    v_mfma_f32_16x16x32_bf16 v[160:163], v[60:63], v[48:51], v[160:163]
    ds_read_b64_tr_b16 v[108:109], v23 offset:4096
    v_mfma_f32_16x16x32_bf16 v[164:167], v[60:63], v[52:55], v[164:167]
    ds_read_b64_tr_b16 v[110:111], v23 offset:4608
    s_add_u32 s83, s83, 128
    s_add_u32 m0, s59, 8192
    v_mfma_f32_16x16x32_bf16 v[168:171], v[64:67], v[40:43], v[168:171]
    ds_read_b64_tr_b16 v[112:113], v22 offset:12288
    buffer_load_dwordx4 v8, s[16:19], s83 offen offset:0  lds
    v_mfma_f32_16x16x32_bf16 v[172:175], v[64:67], v[44:47], v[172:175]
    ds_read_b64_tr_b16 v[114:115], v22 offset:12800
    v_mfma_f32_16x16x32_bf16 v[176:179], v[64:67], v[48:51], v[176:179]
    ds_read_b64_tr_b16 v[116:117], v23 offset:12288
    v_mfma_f32_16x16x32_bf16 v[180:183], v[64:67], v[52:55], v[180:183]
    ds_read_b64_tr_b16 v[118:119], v23 offset:12800
    buffer_load_dwordx4 v9, s[16:19], s83 offen offset:1024  lds
    v_mfma_f32_16x16x32_bf16 v[184:187], v[68:71], v[40:43], v[184:187]
    v_mfma_f32_16x16x32_bf16 v[188:191], v[68:71], v[44:47], v[188:191]
    v_mfma_f32_16x16x32_bf16 v[192:195], v[68:71], v[48:51], v[192:195]
    v_mfma_f32_16x16x32_bf16 v[196:199], v[68:71], v[52:55], v[196:199]
    s_cmp_eq_u32 s93, 0
    s_cbranch_scc1 L_ng2
    v_mfma_f32_16x16x32_bf16 v[232:235], a[8:11], v[40:43], v[232:235]
    v_mfma_f32_16x16x32_bf16 v[236:239], a[8:11], v[44:47], v[236:239]
    v_mfma_f32_16x16x32_bf16 v[240:243], a[8:11], v[48:51], v[240:243]
    v_mfma_f32_16x16x32_bf16 v[244:247], a[8:11], v[52:55], v[244:247]
L_ng2:
    s_waitcnt lgkmcnt(0)
    s_waitcnt vmcnt(9)
    s_barrier
    v_mfma_f32_16x16x32_bf16 v[136:139], v[104:107], v[88:91], v[136:139]
    ds_read_b128 v[40:43], v26 offset:0
    s_lshl_b32 s84, s80, 7
    s_add_u32 s81, s61, s84
    s_add_u32 m0, s58, 40960
    v_mfma_f32_16x16x32_bf16 v[140:143], v[104:107], v[92:95], v[140:143]
    ds_read_b64_tr_b16 v[56:57], v30 offset:0
    buffer_load_dwordx4 v2, s[4:7], s81 offen offset:0  lds
    v_mfma_f32_16x16x32_bf16 v[144:147], v[104:107], v[96:99], v[144:147]
    ds_read_b64_tr_b16 v[58:59], v30 offset:512
    s_mul_i32 s83, s80, 196608
    v_mfma_f32_16x16x32_bf16 v[148:151], v[104:107], v[100:103], v[148:151]
    ds_read_b128 v[44:47], v26 offset:2048
    buffer_load_dwordx4 v3, s[4:7], s81 offen offset:1024  lds
    v_mfma_f32_16x16x32_bf16 v[152:155], v[108:111], v[88:91], v[152:155]
    ds_read_b128 v[48:51], v26 offset:4096
    v_mfma_f32_16x16x32_bf16 v[156:159], v[108:111], v[92:95], v[156:159]
    ds_read_b128 v[52:55], v26 offset:6144
    s_add_u32 s83, s83, s79
    s_add_u32 s80, s80, 1
    v_mfma_f32_16x16x32_bf16 v[160:163], v[108:111], v[96:99], v[160:163]
    ds_read_b64_tr_b16 v[60:61], v31 offset:0
    buffer_load_dwordx4 v4, s[4:7], s81 offen offset:2048  lds
    v_mfma_f32_16x16x32_bf16 v[164:167], v[108:111], v[100:103], v[164:167]
    ds_read_b64_tr_b16 v[62:63], v31 offset:512
    v_mfma_f32_16x16x32_bf16 v[168:171], v[112:115], v[88:91], v[168:171]
    ds_read_b64_tr_b16 v[64:65], v30 offset:8192
    s_cmp_eq_u32 s80, 10
    s_cselect_b32 s80, 0, s80
    v_mfma_f32_16x16x32_bf16 v[172:175], v[112:115], v[92:95], v[172:175]
    ds_read_b64_tr_b16 v[66:67], v30 offset:8704
    buffer_load_dwordx4 v5, s[4:7], s81 offen offset:3072  lds
    v_mfma_f32_16x16x32_bf16 v[176:179], v[112:115], v[96:99], v[176:179]
    ds_read_b64_tr_b16 v[68:69], v31 offset:8192
    v_mfma_f32_16x16x32_bf16 v[180:183], v[112:115], v[100:103], v[180:183]
    ds_read_b64_tr_b16 v[70:71], v31 offset:8704
    s_add_u32 m0, s59, 40960
    v_mfma_f32_16x16x32_bf16 v[184:187], v[116:119], v[88:91], v[184:187]
    buffer_load_dwordx4 v8, s[16:19], s83 offen offset:0  lds
    v_mfma_f32_16x16x32_bf16 v[188:191], v[116:119], v[92:95], v[188:191]
    v_mfma_f32_16x16x32_bf16 v[192:195], v[116:119], v[96:99], v[192:195]
    v_mfma_f32_16x16x32_bf16 v[196:199], v[116:119], v[100:103], v[196:199]
    s_cmp_eq_u32 s93, 0
    s_cbranch_scc1 L_ng3
    v_mfma_f32_16x16x32_bf16 v[232:235], a[12:15], v[88:91], v[232:235]
    v_mfma_f32_16x16x32_bf16 v[236:239], a[12:15], v[92:95], v[236:239]
    v_mfma_f32_16x16x32_bf16 v[240:243], a[12:15], v[96:99], v[240:243]
    v_mfma_f32_16x16x32_bf16 v[244:247], a[12:15], v[100:103], v[244:247]
L_ng3:
    s_waitcnt lgkmcnt(0)
    v_mfma_f32_16x16x32_bf16 v[136:139], v[56:59], v[40:43], v[136:139]
    ds_read_b128 v[88:91], v27 offset:0
    v_mfma_f32_16x16x32_bf16 v[140:143], v[56:59], v[44:47], v[140:143]
    ds_read_b64_tr_b16 v[104:105], v30 offset:4096
    buffer_load_dwordx4 v9, s[16:19], s83 offen offset:1024  lds
    v_mfma_f32_16x16x32_bf16 v[144:147], v[56:59], v[48:51], v[144:147]
    ds_read_b64_tr_b16 v[106:107], v30 offset:4608
    v_mfma_f32_16x16x32_bf16 v[148:151], v[56:59], v[52:55], v[148:151]
    ds_read_b128 v[92:95], v27 offset:2048
    v_mfma_f32_16x16x32_bf16 v[152:155], v[60:63], v[40:43], v[152:155]
    ds_read_b128 v[96:99], v27 offset:4096
    s_add_u32 s83, s83, 128
    s_add_u32 m0, s59, 49152
    v_mfma_f32_16x16x32_bf16 v[156:159], v[60:63], v[44:47], v[156:159]
    ds_read_b128 v[100:103], v27 offset:6144
    buffer_load_dwordx4 v8, s[16:19], s83 offen offset:0  lds
    v_mfma_f32_16x16x32_bf16 v[160:163], v[60:63], v[48:51], v[160:163]
    ds_read_b64_tr_b16 v[108:109], v31 offset:4096
    v_mfma_f32_16x16x32_bf16 v[164:167], v[60:63], v[52:55], v[164:167]
    ds_read_b64_tr_b16 v[110:111], v31 offset:4608
    v_mfma_f32_16x16x32_bf16 v[168:171], v[64:67], v[40:43], v[168:171]
    ds_read_b64_tr_b16 v[112:113], v30 offset:12288
    v_mfma_f32_16x16x32_bf16 v[172:175], v[64:67], v[44:47], v[172:175]
    ds_read_b64_tr_b16 v[114:115], v30 offset:12800
    v_mfma_f32_16x16x32_bf16 v[176:179], v[64:67], v[48:51], v[176:179]
    ds_read_b64_tr_b16 v[116:117], v31 offset:12288
    buffer_load_dwordx4 v9, s[16:19], s83 offen offset:1024  lds
    v_mfma_f32_16x16x32_bf16 v[180:183], v[64:67], v[52:55], v[180:183]
    ds_read_b64_tr_b16 v[118:119], v31 offset:12800
    v_mfma_f32_16x16x32_bf16 v[184:187], v[68:71], v[40:43], v[184:187]
    v_mfma_f32_16x16x32_bf16 v[188:191], v[68:71], v[44:47], v[188:191]
    v_mfma_f32_16x16x32_bf16 v[192:195], v[68:71], v[48:51], v[192:195]
    v_mfma_f32_16x16x32_bf16 v[196:199], v[68:71], v[52:55], v[196:199]
    s_cmp_eq_u32 s93, 0
    s_cbranch_scc1 L_ng4
    v_mfma_f32_16x16x32_bf16 v[232:235], a[16:19], v[40:43], v[232:235]
    v_mfma_f32_16x16x32_bf16 v[236:239], a[16:19], v[44:47], v[236:239]
    v_mfma_f32_16x16x32_bf16 v[240:243], a[16:19], v[48:51], v[240:243]
    v_mfma_f32_16x16x32_bf16 v[244:247], a[16:19], v[52:55], v[244:247]
L_ng4:
    s_waitcnt lgkmcnt(0)
    s_waitcnt vmcnt(8)
    s_barrier
    v_mfma_f32_16x16x32_bf16 v[136:139], v[104:107], v[88:91], v[136:139]
    ds_read_b128 v[40:43], v10 offset:0
    s_lshl_b32 s84, s80, 7
    s_add_u32 s81, s61, s84
    s_add_u32 m0, s58, 81920
    v_mfma_f32_16x16x32_bf16 v[140:143], v[104:107], v[92:95], v[140:143]
    ds_read_b64_tr_b16 v[56:57], v14 offset:0
    buffer_load_dwordx4 v2, s[4:7], s81 offen offset:0  lds
    v_mfma_f32_16x16x32_bf16 v[144:147], v[104:107], v[96:99], v[144:147]
    ds_read_b64_tr_b16 v[58:59], v14 offset:512
    s_mul_i32 s83, s80, 196608
    v_mfma_f32_16x16x32_bf16 v[148:151], v[104:107], v[100:103], v[148:151]
    ds_read_b128 v[44:47], v10 offset:2048
    buffer_load_dwordx4 v3, s[4:7], s81 offen offset:1024  lds
    v_mfma_f32_16x16x32_bf16 v[152:155], v[108:111], v[88:91], v[152:155]
    ds_read_b128 v[48:51], v10 offset:4096
    v_mfma_f32_16x16x32_bf16 v[156:159], v[108:111], v[92:95], v[156:159]
    ds_read_b128 v[52:55], v10 offset:6144
    s_add_u32 s83, s83, s79
    s_add_u32 s80, s80, 1
    v_mfma_f32_16x16x32_bf16 v[160:163], v[108:111], v[96:99], v[160:163]
    ds_read_b64_tr_b16 v[60:61], v15 offset:0
    buffer_load_dwordx4 v4, s[4:7], s81 offen offset:2048  lds
    v_mfma_f32_16x16x32_bf16 v[164:167], v[108:111], v[100:103], v[164:167]
    ds_read_b64_tr_b16 v[62:63], v15 offset:512
    v_mfma_f32_16x16x32_bf16 v[168:171], v[112:115], v[88:91], v[168:171]
    ds_read_b64_tr_b16 v[64:65], v14 offset:8192
    s_cmp_eq_u32 s80, 10
    s_cselect_b32 s80, 0, s80
    v_mfma_f32_16x16x32_bf16 v[172:175], v[112:115], v[92:95], v[172:175]
    ds_read_b64_tr_b16 v[66:67], v14 offset:8704
    buffer_load_dwordx4 v5, s[4:7], s81 offen offset:3072  lds
    v_mfma_f32_16x16x32_bf16 v[176:179], v[112:115], v[96:99], v[176:179]
    ds_read_b64_tr_b16 v[68:69], v15 offset:8192
    v_mfma_f32_16x16x32_bf16 v[180:183], v[112:115], v[100:103], v[180:183]
    ds_read_b64_tr_b16 v[70:71], v15 offset:8704
    s_add_u32 m0, s59, 81920
    v_mfma_f32_16x16x32_bf16 v[184:187], v[116:119], v[88:91], v[184:187]
    buffer_load_dwordx4 v8, s[16:19], s83 offen offset:0  lds
    v_mfma_f32_16x16x32_bf16 v[188:191], v[116:119], v[92:95], v[188:191]
    v_mfma_f32_16x16x32_bf16 v[192:195], v[116:119], v[96:99], v[192:195]
    v_mfma_f32_16x16x32_bf16 v[196:199], v[116:119], v[100:103], v[196:199]
    s_cmp_eq_u32 s93, 0
    s_cbranch_scc1 L_ng5
    v_mfma_f32_16x16x32_bf16 v[232:235], a[20:23], v[88:91], v[232:235]
    v_mfma_f32_16x16x32_bf16 v[236:239], a[20:23], v[92:95], v[236:239]
    v_mfma_f32_16x16x32_bf16 v[240:243], a[20:23], v[96:99], v[240:243]
    v_mfma_f32_16x16x32_bf16 v[244:247], a[20:23], v[100:103], v[244:247]
L_ng5:
    s_waitcnt lgkmcnt(0)
    v_mfma_f32_16x16x32_bf16 v[136:139], v[56:59], v[40:43], v[136:139]
    ds_read_b128 v[88:91], v11 offset:0
    v_mfma_f32_16x16x32_bf16 v[140:143], v[56:59], v[44:47], v[140:143]
    ds_read_b64_tr_b16 v[104:105], v14 offset:4096
    buffer_load_dwordx4 v9, s[16:19], s83 offen offset:1024  lds
    v_mfma_f32_16x16x32_bf16 v[144:147], v[56:59], v[48:51], v[144:147]
    ds_read_b64_tr_b16 v[106:107], v14 offset:4608
    v_mfma_f32_16x16x32_bf16 v[148:151], v[56:59], v[52:55], v[148:151]
    ds_read_b128 v[92:95], v11 offset:2048
    v_mfma_f32_16x16x32_bf16 v[152:155], v[60:63], v[40:43], v[152:155]
    ds_read_b128 v[96:99], v11 offset:4096
    s_add_u32 s83, s83, 128
    s_add_u32 m0, s59, 90112
    v_mfma_f32_16x16x32_bf16 v[156:159], v[60:63], v[44:47], v[156:159]
    ds_read_b128 v[100:103], v11 offset:6144
    buffer_load_dwordx4 v8, s[16:19], s83 offen offset:0  lds
    v_mfma_f32_16x16x32_bf16 v[160:163], v[60:63], v[48:51], v[160:163]
    ds_read_b64_tr_b16 v[108:109], v15 offset:4096
    v_mfma_f32_16x16x32_bf16 v[164:167], v[60:63], v[52:55], v[164:167]
    ds_read_b64_tr_b16 v[110:111], v15 offset:4608
    v_mfma_f32_16x16x32_bf16 v[168:171], v[64:67], v[40:43], v[168:171]
    ds_read_b64_tr_b16 v[112:113], v14 offset:12288
    v_mfma_f32_16x16x32_bf16 v[172:175], v[64:67], v[44:47], v[172:175]
    ds_read_b64_tr_b16 v[114:115], v14 offset:12800
    v_mfma_f32_16x16x32_bf16 v[176:179], v[64:67], v[48:51], v[176:179]
    ds_read_b64_tr_b16 v[116:117], v15 offset:12288
    buffer_load_dwordx4 v9, s[16:19], s83 offen offset:1024  lds
    v_mfma_f32_16x16x32_bf16 v[180:183], v[64:67], v[52:55], v[180:183]
    ds_read_b64_tr_b16 v[118:119], v15 offset:12800
    v_mfma_f32_16x16x32_bf16 v[184:187], v[68:71], v[40:43], v[184:187]
    v_readfirstlane_b32 s88, v35
    s_nop 1
    s_cmp_eq_u32 s88, 0
    s_cbranch_scc1 L_tagslow22
L_tagok22:
    v_mov_b32 v36, s88
    v_mov_b32 v37, s88
    v_mfma_f32_16x16x32_bf16 v[188:191], v[68:71], v[44:47], v[188:191]
    v_mfma_f32_16x16x32_bf16 v[192:195], v[68:71], v[48:51], v[192:195]
    v_mfma_f32_16x16x32_bf16 v[196:199], v[68:71], v[52:55], v[196:199]
    s_cmp_eq_u32 s93, 0
    s_cbranch_scc1 L_ng6
    v_mfma_f32_16x16x32_bf16 v[232:235], a[24:27], v[40:43], v[232:235]
    v_mfma_f32_16x16x32_bf16 v[236:239], a[24:27], v[44:47], v[236:239]
    v_mfma_f32_16x16x32_bf16 v[240:243], a[24:27], v[48:51], v[240:243]
    v_mfma_f32_16x16x32_bf16 v[244:247], a[24:27], v[52:55], v[244:247]
L_ng6:
    s_waitcnt lgkmcnt(0)
    s_waitcnt vmcnt(8)
    s_barrier
    v_mfma_f32_16x16x32_bf16 v[136:139], v[104:107], v[88:91], v[136:139]
    ds_read_b128 v[40:43], v18 offset:0
    s_lshl_b32 s84, s80, 7
    s_add_u32 s81, s61, s84
    s_add_u32 m0, s58, 0
    v_mfma_f32_16x16x32_bf16 v[140:143], v[104:107], v[92:95], v[140:143]
    ds_read_b64_tr_b16 v[56:57], v22 offset:0
    buffer_load_dwordx4 v2, s[4:7], s81 offen offset:0  lds
    v_mfma_f32_16x16x32_bf16 v[144:147], v[104:107], v[96:99], v[144:147]
    ds_read_b64_tr_b16 v[58:59], v22 offset:512
    s_mul_i32 s83, s80, 196608
    v_mfma_f32_16x16x32_bf16 v[148:151], v[104:107], v[100:103], v[148:151]
    ds_read_b128 v[44:47], v18 offset:2048
    buffer_load_dwordx4 v3, s[4:7], s81 offen offset:1024  lds
    v_mfma_f32_16x16x32_bf16 v[152:155], v[108:111], v[88:91], v[152:155]
    ds_read_b128 v[48:51], v18 offset:4096
    v_mfma_f32_16x16x32_bf16 v[156:159], v[108:111], v[92:95], v[156:159]
    ds_read_b128 v[52:55], v18 offset:6144
    s_add_u32 s83, s83, s79
    s_add_u32 s80, s80, 1
    v_mfma_f32_16x16x32_bf16 v[160:163], v[108:111], v[96:99], v[160:163]
    ds_read_b64_tr_b16 v[60:61], v23 offset:0
    buffer_load_dwordx4 v4, s[4:7], s81 offen offset:2048  lds
    v_mfma_f32_16x16x32_bf16 v[164:167], v[108:111], v[100:103], v[164:167]
    ds_read_b64_tr_b16 v[62:63], v23 offset:512
    v_mfma_f32_16x16x32_bf16 v[168:171], v[112:115], v[88:91], v[168:171]
    ds_read_b64_tr_b16 v[64:65], v22 offset:8192
    s_cmp_eq_u32 s80, 10
    s_cselect_b32 s80, 0, s80
    v_mfma_f32_16x16x32_bf16 v[172:175], v[112:115], v[92:95], v[172:175]
    ds_read_b64_tr_b16 v[66:67], v22 offset:8704
    buffer_load_dwordx4 v5, s[4:7], s81 offen offset:3072  lds
    v_mfma_f32_16x16x32_bf16 v[176:179], v[112:115], v[96:99], v[176:179]
    ds_read_b64_tr_b16 v[68:69], v23 offset:8192
    v_mfma_f32_16x16x32_bf16 v[180:183], v[112:115], v[100:103], v[180:183]
    ds_read_b64_tr_b16 v[70:71], v23 offset:8704
    s_add_u32 m0, s59, 0
    v_mfma_f32_16x16x32_bf16 v[184:187], v[116:119], v[88:91], v[184:187]
    buffer_load_dwordx4 v8, s[16:19], s83 offen offset:0  lds
    v_mfma_f32_16x16x32_bf16 v[188:191], v[116:119], v[92:95], v[188:191]
    v_mfma_f32_16x16x32_bf16 v[192:195], v[116:119], v[96:99], v[192:195]
    v_mfma_f32_16x16x32_bf16 v[196:199], v[116:119], v[100:103], v[196:199]
    s_cmp_eq_u32 s93, 0
    s_cbranch_scc1 L_ng7
    v_mfma_f32_16x16x32_bf16 v[232:235], a[28:31], v[88:91], v[232:235]
    v_mfma_f32_16x16x32_bf16 v[236:239], a[28:31], v[92:95], v[236:239]
    v_mfma_f32_16x16x32_bf16 v[240:243], a[28:31], v[96:99], v[240:243]
    v_mfma_f32_16x16x32_bf16 v[244:247], a[28:31], v[100:103], v[244:247]
L_ng7:
    s_waitcnt lgkmcnt(0)
    v_mfma_f32_16x16x32_bf16 v[136:139], v[56:59], v[40:43], v[136:139]
    ds_read_b128 v[88:91], v19 offset:0
    v_mfma_f32_16x16x32_bf16 v[140:143], v[56:59], v[44:47], v[140:143]
    ds_read_b64_tr_b16 v[104:105], v22 offset:4096
    buffer_load_dwordx4 v9, s[16:19], s83 offen offset:1024  lds
    v_mfma_f32_16x16x32_bf16 v[144:147], v[56:59], v[48:51], v[144:147]
    ds_read_b64_tr_b16 v[106:107], v22 offset:4608
    v_mfma_f32_16x16x32_bf16 v[148:151], v[56:59], v[52:55], v[148:151]
    ds_read_b128 v[92:95], v19 offset:2048
    v_mfma_f32_16x16x32_bf16 v[152:155], v[60:63], v[40:43], v[152:155]
    ds_read_b128 v[96:99], v19 offset:4096
    s_add_u32 s83, s83, 128
    s_add_u32 m0, s59, 8192
    v_mfma_f32_16x16x32_bf16 v[156:159], v[60:63], v[44:47], v[156:159]
    ds_read_b128 v[100:103], v19 offset:6144
    buffer_load_dwordx4 v8, s[16:19], s83 offen offset:0  lds
    v_mfma_f32_16x16x32_bf16 v[160:163], v[60:63], v[48:51], v[160:163]
    ds_read_b64_tr_b16 v[108:109], v23 offset:4096
    v_mfma_f32_16x16x32_bf16 v[164:167], v[60:63], v[52:55], v[164:167]
    ds_read_b64_tr_b16 v[110:111], v23 offset:4608
    v_mfma_f32_16x16x32_bf16 v[168:171], v[64:67], v[40:43], v[168:171]
    ds_read_b64_tr_b16 v[112:113], v22 offset:12288
    v_mfma_f32_16x16x32_bf16 v[172:175], v[64:67], v[44:47], v[172:175]
    ds_read_b64_tr_b16 v[114:115], v22 offset:12800
    v_mfma_f32_16x16x32_bf16 v[176:179], v[64:67], v[48:51], v[176:179]
    ds_read_b64_tr_b16 v[116:117], v23 offset:12288
    buffer_load_dwordx4 v9, s[16:19], s83 offen offset:1024  lds
    v_mfma_f32_16x16x32_bf16 v[180:183], v[64:67], v[52:55], v[180:183]
    ds_read_b64_tr_b16 v[118:119], v23 offset:12800
    v_mfma_f32_16x16x32_bf16 v[184:187], v[68:71], v[40:43], v[184:187]
    v_mfma_f32_16x16x32_bf16 v[188:191], v[68:71], v[44:47], v[188:191]
    v_mfma_f32_16x16x32_bf16 v[192:195], v[68:71], v[48:51], v[192:195]
    v_mfma_f32_16x16x32_bf16 v[196:199], v[68:71], v[52:55], v[196:199]
    s_cmp_eq_u32 s93, 0
    s_cbranch_scc1 L_ng8
    v_mfma_f32_16x16x32_bf16 v[232:235], a[32:35], v[40:43], v[232:235]
    v_mfma_f32_16x16x32_bf16 v[236:239], a[32:35], v[44:47], v[236:239]
    v_mfma_f32_16x16x32_bf16 v[240:243], a[32:35], v[48:51], v[240:243]
    v_mfma_f32_16x16x32_bf16 v[244:247], a[32:35], v[52:55], v[244:247]
L_ng8:
    s_waitcnt lgkmcnt(0)
    s_waitcnt vmcnt(8)
    s_barrier
    v_mfma_f32_16x16x32_bf16 v[136:139], v[104:107], v[88:91], v[136:139]
    ds_read_b128 v[40:43], v26 offset:0
    s_lshl_b32 s84, s80, 7
    s_add_u32 s81, s61, s84
    s_add_u32 m0, s58, 40960
    v_mfma_f32_16x16x32_bf16 v[140:143], v[104:107], v[92:95], v[140:143]
    ds_read_b64_tr_b16 v[56:57], v30 offset:0
    buffer_load_dwordx4 v2, s[4:7], s81 offen offset:0  lds
    v_mfma_f32_16x16x32_bf16 v[144:147], v[104:107], v[96:99], v[144:147]
    ds_read_b64_tr_b16 v[58:59], v30 offset:512
    s_mul_i32 s83, s80, 196608
    v_mfma_f32_16x16x32_bf16 v[148:151], v[104:107], v[100:103], v[148:151]
    ds_read_b128 v[44:47], v26 offset:2048
    buffer_load_dwordx4 v3, s[4:7], s81 offen offset:1024  lds
    v_mfma_f32_16x16x32_bf16 v[152:155], v[108:111], v[88:91], v[152:155]
    ds_read_b128 v[48:51], v26 offset:4096
    v_mfma_f32_16x16x32_bf16 v[156:159], v[108:111], v[92:95], v[156:159]
    ds_read_b128 v[52:55], v26 offset:6144
    s_add_u32 s83, s83, s79
    s_add_u32 s80, s80, 1
    v_mfma_f32_16x16x32_bf16 v[160:163], v[108:111], v[96:99], v[160:163]
    ds_read_b64_tr_b16 v[60:61], v31 offset:0
    buffer_load_dwordx4 v4, s[4:7], s81 offen offset:2048  lds
    v_mfma_f32_16x16x32_bf16 v[164:167], v[108:111], v[100:103], v[164:167]
    ds_read_b64_tr_b16 v[62:63], v31 offset:512
    v_mfma_f32_16x16x32_bf16 v[168:171], v[112:115], v[88:91], v[168:171]
    ds_read_b64_tr_b16 v[64:65], v30 offset:8192
    s_cmp_eq_u32 s80, 10
    s_cselect_b32 s80, 0, s80
    v_mfma_f32_16x16x32_bf16 v[172:175], v[112:115], v[92:95], v[172:175]
    ds_read_b64_tr_b16 v[66:67], v30 offset:8704
    buffer_load_dwordx4 v5, s[4:7], s81 offen offset:3072  lds
    v_mfma_f32_16x16x32_bf16 v[176:179], v[112:115], v[96:99], v[176:179]
    ds_read_b64_tr_b16 v[68:69], v31 offset:8192
    v_mfma_f32_16x16x32_bf16 v[180:183], v[112:115], v[100:103], v[180:183]
    ds_read_b64_tr_b16 v[70:71], v31 offset:8704
    s_add_u32 m0, s59, 40960
    v_mfma_f32_16x16x32_bf16 v[184:187], v[116:119], v[88:91], v[184:187]
    buffer_load_dwordx4 v8, s[16:19], s83 offen offset:0  lds
    v_mfma_f32_16x16x32_bf16 v[188:191], v[116:119], v[92:95], v[188:191]
    v_mfma_f32_16x16x32_bf16 v[192:195], v[116:119], v[96:99], v[192:195]
    v_mfma_f32_16x16x32_bf16 v[196:199], v[116:119], v[100:103], v[196:199]
    s_cmp_eq_u32 s93, 0
    s_cbranch_scc1 L_ng9
    v_mfma_f32_16x16x32_bf16 v[232:235], a[36:39], v[88:91], v[232:235]
    v_mfma_f32_16x16x32_bf16 v[236:239], a[36:39], v[92:95], v[236:239]
    v_mfma_f32_16x16x32_bf16 v[240:243], a[36:39], v[96:99], v[240:243]
    v_mfma_f32_16x16x32_bf16 v[244:247], a[36:39], v[100:103], v[244:247]
L_ng9:
    s_waitcnt lgkmcnt(0)
    v_mfma_f32_16x16x32_bf16 v[136:139], v[56:59], v[40:43], v[136:139]
    ds_read_b128 v[88:91], v27 offset:0
    v_mfma_f32_16x16x32_bf16 v[140:143], v[56:59], v[44:47], v[140:143]
    ds_read_b64_tr_b16 v[104:105], v30 offset:4096
    buffer_load_dwordx4 v9, s[16:19], s83 offen offset:1024  lds
    v_mfma_f32_16x16x32_bf16 v[144:147], v[56:59], v[48:51], v[144:147]
    ds_read_b64_tr_b16 v[106:107], v30 offset:4608
    s_add_u32 s83, s83, 128
    s_add_u32 m0, s59, 49152
    v_mfma_f32_16x16x32_bf16 v[148:151], v[56:59], v[52:55], v[148:151]
    ds_read_b128 v[92:95], v27 offset:2048
    buffer_load_dwordx4 v8, s[16:19], s83 offen offset:0  lds
    v_mfma_f32_16x16x32_bf16 v[152:155], v[60:63], v[40:43], v[152:155]
    ds_read_b128 v[96:99], v27 offset:4096
    v_mfma_f32_16x16x32_bf16 v[156:159], v[60:63], v[44:47], v[156:159]
    ds_read_b128 v[100:103], v27 offset:6144
    buffer_load_dwordx4 v9, s[16:19], s83 offen offset:1024  lds
    v_mfma_f32_16x16x32_bf16 v[160:163], v[60:63], v[48:51], v[160:163]
    ds_read_b64_tr_b16 v[108:109], v31 offset:4096
    v_mfma_f32_16x16x32_bf16 v[164:167], v[60:63], v[52:55], v[164:167]
    ds_read_b64_tr_b16 v[110:111], v31 offset:4608
    s_add_u32 m0, s63, 122880
    v_mfma_f32_16x16x32_bf16 v[168:171], v[64:67], v[40:43], v[168:171]
    ds_read_b64_tr_b16 v[112:113], v30 offset:12288
    buffer_load_dwordx4 v202, s[12:15], s72 offen offset:0 lds
    v_mfma_f32_16x16x32_bf16 v[172:175], v[64:67], v[44:47], v[172:175]
    ds_read_b64_tr_b16 v[114:115], v30 offset:12800
    v_mfma_f32_16x16x32_bf16 v[176:179], v[64:67], v[48:51], v[176:179]
    ds_read_b64_tr_b16 v[116:117], v31 offset:12288
    buffer_load_dwordx4 v203, s[12:15], s72 offen offset:1024 lds
    v_mfma_f32_16x16x32_bf16 v[180:183], v[64:67], v[52:55], v[180:183]
    ds_read_b64_tr_b16 v[118:119], v31 offset:12800
    v_mfma_f32_16x16x32_bf16 v[184:187], v[68:71], v[40:43], v[184:187]
    buffer_load_dwordx4 v204, s[12:15], s72 offen offset:2048 lds
    v_mfma_f32_16x16x32_bf16 v[188:191], v[68:71], v[44:47], v[188:191]
    v_mfma_f32_16x16x32_bf16 v[192:195], v[68:71], v[48:51], v[192:195]
    v_mfma_f32_16x16x32_bf16 v[196:199], v[68:71], v[52:55], v[196:199]
    s_cmp_eq_u32 s93, 0
    s_cbranch_scc1 L_ng10
    v_mfma_f32_16x16x32_bf16 v[232:235], a[40:43], v[40:43], v[232:235]
    v_mfma_f32_16x16x32_bf16 v[236:239], a[40:43], v[44:47], v[236:239]
    v_mfma_f32_16x16x32_bf16 v[240:243], a[40:43], v[48:51], v[240:243]
    v_mfma_f32_16x16x32_bf16 v[244:247], a[40:43], v[52:55], v[244:247]
L_ng10:
    s_waitcnt lgkmcnt(0)
    s_waitcnt vmcnt(11)
    s_barrier
    v_mfma_f32_16x16x32_bf16 v[136:139], v[104:107], v[88:91], v[136:139]
    ds_read_b128 v[40:43], v10 offset:0
    v_mfma_f32_16x16x32_bf16 v[140:143], v[104:107], v[92:95], v[140:143]
    ds_read_b64_tr_b16 v[56:57], v14 offset:0
    buffer_load_dwordx4 v205, s[12:15], s72 offen offset:3072 lds
    v_mfma_f32_16x16x32_bf16 v[144:147], v[104:107], v[96:99], v[144:147]
    ds_read_b64_tr_b16 v[58:59], v14 offset:512
    v_mfma_f32_16x16x32_bf16 v[148:151], v[104:107], v[100:103], v[148:151]
    ds_read_b128 v[44:47], v10 offset:2048
    global_load_dword a255, v201, s[12:13]
    v_mfma_f32_16x16x32_bf16 v[152:155], v[108:111], v[88:91], v[152:155]
    ds_read_b128 v[48:51], v10 offset:4096
    v_mfma_f32_16x16x32_bf16 v[156:159], v[108:111], v[92:95], v[156:159]
    ds_read_b128 v[52:55], v10 offset:6144
    global_load_dword a255, v200, s[8:9]
    v_mfma_f32_16x16x32_bf16 v[160:163], v[108:111], v[96:99], v[160:163]
    ds_read_b64_tr_b16 v[60:61], v15 offset:0
    v_mfma_f32_16x16x32_bf16 v[164:167], v[108:111], v[100:103], v[164:167]
    ds_read_b64_tr_b16 v[62:63], v15 offset:512
    v_mfma_f32_16x16x32_bf16 v[168:171], v[112:115], v[88:91], v[168:171]
    ds_read_b64_tr_b16 v[64:65], v14 offset:8192
    global_load_dword a255, v200, s[10:11]
    v_mfma_f32_16x16x32_bf16 v[172:175], v[112:115], v[92:95], v[172:175]
    ds_read_b64_tr_b16 v[66:67], v14 offset:8704
    s_lshl_b32 s84, s80, 7
    s_add_u32 s81, s61, s84
    s_add_u32 m0, s58, 81920
    v_mfma_f32_16x16x32_bf16 v[176:179], v[112:115], v[96:99], v[176:179]
    ds_read_b64_tr_b16 v[68:69], v15 offset:8192
    buffer_load_dwordx4 v2, s[4:7], s81 offen offset:0  lds
    v_mfma_f32_16x16x32_bf16 v[180:183], v[112:115], v[100:103], v[180:183]
    ds_read_b64_tr_b16 v[70:71], v15 offset:8704
    s_mul_i32 s83, s80, 196608
    v_mfma_f32_16x16x32_bf16 v[184:187], v[116:119], v[88:91], v[184:187]
    buffer_load_dwordx4 v3, s[4:7], s81 offen offset:1024  lds
    v_mfma_f32_16x16x32_bf16 v[188:191], v[116:119], v[92:95], v[188:191]
    v_mfma_f32_16x16x32_bf16 v[192:195], v[116:119], v[96:99], v[192:195]
    v_mfma_f32_16x16x32_bf16 v[196:199], v[116:119], v[100:103], v[196:199]
    s_cmp_eq_u32 s93, 0
    s_cbranch_scc1 L_ng11
    v_mfma_f32_16x16x32_bf16 v[232:235], a[44:47], v[88:91], v[232:235]
    v_mfma_f32_16x16x32_bf16 v[236:239], a[44:47], v[92:95], v[236:239]
    v_mfma_f32_16x16x32_bf16 v[240:243], a[44:47], v[96:99], v[240:243]
    v_mfma_f32_16x16x32_bf16 v[244:247], a[44:47], v[100:103], v[244:247]
L_ng11:
    s_waitcnt lgkmcnt(0)
    v_mfma_f32_16x16x32_bf16 v[136:139], v[56:59], v[40:43], v[136:139]
    ds_read_b128 v[88:91], v11 offset:0
    s_add_u32 s83, s83, s79
    s_add_u32 s80, s80, 1
    v_mfma_f32_16x16x32_bf16 v[140:143], v[56:59], v[44:47], v[140:143]
    ds_read_b64_tr_b16 v[104:105], v14 offset:4096
    buffer_load_dwordx4 v4, s[4:7], s81 offen offset:2048  lds
    v_mfma_f32_16x16x32_bf16 v[144:147], v[56:59], v[48:51], v[144:147]
    ds_read_b64_tr_b16 v[106:107], v14 offset:4608
    s_cmp_eq_u32 s80, 10
    s_cselect_b32 s80, 0, s80
    v_mfma_f32_16x16x32_bf16 v[148:151], v[56:59], v[52:55], v[148:151]
    ds_read_b128 v[92:95], v11 offset:2048
    buffer_load_dwordx4 v5, s[4:7], s81 offen offset:3072  lds
    v_mfma_f32_16x16x32_bf16 v[152:155], v[60:63], v[40:43], v[152:155]
    ds_read_b128 v[96:99], v11 offset:4096
    s_add_u32 m0, s59, 81920
    v_mfma_f32_16x16x32_bf16 v[156:159], v[60:63], v[44:47], v[156:159]
    ds_read_b128 v[100:103], v11 offset:6144
    buffer_load_dwordx4 v8, s[16:19], s83 offen offset:0  lds
    v_mfma_f32_16x16x32_bf16 v[160:163], v[60:63], v[48:51], v[160:163]
    ds_read_b64_tr_b16 v[108:109], v15 offset:4096
    v_mfma_f32_16x16x32_bf16 v[164:167], v[60:63], v[52:55], v[164:167]
    ds_read_b64_tr_b16 v[110:111], v15 offset:4608
    v_mfma_f32_16x16x32_bf16 v[168:171], v[64:67], v[40:43], v[168:171]
    ds_read_b64_tr_b16 v[112:113], v14 offset:12288
    buffer_load_dwordx4 v9, s[16:19], s83 offen offset:1024  lds
    v_mfma_f32_16x16x32_bf16 v[172:175], v[64:67], v[44:47], v[172:175]
    ds_read_b64_tr_b16 v[114:115], v14 offset:12800
    s_add_u32 s83, s83, 128
    s_add_u32 m0, s59, 90112
    v_mfma_f32_16x16x32_bf16 v[176:179], v[64:67], v[48:51], v[176:179]
    ds_read_b64_tr_b16 v[116:117], v15 offset:12288
    buffer_load_dwordx4 v8, s[16:19], s83 offen offset:0  lds
    v_mfma_f32_16x16x32_bf16 v[180:183], v[64:67], v[52:55], v[180:183]
    ds_read_b64_tr_b16 v[118:119], v15 offset:12800
    v_mfma_f32_16x16x32_bf16 v[184:187], v[68:71], v[40:43], v[184:187]
    buffer_load_dwordx4 v9, s[16:19], s83 offen offset:1024  lds
    v_mfma_f32_16x16x32_bf16 v[188:191], v[68:71], v[44:47], v[188:191]
    v_mfma_f32_16x16x32_bf16 v[192:195], v[68:71], v[48:51], v[192:195]
    v_mfma_f32_16x16x32_bf16 v[196:199], v[68:71], v[52:55], v[196:199]
    s_cmp_eq_u32 s93, 0
    s_cbranch_scc1 L_ng12
    v_mfma_f32_16x16x32_bf16 v[232:235], a[48:51], v[40:43], v[232:235]
    v_mfma_f32_16x16x32_bf16 v[236:239], a[48:51], v[44:47], v[236:239]
    v_mfma_f32_16x16x32_bf16 v[240:243], a[48:51], v[48:51], v[240:243]
    v_mfma_f32_16x16x32_bf16 v[244:247], a[48:51], v[52:55], v[244:247]
L_ng12:
    s_waitcnt lgkmcnt(0)
    s_waitcnt vmcnt(15)
    s_barrier
    v_mfma_f32_16x16x32_bf16 v[136:139], v[104:107], v[88:91], v[136:139]
    ds_read_b128 v[40:43], v18 offset:0
    v_accvgpr_read_b32 v254, a242
    v_accvgpr_read_b32 v255, a243
    v_mfma_f32_16x16x32_bf16 v[140:143], v[104:107], v[92:95], v[140:143]
    ds_read_b64_tr_b16 v[56:57], v22 offset:0
    global_load_dwordx2 a[250:251], v254, s[56:57]
    v_mfma_f32_16x16x32_bf16 v[144:147], v[104:107], v[96:99], v[144:147]
    ds_read_b64_tr_b16 v[58:59], v22 offset:512
    v_mfma_f32_16x16x32_bf16 v[148:151], v[104:107], v[100:103], v[148:151]
    ds_read_b128 v[44:47], v18 offset:2048
    global_load_dwordx2 a[252:253], v255, s[56:57]
    s_waitcnt vmcnt(13)
    v_mfma_f32_16x16x32_bf16 v[152:155], v[108:111], v[88:91], v[152:155]
    ds_read_b128 v[48:51], v18 offset:4096
    v_xor_b32 v207, 0, v206
    v_accvgpr_read_b32 v254, a240
    v_accvgpr_read_b32 v255, a241
    v_mfma_f32_16x16x32_bf16 v[156:159], v[108:111], v[92:95], v[156:159]
    ds_read_b128 v[52:55], v18 offset:6144
    buffer_load_dwordx2 a[248:249], v255, s[4:7], s94 offen
    ds_read_b64_tr_b16 v[208:209], v207 offset:0
    v_mfma_f32_16x16x32_bf16 v[160:163], v[108:111], v[96:99], v[160:163]
    ds_read_b64_tr_b16 v[60:61], v23 offset:0
    ds_read_b64_tr_b16 v[210:211], v207 offset:2048
    v_mfma_f32_16x16x32_bf16 v[164:167], v[108:111], v[100:103], v[164:167]
    ds_read_b64_tr_b16 v[62:63], v23 offset:512
    v_xor_b32 v207, 32, v206
    s_add_u32 s85, s94, 0
    v_mfma_f32_16x16x32_bf16 v[168:171], v[112:115], v[88:91], v[168:171]
    ds_read_b64_tr_b16 v[64:65], v22 offset:8192
    buffer_load_dwordx2 a[240:241], v254, s[4:7], s85 offen
    ds_read_b64_tr_b16 v[212:213], v207 offset:0
    v_mfma_f32_16x16x32_bf16 v[172:175], v[112:115], v[92:95], v[172:175]
    ds_read_b64_tr_b16 v[66:67], v22 offset:8704
    ds_read_b64_tr_b16 v[214:215], v207 offset:2048
    s_add_u32 s85, s94, 5120
    v_mfma_f32_16x16x32_bf16 v[176:179], v[112:115], v[96:99], v[176:179]
    ds_read_b64_tr_b16 v[68:69], v23 offset:8192
    buffer_load_dwordx2 a[242:243], v254, s[4:7], s85 offen
    v_xor_b32 v207, 64, v206
    v_mfma_f32_16x16x32_bf16 v[180:183], v[112:115], v[100:103], v[180:183]
    ds_read_b64_tr_b16 v[70:71], v23 offset:8704
    ds_read_b64_tr_b16 v[216:217], v207 offset:0
    s_add_u32 s85, s94, 10240
    v_mfma_f32_16x16x32_bf16 v[184:187], v[116:119], v[88:91], v[184:187]
    buffer_load_dwordx2 a[244:245], v254, s[4:7], s85 offen
    ds_read_b64_tr_b16 v[218:219], v207 offset:2048
    v_mfma_f32_16x16x32_bf16 v[188:191], v[116:119], v[92:95], v[188:191]
    v_xor_b32 v207, 96, v206
    v_mfma_f32_16x16x32_bf16 v[192:195], v[116:119], v[96:99], v[192:195]
    ds_read_b64_tr_b16 v[220:221], v207 offset:0
    v_mfma_f32_16x16x32_bf16 v[196:199], v[116:119], v[100:103], v[196:199]
    ds_read_b64_tr_b16 v[222:223], v207 offset:2048
    s_cmp_eq_u32 s93, 0
    s_cbranch_scc1 L_ng13
    v_mfma_f32_16x16x32_bf16 v[232:235], a[52:55], v[88:91], v[232:235]
    v_mfma_f32_16x16x32_bf16 v[236:239], a[52:55], v[92:95], v[236:239]
    v_mfma_f32_16x16x32_bf16 v[240:243], a[52:55], v[96:99], v[240:243]
    v_mfma_f32_16x16x32_bf16 v[244:247], a[52:55], v[100:103], v[244:247]
L_ng13:
    s_waitcnt lgkmcnt(0)
    v_mfma_f32_16x16x32_bf16 v[136:139], v[56:59], v[40:43], v[136:139]
    ds_read_b128 v[88:91], v19 offset:0
    v_mfma_f32_16x16x32_bf16 v[140:143], v[56:59], v[44:47], v[140:143]
    ds_read_b64_tr_b16 v[104:105], v22 offset:4096
    buffer_store_dwordx4 v[208:211], v1, s[20:23], s73 offen sc1
    s_add_u32 s73, s73, 49152
    v_mfma_f32_16x16x32_bf16 v[144:147], v[56:59], v[48:51], v[144:147]
    ds_read_b64_tr_b16 v[106:107], v22 offset:4608
    buffer_store_dwordx4 v[212:215], v1, s[20:23], s73 offen sc1
    s_add_u32 s73, s73, 49152
    v_mfma_f32_16x16x32_bf16 v[148:151], v[56:59], v[52:55], v[148:151]
    ds_read_b128 v[92:95], v19 offset:2048
    buffer_store_dwordx4 v[216:219], v1, s[20:23], s73 offen sc1
    v_mfma_f32_16x16x32_bf16 v[152:155], v[60:63], v[40:43], v[152:155]
    ds_read_b128 v[96:99], v19 offset:4096
    s_add_u32 s73, s73, 49152
    v_mfma_f32_16x16x32_bf16 v[156:159], v[60:63], v[44:47], v[156:159]
    ds_read_b128 v[100:103], v19 offset:6144
    buffer_store_dwordx4 v[220:223], v1, s[20:23], s73 offen sc1
    s_add_u32 s85, s94, 15360
    s_lshl_b32 s94, s94, 1
    v_mfma_f32_16x16x32_bf16 v[160:163], v[60:63], v[48:51], v[160:163]
    ds_read_b64_tr_b16 v[108:109], v23 offset:4096
    buffer_load_dwordx2 a[246:247], v254, s[4:7], s85 offen
    v_mfma_f32_16x16x32_bf16 v[164:167], v[60:63], v[52:55], v[164:167]
    ds_read_b64_tr_b16 v[110:111], v23 offset:4608
    s_lshl_b32 s84, s80, 7
    s_add_u32 s81, s61, s84
    s_add_u32 m0, s58, 0
    v_mfma_f32_16x16x32_bf16 v[168:171], v[64:67], v[40:43], v[168:171]
    ds_read_b64_tr_b16 v[112:113], v22 offset:12288
    buffer_load_dwordx4 v2, s[4:7], s81 offen offset:0  lds
    s_mul_i32 s83, s80, 196608
    v_mfma_f32_16x16x32_bf16 v[172:175], v[64:67], v[44:47], v[172:175]
    ds_read_b64_tr_b16 v[114:115], v22 offset:12800
    buffer_load_dwordx4 v3, s[4:7], s81 offen offset:1024  lds
    s_add_u32 s83, s83, s79
    s_add_u32 s80, s80, 1
    v_mfma_f32_16x16x32_bf16 v[176:179], v[64:67], v[48:51], v[176:179]
    ds_read_b64_tr_b16 v[116:117], v23 offset:12288
    buffer_load_dwordx4 v4, s[4:7], s81 offen offset:2048  lds
    v_mfma_f32_16x16x32_bf16 v[180:183], v[64:67], v[52:55], v[180:183]
    ds_read_b64_tr_b16 v[118:119], v23 offset:12800
    s_cmp_eq_u32 s80, 10
    s_cselect_b32 s80, 0, s80
    v_mfma_f32_16x16x32_bf16 v[184:187], v[68:71], v[40:43], v[184:187]
    buffer_load_dwordx4 v5, s[4:7], s81 offen offset:3072  lds
    s_add_u32 m0, s59, 0
    v_mfma_f32_16x16x32_bf16 v[188:191], v[68:71], v[44:47], v[188:191]
    buffer_load_dwordx4 v8, s[16:19], s83 offen offset:0  lds
    v_mfma_f32_16x16x32_bf16 v[192:195], v[68:71], v[48:51], v[192:195]
    v_mfma_f32_16x16x32_bf16 v[196:199], v[68:71], v[52:55], v[196:199]
    s_cmp_eq_u32 s93, 0
    s_cbranch_scc1 L_ng14
    v_mfma_f32_16x16x32_bf16 v[232:235], a[56:59], v[40:43], v[232:235]
    v_mfma_f32_16x16x32_bf16 v[236:239], a[56:59], v[44:47], v[236:239]
    v_mfma_f32_16x16x32_bf16 v[240:243], a[56:59], v[48:51], v[240:243]
    v_mfma_f32_16x16x32_bf16 v[244:247], a[56:59], v[52:55], v[244:247]
L_ng14:
    s_waitcnt lgkmcnt(0)
    s_waitcnt vmcnt(16)
    s_barrier
    v_mfma_f32_16x16x32_bf16 v[136:139], v[104:107], v[88:91], v[136:139]
    ds_read_b128 v[40:43], v26 offset:0
    v_mfma_f32_16x16x32_bf16 v[140:143], v[104:107], v[92:95], v[140:143]
    ds_read_b64_tr_b16 v[56:57], v30 offset:0
    buffer_load_dwordx4 v9, s[16:19], s83 offen offset:1024  lds
    v_mfma_f32_16x16x32_bf16 v[144:147], v[104:107], v[96:99], v[144:147]
    ds_read_b64_tr_b16 v[58:59], v30 offset:512
    v_mfma_f32_16x16x32_bf16 v[148:151], v[104:107], v[100:103], v[148:151]
    ds_read_b128 v[44:47], v26 offset:2048
    s_add_u32 s83, s83, 128
    s_add_u32 m0, s59, 8192
    v_mfma_f32_16x16x32_bf16 v[152:155], v[108:111], v[88:91], v[152:155]
    ds_read_b128 v[48:51], v26 offset:4096
    buffer_load_dwordx4 v8, s[16:19], s83 offen offset:0  lds
    v_mfma_f32_16x16x32_bf16 v[156:159], v[108:111], v[92:95], v[156:159]
    ds_read_b128 v[52:55], v26 offset:6144
    v_mfma_f32_16x16x32_bf16 v[160:163], v[108:111], v[96:99], v[160:163]
    ds_read_b64_tr_b16 v[60:61], v31 offset:0
    v_mfma_f32_16x16x32_bf16 v[164:167], v[108:111], v[100:103], v[164:167]
    ds_read_b64_tr_b16 v[62:63], v31 offset:512
    v_mfma_f32_16x16x32_bf16 v[168:171], v[112:115], v[88:91], v[168:171]
    ds_read_b64_tr_b16 v[64:65], v30 offset:8192
    buffer_load_dwordx4 v9, s[16:19], s83 offen offset:1024  lds
    v_mfma_f32_16x16x32_bf16 v[172:175], v[112:115], v[92:95], v[172:175]
    ds_read_b64_tr_b16 v[66:67], v30 offset:8704
    v_mfma_f32_16x16x32_bf16 v[176:179], v[112:115], v[96:99], v[176:179]
    ds_read_b64_tr_b16 v[68:69], v31 offset:8192
    s_mov_b32 s62, s91
    s_add_u32 m0, s63, 122880
    v_mfma_f32_16x16x32_bf16 v[180:183], v[112:115], v[100:103], v[180:183]
    ds_read_b64_tr_b16 v[70:71], v31 offset:8704
    buffer_load_dwordx4 v248, s[28:31], s62 offen offset:0  lds
    v_mfma_f32_16x16x32_bf16 v[184:187], v[116:119], v[88:91], v[184:187]
    v_mfma_f32_16x16x32_bf16 v[188:191], v[116:119], v[92:95], v[188:191]
    v_mfma_f32_16x16x32_bf16 v[192:195], v[116:119], v[96:99], v[192:195]
    v_mfma_f32_16x16x32_bf16 v[196:199], v[116:119], v[100:103], v[196:199]
    s_cmp_eq_u32 s93, 0
    s_cbranch_scc1 L_ng15
    v_mfma_f32_16x16x32_bf16 v[232:235], a[60:63], v[88:91], v[232:235]
    v_mfma_f32_16x16x32_bf16 v[236:239], a[60:63], v[92:95], v[236:239]
    v_mfma_f32_16x16x32_bf16 v[240:243], a[60:63], v[96:99], v[240:243]
    v_mfma_f32_16x16x32_bf16 v[244:247], a[60:63], v[100:103], v[244:247]
L_ng15:
    s_waitcnt lgkmcnt(0)
    v_mfma_f32_16x16x32_bf16 v[136:139], v[56:59], v[40:43], v[136:139]
    ds_read_b128 v[88:91], v27 offset:0
    v_mfma_f32_16x16x32_bf16 v[140:143], v[56:59], v[44:47], v[140:143]
    ds_read_b64_tr_b16 v[104:105], v30 offset:4096
    buffer_load_dwordx4 v249, s[28:31], s62 offen offset:1024  lds
    v_mfma_f32_16x16x32_bf16 v[144:147], v[56:59], v[48:51], v[144:147]
    ds_read_b64_tr_b16 v[106:107], v30 offset:4608
    v_mfma_f32_16x16x32_bf16 v[148:151], v[56:59], v[52:55], v[148:151]
    ds_read_b128 v[92:95], v27 offset:2048
    v_mfma_f32_16x16x32_bf16 v[152:155], v[60:63], v[40:43], v[152:155]
    ds_read_b128 v[96:99], v27 offset:4096
    buffer_load_dwordx4 v250, s[28:31], s62 offen offset:2048  lds
    v_mfma_f32_16x16x32_bf16 v[156:159], v[60:63], v[44:47], v[156:159]
    ds_read_b128 v[100:103], v27 offset:6144
    v_mfma_f32_16x16x32_bf16 v[160:163], v[60:63], v[48:51], v[160:163]
    ds_read_b64_tr_b16 v[108:109], v31 offset:4096
    v_mfma_f32_16x16x32_bf16 v[164:167], v[60:63], v[52:55], v[164:167]
    ds_read_b64_tr_b16 v[110:111], v31 offset:4608
    v_mfma_f32_16x16x32_bf16 v[168:171], v[64:67], v[40:43], v[168:171]
    ds_read_b64_tr_b16 v[112:113], v30 offset:12288
    buffer_load_dwordx4 v251, s[28:31], s62 offen offset:3072  lds
    v_mfma_f32_16x16x32_bf16 v[172:175], v[64:67], v[44:47], v[172:175]
    ds_read_b64_tr_b16 v[114:115], v30 offset:12800
    v_mfma_f32_16x16x32_bf16 v[176:179], v[64:67], v[48:51], v[176:179]
    ds_read_b64_tr_b16 v[116:117], v31 offset:12288
    s_add_u32 m0, s63, 126976
    v_mfma_f32_16x16x32_bf16 v[180:183], v[64:67], v[52:55], v[180:183]
    ds_read_b64_tr_b16 v[118:119], v31 offset:12800
    s_cmp_eq_u32 s92, 1
    s_cbranch_scc1 L_s523
    buffer_load_dwordx4 v253, s[28:31], s62 offen offset:0  lds
L_s523:
    v_mfma_f32_16x16x32_bf16 v[184:187], v[68:71], v[40:43], v[184:187]
    v_mfma_f32_16x16x32_bf16 v[188:191], v[68:71], v[44:47], v[188:191]
    v_mfma_f32_16x16x32_bf16 v[192:195], v[68:71], v[48:51], v[192:195]
    v_mfma_f32_16x16x32_bf16 v[196:199], v[68:71], v[52:55], v[196:199]
    s_cmp_eq_u32 s93, 0
    s_cbranch_scc1 L_ng16
    v_mfma_f32_16x16x32_bf16 v[232:235], a[64:67], v[40:43], v[232:235]
    v_mfma_f32_16x16x32_bf16 v[236:239], a[64:67], v[44:47], v[236:239]
    v_mfma_f32_16x16x32_bf16 v[240:243], a[64:67], v[48:51], v[240:243]
    v_mfma_f32_16x16x32_bf16 v[244:247], a[64:67], v[52:55], v[244:247]
L_ng16:
    s_waitcnt lgkmcnt(0)
    s_waitcnt vmcnt(4)
    s_barrier
    v_mfma_f32_16x16x32_bf16 v[136:139], v[104:107], v[88:91], v[136:139]
    ds_read_b128 v[40:43], v10 offset:0
    s_add_u32 s62, s62, s64
    s_add_u32 m0, s63, 128000
    v_mfma_f32_16x16x32_bf16 v[140:143], v[104:107], v[92:95], v[140:143]
    ds_read_b64_tr_b16 v[56:57], v14 offset:0
    buffer_load_dwordx4 v248, s[28:31], s62 offen offset:0  lds
    v_mfma_f32_16x16x32_bf16 v[144:147], v[104:107], v[96:99], v[144:147]
    ds_read_b64_tr_b16 v[58:59], v14 offset:512
    v_mfma_f32_16x16x32_bf16 v[148:151], v[104:107], v[100:103], v[148:151]
    ds_read_b128 v[44:47], v10 offset:2048
    v_mfma_f32_16x16x32_bf16 v[152:155], v[108:111], v[88:91], v[152:155]
    ds_read_b128 v[48:51], v10 offset:4096
    buffer_load_dwordx4 v249, s[28:31], s62 offen offset:1024  lds
    v_mfma_f32_16x16x32_bf16 v[156:159], v[108:111], v[92:95], v[156:159]
    ds_read_b128 v[52:55], v10 offset:6144
    v_mfma_f32_16x16x32_bf16 v[160:163], v[108:111], v[96:99], v[160:163]
    ds_read_b64_tr_b16 v[60:61], v15 offset:0
    v_mfma_f32_16x16x32_bf16 v[164:167], v[108:111], v[100:103], v[164:167]
    ds_read_b64_tr_b16 v[62:63], v15 offset:512
    v_mfma_f32_16x16x32_bf16 v[168:171], v[112:115], v[88:91], v[168:171]
    ds_read_b64_tr_b16 v[64:65], v14 offset:8192
    buffer_load_dwordx4 v250, s[28:31], s62 offen offset:2048  lds
    v_mfma_f32_16x16x32_bf16 v[172:175], v[112:115], v[92:95], v[172:175]
    ds_read_b64_tr_b16 v[66:67], v14 offset:8704
    v_mfma_f32_16x16x32_bf16 v[176:179], v[112:115], v[96:99], v[176:179]
    ds_read_b64_tr_b16 v[68:69], v15 offset:8192
    s_add_u32 s62, s62, s53
    v_mfma_f32_16x16x32_bf16 v[180:183], v[112:115], v[100:103], v[180:183]
    ds_read_b64_tr_b16 v[70:71], v15 offset:8704
    buffer_load_dwordx4 v251, s[28:31], s62 offen offset:3072  lds
    v_mfma_f32_16x16x32_bf16 v[184:187], v[116:119], v[88:91], v[184:187]
    s_mov_b64 exec, 1
    buffer_store_dwordx2 v[36:37], v34, s[20:23], s74 offen offset:0 sc1
    s_mov_b64 exec, -1
    v_mfma_f32_16x16x32_bf16 v[188:191], v[116:119], v[92:95], v[188:191]
    v_mfma_f32_16x16x32_bf16 v[192:195], v[116:119], v[96:99], v[192:195]
    v_mfma_f32_16x16x32_bf16 v[196:199], v[116:119], v[100:103], v[196:199]
    s_cmp_eq_u32 s93, 0
    s_cbranch_scc1 L_ng17
    v_mfma_f32_16x16x32_bf16 v[232:235], a[68:71], v[88:91], v[232:235]
    v_mfma_f32_16x16x32_bf16 v[236:239], a[68:71], v[92:95], v[236:239]
    v_mfma_f32_16x16x32_bf16 v[240:243], a[68:71], v[96:99], v[240:243]
    v_mfma_f32_16x16x32_bf16 v[244:247], a[68:71], v[100:103], v[244:247]
L_ng17:
    s_waitcnt lgkmcnt(0)
    v_mfma_f32_16x16x32_bf16 v[136:139], v[56:59], v[40:43], v[136:139]
    ds_read_b128 v[88:91], v11 offset:0
    s_add_u32 m0, s63, 132096
    v_mfma_f32_16x16x32_bf16 v[140:143], v[56:59], v[44:47], v[140:143]
    ds_read_b64_tr_b16 v[104:105], v14 offset:4096
    s_cmp_eq_u32 s92, 1
    s_cbranch_scc1 L_s524
    buffer_load_dwordx4 v253, s[28:31], s62 offen offset:0  lds
L_s524:
    v_mfma_f32_16x16x32_bf16 v[144:147], v[56:59], v[48:51], v[144:147]
    ds_read_b64_tr_b16 v[106:107], v14 offset:4608
    v_mfma_f32_16x16x32_bf16 v[148:151], v[56:59], v[52:55], v[148:151]
    ds_read_b128 v[92:95], v11 offset:2048
    s_mul_i32 s96, s92, 81920
    s_add_u32 s91, s91, s96
    s_cmp_ge_u32 s91, s55
    s_cselect_b32 s96, 491520, 0
    s_sub_u32 s91, s91, s96
    s_mov_b32 s62, s91
    s_add_u32 m0, s63, 40960
    v_mfma_f32_16x16x32_bf16 v[152:155], v[60:63], v[40:43], v[152:155]
    ds_read_b128 v[96:99], v11 offset:4096
    buffer_load_dwordx4 v248, s[36:39], s62 offen offset:0  lds
    v_mfma_f32_16x16x32_bf16 v[156:159], v[60:63], v[44:47], v[156:159]
    ds_read_b128 v[100:103], v11 offset:6144
    v_mfma_f32_16x16x32_bf16 v[160:163], v[60:63], v[48:51], v[160:163]
    ds_read_b64_tr_b16 v[108:109], v15 offset:4096
    v_mfma_f32_16x16x32_bf16 v[164:167], v[60:63], v[52:55], v[164:167]
    ds_read_b64_tr_b16 v[110:111], v15 offset:4608
    v_mfma_f32_16x16x32_bf16 v[168:171], v[64:67], v[40:43], v[168:171]
    ds_read_b64_tr_b16 v[112:113], v14 offset:12288
    buffer_load_dwordx4 v249, s[36:39], s62 offen offset:1024  lds
    v_mfma_f32_16x16x32_bf16 v[172:175], v[64:67], v[44:47], v[172:175]
    ds_read_b64_tr_b16 v[114:115], v14 offset:12800
    v_mfma_f32_16x16x32_bf16 v[176:179], v[64:67], v[48:51], v[176:179]
    ds_read_b64_tr_b16 v[116:117], v15 offset:12288
    v_mfma_f32_16x16x32_bf16 v[180:183], v[64:67], v[52:55], v[180:183]
    ds_read_b64_tr_b16 v[118:119], v15 offset:12800
    buffer_load_dwordx4 v250, s[36:39], s62 offen offset:2048  lds
    v_mfma_f32_16x16x32_bf16 v[184:187], v[68:71], v[40:43], v[184:187]
    v_mfma_f32_16x16x32_bf16 v[188:191], v[68:71], v[44:47], v[188:191]
    v_mfma_f32_16x16x32_bf16 v[192:195], v[68:71], v[48:51], v[192:195]
    v_mfma_f32_16x16x32_bf16 v[196:199], v[68:71], v[52:55], v[196:199]
    s_cmp_eq_u32 s93, 0
    s_cbranch_scc1 L_ng18
    v_mfma_f32_16x16x32_bf16 v[232:235], a[72:75], v[40:43], v[232:235]
    v_mfma_f32_16x16x32_bf16 v[236:239], a[72:75], v[44:47], v[236:239]
    v_mfma_f32_16x16x32_bf16 v[240:243], a[72:75], v[48:51], v[240:243]
    v_mfma_f32_16x16x32_bf16 v[244:247], a[72:75], v[52:55], v[244:247]
L_ng18:
    s_waitcnt lgkmcnt(0)
    s_barrier
    v_mfma_f32_16x16x32_bf16 v[136:139], v[104:107], v[88:91], v[136:139]
    v_and_b32 v254, 15, v0
    v_lshrrev_b32 v255, 4, v0
    v_mfma_f32_16x16x32_bf16 v[140:143], v[104:107], v[92:95], v[140:143]
    buffer_load_dwordx4 v251, s[36:39], s62 offen offset:3072  lds
    s_mul_i32 s85, s3, 5376
    s_add_u32 s85, s85, 33792
    v_mfma_f32_16x16x32_bf16 v[144:147], v[104:107], v[96:99], v[144:147]
    v_mul_u32_u24 v2, 336, v254
    v_lshl_add_u32 v2, v255, 4, v2
    v_mfma_f32_16x16x32_bf16 v[148:151], v[104:107], v[100:103], v[148:151]
    v_add_u32 v2, s85, v2
    v_mul_u32_u24 v8, 205, v0
    s_add_u32 m0, s63, 45056
    v_mfma_f32_16x16x32_bf16 v[152:155], v[108:111], v[88:91], v[152:155]
    s_cmp_eq_u32 s92, 1
    s_cbranch_scc1 L_s525
    buffer_load_dwordx4 v253, s[36:39], s62 offen offset:0  lds
L_s525:
    v_lshrrev_b32 v8, 12, v8
    v_mul_u32_u24 v9, 20, v8
    v_mfma_f32_16x16x32_bf16 v[156:159], v[108:111], v[92:95], v[156:159]
    v_sub_u32 v9, v0, v9
    s_mul_i32 s85, s3, 1344
    v_mfma_f32_16x16x32_bf16 v[160:163], v[108:111], v[96:99], v[160:163]
    s_add_u32 s85, s85, 33792
    v_mul_u32_u24 v3, 336, v8
    v_mfma_f32_16x16x32_bf16 v[164:167], v[108:111], v[100:103], v[164:167]
    v_lshl_add_u32 v3, v9, 4, v3
    v_add_u32 v3, s85, v3
    s_add_u32 s62, s62, s64
    s_add_u32 m0, s63, 46080
    v_mfma_f32_16x16x32_bf16 v[168:171], v[112:115], v[88:91], v[168:171]
    buffer_load_dwordx4 v248, s[36:39], s62 offen offset:0  lds
    s_add_u32 s85, s85, 1072
    v_lshl_add_u32 v4, v254, 4, s85
    v_mfma_f32_16x16x32_bf16 v[172:175], v[112:115], v[92:95], v[172:175]
    v_xor_b32 v5, 2, v255
    v_and_b32 v6, 2, v5
    v_mfma_f32_16x16x32_bf16 v[176:179], v[112:115], v[96:99], v[176:179]
    v_add_u32 v5, v5, v6
    s_movk_i32 s85, 21504
    v_mfma_f32_16x16x32_bf16 v[180:183], v[112:115], v[100:103], v[180:183]
    buffer_load_dwordx4 v249, s[36:39], s62 offen offset:1024  lds
    v_mad_u32_u24 v5, v5, s85, v4
    v_mad_u32_u24 v4, v255, s85, v4
    v_mfma_f32_16x16x32_bf16 v[184:187], v[116:119], v[88:91], v[184:187]
    s_lshl_b32 s85, s51, 2
    v_lshrrev_b32 v6, 4, v9
    v_mfma_f32_16x16x32_bf16 v[188:191], v[116:119], v[92:95], v[188:191]
    v_mul_u32_u24 v6, s85, v6
    v_lshl_add_u32 v6, v9, 4, v6
    v_mfma_f32_16x16x32_bf16 v[192:195], v[116:119], v[96:99], v[192:195]
    s_movk_i32 s86, 2560
    v_mad_u32_u24 v6, v8, s86, v6
    v_mfma_f32_16x16x32_bf16 v[196:199], v[116:119], v[100:103], v[196:199]
    v_add_u32 v7, 4, v254
    v_lshrrev_b32 v7, 4, v7
    v_mul_u32_u24 v7, s85, v7
    v_lshl_add_u32 v7, v254, 4, v7
    s_movk_i32 s86, 10240
    v_mad_u32_u24 v7, v255, s86, v7
    v_add_u32 v7, 7744, v7
    v_lshl_add_u32 v9, v8, 8, v9
    s_mul_i32 s86, s92, 14
    s_add_u32 s86, s86, 9
    v_min_u32 v8, s86, v0
    v_lshlrev_b32 v8, 7, v8
    s_lshl_b32 s86, s89, 1
    s_add_u32 s86, s86, s92
    s_lshl_b32 s86, s86, 7
    s_add_u32 s86, s86, 24510464
    s_sub_u32 s86, s86, s32
    v_writelane_b32 v8, s86, 63
    s_cmp_eq_u32 s93, 0
    s_cbranch_scc1 L_ng19
    v_mfma_f32_16x16x32_bf16 v[232:235], a[76:79], v[88:91], v[232:235]
    v_mfma_f32_16x16x32_bf16 v[236:239], a[76:79], v[92:95], v[236:239]
    v_mfma_f32_16x16x32_bf16 v[240:243], a[76:79], v[96:99], v[240:243]
    v_mfma_f32_16x16x32_bf16 v[244:247], a[76:79], v[100:103], v[244:247]
L_ng19:
    s_cmp_eq_u32 s93, 0
    s_cbranch_scc1 L_nogate
    v_lshrrev_b32 v41, 4, v0
    s_nop 1
    v_mov_b32 v40, v232
    v_cmp_eq_u32 vcc, 1, v41
    s_nop 1
    v_cndmask_b32 v40, v40, v236, vcc
    v_cmp_eq_u32 vcc, 2, v41
    s_nop 1
    v_cndmask_b32 v40, v40, v240, vcc
    v_cmp_eq_u32 vcc, 3, v41
    s_nop 1
    v_cndmask_b32 v40, v40, v244, vcc
    v_cvt_pk_bf16_f32 v40, v40, v40
    v_lshlrev_b32 v40, 16, v40
    v_mul_f32 v40, 0xbfb8aa3b, v40
    v_exp_f32 v40, v40
    s_nop 0
    v_add_f32 v40, 1.0, v40
    v_rcp_f32 v40, v40
    s_nop 0
    v_cvt_pk_bf16_f32 v40, v40, v40
    v_lshlrev_b32 v40, 16, v40
    v_sub_f32 v42, 1.0, v40
    v_cvt_pk_bf16_f32 v40, v40, v42
    v_and_b32 v42, 15, v0
    v_lshlrev_b32 v42, 4, v42
    v_lshl_add_u32 v42, v41, 2, v42
    s_lshl_b32 s70, s76, 9
    s_lshl_b32 s96, s77, 8
    s_add_u32 s70, s70, s96
    s_add_u32 s70, s70, 17301504
    buffer_store_dword v40, v42, s[20:23], s70 offen sc1
L_nogate:
    s_cmp_eq_u32 s92, 1
    s_cbranch_scc1 L_zq
    s_mov_b32 s84, 0xbfb8aa3b
    s_mov_b32 s85, 0xbfb8aa3b
    v_pk_mul_f32 v[44:45], v[136:137], s[84:85]
    v_pk_mul_f32 v[46:47], v[138:139], s[84:85]
    s_add_u32 s71, s0, 0
    v_pk_mul_f32 v[48:49], v[152:153], s[84:85]
    v_pk_mul_f32 v[50:51], v[154:155], s[84:85]
    v_exp_f32 v44, v44
    v_exp_f32 v45, v45
    v_exp_f32 v46, v46
    v_exp_f32 v47, v47
    v_exp_f32 v48, v48
    v_exp_f32 v49, v49
    v_exp_f32 v50, v50
    v_exp_f32 v51, v51
    v_pk_add_f32 v[44:45], v[44:45], 1.0 op_sel_hi:[1,0]
    v_pk_add_f32 v[46:47], v[46:47], 1.0 op_sel_hi:[1,0]
    v_pk_add_f32 v[48:49], v[48:49], 1.0 op_sel_hi:[1,0]
    v_pk_add_f32 v[50:51], v[50:51], 1.0 op_sel_hi:[1,0]
    v_rcp_f32 v44, v44
    v_rcp_f32 v45, v45
    v_rcp_f32 v46, v46
    v_rcp_f32 v47, v47
    v_rcp_f32 v48, v48
    v_rcp_f32 v49, v49
    v_rcp_f32 v50, v50
    v_rcp_f32 v51, v51
    v_pk_mul_f32 v[44:45], v[44:45], v[136:137]
    v_pk_mul_f32 v[46:47], v[46:47], v[138:139]
    v_pk_mul_f32 v[48:49], v[48:49], v[152:153]
    v_pk_mul_f32 v[50:51], v[50:51], v[154:155]
    v_cvt_pk_bf16_f32 v52, v44, v45
    v_cvt_pk_bf16_f32 v53, v46, v47
    v_cvt_pk_bf16_f32 v54, v48, v49
    v_cvt_pk_bf16_f32 v55, v50, v51
    buffer_store_dwordx4 v[52:55], v1, s[20:23], s71 offen sc1
    v_pk_mul_f32 v[56:57], v[140:141], s[84:85]
    v_pk_mul_f32 v[58:59], v[142:143], s[84:85]
    s_add_u32 s71, s0, 49152
    v_pk_mul_f32 v[60:61], v[156:157], s[84:85]
    v_pk_mul_f32 v[62:63], v[158:159], s[84:85]
    v_exp_f32 v56, v56
    v_exp_f32 v57, v57
    v_exp_f32 v58, v58
    v_exp_f32 v59, v59
    v_exp_f32 v60, v60
    v_exp_f32 v61, v61
    v_exp_f32 v62, v62
    v_exp_f32 v63, v63
    v_pk_add_f32 v[56:57], v[56:57], 1.0 op_sel_hi:[1,0]
    v_pk_add_f32 v[58:59], v[58:59], 1.0 op_sel_hi:[1,0]
    v_pk_add_f32 v[60:61], v[60:61], 1.0 op_sel_hi:[1,0]
    v_pk_add_f32 v[62:63], v[62:63], 1.0 op_sel_hi:[1,0]
    v_rcp_f32 v56, v56
    v_rcp_f32 v57, v57
    v_rcp_f32 v58, v58
    v_rcp_f32 v59, v59
    v_rcp_f32 v60, v60
    v_rcp_f32 v61, v61
    v_rcp_f32 v62, v62
    v_rcp_f32 v63, v63
    v_pk_mul_f32 v[56:57], v[56:57], v[140:141]
    v_pk_mul_f32 v[58:59], v[58:59], v[142:143]
    v_pk_mul_f32 v[60:61], v[60:61], v[156:157]
    v_pk_mul_f32 v[62:63], v[62:63], v[158:159]
    v_cvt_pk_bf16_f32 v64, v56, v57
    v_cvt_pk_bf16_f32 v65, v58, v59
    v_cvt_pk_bf16_f32 v66, v60, v61
    v_cvt_pk_bf16_f32 v67, v62, v63
    buffer_store_dwordx4 v[64:67], v1, s[20:23], s71 offen sc1
    v_pk_mul_f32 v[44:45], v[144:145], s[84:85]
    v_pk_mul_f32 v[46:47], v[146:147], s[84:85]
    s_add_u32 s71, s0, 98304
    v_pk_mul_f32 v[48:49], v[160:161], s[84:85]
    v_pk_mul_f32 v[50:51], v[162:163], s[84:85]
    v_exp_f32 v44, v44
    v_exp_f32 v45, v45
    v_exp_f32 v46, v46
    v_exp_f32 v47, v47
    v_exp_f32 v48, v48
    v_exp_f32 v49, v49
    v_exp_f32 v50, v50
    v_exp_f32 v51, v51
    v_pk_add_f32 v[44:45], v[44:45], 1.0 op_sel_hi:[1,0]
    v_pk_add_f32 v[46:47], v[46:47], 1.0 op_sel_hi:[1,0]
    v_pk_add_f32 v[48:49], v[48:49], 1.0 op_sel_hi:[1,0]
    v_pk_add_f32 v[50:51], v[50:51], 1.0 op_sel_hi:[1,0]
    v_rcp_f32 v44, v44
    v_rcp_f32 v45, v45
    v_rcp_f32 v46, v46
    v_rcp_f32 v47, v47
    v_rcp_f32 v48, v48
    v_rcp_f32 v49, v49
    v_rcp_f32 v50, v50
    v_rcp_f32 v51, v51
    v_pk_mul_f32 v[44:45], v[44:45], v[144:145]
    v_pk_mul_f32 v[46:47], v[46:47], v[146:147]
    v_pk_mul_f32 v[48:49], v[48:49], v[160:161]
    v_pk_mul_f32 v[50:51], v[50:51], v[162:163]
    v_cvt_pk_bf16_f32 v52, v44, v45
    v_cvt_pk_bf16_f32 v53, v46, v47
    v_cvt_pk_bf16_f32 v54, v48, v49
    v_cvt_pk_bf16_f32 v55, v50, v51
    buffer_store_dwordx4 v[52:55], v1, s[20:23], s71 offen sc1
    v_pk_mul_f32 v[56:57], v[148:149], s[84:85]
    v_pk_mul_f32 v[58:59], v[150:151], s[84:85]
    s_add_u32 s71, s0, 147456
    v_pk_mul_f32 v[60:61], v[164:165], s[84:85]
    v_pk_mul_f32 v[62:63], v[166:167], s[84:85]
    v_exp_f32 v56, v56
    v_exp_f32 v57, v57
    v_exp_f32 v58, v58
    v_exp_f32 v59, v59
    v_exp_f32 v60, v60
    v_exp_f32 v61, v61
    v_exp_f32 v62, v62
    v_exp_f32 v63, v63
    v_pk_add_f32 v[56:57], v[56:57], 1.0 op_sel_hi:[1,0]
    v_pk_add_f32 v[58:59], v[58:59], 1.0 op_sel_hi:[1,0]
    v_pk_add_f32 v[60:61], v[60:61], 1.0 op_sel_hi:[1,0]
    v_pk_add_f32 v[62:63], v[62:63], 1.0 op_sel_hi:[1,0]
    v_rcp_f32 v56, v56
    v_rcp_f32 v57, v57
    v_rcp_f32 v58, v58
    v_rcp_f32 v59, v59
    v_rcp_f32 v60, v60
    v_rcp_f32 v61, v61
    v_rcp_f32 v62, v62
    v_rcp_f32 v63, v63
    v_pk_mul_f32 v[56:57], v[56:57], v[148:149]
    v_pk_mul_f32 v[58:59], v[58:59], v[150:151]
    v_pk_mul_f32 v[60:61], v[60:61], v[164:165]
    v_pk_mul_f32 v[62:63], v[62:63], v[166:167]
    v_cvt_pk_bf16_f32 v64, v56, v57
    v_cvt_pk_bf16_f32 v65, v58, v59
    v_cvt_pk_bf16_f32 v66, v60, v61
    v_cvt_pk_bf16_f32 v67, v62, v63
    buffer_store_dwordx4 v[64:67], v1, s[20:23], s71 offen sc1
    v_pk_mul_f32 v[44:45], v[168:169], s[84:85]
    v_pk_mul_f32 v[46:47], v[170:171], s[84:85]
    s_add_u32 s71, s0, 2048
    v_pk_mul_f32 v[48:49], v[184:185], s[84:85]
    v_pk_mul_f32 v[50:51], v[186:187], s[84:85]
    v_exp_f32 v44, v44
    v_exp_f32 v45, v45
    v_exp_f32 v46, v46
    v_exp_f32 v47, v47
    v_exp_f32 v48, v48
    v_exp_f32 v49, v49
    v_exp_f32 v50, v50
    v_exp_f32 v51, v51
    v_pk_add_f32 v[44:45], v[44:45], 1.0 op_sel_hi:[1,0]
    v_pk_add_f32 v[46:47], v[46:47], 1.0 op_sel_hi:[1,0]
    v_pk_add_f32 v[48:49], v[48:49], 1.0 op_sel_hi:[1,0]
    v_pk_add_f32 v[50:51], v[50:51], 1.0 op_sel_hi:[1,0]
    v_rcp_f32 v44, v44
    v_rcp_f32 v45, v45
    v_rcp_f32 v46, v46
    v_rcp_f32 v47, v47
    v_rcp_f32 v48, v48
    v_rcp_f32 v49, v49
    v_rcp_f32 v50, v50
    v_rcp_f32 v51, v51
    v_pk_mul_f32 v[44:45], v[44:45], v[168:169]
    v_pk_mul_f32 v[46:47], v[46:47], v[170:171]
    v_pk_mul_f32 v[48:49], v[48:49], v[184:185]
    v_pk_mul_f32 v[50:51], v[50:51], v[186:187]
    v_cvt_pk_bf16_f32 v52, v44, v45
    v_cvt_pk_bf16_f32 v53, v46, v47
    v_cvt_pk_bf16_f32 v54, v48, v49
    v_cvt_pk_bf16_f32 v55, v50, v51
    buffer_store_dwordx4 v[52:55], v1, s[20:23], s71 offen sc1
    v_pk_mul_f32 v[56:57], v[172:173], s[84:85]
    v_pk_mul_f32 v[58:59], v[174:175], s[84:85]
    s_add_u32 s71, s0, 51200
    v_pk_mul_f32 v[60:61], v[188:189], s[84:85]
    v_pk_mul_f32 v[62:63], v[190:191], s[84:85]
    v_exp_f32 v56, v56
    v_exp_f32 v57, v57
    v_exp_f32 v58, v58
    v_exp_f32 v59, v59
    v_exp_f32 v60, v60
    v_exp_f32 v61, v61
    v_exp_f32 v62, v62
    v_exp_f32 v63, v63
    v_pk_add_f32 v[56:57], v[56:57], 1.0 op_sel_hi:[1,0]
    v_pk_add_f32 v[58:59], v[58:59], 1.0 op_sel_hi:[1,0]
    v_pk_add_f32 v[60:61], v[60:61], 1.0 op_sel_hi:[1,0]
    v_pk_add_f32 v[62:63], v[62:63], 1.0 op_sel_hi:[1,0]
    v_rcp_f32 v56, v56
    v_rcp_f32 v57, v57
    v_rcp_f32 v58, v58
    v_rcp_f32 v59, v59
    v_rcp_f32 v60, v60
    v_rcp_f32 v61, v61
    v_rcp_f32 v62, v62
    v_rcp_f32 v63, v63
    v_pk_mul_f32 v[56:57], v[56:57], v[172:173]
    v_pk_mul_f32 v[58:59], v[58:59], v[174:175]
    v_pk_mul_f32 v[60:61], v[60:61], v[188:189]
    v_pk_mul_f32 v[62:63], v[62:63], v[190:191]
    v_cvt_pk_bf16_f32 v64, v56, v57
    v_cvt_pk_bf16_f32 v65, v58, v59
    v_cvt_pk_bf16_f32 v66, v60, v61
    v_cvt_pk_bf16_f32 v67, v62, v63
    buffer_store_dwordx4 v[64:67], v1, s[20:23], s71 offen sc1
    v_pk_mul_f32 v[44:45], v[176:177], s[84:85]
    v_pk_mul_f32 v[46:47], v[178:179], s[84:85]
    s_add_u32 s71, s0, 100352
    v_pk_mul_f32 v[48:49], v[192:193], s[84:85]
    v_pk_mul_f32 v[50:51], v[194:195], s[84:85]
    v_exp_f32 v44, v44
    v_exp_f32 v45, v45
    v_exp_f32 v46, v46
    v_exp_f32 v47, v47
    v_exp_f32 v48, v48
    v_exp_f32 v49, v49
    v_exp_f32 v50, v50
    v_exp_f32 v51, v51
    v_pk_add_f32 v[44:45], v[44:45], 1.0 op_sel_hi:[1,0]
    v_pk_add_f32 v[46:47], v[46:47], 1.0 op_sel_hi:[1,0]
    v_pk_add_f32 v[48:49], v[48:49], 1.0 op_sel_hi:[1,0]
    v_pk_add_f32 v[50:51], v[50:51], 1.0 op_sel_hi:[1,0]
    v_rcp_f32 v44, v44
    v_rcp_f32 v45, v45
    v_rcp_f32 v46, v46
    v_rcp_f32 v47, v47
    v_rcp_f32 v48, v48
    v_rcp_f32 v49, v49
    v_rcp_f32 v50, v50
    v_rcp_f32 v51, v51
    v_pk_mul_f32 v[44:45], v[44:45], v[176:177]
    v_pk_mul_f32 v[46:47], v[46:47], v[178:179]
    v_pk_mul_f32 v[48:49], v[48:49], v[192:193]
    v_pk_mul_f32 v[50:51], v[50:51], v[194:195]
    v_cvt_pk_bf16_f32 v52, v44, v45
    v_cvt_pk_bf16_f32 v53, v46, v47
    v_cvt_pk_bf16_f32 v54, v48, v49
    v_cvt_pk_bf16_f32 v55, v50, v51
    buffer_store_dwordx4 v[52:55], v1, s[20:23], s71 offen sc1
    v_pk_mul_f32 v[56:57], v[180:181], s[84:85]
    v_pk_mul_f32 v[58:59], v[182:183], s[84:85]
    s_add_u32 s71, s0, 149504
    v_pk_mul_f32 v[60:61], v[196:197], s[84:85]
    v_pk_mul_f32 v[62:63], v[198:199], s[84:85]
    v_exp_f32 v56, v56
    v_exp_f32 v57, v57
    v_exp_f32 v58, v58
    v_exp_f32 v59, v59
    v_exp_f32 v60, v60
    v_exp_f32 v61, v61
    v_exp_f32 v62, v62
    v_exp_f32 v63, v63
    v_pk_add_f32 v[56:57], v[56:57], 1.0 op_sel_hi:[1,0]
    v_pk_add_f32 v[58:59], v[58:59], 1.0 op_sel_hi:[1,0]
    v_pk_add_f32 v[60:61], v[60:61], 1.0 op_sel_hi:[1,0]
    v_pk_add_f32 v[62:63], v[62:63], 1.0 op_sel_hi:[1,0]
    v_rcp_f32 v56, v56
    v_rcp_f32 v57, v57
    v_rcp_f32 v58, v58
    v_rcp_f32 v59, v59
    v_rcp_f32 v60, v60
    v_rcp_f32 v61, v61
    v_rcp_f32 v62, v62
    v_rcp_f32 v63, v63
    v_pk_mul_f32 v[56:57], v[56:57], v[180:181]
    v_pk_mul_f32 v[58:59], v[58:59], v[182:183]
    v_pk_mul_f32 v[60:61], v[60:61], v[196:197]
    v_pk_mul_f32 v[62:63], v[62:63], v[198:199]
    v_cvt_pk_bf16_f32 v64, v56, v57
    v_cvt_pk_bf16_f32 v65, v58, v59
    v_cvt_pk_bf16_f32 v66, v60, v61
    v_cvt_pk_bf16_f32 v67, v62, v63
    buffer_store_dwordx4 v[64:67], v1, s[20:23], s71 offen sc1
    s_waitcnt vmcnt(4)
    s_mov_b64 exec, 1
    buffer_store_dwordx2 v[36:37], v34, s[20:23], s1 offen offset:0 sc1
    s_mov_b64 exec, -1
    buffer_load_dwordx4 v250, s[36:39], s62 offen offset:2048  lds
    s_add_u32 s62, s62, s53
    buffer_load_dwordx4 v251, s[36:39], s62 offen offset:3072  lds
    s_add_u32 m0, s63, 50176
    s_nop 0
    s_cmp_eq_u32 s92, 1
    s_cbranch_scc1 L_s526
    buffer_load_dwordx4 v253, s[36:39], s62 offen offset:0  lds
L_s526:
    s_add_u32 s91, s91, s65
    s_cmp_ge_u32 s91, s55
    s_cselect_b32 s96, 491520, 0
    s_sub_u32 s91, s91, s96
    s_mov_b32 s62, s91
    s_add_u32 m0, s63, 81920
    s_nop 0
    buffer_load_dwordx4 v248, s[28:31], s62 offen offset:0  lds
    buffer_load_dwordx4 v249, s[28:31], s62 offen offset:1024  lds
    buffer_load_dwordx4 v250, s[28:31], s62 offen offset:2048  lds
    buffer_load_dwordx4 v251, s[28:31], s62 offen offset:3072  lds
    s_add_u32 m0, s63, 86016
    s_nop 0
    buffer_load_dwordx4 v253, s[28:31], s62 offen offset:0  lds
    s_add_u32 s62, s62, s64
    s_add_u32 m0, s63, 87040
    s_nop 0
    buffer_load_dwordx4 v248, s[28:31], s62 offen offset:0  lds
    buffer_load_dwordx4 v249, s[28:31], s62 offen offset:1024  lds
    buffer_load_dwordx4 v250, s[28:31], s62 offen offset:2048  lds
    s_add_u32 s62, s62, s53
    buffer_load_dwordx4 v251, s[28:31], s62 offen offset:3072  lds
    s_add_u32 m0, s63, 91136
    s_nop 0
    buffer_load_dwordx4 v253, s[28:31], s62 offen offset:0  lds
    s_mov_b32 s58, 0xffff
    s_add_u32 s83, s67, 12288
    s_lshl_b32 s87, s77, 11
    s_add_u32 s87, s87, s33
    s_lshl_b32 s86, s52, 12
    s_add_u32 s8, s87, s86
    s_add_u32 s9, s8, 2048
    s_xor_b32 s86, s86, 4096
    s_add_u32 s10, s87, s86
    s_add_u32 s11, s10, 2048
    s_add_u32 s12, s33, 8192
    s_cmp_eq_u32 s77, 1
    s_cselect_b32 s12, s33, s12
    s_waitcnt vmcnt(13)
    s_mov_b64 exec, 1
    buffer_store_dwordx2 v[36:37], v34, s[20:23], s1 offen offset:512 sc1
    s_mov_b64 exec, -1
    s_cmp_eq_u32 s93, 0
    s_cbranch_scc1 L_ngf27
    s_lshl_b32 s70, s76, 8
    s_lshl_b32 s96, s77, 7
    s_add_u32 s70, s70, s96
    s_add_u32 s70, s70, 24510464
    s_mov_b64 exec, 1
    buffer_store_dwordx2 v[36:37], v34, s[20:23], s70 offen offset:0 sc1
    s_mov_b64 exec, -1
L_ngf27:
    v_add_u32 v254, 122880, v38
    v_xor_b32 v255, 64, v254
    ds_read_b64 a[0:1], v254 offset:0
    ds_read_b64 a[4:5], v254 offset:2048
    ds_read_b64 a[52:53], v254 offset:6144
    ds_read_b64 a[56:57], v254 offset:8192
    ds_read_b64 a[40:41], v255 offset:0
    ds_read_b64 a[44:45], v255 offset:2048
    ds_read_b64 a[12:13], v255 offset:6144
    ds_read_b64 a[16:17], v255 offset:8192
    v_xor_b32 v254, 32, v254
    v_xor_b32 v255, 32, v255
    ds_read_b64 a[20:21], v254 offset:0
    ds_read_b64 a[24:25], v254 offset:2048
    ds_read_b64 a[72:73], v254 offset:6144
    ds_read_b64 a[76:77], v254 offset:8192
    ds_read_b64 a[60:61], v255 offset:0
    ds_read_b64 a[64:65], v255 offset:2048
    ds_read_b64 a[32:33], v255 offset:6144
    ds_read_b64 a[36:37], v255 offset:8192
    v_lshlrev_b32 v255, 3, v0
    v_and_b32 v255, 64, v255
    v_xor_b32 v254, v254, v255
    v_xor_b32 v255, 32, v254
    ds_read_b64 a[28:29], v254 offset:4096
    ds_read_b64 a[8:9], v255 offset:4096
    v_xor_b32 v254, 64, v254
    v_xor_b32 v255, 64, v255
    ds_read_b64 a[68:69], v254 offset:4096
    ds_read_b64 a[48:49], v255 offset:4096
    s_waitcnt lgkmcnt(0)
    s_mul_i32 s96, s92, 81920
    s_add_u32 s91, s91, s96
    s_cmp_ge_u32 s91, s55
    s_cselect_b32 s96, 491520, 0
    s_sub_u32 s91, s91, s96
    s_mov_b32 s62, s91
    s_add_u32 m0, s63, 122880
    s_nop 0
    buffer_load_dwordx4 v248, s[36:39], s62 offen offset:0  lds
    buffer_load_dwordx4 v249, s[36:39], s62 offen offset:1024  lds
    buffer_load_dwordx4 v250, s[36:39], s62 offen offset:2048  lds
    buffer_load_dwordx4 v251, s[36:39], s62 offen offset:3072  lds
    s_add_u32 m0, s63, 126976
    s_nop 0
    buffer_load_dwordx4 v253, s[36:39], s62 offen offset:0  lds
    s_add_u32 s62, s62, s64
    s_add_u32 m0, s63, 128000
    s_nop 0
    buffer_load_dwordx4 v248, s[36:39], s62 offen offset:0  lds
    buffer_load_dwordx4 v249, s[36:39], s62 offen offset:1024  lds
    buffer_load_dwordx4 v250, s[36:39], s62 offen offset:2048  lds
    s_add_u32 s62, s62, s53
    buffer_load_dwordx4 v251, s[36:39], s62 offen offset:3072  lds
    s_add_u32 m0, s63, 132096
    s_nop 0
    buffer_load_dwordx4 v253, s[36:39], s62 offen offset:0  lds
    s_waitcnt vmcnt(21)
    v_add_u32 v254, 40960, v38
    v_xor_b32 v255, 64, v254
    ds_read_b64 a[2:3], v254 offset:0
    ds_read_b64 a[6:7], v254 offset:2048
    ds_read_b64 a[54:55], v254 offset:6144
    ds_read_b64 a[58:59], v254 offset:8192
    ds_read_b64 a[42:43], v255 offset:0
    ds_read_b64 a[46:47], v255 offset:2048
    ds_read_b64 a[14:15], v255 offset:6144
    ds_read_b64 a[18:19], v255 offset:8192
    v_xor_b32 v254, 32, v254
    v_xor_b32 v255, 32, v255
    ds_read_b64 a[22:23], v254 offset:0
    ds_read_b64 a[26:27], v254 offset:2048
    ds_read_b64 a[74:75], v254 offset:6144
    ds_read_b64 a[78:79], v254 offset:8192
    ds_read_b64 a[62:63], v255 offset:0
    ds_read_b64 a[66:67], v255 offset:2048
    ds_read_b64 a[34:35], v255 offset:6144
    ds_read_b64 a[38:39], v255 offset:8192
    v_lshlrev_b32 v255, 3, v0
    v_and_b32 v255, 64, v255
    v_xor_b32 v254, v254, v255
    v_xor_b32 v255, 32, v254
    ds_read_b64 a[30:31], v254 offset:4096
    ds_read_b64 a[10:11], v255 offset:4096
    v_xor_b32 v254, 64, v254
    v_xor_b32 v255, 64, v255
    ds_read_b64 a[70:71], v254 offset:4096
    ds_read_b64 a[50:51], v255 offset:4096
    s_waitcnt lgkmcnt(0)
    s_mov_b32 s91, s54
    v_accvgpr_read_b32 v248, a254
    v_add_u32 v249, 19456, v248
    v_add_u32 v250, 38912, v248
    v_add_u32 v251, 58368, v248
    v_add_u32 v253, 81920, v248
    s_mul_i32 s96, s51, 1280
    v_add_u32 v253, s96, v253
    s_mov_b32 s62, s91
    s_add_u32 m0, s63, 40960
    s_nop 0
    buffer_load_dwordx4 v248, s[28:31], s62 offen offset:0  lds
    buffer_load_dwordx4 v249, s[28:31], s62 offen offset:1024  lds
    buffer_load_dwordx4 v250, s[28:31], s62 offen offset:2048  lds
    buffer_load_dwordx4 v251, s[28:31], s62 offen offset:3072  lds
    s_add_u32 m0, s63, 45056
    s_nop 0
    buffer_load_dwordx4 v253, s[28:31], s62 offen offset:0  lds
    s_mul_i32 s96, s92, 40960
    s_add_u32 s62, s62, s96
    s_add_u32 m0, s63, 46080
    s_nop 0
    buffer_load_dwordx4 v248, s[36:39], s62 offen offset:0  lds
    buffer_load_dwordx4 v249, s[36:39], s62 offen offset:1024  lds
    buffer_load_dwordx4 v250, s[36:39], s62 offen offset:2048  lds
    buffer_load_dwordx4 v251, s[36:39], s62 offen offset:3072  lds
    s_add_u32 m0, s63, 50176
    s_nop 0
    buffer_load_dwordx4 v253, s[36:39], s62 offen offset:0  lds
    buffer_load_dwordx2 v[26:27], v8, s[20:23], s32 offen sc1
    s_waitcnt vmcnt(22)
    v_add_u32 v254, 81920, v38
    v_xor_b32 v255, 64, v254
    ds_read_b64 a[80:81], v254 offset:0
    ds_read_b64 a[84:85], v254 offset:2048
    ds_read_b64 a[132:133], v254 offset:6144
    ds_read_b64 a[136:137], v254 offset:8192
    ds_read_b64 a[120:121], v255 offset:0
    ds_read_b64 a[124:125], v255 offset:2048
    ds_read_b64 a[92:93], v255 offset:6144
    ds_read_b64 a[96:97], v255 offset:8192
    v_xor_b32 v254, 32, v254
    v_xor_b32 v255, 32, v255
    ds_read_b64 a[100:101], v254 offset:0
    ds_read_b64 a[104:105], v254 offset:2048
    ds_read_b64 a[152:153], v254 offset:6144
    ds_read_b64 a[156:157], v254 offset:8192
    ds_read_b64 a[140:141], v255 offset:0
    ds_read_b64 a[144:145], v255 offset:2048
    ds_read_b64 a[112:113], v255 offset:6144
    ds_read_b64 a[116:117], v255 offset:8192
    v_lshlrev_b32 v255, 3, v0
    v_and_b32 v255, 64, v255
    v_xor_b32 v254, v254, v255
    v_xor_b32 v255, 32, v254
    ds_read_b64 a[108:109], v254 offset:4096
    ds_read_b64 a[88:89], v255 offset:4096
    v_xor_b32 v254, 64, v254
    v_xor_b32 v255, 64, v255
    ds_read_b64 a[148:149], v254 offset:4096
    ds_read_b64 a[128:129], v255 offset:4096
    s_waitcnt vmcnt(11)
    v_add_u32 v254, 122880, v38
    v_xor_b32 v255, 64, v254
    ds_read_b64 a[82:83], v254 offset:0
    ds_read_b64 a[86:87], v254 offset:2048
    ds_read_b64 a[134:135], v254 offset:6144
    ds_read_b64 a[138:139], v254 offset:8192
    ds_read_b64 a[122:123], v255 offset:0
    ds_read_b64 a[126:127], v255 offset:2048
    ds_read_b64 a[94:95], v255 offset:6144
    ds_read_b64 a[98:99], v255 offset:8192
    v_xor_b32 v254, 32, v254
    v_xor_b32 v255, 32, v255
    ds_read_b64 a[102:103], v254 offset:0
    ds_read_b64 a[106:107], v254 offset:2048
    ds_read_b64 a[154:155], v254 offset:6144
    ds_read_b64 a[158:159], v254 offset:8192
    ds_read_b64 a[142:143], v255 offset:0
    ds_read_b64 a[146:147], v255 offset:2048
    ds_read_b64 a[114:115], v255 offset:6144
    ds_read_b64 a[118:119], v255 offset:8192
    v_lshlrev_b32 v255, 3, v0
    v_and_b32 v255, 64, v255
    v_xor_b32 v254, v254, v255
    v_xor_b32 v255, 32, v254
    ds_read_b64 a[110:111], v254 offset:4096
    ds_read_b64 a[90:91], v255 offset:4096
    v_xor_b32 v254, 64, v254
    v_xor_b32 v255, 64, v255
    ds_read_b64 a[150:151], v254 offset:4096
    ds_read_b64 a[130:131], v255 offset:4096
    s_waitcnt vmcnt(1)
    v_add_u32 v254, 40960, v39
    v_xor_b32 v255, 32, v254
    ds_read_b64 a[160:161], v254 offset:0
    ds_read_b64 a[162:163], v254 offset:5120
    ds_read_b64 a[164:165], v254 offset:1024
    ds_read_b64 a[166:167], v254 offset:6144
    ds_read_b64 a[168:169], v254 offset:2048
    ds_read_b64 a[170:171], v254 offset:7168
    ds_read_b64 a[172:173], v254 offset:3072
    ds_read_b64 a[174:175], v254 offset:8192
    ds_read_b64 a[176:177], v254 offset:4096
    ds_read_b64 a[178:179], v254 offset:9216
    ds_read_b64 a[180:181], v255 offset:0
    ds_read_b64 a[182:183], v255 offset:5120
    ds_read_b64 a[184:185], v255 offset:1024
    ds_read_b64 a[186:187], v255 offset:6144
    ds_read_b64 a[188:189], v255 offset:2048
    ds_read_b64 a[190:191], v255 offset:7168
    ds_read_b64 a[192:193], v255 offset:3072
    ds_read_b64 a[194:195], v255 offset:8192
    ds_read_b64 a[196:197], v255 offset:4096
    ds_read_b64 a[198:199], v255 offset:9216
    s_nop 0
    s_waitcnt vmcnt(0)
    s_branch L_roleP
L_zq:
    s_mov_b32 s84, 0xbfb8aa3b
    s_mov_b32 s85, 0xbfb8aa3b
    v_pk_mul_f32 v[44:45], v[136:137], s[84:85]
    v_pk_mul_f32 v[46:47], v[138:139], s[84:85]
    s_add_u32 s71, s0, 0
    v_pk_mul_f32 v[48:49], v[152:153], s[84:85]
    v_pk_mul_f32 v[50:51], v[154:155], s[84:85]
    v_exp_f32 v44, v44
    v_exp_f32 v45, v45
    v_exp_f32 v46, v46
    v_exp_f32 v47, v47
    v_exp_f32 v48, v48
    v_exp_f32 v49, v49
    v_exp_f32 v50, v50
    v_exp_f32 v51, v51
    v_pk_add_f32 v[44:45], v[44:45], 1.0 op_sel_hi:[1,0]
    v_pk_add_f32 v[46:47], v[46:47], 1.0 op_sel_hi:[1,0]
    v_pk_add_f32 v[48:49], v[48:49], 1.0 op_sel_hi:[1,0]
    v_pk_add_f32 v[50:51], v[50:51], 1.0 op_sel_hi:[1,0]
    v_rcp_f32 v44, v44
    v_rcp_f32 v45, v45
    v_rcp_f32 v46, v46
    v_rcp_f32 v47, v47
    v_rcp_f32 v48, v48
    v_rcp_f32 v49, v49
    v_rcp_f32 v50, v50
    v_rcp_f32 v51, v51
    v_pk_mul_f32 v[44:45], v[44:45], v[136:137]
    v_pk_mul_f32 v[46:47], v[46:47], v[138:139]
    v_pk_mul_f32 v[48:49], v[48:49], v[152:153]
    v_pk_mul_f32 v[50:51], v[50:51], v[154:155]
    v_cvt_pk_bf16_f32 v52, v44, v45
    v_cvt_pk_bf16_f32 v53, v46, v47
    v_cvt_pk_bf16_f32 v54, v48, v49
    v_cvt_pk_bf16_f32 v55, v50, v51
    buffer_store_dwordx4 v[52:55], v1, s[20:23], s71 offen sc1
    v_pk_mul_f32 v[56:57], v[140:141], s[84:85]
    v_pk_mul_f32 v[58:59], v[142:143], s[84:85]
    s_add_u32 s71, s0, 49152
    v_pk_mul_f32 v[60:61], v[156:157], s[84:85]
    v_pk_mul_f32 v[62:63], v[158:159], s[84:85]
    v_exp_f32 v56, v56
    v_exp_f32 v57, v57
    v_exp_f32 v58, v58
    v_exp_f32 v59, v59
    v_exp_f32 v60, v60
    v_exp_f32 v61, v61
    v_exp_f32 v62, v62
    v_exp_f32 v63, v63
    v_pk_add_f32 v[56:57], v[56:57], 1.0 op_sel_hi:[1,0]
    v_pk_add_f32 v[58:59], v[58:59], 1.0 op_sel_hi:[1,0]
    v_pk_add_f32 v[60:61], v[60:61], 1.0 op_sel_hi:[1,0]
    v_pk_add_f32 v[62:63], v[62:63], 1.0 op_sel_hi:[1,0]
    v_rcp_f32 v56, v56
    v_rcp_f32 v57, v57
    v_rcp_f32 v58, v58
    v_rcp_f32 v59, v59
    v_rcp_f32 v60, v60
    v_rcp_f32 v61, v61
    v_rcp_f32 v62, v62
    v_rcp_f32 v63, v63
    v_pk_mul_f32 v[56:57], v[56:57], v[140:141]
    v_pk_mul_f32 v[58:59], v[58:59], v[142:143]
    v_pk_mul_f32 v[60:61], v[60:61], v[156:157]
    v_pk_mul_f32 v[62:63], v[62:63], v[158:159]
    v_cvt_pk_bf16_f32 v64, v56, v57
    v_cvt_pk_bf16_f32 v65, v58, v59
    v_cvt_pk_bf16_f32 v66, v60, v61
    v_cvt_pk_bf16_f32 v67, v62, v63
    buffer_store_dwordx4 v[64:67], v1, s[20:23], s71 offen sc1
    v_pk_mul_f32 v[44:45], v[144:145], s[84:85]
    v_pk_mul_f32 v[46:47], v[146:147], s[84:85]
    s_add_u32 s71, s0, 98304
    v_pk_mul_f32 v[48:49], v[160:161], s[84:85]
    v_pk_mul_f32 v[50:51], v[162:163], s[84:85]
    v_exp_f32 v44, v44
    v_exp_f32 v45, v45
    v_exp_f32 v46, v46
    v_exp_f32 v47, v47
    v_exp_f32 v48, v48
    v_exp_f32 v49, v49
    v_exp_f32 v50, v50
    v_exp_f32 v51, v51
    v_pk_add_f32 v[44:45], v[44:45], 1.0 op_sel_hi:[1,0]
    v_pk_add_f32 v[46:47], v[46:47], 1.0 op_sel_hi:[1,0]
    v_pk_add_f32 v[48:49], v[48:49], 1.0 op_sel_hi:[1,0]
    v_pk_add_f32 v[50:51], v[50:51], 1.0 op_sel_hi:[1,0]
    v_rcp_f32 v44, v44
    v_rcp_f32 v45, v45
    v_rcp_f32 v46, v46
    v_rcp_f32 v47, v47
    v_rcp_f32 v48, v48
    v_rcp_f32 v49, v49
    v_rcp_f32 v50, v50
    v_rcp_f32 v51, v51
    v_pk_mul_f32 v[44:45], v[44:45], v[144:145]
    v_pk_mul_f32 v[46:47], v[46:47], v[146:147]
    v_pk_mul_f32 v[48:49], v[48:49], v[160:161]
    v_pk_mul_f32 v[50:51], v[50:51], v[162:163]
    v_cvt_pk_bf16_f32 v52, v44, v45
    v_cvt_pk_bf16_f32 v53, v46, v47
    v_cvt_pk_bf16_f32 v54, v48, v49
    v_cvt_pk_bf16_f32 v55, v50, v51
    buffer_store_dwordx4 v[52:55], v1, s[20:23], s71 offen sc1
    v_pk_mul_f32 v[56:57], v[148:149], s[84:85]
    v_pk_mul_f32 v[58:59], v[150:151], s[84:85]
    s_add_u32 s71, s0, 147456
    v_pk_mul_f32 v[60:61], v[164:165], s[84:85]
    v_pk_mul_f32 v[62:63], v[166:167], s[84:85]
    v_exp_f32 v56, v56
    v_exp_f32 v57, v57
    v_exp_f32 v58, v58
    v_exp_f32 v59, v59
    v_exp_f32 v60, v60
    v_exp_f32 v61, v61
    v_exp_f32 v62, v62
    v_exp_f32 v63, v63
    v_pk_add_f32 v[56:57], v[56:57], 1.0 op_sel_hi:[1,0]
    v_pk_add_f32 v[58:59], v[58:59], 1.0 op_sel_hi:[1,0]
    v_pk_add_f32 v[60:61], v[60:61], 1.0 op_sel_hi:[1,0]
    v_pk_add_f32 v[62:63], v[62:63], 1.0 op_sel_hi:[1,0]
    v_rcp_f32 v56, v56
    v_rcp_f32 v57, v57
    v_rcp_f32 v58, v58
    v_rcp_f32 v59, v59
    v_rcp_f32 v60, v60
    v_rcp_f32 v61, v61
    v_rcp_f32 v62, v62
    v_rcp_f32 v63, v63
    v_pk_mul_f32 v[56:57], v[56:57], v[148:149]
    v_pk_mul_f32 v[58:59], v[58:59], v[150:151]
    v_pk_mul_f32 v[60:61], v[60:61], v[164:165]
    v_pk_mul_f32 v[62:63], v[62:63], v[166:167]
    v_cvt_pk_bf16_f32 v64, v56, v57
    v_cvt_pk_bf16_f32 v65, v58, v59
    v_cvt_pk_bf16_f32 v66, v60, v61
    v_cvt_pk_bf16_f32 v67, v62, v63
    buffer_store_dwordx4 v[64:67], v1, s[20:23], s71 offen sc1
    v_pk_mul_f32 v[44:45], v[168:169], s[84:85]
    v_pk_mul_f32 v[46:47], v[170:171], s[84:85]
    s_add_u32 s71, s0, 2048
    v_pk_mul_f32 v[48:49], v[184:185], s[84:85]
    v_pk_mul_f32 v[50:51], v[186:187], s[84:85]
    v_exp_f32 v44, v44
    v_exp_f32 v45, v45
    v_exp_f32 v46, v46
    v_exp_f32 v47, v47
    v_exp_f32 v48, v48
    v_exp_f32 v49, v49
    v_exp_f32 v50, v50
    v_exp_f32 v51, v51
    v_pk_add_f32 v[44:45], v[44:45], 1.0 op_sel_hi:[1,0]
    v_pk_add_f32 v[46:47], v[46:47], 1.0 op_sel_hi:[1,0]
    v_pk_add_f32 v[48:49], v[48:49], 1.0 op_sel_hi:[1,0]
    v_pk_add_f32 v[50:51], v[50:51], 1.0 op_sel_hi:[1,0]
    v_rcp_f32 v44, v44
    v_rcp_f32 v45, v45
    v_rcp_f32 v46, v46
    v_rcp_f32 v47, v47
    v_rcp_f32 v48, v48
    v_rcp_f32 v49, v49
    v_rcp_f32 v50, v50
    v_rcp_f32 v51, v51
    v_pk_mul_f32 v[44:45], v[44:45], v[168:169]
    v_pk_mul_f32 v[46:47], v[46:47], v[170:171]
    v_pk_mul_f32 v[48:49], v[48:49], v[184:185]
    v_pk_mul_f32 v[50:51], v[50:51], v[186:187]
    v_cvt_pk_bf16_f32 v52, v44, v45
    v_cvt_pk_bf16_f32 v53, v46, v47
    v_cvt_pk_bf16_f32 v54, v48, v49
    v_cvt_pk_bf16_f32 v55, v50, v51
    buffer_store_dwordx4 v[52:55], v1, s[20:23], s71 offen sc1
    v_pk_mul_f32 v[56:57], v[172:173], s[84:85]
    v_pk_mul_f32 v[58:59], v[174:175], s[84:85]
    s_add_u32 s71, s0, 51200
    v_pk_mul_f32 v[60:61], v[188:189], s[84:85]
    v_pk_mul_f32 v[62:63], v[190:191], s[84:85]
    v_exp_f32 v56, v56
    v_exp_f32 v57, v57
    v_exp_f32 v58, v58
    v_exp_f32 v59, v59
    v_exp_f32 v60, v60
    v_exp_f32 v61, v61
    v_exp_f32 v62, v62
    v_exp_f32 v63, v63
    v_pk_add_f32 v[56:57], v[56:57], 1.0 op_sel_hi:[1,0]
    v_pk_add_f32 v[58:59], v[58:59], 1.0 op_sel_hi:[1,0]
    v_pk_add_f32 v[60:61], v[60:61], 1.0 op_sel_hi:[1,0]
    v_pk_add_f32 v[62:63], v[62:63], 1.0 op_sel_hi:[1,0]
    v_rcp_f32 v56, v56
    v_rcp_f32 v57, v57
    v_rcp_f32 v58, v58
    v_rcp_f32 v59, v59
    v_rcp_f32 v60, v60
    v_rcp_f32 v61, v61
    v_rcp_f32 v62, v62
    v_rcp_f32 v63, v63
    v_pk_mul_f32 v[56:57], v[56:57], v[172:173]
    v_pk_mul_f32 v[58:59], v[58:59], v[174:175]
    v_pk_mul_f32 v[60:61], v[60:61], v[188:189]
    v_pk_mul_f32 v[62:63], v[62:63], v[190:191]
    v_cvt_pk_bf16_f32 v64, v56, v57
    v_cvt_pk_bf16_f32 v65, v58, v59
    v_cvt_pk_bf16_f32 v66, v60, v61
    v_cvt_pk_bf16_f32 v67, v62, v63
    buffer_store_dwordx4 v[64:67], v1, s[20:23], s71 offen sc1
    v_pk_mul_f32 v[44:45], v[176:177], s[84:85]
    v_pk_mul_f32 v[46:47], v[178:179], s[84:85]
    s_add_u32 s71, s0, 100352
    v_pk_mul_f32 v[48:49], v[192:193], s[84:85]
    v_pk_mul_f32 v[50:51], v[194:195], s[84:85]
    v_exp_f32 v44, v44
    v_exp_f32 v45, v45
    v_exp_f32 v46, v46
    v_exp_f32 v47, v47
    v_exp_f32 v48, v48
    v_exp_f32 v49, v49
    v_exp_f32 v50, v50
    v_exp_f32 v51, v51
    v_pk_add_f32 v[44:45], v[44:45], 1.0 op_sel_hi:[1,0]
    v_pk_add_f32 v[46:47], v[46:47], 1.0 op_sel_hi:[1,0]
    v_pk_add_f32 v[48:49], v[48:49], 1.0 op_sel_hi:[1,0]
    v_pk_add_f32 v[50:51], v[50:51], 1.0 op_sel_hi:[1,0]
    v_rcp_f32 v44, v44
    v_rcp_f32 v45, v45
    v_rcp_f32 v46, v46
    v_rcp_f32 v47, v47
    v_rcp_f32 v48, v48
    v_rcp_f32 v49, v49
    v_rcp_f32 v50, v50
    v_rcp_f32 v51, v51
    v_pk_mul_f32 v[44:45], v[44:45], v[176:177]
    v_pk_mul_f32 v[46:47], v[46:47], v[178:179]
    v_pk_mul_f32 v[48:49], v[48:49], v[192:193]
    v_pk_mul_f32 v[50:51], v[50:51], v[194:195]
    v_cvt_pk_bf16_f32 v52, v44, v45
    v_cvt_pk_bf16_f32 v53, v46, v47
    v_cvt_pk_bf16_f32 v54, v48, v49
    v_cvt_pk_bf16_f32 v55, v50, v51
    buffer_store_dwordx4 v[52:55], v1, s[20:23], s71 offen sc1
    v_pk_mul_f32 v[56:57], v[180:181], s[84:85]
    v_pk_mul_f32 v[58:59], v[182:183], s[84:85]
    s_add_u32 s71, s0, 149504
    v_pk_mul_f32 v[60:61], v[196:197], s[84:85]
    v_pk_mul_f32 v[62:63], v[198:199], s[84:85]
    v_exp_f32 v56, v56
    v_exp_f32 v57, v57
    v_exp_f32 v58, v58
    v_exp_f32 v59, v59
    v_exp_f32 v60, v60
    v_exp_f32 v61, v61
    v_exp_f32 v62, v62
    v_exp_f32 v63, v63
    v_pk_add_f32 v[56:57], v[56:57], 1.0 op_sel_hi:[1,0]
    v_pk_add_f32 v[58:59], v[58:59], 1.0 op_sel_hi:[1,0]
    v_pk_add_f32 v[60:61], v[60:61], 1.0 op_sel_hi:[1,0]
    v_pk_add_f32 v[62:63], v[62:63], 1.0 op_sel_hi:[1,0]
    v_rcp_f32 v56, v56
    v_rcp_f32 v57, v57
    v_rcp_f32 v58, v58
    v_rcp_f32 v59, v59
    v_rcp_f32 v60, v60
    v_rcp_f32 v61, v61
    v_rcp_f32 v62, v62
    v_rcp_f32 v63, v63
    v_pk_mul_f32 v[56:57], v[56:57], v[180:181]
    v_pk_mul_f32 v[58:59], v[58:59], v[182:183]
    v_pk_mul_f32 v[60:61], v[60:61], v[196:197]
    v_pk_mul_f32 v[62:63], v[62:63], v[198:199]
    v_cvt_pk_bf16_f32 v64, v56, v57
    v_cvt_pk_bf16_f32 v65, v58, v59
    v_cvt_pk_bf16_f32 v66, v60, v61
    v_cvt_pk_bf16_f32 v67, v62, v63
    buffer_store_dwordx4 v[64:67], v1, s[20:23], s71 offen sc1
    s_waitcnt vmcnt(4)
    s_mov_b64 exec, 1
    buffer_store_dwordx2 v[36:37], v34, s[20:23], s1 offen offset:0 sc1
    s_mov_b64 exec, -1
    buffer_load_dwordx4 v250, s[36:39], s62 offen offset:2048  lds
    s_add_u32 s62, s62, s53
    buffer_load_dwordx4 v251, s[36:39], s62 offen offset:3072  lds
    s_add_u32 m0, s63, 50176
    s_nop 0
    s_cmp_eq_u32 s92, 1
    s_cbranch_scc1 L_s528
    buffer_load_dwordx4 v253, s[36:39], s62 offen offset:0  lds
L_s528:
    s_add_u32 s91, s91, s65
    s_cmp_ge_u32 s91, s55
    s_cselect_b32 s96, 491520, 0
    s_sub_u32 s91, s91, s96
    s_mov_b32 s62, s91
    s_add_u32 m0, s63, 81920
    s_nop 0
    buffer_load_dwordx4 v248, s[28:31], s62 offen offset:0  lds
    buffer_load_dwordx4 v249, s[28:31], s62 offen offset:1024  lds
    buffer_load_dwordx4 v250, s[28:31], s62 offen offset:2048  lds
    buffer_load_dwordx4 v251, s[28:31], s62 offen offset:3072  lds
    s_add_u32 s62, s62, s64
    s_add_u32 m0, s63, 87040
    s_nop 0
    buffer_load_dwordx4 v248, s[28:31], s62 offen offset:0  lds
    buffer_load_dwordx4 v249, s[28:31], s62 offen offset:1024  lds
    buffer_load_dwordx4 v250, s[28:31], s62 offen offset:2048  lds
    s_add_u32 s62, s62, s53
    buffer_load_dwordx4 v251, s[28:31], s62 offen offset:3072  lds
    s_lshr_b32 s70, s90, 2
    s_mul_i32 s70, s70, 6144
    s_mul_i32 s96, s3, 1536
    s_add_u32 s70, s70, s96
    s_add_u32 s70, s70, 24543232
    v_min_u32 v28, 11, v0
    v_lshlrev_b32 v28, 7, v28
    s_mov_b32 s79, s70
    buffer_load_dwordx2 v[30:31], v28, s[20:23], s79 offen sc1
    s_mov_b32 s58, 0xffff
    s_sub_u32 s83, s67, 12288
    s_lshl_b32 s87, s52, 11
    s_add_u32 s8, s87, s33
    s_add_u32 s87, s33, 12288
    s_add_u32 s9, s8, 2048
    s_cmp_eq_u32 s9, s87
    s_cselect_b32 s9, s33, s9
    s_add_u32 s10, s9, 2048
    s_cmp_eq_u32 s10, s87
    s_cselect_b32 s10, s33, s10
    s_add_u32 s11, s10, 2048
    s_cmp_eq_u32 s11, s87
    s_cselect_b32 s11, s33, s11
    s_add_u32 s12, s11, 2048
    s_cmp_eq_u32 s12, s87
    s_cselect_b32 s12, s33, s12
    s_add_u32 s13, s12, 2048
    s_cmp_eq_u32 s13, s87
    s_cselect_b32 s13, s33, s13
    s_waitcnt vmcnt(12)
    s_mov_b64 exec, 1
    buffer_store_dwordx2 v[36:37], v34, s[20:23], s1 offen offset:512 sc1
    s_mov_b64 exec, -1
    v_add_u32 v254, 122880, v38
    v_xor_b32 v255, 32, v254
    ds_read_b64_tr_b16 a[0:1], v254 offset:0
    ds_read_b64_tr_b16 a[2:3], v254 offset:2048
    ds_read_b64_tr_b16 a[4:5], v255 offset:0
    ds_read_b64_tr_b16 a[6:7], v255 offset:2048
    ds_read_b64_tr_b16 a[20:21], v254 offset:5120
    ds_read_b64_tr_b16 a[22:23], v254 offset:7168
    ds_read_b64_tr_b16 a[24:25], v255 offset:5120
    ds_read_b64_tr_b16 a[26:27], v255 offset:7168
    v_xor_b32 v254, 64, v254
    v_xor_b32 v255, 64, v255
    ds_read_b64_tr_b16 a[8:9], v254 offset:0
    ds_read_b64_tr_b16 a[10:11], v254 offset:2048
    ds_read_b64_tr_b16 a[12:13], v255 offset:0
    ds_read_b64_tr_b16 a[14:15], v255 offset:2048
    ds_read_b64_tr_b16 a[28:29], v254 offset:5120
    ds_read_b64_tr_b16 a[30:31], v254 offset:7168
    ds_read_b64_tr_b16 a[32:33], v255 offset:5120
    ds_read_b64_tr_b16 a[34:35], v255 offset:7168
    s_waitcnt lgkmcnt(0)
    s_mul_i32 s96, s92, 81920
    s_add_u32 s91, s91, s96
    s_cmp_ge_u32 s91, s55
    s_cselect_b32 s96, 491520, 0
    s_sub_u32 s91, s91, s96
    s_mov_b32 s62, s91
    s_add_u32 m0, s63, 122880
    s_nop 0
    buffer_load_dwordx4 v248, s[36:39], s62 offen offset:0  lds
    buffer_load_dwordx4 v249, s[36:39], s62 offen offset:1024  lds
    buffer_load_dwordx4 v250, s[36:39], s62 offen offset:2048  lds
    buffer_load_dwordx4 v251, s[36:39], s62 offen offset:3072  lds
    s_add_u32 s62, s62, s64
    s_add_u32 m0, s63, 128000
    s_nop 0
    buffer_load_dwordx4 v248, s[36:39], s62 offen offset:0  lds
    buffer_load_dwordx4 v249, s[36:39], s62 offen offset:1024  lds
    buffer_load_dwordx4 v250, s[36:39], s62 offen offset:2048  lds
    s_add_u32 s62, s62, s53
    buffer_load_dwordx4 v251, s[36:39], s62 offen offset:3072  lds
    s_waitcnt vmcnt(18)
    v_add_u32 v254, 40960, v38
    v_xor_b32 v255, 32, v254
    ds_read_b64_tr_b16 a[40:41], v254 offset:0
    ds_read_b64_tr_b16 a[42:43], v254 offset:2048
    ds_read_b64_tr_b16 a[44:45], v255 offset:0
    ds_read_b64_tr_b16 a[46:47], v255 offset:2048
    ds_read_b64_tr_b16 a[60:61], v254 offset:5120
    ds_read_b64_tr_b16 a[62:63], v254 offset:7168
    ds_read_b64_tr_b16 a[64:65], v255 offset:5120
    ds_read_b64_tr_b16 a[66:67], v255 offset:7168
    v_xor_b32 v254, 64, v254
    v_xor_b32 v255, 64, v255
    ds_read_b64_tr_b16 a[48:49], v254 offset:0
    ds_read_b64_tr_b16 a[50:51], v254 offset:2048
    ds_read_b64_tr_b16 a[52:53], v255 offset:0
    ds_read_b64_tr_b16 a[54:55], v255 offset:2048
    ds_read_b64_tr_b16 a[68:69], v254 offset:5120
    ds_read_b64_tr_b16 a[70:71], v254 offset:7168
    ds_read_b64_tr_b16 a[72:73], v255 offset:5120
    ds_read_b64_tr_b16 a[74:75], v255 offset:7168
    s_waitcnt lgkmcnt(0)
    s_add_u32 s91, s91, s65
    s_cmp_ge_u32 s91, s55
    s_cselect_b32 s96, 491520, 0
    s_sub_u32 s91, s91, s96
    s_mov_b32 s62, s91
    s_add_u32 m0, s63, 40960
    s_nop 0
    buffer_load_dwordx4 v248, s[28:31], s62 offen offset:0  lds
    buffer_load_dwordx4 v249, s[28:31], s62 offen offset:1024  lds
    buffer_load_dwordx4 v250, s[28:31], s62 offen offset:2048  lds
    buffer_load_dwordx4 v251, s[28:31], s62 offen offset:3072  lds
    s_mul_i32 s96, s92, 40960
    s_add_u32 s62, s62, s96
    s_add_u32 m0, s63, 46080
    s_nop 0
    buffer_load_dwordx4 v248, s[36:39], s62 offen offset:0  lds
    buffer_load_dwordx4 v249, s[36:39], s62 offen offset:1024  lds
    buffer_load_dwordx4 v250, s[36:39], s62 offen offset:2048  lds
    buffer_load_dwordx4 v251, s[36:39], s62 offen offset:3072  lds
    s_waitcnt vmcnt(17)
    v_cmp_ne_u32 vcc, s88, v30
    v_cmp_ne_u32 s[96:97], s88, v31
    s_nop 1
    s_or_b64 vcc, vcc, s[96:97]
    s_cbranch_scc1 L_pslow29
L_pok29:
    s_mul_i32 s70, s90, 49152
    s_mul_i32 s96, s3, 12288
    s_add_u32 s70, s70, s96
    s_add_u32 s70, s70, 12582912
    s_sub_u32 s70, s70, s33
    s_add_u32 s86, s8, s70
    buffer_load_dwordx4 a[16:19], v1, s[20:23], s86 offen offset:0 sc1
    buffer_load_dwordx4 a[36:39], v1, s[20:23], s86 offen offset:1024 sc1
    s_add_u32 s86, s9, s70
    buffer_load_dwordx4 a[56:59], v1, s[20:23], s86 offen offset:0 sc1
    buffer_load_dwordx4 a[76:79], v1, s[20:23], s86 offen offset:1024 sc1
    s_add_u32 s86, s10, s70
    buffer_load_dwordx4 a[96:99], v1, s[20:23], s86 offen offset:0 sc1
    buffer_load_dwordx4 a[116:119], v1, s[20:23], s86 offen offset:1024 sc1
    s_add_u32 s86, s11, s70
    buffer_load_dwordx4 a[136:139], v1, s[20:23], s86 offen offset:0 sc1
    buffer_load_dwordx4 a[156:159], v1, s[20:23], s86 offen offset:1024 sc1
    s_add_u32 s86, s12, s70
    buffer_load_dwordx4 a[176:179], v1, s[20:23], s86 offen offset:0 sc1
    buffer_load_dwordx4 a[196:199], v1, s[20:23], s86 offen offset:1024 sc1
    s_add_u32 s86, s13, s70
    buffer_load_dwordx4 a[216:219], v1, s[20:23], s86 offen offset:0 sc1
    buffer_load_dwordx4 a[236:239], v1, s[20:23], s86 offen offset:1024 sc1
    v_add_u32 v254, 81920, v38
    v_xor_b32 v255, 32, v254
    ds_read_b64_tr_b16 a[80:81], v254 offset:0
    ds_read_b64_tr_b16 a[82:83], v254 offset:2048
    ds_read_b64_tr_b16 a[84:85], v255 offset:0
    ds_read_b64_tr_b16 a[86:87], v255 offset:2048
    ds_read_b64_tr_b16 a[100:101], v254 offset:5120
    ds_read_b64_tr_b16 a[102:103], v254 offset:7168
    ds_read_b64_tr_b16 a[104:105], v255 offset:5120
    ds_read_b64_tr_b16 a[106:107], v255 offset:7168
    v_xor_b32 v254, 64, v254
    v_xor_b32 v255, 64, v255
    ds_read_b64_tr_b16 a[88:89], v254 offset:0
    ds_read_b64_tr_b16 a[90:91], v254 offset:2048
    ds_read_b64_tr_b16 a[92:93], v255 offset:0
    ds_read_b64_tr_b16 a[94:95], v255 offset:2048
    ds_read_b64_tr_b16 a[108:109], v254 offset:5120
    ds_read_b64_tr_b16 a[110:111], v254 offset:7168
    ds_read_b64_tr_b16 a[112:113], v255 offset:5120
    ds_read_b64_tr_b16 a[114:115], v255 offset:7168
    s_waitcnt lgkmcnt(0)
    s_mul_i32 s96, s92, 81920
    s_add_u32 s91, s91, s96
    s_cmp_ge_u32 s91, s55
    s_cselect_b32 s96, 491520, 0
    s_sub_u32 s91, s91, s96
    s_mov_b32 s62, s91
    s_add_u32 m0, s63, 81920
    s_nop 0
    buffer_load_dwordx4 v248, s[28:31], s62 offen offset:0  lds
    buffer_load_dwordx4 v249, s[28:31], s62 offen offset:1024  lds
    buffer_load_dwordx4 v250, s[28:31], s62 offen offset:2048  lds
    buffer_load_dwordx4 v251, s[28:31], s62 offen offset:3072  lds
    s_mul_i32 s96, s92, 40960
    s_add_u32 s62, s62, s96
    s_add_u32 m0, s63, 87040
    s_nop 0
    buffer_load_dwordx4 v248, s[36:39], s62 offen offset:0  lds
    buffer_load_dwordx4 v249, s[36:39], s62 offen offset:1024  lds
    buffer_load_dwordx4 v250, s[36:39], s62 offen offset:2048  lds
    buffer_load_dwordx4 v251, s[36:39], s62 offen offset:3072  lds
    buffer_load_dwordx2 v[26:27], v8, s[20:23], s32 offen sc1
    s_waitcnt vmcnt(29)
    v_add_u32 v254, 122880, v38
    v_xor_b32 v255, 32, v254
    ds_read_b64_tr_b16 a[120:121], v254 offset:0
    ds_read_b64_tr_b16 a[122:123], v254 offset:2048
    ds_read_b64_tr_b16 a[124:125], v255 offset:0
    ds_read_b64_tr_b16 a[126:127], v255 offset:2048
    ds_read_b64_tr_b16 a[140:141], v254 offset:5120
    ds_read_b64_tr_b16 a[142:143], v254 offset:7168
    ds_read_b64_tr_b16 a[144:145], v255 offset:5120
    ds_read_b64_tr_b16 a[146:147], v255 offset:7168
    v_xor_b32 v254, 64, v254
    v_xor_b32 v255, 64, v255
    ds_read_b64_tr_b16 a[128:129], v254 offset:0
    ds_read_b64_tr_b16 a[130:131], v254 offset:2048
    ds_read_b64_tr_b16 a[132:133], v255 offset:0
    ds_read_b64_tr_b16 a[134:135], v255 offset:2048
    ds_read_b64_tr_b16 a[148:149], v254 offset:5120
    ds_read_b64_tr_b16 a[150:151], v254 offset:7168
    ds_read_b64_tr_b16 a[152:153], v255 offset:5120
    ds_read_b64_tr_b16 a[154:155], v255 offset:7168
    s_waitcnt vmcnt(21)
    v_add_u32 v254, 40960, v38
    v_xor_b32 v255, 32, v254
    ds_read_b64_tr_b16 a[160:161], v254 offset:0
    ds_read_b64_tr_b16 a[162:163], v254 offset:2048
    ds_read_b64_tr_b16 a[164:165], v255 offset:0
    ds_read_b64_tr_b16 a[166:167], v255 offset:2048
    ds_read_b64_tr_b16 a[180:181], v254 offset:5120
    ds_read_b64_tr_b16 a[182:183], v254 offset:7168
    ds_read_b64_tr_b16 a[184:185], v255 offset:5120
    ds_read_b64_tr_b16 a[186:187], v255 offset:7168
    v_xor_b32 v254, 64, v254
    v_xor_b32 v255, 64, v255
    ds_read_b64_tr_b16 a[168:169], v254 offset:0
    ds_read_b64_tr_b16 a[170:171], v254 offset:2048
    ds_read_b64_tr_b16 a[172:173], v255 offset:0
    ds_read_b64_tr_b16 a[174:175], v255 offset:2048
    ds_read_b64_tr_b16 a[188:189], v254 offset:5120
    ds_read_b64_tr_b16 a[190:191], v254 offset:7168
    ds_read_b64_tr_b16 a[192:193], v255 offset:5120
    ds_read_b64_tr_b16 a[194:195], v255 offset:7168
    s_waitcnt vmcnt(1)
    v_add_u32 v254, 81920, v38
    v_xor_b32 v255, 32, v254
    ds_read_b64_tr_b16 a[200:201], v254 offset:0
    ds_read_b64_tr_b16 a[202:203], v254 offset:2048
    ds_read_b64_tr_b16 a[204:205], v255 offset:0
    ds_read_b64_tr_b16 a[206:207], v255 offset:2048
    ds_read_b64_tr_b16 a[220:221], v254 offset:5120
    ds_read_b64_tr_b16 a[222:223], v254 offset:7168
    ds_read_b64_tr_b16 a[224:225], v255 offset:5120
    ds_read_b64_tr_b16 a[226:227], v255 offset:7168
    v_xor_b32 v254, 64, v254
    v_xor_b32 v255, 64, v255
    ds_read_b64_tr_b16 a[208:209], v254 offset:0
    ds_read_b64_tr_b16 a[210:211], v254 offset:2048
    ds_read_b64_tr_b16 a[212:213], v255 offset:0
    ds_read_b64_tr_b16 a[214:215], v255 offset:2048
    ds_read_b64_tr_b16 a[228:229], v254 offset:5120
    ds_read_b64_tr_b16 a[230:231], v254 offset:7168
    ds_read_b64_tr_b16 a[232:233], v255 offset:5120
    ds_read_b64_tr_b16 a[234:235], v255 offset:7168
    s_waitcnt vmcnt(0)
    s_branch L_roleQ
L_roleP:
    s_mul_i32 s85, s88, 0x9e3779b1
    v_and_b32 v29, 1, v0
    v_lshlrev_b32 v29, 4, v29
    v_lshlrev_b32 v28, v29, s85
    v_and_b32 v28, 0xffff0000, v28
    v_lshrrev_b32 v10, 8, v9
    v_lshlrev_b32 v10, 4, v10
    v_lshrrev_b32 v11, 4, v0
    v_lshl_add_u32 v11, v11, 2, 48
    v_cmp_ne_u32 vcc, s88, v26
    v_cmp_ne_u32 s[96:97], s88, v27
    s_nop 1
    s_or_b64 vcc, vcc, s[96:97]
    s_cbranch_scc1 L_pslow30
L_pok30:
    s_add_u32 s84, s8, 163840
    buffer_load_dwordx4 v[160:163], v1, s[20:23], s84 offen offset:0 sc1
    buffer_load_dwordx4 v[164:167], v1, s[20:23], s84 offen offset:1024 sc1
    s_add_u32 s84, s9, 163840
    buffer_load_dwordx4 v[168:171], v1, s[20:23], s84 offen offset:0 sc1
    buffer_load_dwordx4 v[172:175], v1, s[20:23], s84 offen offset:1024 sc1
    s_add_u32 s84, s10, 163840
    buffer_load_dwordx4 v[176:179], v1, s[20:23], s84 offen offset:0 sc1
    buffer_load_dwordx4 v[180:183], v1, s[20:23], s84 offen offset:1024 sc1
    s_add_u32 s84, s11, 163840
    buffer_load_dwordx4 v[184:187], v1, s[20:23], s84 offen offset:0 sc1
    buffer_load_dwordx4 v[188:191], v1, s[20:23], s84 offen offset:1024 sc1
    s_add_u32 s84, s12, 163840
    buffer_load_dwordx4 v[192:195], v1, s[20:23], s84 offen offset:0 sc1
    buffer_load_dwordx4 v[196:199], v1, s[20:23], s84 offen offset:1024 sc1
    s_add_u32 s84, s8, 204800
    buffer_load_dwordx4 v[200:203], v1, s[20:23], s84 offen offset:0 sc1
    buffer_load_dwordx4 v[204:207], v1, s[20:23], s84 offen offset:1024 sc1
    s_add_u32 s84, s9, 204800
    buffer_load_dwordx4 v[208:211], v1, s[20:23], s84 offen offset:0 sc1
    buffer_load_dwordx4 v[212:215], v1, s[20:23], s84 offen offset:1024 sc1
    s_add_u32 s84, s10, 204800
    buffer_load_dwordx4 v[216:219], v1, s[20:23], s84 offen offset:0 sc1
    buffer_load_dwordx4 v[220:223], v1, s[20:23], s84 offen offset:1024 sc1
    s_waitcnt lgkmcnt(0)
    s_waitcnt vmcnt(14)
    v_mfma_f32_16x16x32_bf16 v[40:43], a[0:3], v[160:163], 0
    v_mfma_f32_16x16x32_bf16 v[44:47], a[4:7], v[160:163], 0
    s_add_u32 s84, s11, 204800
    buffer_load_dwordx4 v[224:227], v1, s[20:23], s84 offen offset:0 sc1
    v_mfma_f32_16x16x32_bf16 v[48:51], a[8:11], v[160:163], 0
    buffer_load_dwordx4 v[12:15], v10, s[20:23], s95 offen sc1
    v_mfma_f32_16x16x32_bf16 v[52:55], a[12:15], v[160:163], 0
    buffer_load_dword v16, v11, s[20:23], s95 offen sc1
    v_mfma_f32_16x16x32_bf16 v[56:59], a[16:19], v[160:163], 0
    v_mfma_f32_16x16x32_bf16 v[40:43], a[20:23], v[164:167], v[40:43]
    v_mfma_f32_16x16x32_bf16 v[44:47], a[24:27], v[164:167], v[44:47]
    buffer_load_dwordx4 v[228:231], v1, s[20:23], s84 offen offset:1024 sc1
    v_mfma_f32_16x16x32_bf16 v[48:51], a[28:31], v[164:167], v[48:51]
    v_mfma_f32_16x16x32_bf16 v[52:55], a[32:35], v[164:167], v[52:55]
    v_mfma_f32_16x16x32_bf16 v[56:59], a[36:39], v[164:167], v[56:59]
    s_waitcnt vmcnt(16)
    v_mfma_f32_16x16x32_bf16 v[40:43], a[40:43], v[168:171], v[40:43]
    v_accvgpr_read_b32 v18, a250
    v_lshlrev_b32 v132, 16, v18
    v_mfma_f32_16x16x32_bf16 v[44:47], a[44:47], v[168:171], v[44:47]
    s_add_u32 s84, s12, 204800
    buffer_load_dwordx4 v[232:235], v1, s[20:23], s84 offen offset:0 sc1
    v_mfma_f32_16x16x32_bf16 v[48:51], a[48:51], v[168:171], v[48:51]
    v_and_b32 v133, 0xffff0000, v18
    v_accvgpr_read_b32 v18, a251
    v_mfma_f32_16x16x32_bf16 v[52:55], a[52:55], v[168:171], v[52:55]
    v_lshlrev_b32 v134, 16, v18
    v_and_b32 v135, 0xffff0000, v18
    v_mfma_f32_16x16x32_bf16 v[56:59], a[56:59], v[168:171], v[56:59]
    v_mfma_f32_16x16x32_bf16 v[40:43], a[60:63], v[172:175], v[40:43]
    v_accvgpr_read_b32 v18, a252
    v_lshlrev_b32 v136, 16, v18
    v_mfma_f32_16x16x32_bf16 v[44:47], a[64:67], v[172:175], v[44:47]
    buffer_load_dwordx4 v[160:163], v1, s[20:23], s84 offen offset:1024 sc1
    v_mfma_f32_16x16x32_bf16 v[48:51], a[68:71], v[172:175], v[48:51]
    v_and_b32 v137, 0xffff0000, v18
    v_accvgpr_read_b32 v18, a253
    v_mfma_f32_16x16x32_bf16 v[52:55], a[72:75], v[172:175], v[52:55]
    v_lshlrev_b32 v138, 16, v18
    v_and_b32 v139, 0xffff0000, v18
    v_mfma_f32_16x16x32_bf16 v[56:59], a[76:79], v[172:175], v[56:59]
    s_waitcnt vmcnt(16)
    v_mfma_f32_16x16x32_bf16 v[40:43], a[80:83], v[176:179], v[40:43]
    v_mfma_f32_16x16x32_bf16 v[44:47], a[84:87], v[176:179], v[44:47]
    s_add_u32 s84, s8, 245760
    buffer_load_dwordx4 v[164:167], v1, s[20:23], s84 offen offset:0 sc1
    v_mfma_f32_16x16x32_bf16 v[48:51], a[88:91], v[176:179], v[48:51]
    v_mfma_f32_16x16x32_bf16 v[52:55], a[92:95], v[176:179], v[52:55]
    v_mfma_f32_16x16x32_bf16 v[56:59], a[96:99], v[176:179], v[56:59]
    v_mfma_f32_16x16x32_bf16 v[40:43], a[100:103], v[180:183], v[40:43]
    v_mfma_f32_16x16x32_bf16 v[44:47], a[104:107], v[180:183], v[44:47]
    buffer_load_dwordx4 v[168:171], v1, s[20:23], s84 offen offset:1024 sc1
    v_mfma_f32_16x16x32_bf16 v[48:51], a[108:111], v[180:183], v[48:51]
    v_mfma_f32_16x16x32_bf16 v[52:55], a[112:115], v[180:183], v[52:55]
    v_mfma_f32_16x16x32_bf16 v[56:59], a[116:119], v[180:183], v[56:59]
    s_waitcnt vmcnt(16)
    v_mfma_f32_16x16x32_bf16 v[40:43], a[120:123], v[184:187], v[40:43]
    s_waitcnt vmcnt(5)
    v_accvgpr_read_b32 v18, a240
    v_mfma_f32_16x16x32_bf16 v[44:47], a[124:127], v[184:187], v[44:47]
    s_add_u32 s84, s9, 245760
    buffer_load_dwordx4 v[172:175], v1, s[20:23], s84 offen offset:0 sc1
    v_mfma_f32_16x16x32_bf16 v[48:51], a[128:131], v[184:187], v[48:51]
    v_accvgpr_read_b32 v20, a241
    v_and_b32 v19, 0xffff0000, v18
    v_mfma_f32_16x16x32_bf16 v[52:55], a[132:135], v[184:187], v[52:55]
    v_lshlrev_b32 v18, 16, v18
    v_and_b32 v21, 0xffff0000, v20
    v_mfma_f32_16x16x32_bf16 v[56:59], a[136:139], v[184:187], v[56:59]
    v_mfma_f32_16x16x32_bf16 v[40:43], a[140:143], v[188:191], v[40:43]
    v_lshlrev_b32 v20, 16, v20
    v_lshlrev_b32 v22, 16, v12
    v_mfma_f32_16x16x32_bf16 v[44:47], a[144:147], v[188:191], v[44:47]
    buffer_load_dwordx4 v[176:179], v1, s[20:23], s84 offen offset:1024 sc1
    v_mfma_f32_16x16x32_bf16 v[48:51], a[148:151], v[188:191], v[48:51]
    v_mul_f32 v236, v18, v132
    v_mul_f32 v237, v19, v133
    v_mfma_f32_16x16x32_bf16 v[52:55], a[152:155], v[188:191], v[52:55]
    v_mul_f32 v238, v20, v134
    v_mul_f32 v239, v21, v135
    v_mfma_f32_16x16x32_bf16 v[56:59], a[156:159], v[188:191], v[56:59]
    v_mfma_f32_16x16x32_bf16 v[40:43], a[160:163], v[192:195], v[40:43]
    s_barrier
    v_mul_f32 v236, v22, v236
    v_mfma_f32_16x16x32_bf16 v[44:47], a[164:167], v[192:195], v[44:47]
    s_add_u32 s84, s10, 245760
    buffer_load_dwordx4 v[180:183], v1, s[20:23], s84 offen offset:0 sc1
    v_mfma_f32_16x16x32_bf16 v[48:51], a[168:171], v[192:195], v[48:51]
    v_mul_f32 v237, v22, v237
    v_mul_f32 v238, v22, v238
    v_mfma_f32_16x16x32_bf16 v[52:55], a[172:175], v[192:195], v[52:55]
    v_mul_f32 v239, v22, v239
    v_accvgpr_read_b32 v18, a242
    v_mfma_f32_16x16x32_bf16 v[56:59], a[176:179], v[192:195], v[56:59]
    v_mfma_f32_16x16x32_bf16 v[40:43], a[180:183], v[196:199], v[40:43]
    v_accvgpr_read_b32 v20, a243
    v_and_b32 v19, 0xffff0000, v18
    v_mfma_f32_16x16x32_bf16 v[44:47], a[184:187], v[196:199], v[44:47]
    buffer_load_dwordx4 v[184:187], v1, s[20:23], s84 offen offset:1024 sc1
    v_mfma_f32_16x16x32_bf16 v[48:51], a[188:191], v[196:199], v[48:51]
    v_lshlrev_b32 v18, 16, v18
    v_and_b32 v21, 0xffff0000, v20
    v_mfma_f32_16x16x32_bf16 v[52:55], a[192:195], v[196:199], v[52:55]
    v_lshlrev_b32 v20, 16, v20
    v_lshlrev_b32 v22, 16, v13
    v_mfma_f32_16x16x32_bf16 v[56:59], a[196:199], v[196:199], v[56:59]
    v_mfma_f32_16x16x32_bf16 v[60:63], a[0:3], v[200:203], 0
    v_mul_f32 v240, v18, v132
    v_mul_f32 v241, v19, v133
    v_mfma_f32_16x16x32_bf16 v[64:67], a[4:7], v[200:203], 0
    s_add_u32 s84, s11, 245760
    buffer_load_dwordx4 v[188:191], v1, s[20:23], s84 offen offset:0 sc1
    v_mfma_f32_16x16x32_bf16 v[68:71], a[8:11], v[200:203], 0
    v_mul_f32 v242, v20, v134
    v_mul_f32 v243, v21, v135
    v_mfma_f32_16x16x32_bf16 v[72:75], a[12:15], v[200:203], 0
    v_mul_f32 v240, v22, v240
    v_mul_f32 v241, v22, v241
    v_mfma_f32_16x16x32_bf16 v[76:79], a[16:19], v[200:203], 0
    v_mfma_f32_16x16x32_bf16 v[60:63], a[20:23], v[204:207], v[60:63]
    v_mul_f32 v242, v22, v242
    v_mul_f32 v243, v22, v243
    v_mfma_f32_16x16x32_bf16 v[64:67], a[24:27], v[204:207], v[64:67]
    buffer_load_dwordx4 v[192:195], v1, s[20:23], s84 offen offset:1024 sc1
    v_mfma_f32_16x16x32_bf16 v[68:71], a[28:31], v[204:207], v[68:71]
    v_accvgpr_read_b32 v18, a244
    v_accvgpr_read_b32 v20, a245
    v_mfma_f32_16x16x32_bf16 v[72:75], a[32:35], v[204:207], v[72:75]
    ds_write_b128 v2, v[40:43] offset:0
    v_and_b32 v19, 0xffff0000, v18
    v_mfma_f32_16x16x32_bf16 v[76:79], a[36:39], v[204:207], v[76:79]
    v_mfma_f32_16x16x32_bf16 v[60:63], a[40:43], v[208:211], v[60:63]
    v_lshlrev_b32 v18, 16, v18
    v_and_b32 v21, 0xffff0000, v20
    v_mfma_f32_16x16x32_bf16 v[64:67], a[44:47], v[208:211], v[64:67]
    s_add_u32 s84, s12, 245760
    buffer_load_dwordx4 v[196:199], v1, s[20:23], s84 offen offset:0 sc1
    v_mfma_f32_16x16x32_bf16 v[68:71], a[48:51], v[208:211], v[68:71]
    ds_write_b128 v2, v[44:47] offset:64
    v_lshlrev_b32 v20, 16, v20
    v_mfma_f32_16x16x32_bf16 v[72:75], a[52:55], v[208:211], v[72:75]
    v_lshlrev_b32 v22, 16, v14
    v_mul_f32 v244, v18, v132
    v_mfma_f32_16x16x32_bf16 v[76:79], a[56:59], v[208:211], v[76:79]
    v_mfma_f32_16x16x32_bf16 v[60:63], a[60:63], v[212:215], v[60:63]
    ds_write_b128 v2, v[48:51] offset:128
    v_mul_f32 v245, v19, v133
    v_mfma_f32_16x16x32_bf16 v[64:67], a[64:67], v[212:215], v[64:67]
    buffer_load_dwordx4 v[200:203], v1, s[20:23], s84 offen offset:1024 sc1
    v_mfma_f32_16x16x32_bf16 v[68:71], a[68:71], v[212:215], v[68:71]
    v_mul_f32 v246, v20, v134
    v_mul_f32 v247, v21, v135
    v_mfma_f32_16x16x32_bf16 v[72:75], a[72:75], v[212:215], v[72:75]
    ds_write_b128 v2, v[52:55] offset:192
    v_mul_f32 v244, v22, v244
    v_mfma_f32_16x16x32_bf16 v[76:79], a[76:79], v[212:215], v[76:79]
    v_mfma_f32_16x16x32_bf16 v[60:63], a[80:83], v[216:219], v[60:63]
    v_mul_f32 v245, v22, v245
    v_mul_f32 v246, v22, v246
    v_mfma_f32_16x16x32_bf16 v[64:67], a[84:87], v[216:219], v[64:67]
    s_add_u32 s84, s8, 286720
    buffer_load_dwordx4 v[204:207], v1, s[20:23], s84 offen offset:0 sc1
    v_mfma_f32_16x16x32_bf16 v[68:71], a[88:91], v[216:219], v[68:71]
    ds_write_b128 v2, v[56:59] offset:256
    v_mul_f32 v247, v22, v247
    v_mfma_f32_16x16x32_bf16 v[72:75], a[92:95], v[216:219], v[72:75]
    v_accvgpr_read_b32 v18, a246
    v_accvgpr_read_b32 v20, a247
    v_mfma_f32_16x16x32_bf16 v[76:79], a[96:99], v[216:219], v[76:79]
    v_mfma_f32_16x16x32_bf16 v[60:63], a[100:103], v[220:223], v[60:63]
    v_and_b32 v19, 0xffff0000, v18
    v_lshlrev_b32 v18, 16, v18
    v_mfma_f32_16x16x32_bf16 v[64:67], a[104:107], v[220:223], v[64:67]
    buffer_load_dwordx4 v[208:211], v1, s[20:23], s84 offen offset:1024 sc1
    v_mfma_f32_16x16x32_bf16 v[68:71], a[108:111], v[220:223], v[68:71]
    v_and_b32 v21, 0xffff0000, v20
    v_lshlrev_b32 v20, 16, v20
    v_mfma_f32_16x16x32_bf16 v[72:75], a[112:115], v[220:223], v[72:75]
    v_lshlrev_b32 v22, 16, v15
    v_mul_f32 v248, v18, v132
    v_mfma_f32_16x16x32_bf16 v[76:79], a[116:119], v[220:223], v[76:79]
    s_waitcnt vmcnt(14)
    v_mfma_f32_16x16x32_bf16 v[60:63], a[120:123], v[224:227], v[60:63]
    v_mul_f32 v249, v19, v133
    v_mul_f32 v250, v20, v134
    v_mfma_f32_16x16x32_bf16 v[64:67], a[124:127], v[224:227], v[64:67]
    s_add_u32 s84, s9, 286720
    buffer_load_dwordx4 v[212:215], v1, s[20:23], s84 offen offset:0 sc1
    v_mfma_f32_16x16x32_bf16 v[68:71], a[128:131], v[224:227], v[68:71]
    v_mul_f32 v251, v21, v135
    v_mul_f32 v248, v22, v248
    v_mfma_f32_16x16x32_bf16 v[72:75], a[132:135], v[224:227], v[72:75]
    v_mul_f32 v249, v22, v249
    v_mul_f32 v250, v22, v250
    v_mfma_f32_16x16x32_bf16 v[76:79], a[136:139], v[224:227], v[76:79]
    v_mfma_f32_16x16x32_bf16 v[60:63], a[140:143], v[228:231], v[60:63]
    v_mul_f32 v251, v22, v251
    v_accvgpr_read_b32 v18, a248
    v_mfma_f32_16x16x32_bf16 v[64:67], a[144:147], v[228:231], v[64:67]
    buffer_load_dwordx4 v[216:219], v1, s[20:23], s84 offen offset:1024 sc1
    v_mfma_f32_16x16x32_bf16 v[68:71], a[148:151], v[228:231], v[68:71]
    v_accvgpr_read_b32 v20, a249
    v_and_b32 v19, 0xffff0000, v18
    v_mfma_f32_16x16x32_bf16 v[72:75], a[152:155], v[228:231], v[72:75]
    v_lshlrev_b32 v18, 16, v18
    v_and_b32 v21, 0xffff0000, v20
    v_mfma_f32_16x16x32_bf16 v[76:79], a[156:159], v[228:231], v[76:79]
    s_waitcnt vmcnt(14)
    v_mfma_f32_16x16x32_bf16 v[60:63], a[160:163], v[232:235], v[60:63]
    v_lshlrev_b32 v20, 16, v20
    v_lshlrev_b32 v22, 16, v16
    v_mfma_f32_16x16x32_bf16 v[64:67], a[164:167], v[232:235], v[64:67]
    s_add_u32 s84, s10, 286720
    buffer_load_dwordx4 v[220:223], v1, s[20:23], s84 offen offset:0 sc1
    v_mfma_f32_16x16x32_bf16 v[68:71], a[168:171], v[232:235], v[68:71]
    v_mul_f32 v136, v18, v136
    v_mul_f32 v137, v19, v137
    v_mfma_f32_16x16x32_bf16 v[72:75], a[172:175], v[232:235], v[72:75]
    v_mul_f32 v138, v20, v138
    v_mul_f32 v139, v21, v139
    v_mfma_f32_16x16x32_bf16 v[76:79], a[176:179], v[232:235], v[76:79]
    v_mfma_f32_16x16x32_bf16 v[60:63], a[180:183], v[160:163], v[60:63]
    v_mul_f32 v136, v22, v136
    v_mul_f32 v137, v22, v137
    v_mfma_f32_16x16x32_bf16 v[64:67], a[184:187], v[160:163], v[64:67]
    buffer_load_dwordx4 v[224:227], v1, s[20:23], s84 offen offset:1024 sc1
    v_mfma_f32_16x16x32_bf16 v[68:71], a[188:191], v[160:163], v[68:71]
    v_mul_f32 v138, v22, v138
    v_mul_f32 v139, v22, v139
    v_mfma_f32_16x16x32_bf16 v[72:75], a[192:195], v[160:163], v[72:75]
    v_mfma_f32_16x16x32_bf16 v[76:79], a[196:199], v[160:163], v[76:79]
    s_waitcnt vmcnt(14)
    v_mfma_f32_16x16x32_bf16 v[40:43], a[0:3], v[164:167], 0
    v_mfma_f32_16x16x32_bf16 v[44:47], a[4:7], v[164:167], 0
    s_add_u32 s84, s11, 286720
    buffer_load_dwordx4 v[228:231], v1, s[20:23], s84 offen offset:0 sc1
    v_mfma_f32_16x16x32_bf16 v[48:51], a[8:11], v[164:167], 0
    v_mfma_f32_16x16x32_bf16 v[52:55], a[12:15], v[164:167], 0
    v_mfma_f32_16x16x32_bf16 v[56:59], a[16:19], v[164:167], 0
    v_mfma_f32_16x16x32_bf16 v[40:43], a[20:23], v[168:171], v[40:43]
    v_mfma_f32_16x16x32_bf16 v[44:47], a[24:27], v[168:171], v[44:47]
    buffer_load_dwordx4 v[232:235], v1, s[20:23], s84 offen offset:1024 sc1
    v_mfma_f32_16x16x32_bf16 v[48:51], a[28:31], v[168:171], v[48:51]
    v_mfma_f32_16x16x32_bf16 v[52:55], a[32:35], v[168:171], v[52:55]
    ds_write_b128 v2, v[60:63] offset:21504
    v_mfma_f32_16x16x32_bf16 v[56:59], a[36:39], v[168:171], v[56:59]
    s_waitcnt vmcnt(14)
    v_mfma_f32_16x16x32_bf16 v[40:43], a[40:43], v[172:175], v[40:43]
    v_mfma_f32_16x16x32_bf16 v[44:47], a[44:47], v[172:175], v[44:47]
    s_add_u32 s84, s12, 286720
    buffer_load_dwordx4 v[160:163], v1, s[20:23], s84 offen offset:0 sc1
    v_mfma_f32_16x16x32_bf16 v[48:51], a[48:51], v[172:175], v[48:51]
    ds_write_b128 v2, v[64:67] offset:21568
    v_mfma_f32_16x16x32_bf16 v[52:55], a[52:55], v[172:175], v[52:55]
    v_mfma_f32_16x16x32_bf16 v[56:59], a[56:59], v[172:175], v[56:59]
    v_mfma_f32_16x16x32_bf16 v[40:43], a[60:63], v[176:179], v[40:43]
    ds_write_b128 v2, v[68:71] offset:21632
    v_mfma_f32_16x16x32_bf16 v[44:47], a[64:67], v[176:179], v[44:47]
    buffer_load_dwordx4 v[164:167], v1, s[20:23], s84 offen offset:1024 sc1
    v_mfma_f32_16x16x32_bf16 v[48:51], a[68:71], v[176:179], v[48:51]
    v_mfma_f32_16x16x32_bf16 v[52:55], a[72:75], v[176:179], v[52:55]
    ds_write_b128 v2, v[72:75] offset:21696
    v_mfma_f32_16x16x32_bf16 v[56:59], a[76:79], v[176:179], v[56:59]
    s_waitcnt vmcnt(14)
    v_mfma_f32_16x16x32_bf16 v[40:43], a[80:83], v[180:183], v[40:43]
    v_mfma_f32_16x16x32_bf16 v[44:47], a[84:87], v[180:183], v[44:47]
    s_add_u32 s84, s8, 0
    buffer_load_dwordx4 v[168:171], v1, s[20:23], s84 offen offset:0 sc1
    v_mfma_f32_16x16x32_bf16 v[48:51], a[88:91], v[180:183], v[48:51]
    ds_write_b128 v2, v[76:79] offset:21760
    v_mfma_f32_16x16x32_bf16 v[52:55], a[92:95], v[180:183], v[52:55]
    v_mfma_f32_16x16x32_bf16 v[56:59], a[96:99], v[180:183], v[56:59]
    v_mfma_f32_16x16x32_bf16 v[40:43], a[100:103], v[184:187], v[40:43]
    s_waitcnt lgkmcnt(0)
    s_barrier
    v_mfma_f32_16x16x32_bf16 v[44:47], a[104:107], v[184:187], v[44:47]
    buffer_load_dwordx4 v[172:175], v1, s[20:23], s84 offen offset:1024 sc1
    v_mfma_f32_16x16x32_bf16 v[48:51], a[108:111], v[184:187], v[48:51]
    ds_read_b128 v[80:83], v3 offset:0
    v_mfma_f32_16x16x32_bf16 v[52:55], a[112:115], v[184:187], v[52:55]
    ds_read_b128 v[84:87], v3 offset:5376
    v_mfma_f32_16x16x32_bf16 v[56:59], a[116:119], v[184:187], v[56:59]
    s_waitcnt vmcnt(14)
    v_mfma_f32_16x16x32_bf16 v[40:43], a[120:123], v[188:191], v[40:43]
    ds_read_b128 v[88:91], v3 offset:10752
    v_mfma_f32_16x16x32_bf16 v[44:47], a[124:127], v[188:191], v[44:47]
    s_add_u32 s84, s9, 0
    buffer_load_dwordx4 v[176:179], v1, s[20:23], s84 offen offset:0 sc1
    v_mfma_f32_16x16x32_bf16 v[48:51], a[128:131], v[188:191], v[48:51]
    ds_read_b128 v[92:95], v3 offset:16128
    v_mfma_f32_16x16x32_bf16 v[52:55], a[132:135], v[188:191], v[52:55]
    ds_read_b128 v[96:99], v3 offset:21504
    v_mfma_f32_16x16x32_bf16 v[56:59], a[136:139], v[188:191], v[56:59]
    v_mfma_f32_16x16x32_bf16 v[40:43], a[140:143], v[192:195], v[40:43]
    ds_read_b128 v[100:103], v3 offset:26880
    v_mfma_f32_16x16x32_bf16 v[44:47], a[144:147], v[192:195], v[44:47]
    buffer_load_dwordx4 v[180:183], v1, s[20:23], s84 offen offset:1024 sc1
    v_mfma_f32_16x16x32_bf16 v[48:51], a[148:151], v[192:195], v[48:51]
    ds_read_b128 v[104:107], v3 offset:32256
    v_mfma_f32_16x16x32_bf16 v[52:55], a[152:155], v[192:195], v[52:55]
    ds_read_b128 v[108:111], v3 offset:37632
    v_mfma_f32_16x16x32_bf16 v[56:59], a[156:159], v[192:195], v[56:59]
    s_waitcnt vmcnt(14)
    v_mfma_f32_16x16x32_bf16 v[40:43], a[160:163], v[196:199], v[40:43]
    v_mfma_f32_16x16x32_bf16 v[44:47], a[164:167], v[196:199], v[44:47]
    s_add_u32 s84, s10, 0
    buffer_load_dwordx4 v[184:187], v1, s[20:23], s84 offen offset:0 sc1
    v_mfma_f32_16x16x32_bf16 v[48:51], a[168:171], v[196:199], v[48:51]
    v_mfma_f32_16x16x32_bf16 v[52:55], a[172:175], v[196:199], v[52:55]
    s_waitcnt lgkmcnt(0)
    v_add_f32 v80, v80, v84
    v_mfma_f32_16x16x32_bf16 v[56:59], a[176:179], v[196:199], v[56:59]
    v_mfma_f32_16x16x32_bf16 v[40:43], a[180:183], v[200:203], v[40:43]
    v_add_f32 v81, v81, v85
    v_add_f32 v82, v82, v86
    v_mfma_f32_16x16x32_bf16 v[44:47], a[184:187], v[200:203], v[44:47]
    buffer_load_dwordx4 v[188:191], v1, s[20:23], s84 offen offset:1024 sc1
    v_mfma_f32_16x16x32_bf16 v[48:51], a[188:191], v[200:203], v[48:51]
    v_add_f32 v83, v83, v87
    v_add_f32 v88, v88, v92
    v_mfma_f32_16x16x32_bf16 v[52:55], a[192:195], v[200:203], v[52:55]
    v_add_f32 v89, v89, v93
    v_add_f32 v90, v90, v94
    v_mfma_f32_16x16x32_bf16 v[56:59], a[196:199], v[200:203], v[56:59]
    s_waitcnt vmcnt(14)
    v_mfma_f32_16x16x32_bf16 v[60:63], a[0:3], v[204:207], 0
    v_add_f32 v91, v91, v95
    v_add_f32 v112, v80, v88
    v_mfma_f32_16x16x32_bf16 v[64:67], a[4:7], v[204:207], 0
    s_add_u32 s84, s11, 0
    buffer_load_dwordx4 v[192:195], v1, s[20:23], s84 offen offset:0 sc1
    v_mfma_f32_16x16x32_bf16 v[68:71], a[8:11], v[204:207], 0
    v_add_f32 v113, v81, v89
    v_add_f32 v114, v82, v90
    v_mfma_f32_16x16x32_bf16 v[72:75], a[12:15], v[204:207], 0
    v_add_f32 v115, v83, v91
    v_add_f32 v96, v96, v100
    v_mfma_f32_16x16x32_bf16 v[76:79], a[16:19], v[204:207], 0
    v_mfma_f32_16x16x32_bf16 v[60:63], a[20:23], v[208:211], v[60:63]
    v_add_f32 v97, v97, v101
    v_add_f32 v98, v98, v102
    v_mfma_f32_16x16x32_bf16 v[64:67], a[24:27], v[208:211], v[64:67]
    buffer_load_dwordx4 v[196:199], v1, s[20:23], s84 offen offset:1024 sc1
    v_mfma_f32_16x16x32_bf16 v[68:71], a[28:31], v[208:211], v[68:71]
    v_add_f32 v99, v99, v103
    v_add_f32 v104, v104, v108
    v_mfma_f32_16x16x32_bf16 v[72:75], a[32:35], v[208:211], v[72:75]
    ds_write_b128 v2, v[40:43] offset:43008
    v_add_f32 v105, v105, v109
    v_mfma_f32_16x16x32_bf16 v[76:79], a[36:39], v[208:211], v[76:79]
    s_waitcnt vmcnt(14)
    v_mfma_f32_16x16x32_bf16 v[60:63], a[40:43], v[212:215], v[60:63]
    v_add_f32 v106, v106, v110
    v_add_f32 v107, v107, v111
    v_mfma_f32_16x16x32_bf16 v[64:67], a[44:47], v[212:215], v[64:67]
    s_add_u32 s84, s12, 0
    buffer_load_dwordx4 v[200:203], v1, s[20:23], s84 offen offset:0 sc1
    v_mfma_f32_16x16x32_bf16 v[68:71], a[48:51], v[212:215], v[68:71]
    ds_write_b128 v2, v[44:47] offset:43072
    v_add_f32 v116, v96, v104
    v_mfma_f32_16x16x32_bf16 v[72:75], a[52:55], v[212:215], v[72:75]
    v_add_f32 v117, v97, v105
    v_add_f32 v118, v98, v106
    v_mfma_f32_16x16x32_bf16 v[76:79], a[56:59], v[212:215], v[76:79]
    v_mfma_f32_16x16x32_bf16 v[60:63], a[60:63], v[216:219], v[60:63]
    ds_write_b128 v2, v[48:51] offset:43136
    v_add_f32 v119, v99, v107
    v_mfma_f32_16x16x32_bf16 v[64:67], a[64:67], v[216:219], v[64:67]
    buffer_load_dwordx4 v[204:207], v1, s[20:23], s84 offen offset:1024 sc1
    v_mfma_f32_16x16x32_bf16 v[68:71], a[68:71], v[216:219], v[68:71]
    v_cvt_pk_bf16_f32 v152, v112, v113
    v_cvt_pk_bf16_f32 v153, v114, v115
    v_mfma_f32_16x16x32_bf16 v[72:75], a[72:75], v[216:219], v[72:75]
    ds_write_b128 v2, v[52:55] offset:43200
    v_cvt_pk_bf16_f32 v154, v116, v117
    v_mfma_f32_16x16x32_bf16 v[76:79], a[76:79], v[216:219], v[76:79]
    s_waitcnt vmcnt(14)
    v_mfma_f32_16x16x32_bf16 v[60:63], a[80:83], v[220:223], v[60:63]
    v_cvt_pk_bf16_f32 v155, v118, v118
    v_bfi_b32 v155, s58, v155, v28
    v_mfma_f32_16x16x32_bf16 v[64:67], a[84:87], v[220:223], v[64:67]
    s_add_u32 s84, s8, 40960
    buffer_load_dwordx4 v[208:211], v1, s[20:23], s84 offen offset:0 sc1
    v_mfma_f32_16x16x32_bf16 v[68:71], a[88:91], v[220:223], v[68:71]
    ds_write_b128 v2, v[56:59] offset:43264
    buffer_store_dwordx4 v[152:155], v1, s[20:23], s67 offen offset:0 sc1
    v_mfma_f32_16x16x32_bf16 v[72:75], a[92:95], v[220:223], v[72:75]
    v_mfma_f32_16x16x32_bf16 v[76:79], a[96:99], v[220:223], v[76:79]
    v_mfma_f32_16x16x32_bf16 v[60:63], a[100:103], v[224:227], v[60:63]
    s_waitcnt lgkmcnt(0)
    s_barrier
    v_mfma_f32_16x16x32_bf16 v[64:67], a[104:107], v[224:227], v[64:67]
    buffer_load_dwordx4 v[212:215], v1, s[20:23], s84 offen offset:1024 sc1
    v_mfma_f32_16x16x32_bf16 v[68:71], a[108:111], v[224:227], v[68:71]
    ds_read_b128 v[80:83], v3 offset:43008
    v_mfma_f32_16x16x32_bf16 v[72:75], a[112:115], v[224:227], v[72:75]
    ds_read_b128 v[84:87], v3 offset:48384
    v_mfma_f32_16x16x32_bf16 v[76:79], a[116:119], v[224:227], v[76:79]
    s_waitcnt vmcnt(15)
    v_mfma_f32_16x16x32_bf16 v[60:63], a[120:123], v[228:231], v[60:63]
    ds_read_b128 v[88:91], v3 offset:53760
    v_mfma_f32_16x16x32_bf16 v[64:67], a[124:127], v[228:231], v[64:67]
    s_add_u32 s84, s9, 40960
    buffer_load_dwordx4 v[216:219], v1, s[20:23], s84 offen offset:0 sc1
    v_mfma_f32_16x16x32_bf16 v[68:71], a[128:131], v[228:231], v[68:71]
    ds_read_b128 v[92:95], v3 offset:59136
    v_mfma_f32_16x16x32_bf16 v[72:75], a[132:135], v[228:231], v[72:75]
    v_mfma_f32_16x16x32_bf16 v[76:79], a[136:139], v[228:231], v[76:79]
    v_mfma_f32_16x16x32_bf16 v[60:63], a[140:143], v[232:235], v[60:63]
    v_mfma_f32_16x16x32_bf16 v[64:67], a[144:147], v[232:235], v[64:67]
    buffer_load_dwordx4 v[220:223], v1, s[20:23], s84 offen offset:1024 sc1
    v_mfma_f32_16x16x32_bf16 v[68:71], a[148:151], v[232:235], v[68:71]
    s_waitcnt lgkmcnt(0)
    v_add_f32 v80, v80, v84
    v_mfma_f32_16x16x32_bf16 v[72:75], a[152:155], v[232:235], v[72:75]
    v_add_f32 v81, v81, v85
    v_add_f32 v82, v82, v86
    v_mfma_f32_16x16x32_bf16 v[76:79], a[156:159], v[232:235], v[76:79]
    s_waitcnt vmcnt(15)
    v_mfma_f32_16x16x32_bf16 v[60:63], a[160:163], v[160:163], v[60:63]
    v_add_f32 v83, v83, v87
    v_add_f32 v88, v88, v92
    v_mfma_f32_16x16x32_bf16 v[64:67], a[164:167], v[160:163], v[64:67]
    s_add_u32 s84, s10, 40960
    buffer_load_dwordx4 v[224:227], v1, s[20:23], s84 offen offset:0 sc1
    v_mfma_f32_16x16x32_bf16 v[68:71], a[168:171], v[160:163], v[68:71]
    v_add_f32 v89, v89, v93
    v_add_f32 v90, v90, v94
    v_mfma_f32_16x16x32_bf16 v[72:75], a[172:175], v[160:163], v[72:75]
    v_add_f32 v91, v91, v95
    v_add_f32 v120, v80, v88
    v_mfma_f32_16x16x32_bf16 v[76:79], a[176:179], v[160:163], v[76:79]
    v_mfma_f32_16x16x32_bf16 v[60:63], a[180:183], v[164:167], v[60:63]
    v_add_f32 v121, v81, v89
    v_add_f32 v122, v82, v90
    v_mfma_f32_16x16x32_bf16 v[64:67], a[184:187], v[164:167], v[64:67]
    buffer_load_dwordx4 v[228:231], v1, s[20:23], s84 offen offset:1024 sc1
    v_mfma_f32_16x16x32_bf16 v[68:71], a[188:191], v[164:167], v[68:71]
    v_add_f32 v123, v83, v91
    v_mfma_f32_16x16x32_bf16 v[72:75], a[192:195], v[164:167], v[72:75]
    v_mfma_f32_16x16x32_bf16 v[76:79], a[196:199], v[164:167], v[76:79]
    s_waitcnt vmcnt(15)
    v_mfma_f32_16x16x32_bf16 v[40:43], a[0:3], v[168:171], 0
    v_mfma_f32_16x16x32_bf16 v[44:47], a[4:7], v[168:171], 0
    s_add_u32 s84, s11, 40960
    buffer_load_dwordx4 v[232:235], v1, s[20:23], s84 offen offset:0 sc1
    v_mfma_f32_16x16x32_bf16 v[48:51], a[8:11], v[168:171], 0
    v_mfma_f32_16x16x32_bf16 v[52:55], a[12:15], v[168:171], 0
    v_mfma_f32_16x16x32_bf16 v[56:59], a[16:19], v[168:171], 0
    v_mfma_f32_16x16x32_bf16 v[40:43], a[20:23], v[172:175], v[40:43]
    v_mfma_f32_16x16x32_bf16 v[44:47], a[24:27], v[172:175], v[44:47]
    buffer_load_dwordx4 v[160:163], v1, s[20:23], s84 offen offset:1024 sc1
    v_mfma_f32_16x16x32_bf16 v[48:51], a[28:31], v[172:175], v[48:51]
    v_mfma_f32_16x16x32_bf16 v[52:55], a[32:35], v[172:175], v[52:55]
    v_add_u32 v24, 64512, v2
    v_mfma_f32_16x16x32_bf16 v[56:59], a[36:39], v[172:175], v[56:59]
    s_waitcnt vmcnt(15)
    v_mfma_f32_16x16x32_bf16 v[40:43], a[40:43], v[176:179], v[40:43]
    ds_write_b128 v24, v[60:63] offset:0
    v_mfma_f32_16x16x32_bf16 v[44:47], a[44:47], v[176:179], v[44:47]
    s_add_u32 s84, s12, 40960
    buffer_load_dwordx4 v[164:167], v1, s[20:23], s84 offen offset:0 sc1
    v_mfma_f32_16x16x32_bf16 v[48:51], a[48:51], v[176:179], v[48:51]
    v_mfma_f32_16x16x32_bf16 v[52:55], a[52:55], v[176:179], v[52:55]
    ds_write_b128 v24, v[64:67] offset:64
    v_mfma_f32_16x16x32_bf16 v[56:59], a[56:59], v[176:179], v[56:59]
    v_mfma_f32_16x16x32_bf16 v[40:43], a[60:63], v[180:183], v[40:43]
    v_mfma_f32_16x16x32_bf16 v[44:47], a[64:67], v[180:183], v[44:47]
    buffer_load_dwordx4 v[168:171], v1, s[20:23], s84 offen offset:1024 sc1
    v_mfma_f32_16x16x32_bf16 v[48:51], a[68:71], v[180:183], v[48:51]
    ds_write_b128 v24, v[68:71] offset:128
    v_mfma_f32_16x16x32_bf16 v[52:55], a[72:75], v[180:183], v[52:55]
    v_mfma_f32_16x16x32_bf16 v[56:59], a[76:79], v[180:183], v[56:59]
    s_waitcnt vmcnt(15)
    v_mfma_f32_16x16x32_bf16 v[40:43], a[80:83], v[184:187], v[40:43]
    ds_write_b128 v24, v[72:75] offset:192
    v_mfma_f32_16x16x32_bf16 v[44:47], a[84:87], v[184:187], v[44:47]
    s_add_u32 s84, s8, 81920
    buffer_load_dwordx4 v[172:175], v1, s[20:23], s84 offen offset:0 sc1
    v_mfma_f32_16x16x32_bf16 v[48:51], a[88:91], v[184:187], v[48:51]
    v_mfma_f32_16x16x32_bf16 v[52:55], a[92:95], v[184:187], v[52:55]
    ds_write_b128 v24, v[76:79] offset:256
    v_mfma_f32_16x16x32_bf16 v[56:59], a[96:99], v[184:187], v[56:59]
    v_mfma_f32_16x16x32_bf16 v[40:43], a[100:103], v[188:191], v[40:43]
    v_mfma_f32_16x16x32_bf16 v[44:47], a[104:107], v[188:191], v[44:47]
    buffer_load_dwordx4 v[176:179], v1, s[20:23], s84 offen offset:1024 sc1
    v_mfma_f32_16x16x32_bf16 v[48:51], a[108:111], v[188:191], v[48:51]
    s_waitcnt lgkmcnt(0)
    s_barrier
    v_mfma_f32_16x16x32_bf16 v[52:55], a[112:115], v[188:191], v[52:55]
    v_add_u32 v32, 64512, v3
    v_mfma_f32_16x16x32_bf16 v[56:59], a[116:119], v[188:191], v[56:59]
    s_waitcnt vmcnt(15)
    v_mfma_f32_16x16x32_bf16 v[40:43], a[120:123], v[192:195], v[40:43]
    ds_read_b128 v[80:83], v32 offset:0
    v_mfma_f32_16x16x32_bf16 v[44:47], a[124:127], v[192:195], v[44:47]
    s_add_u32 s84, s9, 81920
    buffer_load_dwordx4 v[180:183], v1, s[20:23], s84 offen offset:0 sc1
    v_mfma_f32_16x16x32_bf16 v[48:51], a[128:131], v[192:195], v[48:51]
    ds_read_b128 v[84:87], v32 offset:5376
    v_mfma_f32_16x16x32_bf16 v[52:55], a[132:135], v[192:195], v[52:55]
    ds_read_b128 v[88:91], v32 offset:10752
    v_mfma_f32_16x16x32_bf16 v[56:59], a[136:139], v[192:195], v[56:59]
    v_mfma_f32_16x16x32_bf16 v[40:43], a[140:143], v[196:199], v[40:43]
    ds_read_b128 v[92:95], v32 offset:16128
    v_mfma_f32_16x16x32_bf16 v[44:47], a[144:147], v[196:199], v[44:47]
    buffer_load_dwordx4 v[184:187], v1, s[20:23], s84 offen offset:1024 sc1
    v_mfma_f32_16x16x32_bf16 v[48:51], a[148:151], v[196:199], v[48:51]
    ds_read_b128 v[96:99], v4 offset:0
    v_mfma_f32_16x16x32_bf16 v[52:55], a[152:155], v[196:199], v[52:55]
    ds_read_b128 v[100:103], v4 offset:5376
    v_mfma_f32_16x16x32_bf16 v[56:59], a[156:159], v[196:199], v[56:59]
    s_waitcnt vmcnt(15)
    v_mfma_f32_16x16x32_bf16 v[40:43], a[160:163], v[200:203], v[40:43]
    ds_read_b128 v[104:107], v4 offset:10752
    v_mfma_f32_16x16x32_bf16 v[44:47], a[164:167], v[200:203], v[44:47]
    s_add_u32 s84, s10, 81920
    buffer_load_dwordx4 v[188:191], v1, s[20:23], s84 offen offset:0 sc1
    v_mfma_f32_16x16x32_bf16 v[48:51], a[168:171], v[200:203], v[48:51]
    ds_read_b128 v[108:111], v4 offset:16128
    v_mfma_f32_16x16x32_bf16 v[52:55], a[172:175], v[200:203], v[52:55]
    v_mfma_f32_16x16x32_bf16 v[56:59], a[176:179], v[200:203], v[56:59]
    v_mfma_f32_16x16x32_bf16 v[40:43], a[180:183], v[204:207], v[40:43]
    v_mfma_f32_16x16x32_bf16 v[44:47], a[184:187], v[204:207], v[44:47]
    buffer_load_dwordx4 v[192:195], v1, s[20:23], s84 offen offset:1024 sc1
    v_mfma_f32_16x16x32_bf16 v[48:51], a[188:191], v[204:207], v[48:51]
    s_waitcnt lgkmcnt(0)
    v_add_f32 v80, v80, v84
    v_mfma_f32_16x16x32_bf16 v[52:55], a[192:195], v[204:207], v[52:55]
    v_add_f32 v81, v81, v85
    v_add_f32 v82, v82, v86
    v_mfma_f32_16x16x32_bf16 v[56:59], a[196:199], v[204:207], v[56:59]
    s_waitcnt vmcnt(14)
    v_mfma_f32_16x16x32_bf16 v[60:63], a[0:3], v[208:211], 0
    v_add_f32 v83, v83, v87
    v_add_f32 v88, v88, v92
    v_mfma_f32_16x16x32_bf16 v[64:67], a[4:7], v[208:211], 0
    s_add_u32 s84, s11, 81920
    buffer_load_dwordx4 v[196:199], v1, s[20:23], s84 offen offset:0 sc1
    v_mfma_f32_16x16x32_bf16 v[68:71], a[8:11], v[208:211], 0
    v_add_f32 v89, v89, v93
    v_add_f32 v90, v90, v94
    v_mfma_f32_16x16x32_bf16 v[72:75], a[12:15], v[208:211], 0
    v_add_f32 v91, v91, v95
    v_add_f32 v124, v80, v88
    v_mfma_f32_16x16x32_bf16 v[76:79], a[16:19], v[208:211], 0
    v_mfma_f32_16x16x32_bf16 v[60:63], a[20:23], v[212:215], v[60:63]
    v_add_f32 v125, v81, v89
    v_add_f32 v126, v82, v90
    v_mfma_f32_16x16x32_bf16 v[64:67], a[24:27], v[212:215], v[64:67]
    buffer_load_dwordx4 v[200:203], v1, s[20:23], s84 offen offset:1024 sc1
    v_mfma_f32_16x16x32_bf16 v[68:71], a[28:31], v[212:215], v[68:71]
    v_add_f32 v127, v83, v91
    v_cvt_pk_bf16_f32 v156, v119, v120
    v_mfma_f32_16x16x32_bf16 v[72:75], a[32:35], v[212:215], v[72:75]
    v_add_u32 v24, 86016, v2
    v_cvt_pk_bf16_f32 v157, v121, v122
    v_mfma_f32_16x16x32_bf16 v[76:79], a[36:39], v[212:215], v[76:79]
    s_waitcnt vmcnt(14)
    v_mfma_f32_16x16x32_bf16 v[60:63], a[40:43], v[216:219], v[60:63]
    ds_write_b128 v24, v[40:43] offset:0
    v_cvt_pk_bf16_f32 v158, v123, v124
    v_mfma_f32_16x16x32_bf16 v[64:67], a[44:47], v[216:219], v[64:67]
    s_add_u32 s84, s12, 81920
    buffer_load_dwordx4 v[204:207], v1, s[20:23], s84 offen offset:0 sc1
    v_mfma_f32_16x16x32_bf16 v[68:71], a[48:51], v[216:219], v[68:71]
    v_cvt_pk_bf16_f32 v159, v125, v125
    v_bfi_b32 v159, s58, v159, v28
    v_mfma_f32_16x16x32_bf16 v[72:75], a[52:55], v[216:219], v[72:75]
    ds_write_b128 v24, v[44:47] offset:64
    buffer_store_dwordx4 v[156:159], v1, s[20:23], s67 offen offset:1024 sc1
    v_mfma_f32_16x16x32_bf16 v[76:79], a[56:59], v[216:219], v[76:79]
    v_mfma_f32_16x16x32_bf16 v[60:63], a[60:63], v[220:223], v[60:63]
    v_add_f32 v96, v96, v100
    v_add_f32 v97, v97, v101
    v_mfma_f32_16x16x32_bf16 v[64:67], a[64:67], v[220:223], v[64:67]
    buffer_load_dwordx4 v[208:211], v1, s[20:23], s84 offen offset:1024 sc1
    v_mfma_f32_16x16x32_bf16 v[68:71], a[68:71], v[220:223], v[68:71]
    ds_write_b128 v24, v[48:51] offset:128
    v_add_f32 v98, v98, v102
    v_mfma_f32_16x16x32_bf16 v[72:75], a[72:75], v[220:223], v[72:75]
    v_add_f32 v99, v99, v103
    v_add_f32 v104, v104, v108
    v_mfma_f32_16x16x32_bf16 v[76:79], a[76:79], v[220:223], v[76:79]
    s_waitcnt vmcnt(15)
    v_mfma_f32_16x16x32_bf16 v[60:63], a[80:83], v[224:227], v[60:63]
    ds_write_b128 v24, v[52:55] offset:192
    v_add_f32 v105, v105, v109
    v_mfma_f32_16x16x32_bf16 v[64:67], a[84:87], v[224:227], v[64:67]
    s_add_u32 s84, s8, 122880
    buffer_load_dwordx4 v[212:215], v1, s[20:23], s84 offen offset:0 sc1
    v_mfma_f32_16x16x32_bf16 v[68:71], a[88:91], v[224:227], v[68:71]
    v_add_f32 v106, v106, v110
    v_add_f32 v107, v107, v111
    v_mfma_f32_16x16x32_bf16 v[72:75], a[92:95], v[224:227], v[72:75]
    ds_write_b128 v24, v[56:59] offset:256
    v_add_f32 v128, v96, v104
    v_mfma_f32_16x16x32_bf16 v[76:79], a[96:99], v[224:227], v[76:79]
    v_mfma_f32_16x16x32_bf16 v[60:63], a[100:103], v[228:231], v[60:63]
    v_add_f32 v129, v97, v105
    v_add_f32 v130, v98, v106
    v_mfma_f32_16x16x32_bf16 v[64:67], a[104:107], v[228:231], v[64:67]
    buffer_load_dwordx4 v[216:219], v1, s[20:23], s84 offen offset:1024 sc1
    v_mfma_f32_16x16x32_bf16 v[68:71], a[108:111], v[228:231], v[68:71]
    v_add_f32 v131, v99, v107
    v_cvt_pk_bf16_f32 v152, v126, v127
    v_mfma_f32_16x16x32_bf16 v[72:75], a[112:115], v[228:231], v[72:75]
    v_cvt_pk_bf16_f32 v153, v128, v129
    v_cvt_pk_bf16_f32 v154, v130, v131
    v_mfma_f32_16x16x32_bf16 v[76:79], a[116:119], v[228:231], v[76:79]
    s_waitcnt vmcnt(15)
    v_mfma_f32_16x16x32_bf16 v[60:63], a[120:123], v[232:235], v[60:63]
    v_mov_b32 v155, v28
    buffer_store_dwordx4 v[152:155], v1, s[20:23], s67 offen offset:2048 sc1
    v_mfma_f32_16x16x32_bf16 v[64:67], a[124:127], v[232:235], v[64:67]
    s_add_u32 s84, s9, 122880
    buffer_load_dwordx4 v[220:223], v1, s[20:23], s84 offen offset:0 sc1
    v_mfma_f32_16x16x32_bf16 v[68:71], a[128:131], v[232:235], v[68:71]
    s_waitcnt lgkmcnt(0)
    s_barrier
    v_mfma_f32_16x16x32_bf16 v[72:75], a[132:135], v[232:235], v[72:75]
    v_add_u32 v32, 86016, v3
    v_mfma_f32_16x16x32_bf16 v[76:79], a[136:139], v[232:235], v[76:79]
    v_mfma_f32_16x16x32_bf16 v[60:63], a[140:143], v[160:163], v[60:63]
    ds_read_b128 v[80:83], v32 offset:0
    v_mfma_f32_16x16x32_bf16 v[64:67], a[144:147], v[160:163], v[64:67]
    buffer_load_dwordx4 v[224:227], v1, s[20:23], s84 offen offset:1024 sc1
    v_mfma_f32_16x16x32_bf16 v[68:71], a[148:151], v[160:163], v[68:71]
    ds_read_b128 v[84:87], v32 offset:5376
    v_mfma_f32_16x16x32_bf16 v[72:75], a[152:155], v[160:163], v[72:75]
    ds_read_b128 v[88:91], v32 offset:10752
    v_mfma_f32_16x16x32_bf16 v[76:79], a[156:159], v[160:163], v[76:79]
    s_waitcnt vmcnt(16)
    v_mfma_f32_16x16x32_bf16 v[60:63], a[160:163], v[164:167], v[60:63]
    ds_read_b128 v[92:95], v32 offset:16128
    v_mfma_f32_16x16x32_bf16 v[64:67], a[164:167], v[164:167], v[64:67]
    s_add_u32 s84, s10, 122880
    buffer_load_dwordx4 v[228:231], v1, s[20:23], s84 offen offset:0 sc1
    v_mfma_f32_16x16x32_bf16 v[68:71], a[168:171], v[164:167], v[68:71]
    v_mfma_f32_16x16x32_bf16 v[72:75], a[172:175], v[164:167], v[72:75]
    v_mfma_f32_16x16x32_bf16 v[76:79], a[176:179], v[164:167], v[76:79]
    v_mfma_f32_16x16x32_bf16 v[60:63], a[180:183], v[168:171], v[60:63]
    s_waitcnt lgkmcnt(0)
    v_add_f32 v80, v80, v84
    v_mfma_f32_16x16x32_bf16 v[64:67], a[184:187], v[168:171], v[64:67]
    buffer_load_dwordx4 v[232:235], v1, s[20:23], s84 offen offset:1024 sc1
    v_mfma_f32_16x16x32_bf16 v[68:71], a[188:191], v[168:171], v[68:71]
    v_add_f32 v81, v81, v85
    v_add_f32 v82, v82, v86
    v_mfma_f32_16x16x32_bf16 v[72:75], a[192:195], v[168:171], v[72:75]
    v_add_f32 v83, v83, v87
    v_add_f32 v88, v88, v92
    v_mfma_f32_16x16x32_bf16 v[76:79], a[196:199], v[168:171], v[76:79]
    s_waitcnt vmcnt(16)
    v_mfma_f32_16x16x32_bf16 v[40:43], a[0:3], v[172:175], 0
    v_add_f32 v89, v89, v93
    v_add_f32 v90, v90, v94
    v_mfma_f32_16x16x32_bf16 v[44:47], a[4:7], v[172:175], 0
    s_add_u32 s84, s11, 122880
    buffer_load_dwordx4 v[160:163], v1, s[20:23], s84 offen offset:0 sc1
    v_mfma_f32_16x16x32_bf16 v[48:51], a[8:11], v[172:175], 0
    v_add_f32 v91, v91, v95
    v_add_f32 v112, v80, v88
    v_mfma_f32_16x16x32_bf16 v[52:55], a[12:15], v[172:175], 0
    v_add_f32 v113, v81, v89
    v_add_f32 v114, v82, v90
    v_mfma_f32_16x16x32_bf16 v[56:59], a[16:19], v[172:175], 0
    v_mfma_f32_16x16x32_bf16 v[40:43], a[20:23], v[176:179], v[40:43]
    v_add_f32 v115, v83, v91
    v_mfma_f32_16x16x32_bf16 v[44:47], a[24:27], v[176:179], v[44:47]
    buffer_load_dwordx4 v[164:167], v1, s[20:23], s84 offen offset:1024 sc1
    v_mfma_f32_16x16x32_bf16 v[48:51], a[28:31], v[176:179], v[48:51]
    v_mfma_f32_16x16x32_bf16 v[52:55], a[32:35], v[176:179], v[52:55]
    v_add_u32 v24, 107520, v2
    v_mfma_f32_16x16x32_bf16 v[56:59], a[36:39], v[176:179], v[56:59]
    s_waitcnt vmcnt(16)
    v_mfma_f32_16x16x32_bf16 v[40:43], a[40:43], v[180:183], v[40:43]
    ds_write_b128 v24, v[60:63] offset:0
    v_mfma_f32_16x16x32_bf16 v[44:47], a[44:47], v[180:183], v[44:47]
    s_add_u32 s84, s12, 122880
    buffer_load_dwordx4 v[168:171], v1, s[20:23], s84 offen offset:0 sc1
    v_mfma_f32_16x16x32_bf16 v[48:51], a[48:51], v[180:183], v[48:51]
    v_mfma_f32_16x16x32_bf16 v[52:55], a[52:55], v[180:183], v[52:55]
    ds_write_b128 v24, v[64:67] offset:64
    v_mfma_f32_16x16x32_bf16 v[56:59], a[56:59], v[180:183], v[56:59]
    v_mfma_f32_16x16x32_bf16 v[40:43], a[60:63], v[184:187], v[40:43]
    v_mfma_f32_16x16x32_bf16 v[44:47], a[64:67], v[184:187], v[44:47]
    buffer_load_dwordx4 v[172:175], v1, s[20:23], s84 offen offset:1024 sc1
    v_mfma_f32_16x16x32_bf16 v[48:51], a[68:71], v[184:187], v[48:51]
    ds_write_b128 v24, v[68:71] offset:128
    v_mfma_f32_16x16x32_bf16 v[52:55], a[72:75], v[184:187], v[52:55]
    v_mfma_f32_16x16x32_bf16 v[56:59], a[76:79], v[184:187], v[56:59]
    s_waitcnt vmcnt(16)
    v_mfma_f32_16x16x32_bf16 v[40:43], a[80:83], v[188:191], v[40:43]
    ds_write_b128 v24, v[72:75] offset:192
    v_mfma_f32_16x16x32_bf16 v[44:47], a[84:87], v[188:191], v[44:47]
    v_mfma_f32_16x16x32_bf16 v[48:51], a[88:91], v[188:191], v[48:51]
    v_mfma_f32_16x16x32_bf16 v[52:55], a[92:95], v[188:191], v[52:55]
    ds_write_b128 v24, v[76:79] offset:256
    v_mfma_f32_16x16x32_bf16 v[56:59], a[96:99], v[188:191], v[56:59]
    v_mfma_f32_16x16x32_bf16 v[40:43], a[100:103], v[192:195], v[40:43]
    buffer_load_dwordx4 v[140:143], v1, s[20:23], s83 offen offset:0 sc1
    v_mfma_f32_16x16x32_bf16 v[44:47], a[104:107], v[192:195], v[44:47]
    s_waitcnt lgkmcnt(0)
    s_barrier
    v_mfma_f32_16x16x32_bf16 v[48:51], a[108:111], v[192:195], v[48:51]
    v_add_u32 v32, 107520, v3
    v_mfma_f32_16x16x32_bf16 v[52:55], a[112:115], v[192:195], v[52:55]
    ds_read_b128 v[80:83], v32 offset:0
    v_mfma_f32_16x16x32_bf16 v[56:59], a[116:119], v[192:195], v[56:59]
    ds_read_b128 v[84:87], v32 offset:5376
    s_waitcnt vmcnt(15)
    v_mfma_f32_16x16x32_bf16 v[40:43], a[120:123], v[196:199], v[40:43]
    ds_read_b128 v[88:91], v32 offset:10752
    v_mfma_f32_16x16x32_bf16 v[44:47], a[124:127], v[196:199], v[44:47]
    ds_read_b128 v[92:95], v32 offset:16128
    v_mfma_f32_16x16x32_bf16 v[48:51], a[128:131], v[196:199], v[48:51]
    buffer_load_dwordx4 v[144:147], v1, s[20:23], s83 offen offset:1024 sc1
    v_mfma_f32_16x16x32_bf16 v[52:55], a[132:135], v[196:199], v[52:55]
    buffer_load_dwordx4 v[148:151], v1, s[20:23], s83 offen offset:2048 sc1
    v_mfma_f32_16x16x32_bf16 v[56:59], a[136:139], v[196:199], v[56:59]
    v_mfma_f32_16x16x32_bf16 v[40:43], a[140:143], v[200:203], v[40:43]
    v_mfma_f32_16x16x32_bf16 v[44:47], a[144:147], v[200:203], v[44:47]
    s_waitcnt lgkmcnt(0)
    v_mfma_f32_16x16x32_bf16 v[48:51], a[148:151], v[200:203], v[48:51]
    v_add_f32 v80, v80, v84
    v_add_f32 v81, v81, v85
    v_mfma_f32_16x16x32_bf16 v[52:55], a[152:155], v[200:203], v[52:55]
    v_add_f32 v82, v82, v86
    v_add_f32 v83, v83, v87
    v_mfma_f32_16x16x32_bf16 v[56:59], a[156:159], v[200:203], v[56:59]
    v_add_f32 v88, v88, v92
    s_waitcnt vmcnt(14)
    v_mfma_f32_16x16x32_bf16 v[40:43], a[160:163], v[204:207], v[40:43]
    v_add_f32 v89, v89, v93
    v_add_f32 v90, v90, v94
    v_mfma_f32_16x16x32_bf16 v[44:47], a[164:167], v[204:207], v[44:47]
    v_add_f32 v91, v91, v95
    v_mfma_f32_16x16x32_bf16 v[48:51], a[168:171], v[204:207], v[48:51]
    v_add_f32 v116, v80, v88
    v_add_f32 v117, v81, v89
    v_mfma_f32_16x16x32_bf16 v[52:55], a[172:175], v[204:207], v[52:55]
    v_add_f32 v118, v82, v90
    v_add_f32 v119, v83, v91
    v_mfma_f32_16x16x32_bf16 v[56:59], a[176:179], v[204:207], v[56:59]
    v_mfma_f32_16x16x32_bf16 v[40:43], a[180:183], v[208:211], v[40:43]
    v_mfma_f32_16x16x32_bf16 v[44:47], a[184:187], v[208:211], v[44:47]
    v_mfma_f32_16x16x32_bf16 v[48:51], a[188:191], v[208:211], v[48:51]
    v_mfma_f32_16x16x32_bf16 v[52:55], a[192:195], v[208:211], v[52:55]
    v_mfma_f32_16x16x32_bf16 v[56:59], a[196:199], v[208:211], v[56:59]
    s_waitcnt vmcnt(12)
    v_mfma_f32_16x16x32_bf16 v[60:63], a[0:3], v[212:215], 0
    v_mfma_f32_16x16x32_bf16 v[64:67], a[4:7], v[212:215], 0
    v_mfma_f32_16x16x32_bf16 v[68:71], a[8:11], v[212:215], 0
    v_mfma_f32_16x16x32_bf16 v[72:75], a[12:15], v[212:215], 0
    v_mfma_f32_16x16x32_bf16 v[76:79], a[16:19], v[212:215], 0
    v_mfma_f32_16x16x32_bf16 v[60:63], a[20:23], v[216:219], v[60:63]
    v_mfma_f32_16x16x32_bf16 v[64:67], a[24:27], v[216:219], v[64:67]
    v_mfma_f32_16x16x32_bf16 v[68:71], a[28:31], v[216:219], v[68:71]
    v_mfma_f32_16x16x32_bf16 v[72:75], a[32:35], v[216:219], v[72:75]
    ds_write_b128 v2, v[40:43] offset:0
    v_mfma_f32_16x16x32_bf16 v[76:79], a[36:39], v[216:219], v[76:79]
    s_waitcnt vmcnt(9)
    v_mfma_f32_16x16x32_bf16 v[60:63], a[40:43], v[220:223], v[60:63]
    v_mfma_f32_16x16x32_bf16 v[64:67], a[44:47], v[220:223], v[64:67]
    ds_write_b128 v2, v[44:47] offset:64
    v_mfma_f32_16x16x32_bf16 v[68:71], a[48:51], v[220:223], v[68:71]
    v_mfma_f32_16x16x32_bf16 v[72:75], a[52:55], v[220:223], v[72:75]
    v_mfma_f32_16x16x32_bf16 v[76:79], a[56:59], v[220:223], v[76:79]
    ds_write_b128 v2, v[48:51] offset:128
    v_mfma_f32_16x16x32_bf16 v[60:63], a[60:63], v[224:227], v[60:63]
    v_mfma_f32_16x16x32_bf16 v[64:67], a[64:67], v[224:227], v[64:67]
    v_mfma_f32_16x16x32_bf16 v[68:71], a[68:71], v[224:227], v[68:71]
    ds_write_b128 v2, v[52:55] offset:192
    v_mfma_f32_16x16x32_bf16 v[72:75], a[72:75], v[224:227], v[72:75]
    v_mfma_f32_16x16x32_bf16 v[76:79], a[76:79], v[224:227], v[76:79]
    s_waitcnt vmcnt(7)
    v_mfma_f32_16x16x32_bf16 v[60:63], a[80:83], v[228:231], v[60:63]
    ds_write_b128 v2, v[56:59] offset:256
    v_mfma_f32_16x16x32_bf16 v[64:67], a[84:87], v[228:231], v[64:67]
    v_mfma_f32_16x16x32_bf16 v[68:71], a[88:91], v[228:231], v[68:71]
    v_mfma_f32_16x16x32_bf16 v[72:75], a[92:95], v[228:231], v[72:75]
    v_mfma_f32_16x16x32_bf16 v[76:79], a[96:99], v[228:231], v[76:79]
    v_mfma_f32_16x16x32_bf16 v[60:63], a[100:103], v[232:235], v[60:63]
    s_waitcnt lgkmcnt(0)
    s_barrier
    v_mfma_f32_16x16x32_bf16 v[64:67], a[104:107], v[232:235], v[64:67]
    ds_read_b128 v[80:83], v3 offset:0
    v_mfma_f32_16x16x32_bf16 v[68:71], a[108:111], v[232:235], v[68:71]
    ds_read_b128 v[84:87], v3 offset:5376
    v_mfma_f32_16x16x32_bf16 v[72:75], a[112:115], v[232:235], v[72:75]
    ds_read_b128 v[88:91], v3 offset:10752
    v_mfma_f32_16x16x32_bf16 v[76:79], a[116:119], v[232:235], v[76:79]
    ds_read_b128 v[92:95], v3 offset:16128
    s_waitcnt vmcnt(3)
    v_mfma_f32_16x16x32_bf16 v[60:63], a[120:123], v[160:163], v[60:63]
    v_mfma_f32_16x16x32_bf16 v[60:63], a[140:143], v[164:167], v[60:63]
    v_mfma_f32_16x16x32_bf16 v[60:63], a[160:163], v[168:171], v[60:63]
    v_mfma_f32_16x16x32_bf16 v[60:63], a[180:183], v[172:175], v[60:63]
    s_waitcnt vmcnt(0)
    v_xor_b32 v26, v143, v28
    v_mfma_f32_16x16x32_bf16 v[64:67], a[124:127], v[160:163], v[64:67]
    s_waitcnt lgkmcnt(0)
    v_mfma_f32_16x16x32_bf16 v[64:67], a[144:147], v[164:167], v[64:67]
    v_add_f32 v80, v80, v84
    v_add_f32 v81, v81, v85
    v_mfma_f32_16x16x32_bf16 v[64:67], a[164:167], v[168:171], v[64:67]
    v_add_f32 v82, v82, v86
    v_mfma_f32_16x16x32_bf16 v[64:67], a[184:187], v[172:175], v[64:67]
    v_add_f32 v83, v83, v87
    v_add_f32 v88, v88, v92
    v_mfma_f32_16x16x32_bf16 v[68:71], a[128:131], v[160:163], v[68:71]
    v_add_f32 v89, v89, v93
    v_add_f32 v90, v90, v94
    v_mfma_f32_16x16x32_bf16 v[68:71], a[148:151], v[164:167], v[68:71]
    v_add_f32 v91, v91, v95
    v_mfma_f32_16x16x32_bf16 v[68:71], a[168:171], v[168:171], v[68:71]
    v_add_f32 v120, v80, v88
    v_add_f32 v121, v81, v89
    v_mfma_f32_16x16x32_bf16 v[68:71], a[188:191], v[172:175], v[68:71]
    v_add_f32 v122, v82, v90
    ds_write_b128 v2, v[60:63] offset:21504
    v_mfma_f32_16x16x32_bf16 v[72:75], a[132:135], v[160:163], v[72:75]
    v_add_f32 v123, v83, v91
    v_bitop3_b32 v26, v26, v147, v28 bitop3:0xf6
    v_mfma_f32_16x16x32_bf16 v[72:75], a[152:155], v[164:167], v[72:75]
    v_bitop3_b32 v26, v26, v151, v28 bitop3:0xf6
    v_cmp_lt_u32 vcc, s58, v26
    v_mfma_f32_16x16x32_bf16 v[72:75], a[172:175], v[168:171], v[72:75]
    s_cmp_lg_u64 vcc, 0
    s_cbranch_scc1 L_xslow31
L_xok31:
    v_mfma_f32_16x16x32_bf16 v[72:75], a[192:195], v[172:175], v[72:75]
    v_and_b32 v22, 0xffff0000, v12
    v_lshlrev_b32 v18, 16, v140
    ds_write_b128 v2, v[64:67] offset:21568
    v_mfma_f32_16x16x32_bf16 v[76:79], a[136:139], v[160:163], v[76:79]
    v_and_b32 v19, 0xffff0000, v140
    v_mfma_f32_16x16x32_bf16 v[76:79], a[156:159], v[164:167], v[76:79]
    v_lshlrev_b32 v20, 16, v141
    v_and_b32 v21, 0xffff0000, v141
    v_mfma_f32_16x16x32_bf16 v[76:79], a[176:179], v[168:171], v[76:79]
    v_fmac_f32 v236, v22, v18
    v_fmac_f32 v237, v22, v19
    v_mfma_f32_16x16x32_bf16 v[76:79], a[196:199], v[172:175], v[76:79]
    v_fmac_f32 v238, v22, v20
    v_fmac_f32 v239, v22, v21
    v_lshlrev_b32 v23, 16, v12
    v_fmac_f32 v236, v23, v112
    v_fmac_f32 v237, v23, v113
    v_fmac_f32 v238, v23, v114
    v_fmac_f32 v239, v23, v115
    s_add_u32 s85, s94, 0
    buffer_store_dwordx4 v[236:239], v6, s[24:27], s85 offen nt
    v_and_b32 v22, 0xffff0000, v13
    v_lshlrev_b32 v18, 16, v142
    v_and_b32 v19, 0xffff0000, v142
    v_lshlrev_b32 v20, 16, v143
    v_lshlrev_b32 v21, 16, v144
    v_fmac_f32 v240, v22, v18
    v_fmac_f32 v241, v22, v19
    v_fmac_f32 v242, v22, v20
    v_fmac_f32 v243, v22, v21
    v_lshlrev_b32 v23, 16, v13
    v_fmac_f32 v240, v23, v116
    v_fmac_f32 v241, v23, v117
    v_fmac_f32 v242, v23, v118
    v_fmac_f32 v243, v23, v119
    s_add_u32 s85, s94, 10240
    buffer_store_dwordx4 v[240:243], v6, s[24:27], s85 offen nt
    v_and_b32 v22, 0xffff0000, v14
    v_and_b32 v18, 0xffff0000, v144
    v_lshlrev_b32 v19, 16, v145
    v_and_b32 v20, 0xffff0000, v145
    v_lshlrev_b32 v21, 16, v146
    v_fmac_f32 v244, v22, v18
    v_fmac_f32 v245, v22, v19
    v_fmac_f32 v246, v22, v20
    v_fmac_f32 v247, v22, v21
    v_and_b32 v22, 0xffff0000, v15
    v_and_b32 v18, 0xffff0000, v146
    v_lshlrev_b32 v19, 16, v147
    v_lshlrev_b32 v20, 16, v148
    v_and_b32 v21, 0xffff0000, v148
    v_fmac_f32 v248, v22, v18
    v_fmac_f32 v249, v22, v19
    v_fmac_f32 v250, v22, v20
    v_fmac_f32 v251, v22, v21
    v_and_b32 v22, 0xffff0000, v16
    v_lshlrev_b32 v18, 16, v149
    v_and_b32 v19, 0xffff0000, v149
    v_lshlrev_b32 v20, 16, v150
    v_and_b32 v21, 0xffff0000, v150
    v_fmac_f32 v136, v22, v18
    v_fmac_f32 v137, v22, v19
    v_fmac_f32 v138, v22, v20
    v_fmac_f32 v139, v22, v21
    v_lshlrev_b32 v23, 16, v14
    v_fmac_f32 v244, v23, v120
    v_fmac_f32 v245, v23, v121
    v_fmac_f32 v246, v23, v122
    v_fmac_f32 v247, v23, v123
    s_add_u32 s85, s94, 20480
    buffer_store_dwordx4 v[244:247], v6, s[24:27], s85 offen nt
    ds_write_b128 v2, v[68:71] offset:21632
    ds_write_b128 v2, v[72:75] offset:21696
    ds_write_b128 v2, v[76:79] offset:21760
    s_waitcnt lgkmcnt(0)
    s_barrier
    ds_read_b128 v[80:83], v3 offset:21504
    ds_read_b128 v[84:87], v3 offset:26880
    ds_read_b128 v[88:91], v3 offset:32256
    ds_read_b128 v[92:95], v3 offset:37632
    ds_read_b128 v[96:99], v5 offset:0
    ds_read_b128 v[100:103], v5 offset:5376
    ds_read_b128 v[104:107], v5 offset:10752
    ds_read_b128 v[108:111], v5 offset:16128
    v_lshlrev_b32 v23, 16, v15
    s_waitcnt lgkmcnt(4)
    v_pk_add_f32 v[80:81], v[80:81], v[84:85]
    v_pk_add_f32 v[82:83], v[82:83], v[86:87]
    v_pk_add_f32 v[88:89], v[88:89], v[92:93]
    v_pk_add_f32 v[90:91], v[90:91], v[94:95]
    v_pk_add_f32 v[124:125], v[80:81], v[88:89]
    v_pk_add_f32 v[126:127], v[82:83], v[90:91]
    v_fmac_f32 v248, v23, v124
    v_fmac_f32 v249, v23, v125
    v_fmac_f32 v250, v23, v126
    v_fmac_f32 v251, v23, v127
    s_add_u32 s85, s94, 30720
    buffer_store_dwordx4 v[248:251], v6, s[24:27], s85 offen nt
    v_lshlrev_b32 v23, 16, v16
    s_waitcnt lgkmcnt(0)
    v_pk_add_f32 v[96:97], v[96:97], v[100:101]
    v_pk_add_f32 v[98:99], v[98:99], v[102:103]
    v_pk_add_f32 v[104:105], v[104:105], v[108:109]
    v_pk_add_f32 v[106:107], v[106:107], v[110:111]
    v_pk_add_f32 v[128:129], v[96:97], v[104:105]
    v_pk_add_f32 v[130:131], v[98:99], v[106:107]
    v_fmac_f32 v136, v23, v128
    v_fmac_f32 v137, v23, v129
    v_fmac_f32 v138, v23, v130
    v_fmac_f32 v139, v23, v131
    buffer_store_dwordx4 v[136:139], v7, s[24:27], s94 offen nt
    s_branch L_fin
L_roleQ:
    s_mul_i32 s85, s88, 0x9e3779b1
    v_and_b32 v29, 1, v0
    v_lshlrev_b32 v29, 4, v29
    v_lshlrev_b32 v28, v29, s85
    v_and_b32 v28, 0xffff0000, v28
    v_lshrrev_b32 v10, 8, v9
    v_lshlrev_b32 v10, 4, v10
    v_lshrrev_b32 v11, 4, v0
    v_lshl_add_u32 v11, v11, 2, 48
    v_cmp_ne_u32 vcc, s88, v26
    v_cmp_ne_u32 s[96:97], s88, v27
    s_nop 1
    s_or_b64 vcc, vcc, s[96:97]
    s_cbranch_scc1 L_pslow32
L_pok32:
    s_add_u32 s84, s8, 0
    buffer_load_dwordx4 v[160:163], v1, s[20:23], s84 offen offset:0 sc1
    buffer_load_dwordx4 v[164:167], v1, s[20:23], s84 offen offset:1024 sc1
    s_add_u32 s84, s9, 0
    buffer_load_dwordx4 v[168:171], v1, s[20:23], s84 offen offset:0 sc1
    buffer_load_dwordx4 v[172:175], v1, s[20:23], s84 offen offset:1024 sc1
    s_add_u32 s84, s10, 0
    buffer_load_dwordx4 v[176:179], v1, s[20:23], s84 offen offset:0 sc1
    buffer_load_dwordx4 v[180:183], v1, s[20:23], s84 offen offset:1024 sc1
    s_add_u32 s84, s11, 0
    buffer_load_dwordx4 v[184:187], v1, s[20:23], s84 offen offset:0 sc1
    buffer_load_dwordx4 v[188:191], v1, s[20:23], s84 offen offset:1024 sc1
    s_add_u32 s84, s12, 0
    buffer_load_dwordx4 v[192:195], v1, s[20:23], s84 offen offset:0 sc1
    buffer_load_dwordx4 v[196:199], v1, s[20:23], s84 offen offset:1024 sc1
    s_add_u32 s84, s13, 0
    buffer_load_dwordx4 v[200:203], v1, s[20:23], s84 offen offset:0 sc1
    buffer_load_dwordx4 v[204:207], v1, s[20:23], s84 offen offset:1024 sc1
    s_add_u32 s84, s8, 49152
    buffer_load_dwordx4 v[208:211], v1, s[20:23], s84 offen offset:0 sc1
    buffer_load_dwordx4 v[212:215], v1, s[20:23], s84 offen offset:1024 sc1
    s_add_u32 s84, s9, 49152
    buffer_load_dwordx4 v[216:219], v1, s[20:23], s84 offen offset:0 sc1
    buffer_load_dwordx4 v[220:223], v1, s[20:23], s84 offen offset:1024 sc1
    s_waitcnt lgkmcnt(0)
    s_waitcnt vmcnt(14)
    v_mfma_f32_16x16x32_bf16 v[40:43], a[0:3], v[160:163], 0
    v_mfma_f32_16x16x32_bf16 v[44:47], a[4:7], v[160:163], 0
    s_add_u32 s84, s10, 49152
    buffer_load_dwordx4 v[224:227], v1, s[20:23], s84 offen offset:0 sc1
    v_mfma_f32_16x16x32_bf16 v[48:51], a[8:11], v[160:163], 0
    buffer_load_dwordx4 v[12:15], v10, s[20:23], s95 offen sc1
    v_mfma_f32_16x16x32_bf16 v[52:55], a[12:15], v[160:163], 0
    buffer_load_dword v16, v11, s[20:23], s95 offen sc1
    v_mfma_f32_16x16x32_bf16 v[56:59], a[16:19], v[160:163], 0
    v_mfma_f32_16x16x32_bf16 v[40:43], a[20:23], v[164:167], v[40:43]
    v_mfma_f32_16x16x32_bf16 v[44:47], a[24:27], v[164:167], v[44:47]
    buffer_load_dwordx4 v[228:231], v1, s[20:23], s84 offen offset:1024 sc1
    v_mfma_f32_16x16x32_bf16 v[48:51], a[28:31], v[164:167], v[48:51]
    v_mfma_f32_16x16x32_bf16 v[52:55], a[32:35], v[164:167], v[52:55]
    v_mfma_f32_16x16x32_bf16 v[56:59], a[36:39], v[164:167], v[56:59]
    s_waitcnt vmcnt(16)
    v_mfma_f32_16x16x32_bf16 v[40:43], a[40:43], v[168:171], v[40:43]
    v_accvgpr_read_b32 v18, a250
    v_lshlrev_b32 v132, 16, v18
    v_mfma_f32_16x16x32_bf16 v[44:47], a[44:47], v[168:171], v[44:47]
    s_add_u32 s84, s11, 49152
    buffer_load_dwordx4 v[232:235], v1, s[20:23], s84 offen offset:0 sc1
    v_mfma_f32_16x16x32_bf16 v[48:51], a[48:51], v[168:171], v[48:51]
    v_and_b32 v133, 0xffff0000, v18
    v_accvgpr_read_b32 v18, a251
    v_mfma_f32_16x16x32_bf16 v[52:55], a[52:55], v[168:171], v[52:55]
    v_lshlrev_b32 v134, 16, v18
    v_and_b32 v135, 0xffff0000, v18
    v_mfma_f32_16x16x32_bf16 v[56:59], a[56:59], v[168:171], v[56:59]
    v_mfma_f32_16x16x32_bf16 v[40:43], a[60:63], v[172:175], v[40:43]
    v_accvgpr_read_b32 v18, a252
    v_lshlrev_b32 v136, 16, v18
    v_mfma_f32_16x16x32_bf16 v[44:47], a[64:67], v[172:175], v[44:47]
    buffer_load_dwordx4 v[160:163], v1, s[20:23], s84 offen offset:1024 sc1
    v_mfma_f32_16x16x32_bf16 v[48:51], a[68:71], v[172:175], v[48:51]
    v_and_b32 v137, 0xffff0000, v18
    v_accvgpr_read_b32 v18, a253
    v_mfma_f32_16x16x32_bf16 v[52:55], a[72:75], v[172:175], v[52:55]
    v_lshlrev_b32 v138, 16, v18
    v_and_b32 v139, 0xffff0000, v18
    v_mfma_f32_16x16x32_bf16 v[56:59], a[76:79], v[172:175], v[56:59]
    s_waitcnt vmcnt(16)
    v_mfma_f32_16x16x32_bf16 v[40:43], a[80:83], v[176:179], v[40:43]
    v_mfma_f32_16x16x32_bf16 v[44:47], a[84:87], v[176:179], v[44:47]
    s_add_u32 s84, s12, 49152
    buffer_load_dwordx4 v[164:167], v1, s[20:23], s84 offen offset:0 sc1
    v_mfma_f32_16x16x32_bf16 v[48:51], a[88:91], v[176:179], v[48:51]
    v_mfma_f32_16x16x32_bf16 v[52:55], a[92:95], v[176:179], v[52:55]
    v_mfma_f32_16x16x32_bf16 v[56:59], a[96:99], v[176:179], v[56:59]
    v_mfma_f32_16x16x32_bf16 v[40:43], a[100:103], v[180:183], v[40:43]
    v_mfma_f32_16x16x32_bf16 v[44:47], a[104:107], v[180:183], v[44:47]
    buffer_load_dwordx4 v[168:171], v1, s[20:23], s84 offen offset:1024 sc1
    v_mfma_f32_16x16x32_bf16 v[48:51], a[108:111], v[180:183], v[48:51]
    v_mfma_f32_16x16x32_bf16 v[52:55], a[112:115], v[180:183], v[52:55]
    v_mfma_f32_16x16x32_bf16 v[56:59], a[116:119], v[180:183], v[56:59]
    s_waitcnt vmcnt(16)
    v_mfma_f32_16x16x32_bf16 v[40:43], a[120:123], v[184:187], v[40:43]
    s_waitcnt vmcnt(5)
    v_accvgpr_read_b32 v18, a240
    v_mfma_f32_16x16x32_bf16 v[44:47], a[124:127], v[184:187], v[44:47]
    s_add_u32 s84, s13, 49152
    buffer_load_dwordx4 v[172:175], v1, s[20:23], s84 offen offset:0 sc1
    v_mfma_f32_16x16x32_bf16 v[48:51], a[128:131], v[184:187], v[48:51]
    v_accvgpr_read_b32 v20, a241
    v_and_b32 v19, 0xffff0000, v18
    v_mfma_f32_16x16x32_bf16 v[52:55], a[132:135], v[184:187], v[52:55]
    v_lshlrev_b32 v18, 16, v18
    v_and_b32 v21, 0xffff0000, v20
    v_mfma_f32_16x16x32_bf16 v[56:59], a[136:139], v[184:187], v[56:59]
    v_mfma_f32_16x16x32_bf16 v[40:43], a[140:143], v[188:191], v[40:43]
    v_lshlrev_b32 v20, 16, v20
    v_lshlrev_b32 v22, 16, v12
    v_mfma_f32_16x16x32_bf16 v[44:47], a[144:147], v[188:191], v[44:47]
    buffer_load_dwordx4 v[176:179], v1, s[20:23], s84 offen offset:1024 sc1
    v_mfma_f32_16x16x32_bf16 v[48:51], a[148:151], v[188:191], v[48:51]
    v_mul_f32 v236, v18, v132
    v_mul_f32 v237, v19, v133
    v_mfma_f32_16x16x32_bf16 v[52:55], a[152:155], v[188:191], v[52:55]
    v_mul_f32 v238, v20, v134
    v_mul_f32 v239, v21, v135
    v_mfma_f32_16x16x32_bf16 v[56:59], a[156:159], v[188:191], v[56:59]
    v_mfma_f32_16x16x32_bf16 v[40:43], a[160:163], v[192:195], v[40:43]
    s_barrier
    v_mul_f32 v236, v22, v236
    v_mfma_f32_16x16x32_bf16 v[44:47], a[164:167], v[192:195], v[44:47]
    s_add_u32 s84, s8, 98304
    buffer_load_dwordx4 v[180:183], v1, s[20:23], s84 offen offset:0 sc1
    v_mfma_f32_16x16x32_bf16 v[48:51], a[168:171], v[192:195], v[48:51]
    v_mul_f32 v237, v22, v237
    v_mul_f32 v238, v22, v238
    v_mfma_f32_16x16x32_bf16 v[52:55], a[172:175], v[192:195], v[52:55]
    v_mul_f32 v239, v22, v239
    v_accvgpr_read_b32 v18, a242
    v_mfma_f32_16x16x32_bf16 v[56:59], a[176:179], v[192:195], v[56:59]
    v_mfma_f32_16x16x32_bf16 v[40:43], a[180:183], v[196:199], v[40:43]
    v_accvgpr_read_b32 v20, a243
    v_and_b32 v19, 0xffff0000, v18
    v_mfma_f32_16x16x32_bf16 v[44:47], a[184:187], v[196:199], v[44:47]
    buffer_load_dwordx4 v[184:187], v1, s[20:23], s84 offen offset:1024 sc1
    v_mfma_f32_16x16x32_bf16 v[48:51], a[188:191], v[196:199], v[48:51]
    v_lshlrev_b32 v18, 16, v18
    v_and_b32 v21, 0xffff0000, v20
    v_mfma_f32_16x16x32_bf16 v[52:55], a[192:195], v[196:199], v[52:55]
    v_lshlrev_b32 v20, 16, v20
    v_lshlrev_b32 v22, 16, v13
    v_mfma_f32_16x16x32_bf16 v[56:59], a[196:199], v[196:199], v[56:59]
    v_mfma_f32_16x16x32_bf16 v[40:43], a[200:203], v[200:203], v[40:43]
    v_mul_f32 v240, v18, v132
    v_mul_f32 v241, v19, v133
    v_mfma_f32_16x16x32_bf16 v[44:47], a[204:207], v[200:203], v[44:47]
    s_add_u32 s84, s9, 98304
    buffer_load_dwordx4 v[188:191], v1, s[20:23], s84 offen offset:0 sc1
    v_mfma_f32_16x16x32_bf16 v[48:51], a[208:211], v[200:203], v[48:51]
    v_mul_f32 v242, v20, v134
    v_mul_f32 v243, v21, v135
    v_mfma_f32_16x16x32_bf16 v[52:55], a[212:215], v[200:203], v[52:55]
    v_mul_f32 v240, v22, v240
    v_mul_f32 v241, v22, v241
    v_mfma_f32_16x16x32_bf16 v[56:59], a[216:219], v[200:203], v[56:59]
    v_mfma_f32_16x16x32_bf16 v[40:43], a[220:223], v[204:207], v[40:43]
    v_mul_f32 v242, v22, v242
    v_mul_f32 v243, v22, v243
    v_mfma_f32_16x16x32_bf16 v[44:47], a[224:227], v[204:207], v[44:47]
    buffer_load_dwordx4 v[192:195], v1, s[20:23], s84 offen offset:1024 sc1
    v_mfma_f32_16x16x32_bf16 v[48:51], a[228:231], v[204:207], v[48:51]
    v_accvgpr_read_b32 v18, a244
    v_accvgpr_read_b32 v20, a245
    v_mfma_f32_16x16x32_bf16 v[52:55], a[232:235], v[204:207], v[52:55]
    v_and_b32 v19, 0xffff0000, v18
    v_lshlrev_b32 v18, 16, v18
    v_mfma_f32_16x16x32_bf16 v[56:59], a[236:239], v[204:207], v[56:59]
    v_mfma_f32_16x16x32_bf16 v[60:63], a[0:3], v[208:211], 0
    v_and_b32 v21, 0xffff0000, v20
    v_lshlrev_b32 v20, 16, v20
    v_mfma_f32_16x16x32_bf16 v[64:67], a[4:7], v[208:211], 0
    s_add_u32 s84, s10, 98304
    buffer_load_dwordx4 v[196:199], v1, s[20:23], s84 offen offset:0 sc1
    v_mfma_f32_16x16x32_bf16 v[68:71], a[8:11], v[208:211], 0
    v_lshlrev_b32 v22, 16, v14
    v_mul_f32 v244, v18, v132
    v_mfma_f32_16x16x32_bf16 v[72:75], a[12:15], v[208:211], 0
    v_mul_f32 v245, v19, v133
    v_mul_f32 v246, v20, v134
    v_mfma_f32_16x16x32_bf16 v[76:79], a[16:19], v[208:211], 0
    v_mfma_f32_16x16x32_bf16 v[60:63], a[20:23], v[212:215], v[60:63]
    v_mul_f32 v247, v21, v135
    v_mul_f32 v244, v22, v244
    v_mfma_f32_16x16x32_bf16 v[64:67], a[24:27], v[212:215], v[64:67]
    buffer_load_dwordx4 v[200:203], v1, s[20:23], s84 offen offset:1024 sc1
    v_mfma_f32_16x16x32_bf16 v[68:71], a[28:31], v[212:215], v[68:71]
    v_mul_f32 v245, v22, v245
    v_mul_f32 v246, v22, v246
    v_mfma_f32_16x16x32_bf16 v[72:75], a[32:35], v[212:215], v[72:75]
    ds_write_b128 v2, v[40:43] offset:0
    v_mul_f32 v247, v22, v247
    v_mfma_f32_16x16x32_bf16 v[76:79], a[36:39], v[212:215], v[76:79]
    v_mfma_f32_16x16x32_bf16 v[60:63], a[40:43], v[216:219], v[60:63]
    v_accvgpr_read_b32 v18, a246
    v_accvgpr_read_b32 v20, a247
    v_mfma_f32_16x16x32_bf16 v[64:67], a[44:47], v[216:219], v[64:67]
    s_add_u32 s84, s11, 98304
    buffer_load_dwordx4 v[204:207], v1, s[20:23], s84 offen offset:0 sc1
    v_mfma_f32_16x16x32_bf16 v[68:71], a[48:51], v[216:219], v[68:71]
    ds_write_b128 v2, v[44:47] offset:64
    v_and_b32 v19, 0xffff0000, v18
    v_mfma_f32_16x16x32_bf16 v[72:75], a[52:55], v[216:219], v[72:75]
    v_lshlrev_b32 v18, 16, v18
    v_and_b32 v21, 0xffff0000, v20
    v_mfma_f32_16x16x32_bf16 v[76:79], a[56:59], v[216:219], v[76:79]
    v_mfma_f32_16x16x32_bf16 v[60:63], a[60:63], v[220:223], v[60:63]
    ds_write_b128 v2, v[48:51] offset:128
    v_lshlrev_b32 v20, 16, v20
    v_mfma_f32_16x16x32_bf16 v[64:67], a[64:67], v[220:223], v[64:67]
    buffer_load_dwordx4 v[208:211], v1, s[20:23], s84 offen offset:1024 sc1
    v_mfma_f32_16x16x32_bf16 v[68:71], a[68:71], v[220:223], v[68:71]
    v_lshlrev_b32 v22, 16, v15
    v_mul_f32 v248, v18, v132
    v_mfma_f32_16x16x32_bf16 v[72:75], a[72:75], v[220:223], v[72:75]
    ds_write_b128 v2, v[52:55] offset:192
    v_mul_f32 v249, v19, v133
    v_mfma_f32_16x16x32_bf16 v[76:79], a[76:79], v[220:223], v[76:79]
    s_waitcnt vmcnt(14)
    v_mfma_f32_16x16x32_bf16 v[60:63], a[80:83], v[224:227], v[60:63]
    v_mul_f32 v250, v20, v134
    v_mul_f32 v251, v21, v135
    v_mfma_f32_16x16x32_bf16 v[64:67], a[84:87], v[224:227], v[64:67]
    s_add_u32 s84, s12, 98304
    buffer_load_dwordx4 v[212:215], v1, s[20:23], s84 offen offset:0 sc1
    v_mfma_f32_16x16x32_bf16 v[68:71], a[88:91], v[224:227], v[68:71]
    ds_write_b128 v2, v[56:59] offset:256
    v_mul_f32 v248, v22, v248
    v_mfma_f32_16x16x32_bf16 v[72:75], a[92:95], v[224:227], v[72:75]
    v_mul_f32 v249, v22, v249
    v_mul_f32 v250, v22, v250
    v_mfma_f32_16x16x32_bf16 v[76:79], a[96:99], v[224:227], v[76:79]
    v_mfma_f32_16x16x32_bf16 v[60:63], a[100:103], v[228:231], v[60:63]
    v_mul_f32 v251, v22, v251
    v_accvgpr_read_b32 v18, a248
    v_mfma_f32_16x16x32_bf16 v[64:67], a[104:107], v[228:231], v[64:67]
    buffer_load_dwordx4 v[216:219], v1, s[20:23], s84 offen offset:1024 sc1
    v_mfma_f32_16x16x32_bf16 v[68:71], a[108:111], v[228:231], v[68:71]
    v_accvgpr_read_b32 v20, a249
    v_and_b32 v19, 0xffff0000, v18
    v_mfma_f32_16x16x32_bf16 v[72:75], a[112:115], v[228:231], v[72:75]
    v_lshlrev_b32 v18, 16, v18
    v_and_b32 v21, 0xffff0000, v20
    v_mfma_f32_16x16x32_bf16 v[76:79], a[116:119], v[228:231], v[76:79]
    s_waitcnt vmcnt(14)
    v_mfma_f32_16x16x32_bf16 v[60:63], a[120:123], v[232:235], v[60:63]
    v_lshlrev_b32 v20, 16, v20
    v_lshlrev_b32 v22, 16, v16
    v_mfma_f32_16x16x32_bf16 v[64:67], a[124:127], v[232:235], v[64:67]
    s_add_u32 s84, s13, 98304
    buffer_load_dwordx4 v[220:223], v1, s[20:23], s84 offen offset:0 sc1
    v_mfma_f32_16x16x32_bf16 v[68:71], a[128:131], v[232:235], v[68:71]
    v_mul_f32 v136, v18, v136
    v_mul_f32 v137, v19, v137
    v_mfma_f32_16x16x32_bf16 v[72:75], a[132:135], v[232:235], v[72:75]
    v_mul_f32 v138, v20, v138
    v_mul_f32 v139, v21, v139
    v_mfma_f32_16x16x32_bf16 v[76:79], a[136:139], v[232:235], v[76:79]
    v_mfma_f32_16x16x32_bf16 v[60:63], a[140:143], v[160:163], v[60:63]
    v_mul_f32 v136, v22, v136
    v_mul_f32 v137, v22, v137
    v_mfma_f32_16x16x32_bf16 v[64:67], a[144:147], v[160:163], v[64:67]
    buffer_load_dwordx4 v[224:227], v1, s[20:23], s84 offen offset:1024 sc1
    v_mfma_f32_16x16x32_bf16 v[68:71], a[148:151], v[160:163], v[68:71]
    v_mul_f32 v138, v22, v138
    v_mul_f32 v139, v22, v139
    v_mfma_f32_16x16x32_bf16 v[72:75], a[152:155], v[160:163], v[72:75]
    v_mfma_f32_16x16x32_bf16 v[76:79], a[156:159], v[160:163], v[76:79]
    s_waitcnt vmcnt(14)
    v_mfma_f32_16x16x32_bf16 v[60:63], a[160:163], v[164:167], v[60:63]
    v_mfma_f32_16x16x32_bf16 v[64:67], a[164:167], v[164:167], v[64:67]
    s_add_u32 s84, s8, 147456
    buffer_load_dwordx4 v[228:231], v1, s[20:23], s84 offen offset:0 sc1
    v_mfma_f32_16x16x32_bf16 v[68:71], a[168:171], v[164:167], v[68:71]
    v_mfma_f32_16x16x32_bf16 v[72:75], a[172:175], v[164:167], v[72:75]
    v_mfma_f32_16x16x32_bf16 v[76:79], a[176:179], v[164:167], v[76:79]
    v_mfma_f32_16x16x32_bf16 v[60:63], a[180:183], v[168:171], v[60:63]
    v_mfma_f32_16x16x32_bf16 v[64:67], a[184:187], v[168:171], v[64:67]
    buffer_load_dwordx4 v[232:235], v1, s[20:23], s84 offen offset:1024 sc1
    v_mfma_f32_16x16x32_bf16 v[68:71], a[188:191], v[168:171], v[68:71]
    v_mfma_f32_16x16x32_bf16 v[72:75], a[192:195], v[168:171], v[72:75]
    v_mfma_f32_16x16x32_bf16 v[76:79], a[196:199], v[168:171], v[76:79]
    s_waitcnt vmcnt(14)
    v_mfma_f32_16x16x32_bf16 v[60:63], a[200:203], v[172:175], v[60:63]
    v_mfma_f32_16x16x32_bf16 v[64:67], a[204:207], v[172:175], v[64:67]
    s_add_u32 s84, s9, 147456
    buffer_load_dwordx4 v[160:163], v1, s[20:23], s84 offen offset:0 sc1
    v_mfma_f32_16x16x32_bf16 v[68:71], a[208:211], v[172:175], v[68:71]
    v_mfma_f32_16x16x32_bf16 v[72:75], a[212:215], v[172:175], v[72:75]
    v_mfma_f32_16x16x32_bf16 v[76:79], a[216:219], v[172:175], v[76:79]
    v_mfma_f32_16x16x32_bf16 v[60:63], a[220:223], v[176:179], v[60:63]
    v_mfma_f32_16x16x32_bf16 v[64:67], a[224:227], v[176:179], v[64:67]
    buffer_load_dwordx4 v[164:167], v1, s[20:23], s84 offen offset:1024 sc1
    v_mfma_f32_16x16x32_bf16 v[68:71], a[228:231], v[176:179], v[68:71]
    v_mfma_f32_16x16x32_bf16 v[72:75], a[232:235], v[176:179], v[72:75]
    v_mfma_f32_16x16x32_bf16 v[76:79], a[236:239], v[176:179], v[76:79]
    s_waitcnt vmcnt(14)
    v_mfma_f32_16x16x32_bf16 v[40:43], a[0:3], v[180:183], 0
    v_mfma_f32_16x16x32_bf16 v[44:47], a[4:7], v[180:183], 0
    s_add_u32 s84, s10, 147456
    buffer_load_dwordx4 v[168:171], v1, s[20:23], s84 offen offset:0 sc1
    v_mfma_f32_16x16x32_bf16 v[48:51], a[8:11], v[180:183], 0
    v_mfma_f32_16x16x32_bf16 v[52:55], a[12:15], v[180:183], 0
    v_mfma_f32_16x16x32_bf16 v[56:59], a[16:19], v[180:183], 0
    v_mfma_f32_16x16x32_bf16 v[40:43], a[20:23], v[184:187], v[40:43]
    v_mfma_f32_16x16x32_bf16 v[44:47], a[24:27], v[184:187], v[44:47]
    buffer_load_dwordx4 v[172:175], v1, s[20:23], s84 offen offset:1024 sc1
    v_mfma_f32_16x16x32_bf16 v[48:51], a[28:31], v[184:187], v[48:51]
    v_mfma_f32_16x16x32_bf16 v[52:55], a[32:35], v[184:187], v[52:55]
    ds_write_b128 v2, v[60:63] offset:21504
    v_mfma_f32_16x16x32_bf16 v[56:59], a[36:39], v[184:187], v[56:59]
    s_waitcnt vmcnt(14)
    v_mfma_f32_16x16x32_bf16 v[40:43], a[40:43], v[188:191], v[40:43]
    v_mfma_f32_16x16x32_bf16 v[44:47], a[44:47], v[188:191], v[44:47]
    s_add_u32 s84, s11, 147456
    buffer_load_dwordx4 v[176:179], v1, s[20:23], s84 offen offset:0 sc1
    v_mfma_f32_16x16x32_bf16 v[48:51], a[48:51], v[188:191], v[48:51]
    ds_write_b128 v2, v[64:67] offset:21568
    v_mfma_f32_16x16x32_bf16 v[52:55], a[52:55], v[188:191], v[52:55]
    v_mfma_f32_16x16x32_bf16 v[56:59], a[56:59], v[188:191], v[56:59]
    v_mfma_f32_16x16x32_bf16 v[40:43], a[60:63], v[192:195], v[40:43]
    ds_write_b128 v2, v[68:71] offset:21632
    v_mfma_f32_16x16x32_bf16 v[44:47], a[64:67], v[192:195], v[44:47]
    buffer_load_dwordx4 v[180:183], v1, s[20:23], s84 offen offset:1024 sc1
    v_mfma_f32_16x16x32_bf16 v[48:51], a[68:71], v[192:195], v[48:51]
    v_mfma_f32_16x16x32_bf16 v[52:55], a[72:75], v[192:195], v[52:55]
    ds_write_b128 v2, v[72:75] offset:21696
    v_mfma_f32_16x16x32_bf16 v[56:59], a[76:79], v[192:195], v[56:59]
    s_waitcnt vmcnt(14)
    v_mfma_f32_16x16x32_bf16 v[40:43], a[80:83], v[196:199], v[40:43]
    v_mfma_f32_16x16x32_bf16 v[44:47], a[84:87], v[196:199], v[44:47]
    s_add_u32 s84, s12, 147456
    buffer_load_dwordx4 v[184:187], v1, s[20:23], s84 offen offset:0 sc1
    v_mfma_f32_16x16x32_bf16 v[48:51], a[88:91], v[196:199], v[48:51]
    ds_write_b128 v2, v[76:79] offset:21760
    v_mfma_f32_16x16x32_bf16 v[52:55], a[92:95], v[196:199], v[52:55]
    v_mfma_f32_16x16x32_bf16 v[56:59], a[96:99], v[196:199], v[56:59]
    v_mfma_f32_16x16x32_bf16 v[40:43], a[100:103], v[200:203], v[40:43]
    s_waitcnt lgkmcnt(0)
    s_barrier
    v_mfma_f32_16x16x32_bf16 v[44:47], a[104:107], v[200:203], v[44:47]
    buffer_load_dwordx4 v[188:191], v1, s[20:23], s84 offen offset:1024 sc1
    v_mfma_f32_16x16x32_bf16 v[48:51], a[108:111], v[200:203], v[48:51]
    ds_read_b128 v[80:83], v3 offset:0
    v_mfma_f32_16x16x32_bf16 v[52:55], a[112:115], v[200:203], v[52:55]
    ds_read_b128 v[84:87], v3 offset:5376
    v_mfma_f32_16x16x32_bf16 v[56:59], a[116:119], v[200:203], v[56:59]
    s_waitcnt vmcnt(14)
    v_mfma_f32_16x16x32_bf16 v[40:43], a[120:123], v[204:207], v[40:43]
    ds_read_b128 v[88:91], v3 offset:10752
    v_mfma_f32_16x16x32_bf16 v[44:47], a[124:127], v[204:207], v[44:47]
    s_add_u32 s84, s13, 147456
    buffer_load_dwordx4 v[192:195], v1, s[20:23], s84 offen offset:0 sc1
    v_mfma_f32_16x16x32_bf16 v[48:51], a[128:131], v[204:207], v[48:51]
    ds_read_b128 v[92:95], v3 offset:16128
    v_mfma_f32_16x16x32_bf16 v[52:55], a[132:135], v[204:207], v[52:55]
    ds_read_b128 v[96:99], v3 offset:21504
    v_mfma_f32_16x16x32_bf16 v[56:59], a[136:139], v[204:207], v[56:59]
    v_mfma_f32_16x16x32_bf16 v[40:43], a[140:143], v[208:211], v[40:43]
    ds_read_b128 v[100:103], v3 offset:26880
    v_mfma_f32_16x16x32_bf16 v[44:47], a[144:147], v[208:211], v[44:47]
    buffer_load_dwordx4 v[196:199], v1, s[20:23], s84 offen offset:1024 sc1
    v_mfma_f32_16x16x32_bf16 v[48:51], a[148:151], v[208:211], v[48:51]
    ds_read_b128 v[104:107], v3 offset:32256
    v_mfma_f32_16x16x32_bf16 v[52:55], a[152:155], v[208:211], v[52:55]
    ds_read_b128 v[108:111], v3 offset:37632
    v_mfma_f32_16x16x32_bf16 v[56:59], a[156:159], v[208:211], v[56:59]
    s_waitcnt vmcnt(14)
    v_mfma_f32_16x16x32_bf16 v[40:43], a[160:163], v[212:215], v[40:43]
    v_mfma_f32_16x16x32_bf16 v[44:47], a[164:167], v[212:215], v[44:47]
    s_add_u32 s84, s8, 196608
    buffer_load_dwordx4 v[200:203], v1, s[20:23], s84 offen offset:0 sc1
    v_mfma_f32_16x16x32_bf16 v[48:51], a[168:171], v[212:215], v[48:51]
    v_mfma_f32_16x16x32_bf16 v[52:55], a[172:175], v[212:215], v[52:55]
    s_waitcnt lgkmcnt(0)
    v_add_f32 v80, v80, v84
    v_mfma_f32_16x16x32_bf16 v[56:59], a[176:179], v[212:215], v[56:59]
    v_mfma_f32_16x16x32_bf16 v[40:43], a[180:183], v[216:219], v[40:43]
    v_add_f32 v81, v81, v85
    v_add_f32 v82, v82, v86
    v_mfma_f32_16x16x32_bf16 v[44:47], a[184:187], v[216:219], v[44:47]
    buffer_load_dwordx4 v[204:207], v1, s[20:23], s84 offen offset:1024 sc1
    v_mfma_f32_16x16x32_bf16 v[48:51], a[188:191], v[216:219], v[48:51]
    v_add_f32 v83, v83, v87
    v_add_f32 v88, v88, v92
    v_mfma_f32_16x16x32_bf16 v[52:55], a[192:195], v[216:219], v[52:55]
    v_add_f32 v89, v89, v93
    v_add_f32 v90, v90, v94
    v_mfma_f32_16x16x32_bf16 v[56:59], a[196:199], v[216:219], v[56:59]
    s_waitcnt vmcnt(14)
    v_mfma_f32_16x16x32_bf16 v[40:43], a[200:203], v[220:223], v[40:43]
    v_add_f32 v91, v91, v95
    v_add_f32 v112, v80, v88
    v_mfma_f32_16x16x32_bf16 v[44:47], a[204:207], v[220:223], v[44:47]
    s_add_u32 s84, s9, 196608
    buffer_load_dwordx4 v[208:211], v1, s[20:23], s84 offen offset:0 sc1
    v_mfma_f32_16x16x32_bf16 v[48:51], a[208:211], v[220:223], v[48:51]
    v_add_f32 v113, v81, v89
    v_add_f32 v114, v82, v90
    v_mfma_f32_16x16x32_bf16 v[52:55], a[212:215], v[220:223], v[52:55]
    v_add_f32 v115, v83, v91
    v_add_f32 v96, v96, v100
    v_mfma_f32_16x16x32_bf16 v[56:59], a[216:219], v[220:223], v[56:59]
    v_mfma_f32_16x16x32_bf16 v[40:43], a[220:223], v[224:227], v[40:43]
    v_add_f32 v97, v97, v101
    v_add_f32 v98, v98, v102
    v_mfma_f32_16x16x32_bf16 v[44:47], a[224:227], v[224:227], v[44:47]
    buffer_load_dwordx4 v[212:215], v1, s[20:23], s84 offen offset:1024 sc1
    v_mfma_f32_16x16x32_bf16 v[48:51], a[228:231], v[224:227], v[48:51]
    v_add_f32 v99, v99, v103
    v_add_f32 v104, v104, v108
    v_mfma_f32_16x16x32_bf16 v[52:55], a[232:235], v[224:227], v[52:55]
    v_add_f32 v105, v105, v109
    v_add_f32 v106, v106, v110
    v_mfma_f32_16x16x32_bf16 v[56:59], a[236:239], v[224:227], v[56:59]
    s_waitcnt vmcnt(14)
    v_mfma_f32_16x16x32_bf16 v[60:63], a[0:3], v[228:231], 0
    v_add_f32 v107, v107, v111
    v_add_f32 v116, v96, v104
    v_mfma_f32_16x16x32_bf16 v[64:67], a[4:7], v[228:231], 0
    s_add_u32 s84, s10, 196608
    buffer_load_dwordx4 v[216:219], v1, s[20:23], s84 offen offset:0 sc1
    v_mfma_f32_16x16x32_bf16 v[68:71], a[8:11], v[228:231], 0
    v_add_f32 v117, v97, v105
    v_add_f32 v118, v98, v106
    v_mfma_f32_16x16x32_bf16 v[72:75], a[12:15], v[228:231], 0
    v_add_f32 v119, v99, v107
    v_cvt_pk_bf16_f32 v152, v112, v113
    v_mfma_f32_16x16x32_bf16 v[76:79], a[16:19], v[228:231], 0
    v_mfma_f32_16x16x32_bf16 v[60:63], a[20:23], v[232:235], v[60:63]
    v_cvt_pk_bf16_f32 v153, v114, v115
    v_cvt_pk_bf16_f32 v154, v116, v117
    v_mfma_f32_16x16x32_bf16 v[64:67], a[24:27], v[232:235], v[64:67]
    buffer_load_dwordx4 v[220:223], v1, s[20:23], s84 offen offset:1024 sc1
    v_mfma_f32_16x16x32_bf16 v[68:71], a[28:31], v[232:235], v[68:71]
    v_cvt_pk_bf16_f32 v155, v118, v118
    v_bfi_b32 v155, s58, v155, v28
    v_mfma_f32_16x16x32_bf16 v[72:75], a[32:35], v[232:235], v[72:75]
    ds_write_b128 v2, v[40:43] offset:43008
    buffer_store_dwordx4 v[152:155], v1, s[20:23], s67 offen offset:0 sc1
    v_mfma_f32_16x16x32_bf16 v[76:79], a[36:39], v[232:235], v[76:79]
    s_waitcnt vmcnt(15)
    v_mfma_f32_16x16x32_bf16 v[60:63], a[40:43], v[160:163], v[60:63]
    v_mfma_f32_16x16x32_bf16 v[64:67], a[44:47], v[160:163], v[64:67]
    s_add_u32 s84, s11, 196608
    buffer_load_dwordx4 v[224:227], v1, s[20:23], s84 offen offset:0 sc1
    v_mfma_f32_16x16x32_bf16 v[68:71], a[48:51], v[160:163], v[68:71]
    ds_write_b128 v2, v[44:47] offset:43072
    v_mfma_f32_16x16x32_bf16 v[72:75], a[52:55], v[160:163], v[72:75]
    v_mfma_f32_16x16x32_bf16 v[76:79], a[56:59], v[160:163], v[76:79]
    v_mfma_f32_16x16x32_bf16 v[60:63], a[60:63], v[164:167], v[60:63]
    ds_write_b128 v2, v[48:51] offset:43136
    v_mfma_f32_16x16x32_bf16 v[64:67], a[64:67], v[164:167], v[64:67]
    buffer_load_dwordx4 v[228:231], v1, s[20:23], s84 offen offset:1024 sc1
    v_mfma_f32_16x16x32_bf16 v[68:71], a[68:71], v[164:167], v[68:71]
    v_mfma_f32_16x16x32_bf16 v[72:75], a[72:75], v[164:167], v[72:75]
    ds_write_b128 v2, v[52:55] offset:43200
    v_mfma_f32_16x16x32_bf16 v[76:79], a[76:79], v[164:167], v[76:79]
    s_waitcnt vmcnt(15)
    v_mfma_f32_16x16x32_bf16 v[60:63], a[80:83], v[168:171], v[60:63]
    v_mfma_f32_16x16x32_bf16 v[64:67], a[84:87], v[168:171], v[64:67]
    s_add_u32 s84, s12, 196608
    buffer_load_dwordx4 v[232:235], v1, s[20:23], s84 offen offset:0 sc1
    v_mfma_f32_16x16x32_bf16 v[68:71], a[88:91], v[168:171], v[68:71]
    ds_write_b128 v2, v[56:59] offset:43264
    v_mfma_f32_16x16x32_bf16 v[72:75], a[92:95], v[168:171], v[72:75]
    v_mfma_f32_16x16x32_bf16 v[76:79], a[96:99], v[168:171], v[76:79]
    v_mfma_f32_16x16x32_bf16 v[60:63], a[100:103], v[172:175], v[60:63]
    s_waitcnt lgkmcnt(0)
    s_barrier
    v_mfma_f32_16x16x32_bf16 v[64:67], a[104:107], v[172:175], v[64:67]
    buffer_load_dwordx4 v[160:163], v1, s[20:23], s84 offen offset:1024 sc1
    v_mfma_f32_16x16x32_bf16 v[68:71], a[108:111], v[172:175], v[68:71]
    ds_read_b128 v[80:83], v3 offset:43008
    v_mfma_f32_16x16x32_bf16 v[72:75], a[112:115], v[172:175], v[72:75]
    ds_read_b128 v[84:87], v3 offset:48384
    v_mfma_f32_16x16x32_bf16 v[76:79], a[116:119], v[172:175], v[76:79]
    s_waitcnt vmcnt(15)
    v_mfma_f32_16x16x32_bf16 v[60:63], a[120:123], v[176:179], v[60:63]
    ds_read_b128 v[88:91], v3 offset:53760
    v_mfma_f32_16x16x32_bf16 v[64:67], a[124:127], v[176:179], v[64:67]
    s_add_u32 s84, s13, 196608
    buffer_load_dwordx4 v[164:167], v1, s[20:23], s84 offen offset:0 sc1
    v_mfma_f32_16x16x32_bf16 v[68:71], a[128:131], v[176:179], v[68:71]
    ds_read_b128 v[92:95], v3 offset:59136
    v_mfma_f32_16x16x32_bf16 v[72:75], a[132:135], v[176:179], v[72:75]
    v_mfma_f32_16x16x32_bf16 v[76:79], a[136:139], v[176:179], v[76:79]
    v_mfma_f32_16x16x32_bf16 v[60:63], a[140:143], v[180:183], v[60:63]
    v_mfma_f32_16x16x32_bf16 v[64:67], a[144:147], v[180:183], v[64:67]
    buffer_load_dwordx4 v[168:171], v1, s[20:23], s84 offen offset:1024 sc1
    v_mfma_f32_16x16x32_bf16 v[68:71], a[148:151], v[180:183], v[68:71]
    s_waitcnt lgkmcnt(0)
    v_add_f32 v80, v80, v84
    v_mfma_f32_16x16x32_bf16 v[72:75], a[152:155], v[180:183], v[72:75]
    v_add_f32 v81, v81, v85
    v_add_f32 v82, v82, v86
    v_mfma_f32_16x16x32_bf16 v[76:79], a[156:159], v[180:183], v[76:79]
    s_waitcnt vmcnt(15)
    v_mfma_f32_16x16x32_bf16 v[60:63], a[160:163], v[184:187], v[60:63]
    v_add_f32 v83, v83, v87
    v_add_f32 v88, v88, v92
    v_mfma_f32_16x16x32_bf16 v[64:67], a[164:167], v[184:187], v[64:67]
    s_add_u32 s84, s8, 245760
    buffer_load_dwordx4 v[172:175], v1, s[20:23], s84 offen offset:0 sc1
    v_mfma_f32_16x16x32_bf16 v[68:71], a[168:171], v[184:187], v[68:71]
    v_add_f32 v89, v89, v93
    v_add_f32 v90, v90, v94
    v_mfma_f32_16x16x32_bf16 v[72:75], a[172:175], v[184:187], v[72:75]
    v_add_f32 v91, v91, v95
    v_add_f32 v120, v80, v88
    v_mfma_f32_16x16x32_bf16 v[76:79], a[176:179], v[184:187], v[76:79]
    v_mfma_f32_16x16x32_bf16 v[60:63], a[180:183], v[188:191], v[60:63]
    v_add_f32 v121, v81, v89
    v_add_f32 v122, v82, v90
    v_mfma_f32_16x16x32_bf16 v[64:67], a[184:187], v[188:191], v[64:67]
    buffer_load_dwordx4 v[176:179], v1, s[20:23], s84 offen offset:1024 sc1
    v_mfma_f32_16x16x32_bf16 v[68:71], a[188:191], v[188:191], v[68:71]
    v_add_f32 v123, v83, v91
    v_mfma_f32_16x16x32_bf16 v[72:75], a[192:195], v[188:191], v[72:75]
    v_mfma_f32_16x16x32_bf16 v[76:79], a[196:199], v[188:191], v[76:79]
    s_waitcnt vmcnt(15)
    v_mfma_f32_16x16x32_bf16 v[60:63], a[200:203], v[192:195], v[60:63]
    v_mfma_f32_16x16x32_bf16 v[64:67], a[204:207], v[192:195], v[64:67]
    s_add_u32 s84, s9, 245760
    buffer_load_dwordx4 v[180:183], v1, s[20:23], s84 offen offset:0 sc1
    v_mfma_f32_16x16x32_bf16 v[68:71], a[208:211], v[192:195], v[68:71]
    v_mfma_f32_16x16x32_bf16 v[72:75], a[212:215], v[192:195], v[72:75]
    v_mfma_f32_16x16x32_bf16 v[76:79], a[216:219], v[192:195], v[76:79]
    v_mfma_f32_16x16x32_bf16 v[60:63], a[220:223], v[196:199], v[60:63]
    v_mfma_f32_16x16x32_bf16 v[64:67], a[224:227], v[196:199], v[64:67]
    buffer_load_dwordx4 v[184:187], v1, s[20:23], s84 offen offset:1024 sc1
    v_mfma_f32_16x16x32_bf16 v[68:71], a[228:231], v[196:199], v[68:71]
    v_mfma_f32_16x16x32_bf16 v[72:75], a[232:235], v[196:199], v[72:75]
    v_mfma_f32_16x16x32_bf16 v[76:79], a[236:239], v[196:199], v[76:79]
    s_waitcnt vmcnt(15)
    v_mfma_f32_16x16x32_bf16 v[40:43], a[0:3], v[200:203], 0
    v_mfma_f32_16x16x32_bf16 v[44:47], a[4:7], v[200:203], 0
    s_add_u32 s84, s10, 245760
    buffer_load_dwordx4 v[188:191], v1, s[20:23], s84 offen offset:0 sc1
    v_mfma_f32_16x16x32_bf16 v[48:51], a[8:11], v[200:203], 0
    v_mfma_f32_16x16x32_bf16 v[52:55], a[12:15], v[200:203], 0
    v_mfma_f32_16x16x32_bf16 v[56:59], a[16:19], v[200:203], 0
    v_mfma_f32_16x16x32_bf16 v[40:43], a[20:23], v[204:207], v[40:43]
    v_mfma_f32_16x16x32_bf16 v[44:47], a[24:27], v[204:207], v[44:47]
    buffer_load_dwordx4 v[192:195], v1, s[20:23], s84 offen offset:1024 sc1
    v_mfma_f32_16x16x32_bf16 v[48:51], a[28:31], v[204:207], v[48:51]
    v_mfma_f32_16x16x32_bf16 v[52:55], a[32:35], v[204:207], v[52:55]
    v_add_u32 v24, 64512, v2
    v_mfma_f32_16x16x32_bf16 v[56:59], a[36:39], v[204:207], v[56:59]
    s_waitcnt vmcnt(15)
    v_mfma_f32_16x16x32_bf16 v[40:43], a[40:43], v[208:211], v[40:43]
    ds_write_b128 v24, v[60:63] offset:0
    v_mfma_f32_16x16x32_bf16 v[44:47], a[44:47], v[208:211], v[44:47]
    s_add_u32 s84, s11, 245760
    buffer_load_dwordx4 v[196:199], v1, s[20:23], s84 offen offset:0 sc1
    v_mfma_f32_16x16x32_bf16 v[48:51], a[48:51], v[208:211], v[48:51]
    v_mfma_f32_16x16x32_bf16 v[52:55], a[52:55], v[208:211], v[52:55]
    ds_write_b128 v24, v[64:67] offset:64
    v_mfma_f32_16x16x32_bf16 v[56:59], a[56:59], v[208:211], v[56:59]
    v_mfma_f32_16x16x32_bf16 v[40:43], a[60:63], v[212:215], v[40:43]
    v_mfma_f32_16x16x32_bf16 v[44:47], a[64:67], v[212:215], v[44:47]
    buffer_load_dwordx4 v[200:203], v1, s[20:23], s84 offen offset:1024 sc1
    v_mfma_f32_16x16x32_bf16 v[48:51], a[68:71], v[212:215], v[48:51]
    ds_write_b128 v24, v[68:71] offset:128
    v_mfma_f32_16x16x32_bf16 v[52:55], a[72:75], v[212:215], v[52:55]
    v_mfma_f32_16x16x32_bf16 v[56:59], a[76:79], v[212:215], v[56:59]
    s_waitcnt vmcnt(15)
    v_mfma_f32_16x16x32_bf16 v[40:43], a[80:83], v[216:219], v[40:43]
    ds_write_b128 v24, v[72:75] offset:192
    v_mfma_f32_16x16x32_bf16 v[44:47], a[84:87], v[216:219], v[44:47]
    s_add_u32 s84, s12, 245760
    buffer_load_dwordx4 v[204:207], v1, s[20:23], s84 offen offset:0 sc1
    v_mfma_f32_16x16x32_bf16 v[48:51], a[88:91], v[216:219], v[48:51]
    v_mfma_f32_16x16x32_bf16 v[52:55], a[92:95], v[216:219], v[52:55]
    ds_write_b128 v24, v[76:79] offset:256
    v_mfma_f32_16x16x32_bf16 v[56:59], a[96:99], v[216:219], v[56:59]
    v_mfma_f32_16x16x32_bf16 v[40:43], a[100:103], v[220:223], v[40:43]
    v_mfma_f32_16x16x32_bf16 v[44:47], a[104:107], v[220:223], v[44:47]
    buffer_load_dwordx4 v[208:211], v1, s[20:23], s84 offen offset:1024 sc1
    v_mfma_f32_16x16x32_bf16 v[48:51], a[108:111], v[220:223], v[48:51]
    s_waitcnt lgkmcnt(0)
    s_barrier
    v_mfma_f32_16x16x32_bf16 v[52:55], a[112:115], v[220:223], v[52:55]
    v_add_u32 v32, 64512, v3
    v_mfma_f32_16x16x32_bf16 v[56:59], a[116:119], v[220:223], v[56:59]
    s_waitcnt vmcnt(14)
    v_mfma_f32_16x16x32_bf16 v[40:43], a[120:123], v[224:227], v[40:43]
    ds_read_b128 v[80:83], v32 offset:0
    v_mfma_f32_16x16x32_bf16 v[44:47], a[124:127], v[224:227], v[44:47]
    s_add_u32 s84, s13, 245760
    buffer_load_dwordx4 v[212:215], v1, s[20:23], s84 offen offset:0 sc1
    v_mfma_f32_16x16x32_bf16 v[48:51], a[128:131], v[224:227], v[48:51]
    ds_read_b128 v[84:87], v32 offset:5376
    v_mfma_f32_16x16x32_bf16 v[52:55], a[132:135], v[224:227], v[52:55]
    ds_read_b128 v[88:91], v32 offset:10752
    v_mfma_f32_16x16x32_bf16 v[56:59], a[136:139], v[224:227], v[56:59]
    v_mfma_f32_16x16x32_bf16 v[40:43], a[140:143], v[228:231], v[40:43]
    ds_read_b128 v[92:95], v32 offset:16128
    v_mfma_f32_16x16x32_bf16 v[44:47], a[144:147], v[228:231], v[44:47]
    buffer_load_dwordx4 v[216:219], v1, s[20:23], s84 offen offset:1024 sc1
    v_mfma_f32_16x16x32_bf16 v[48:51], a[148:151], v[228:231], v[48:51]
    ds_read_b128 v[96:99], v4 offset:0
    v_mfma_f32_16x16x32_bf16 v[52:55], a[152:155], v[228:231], v[52:55]
    ds_read_b128 v[100:103], v4 offset:5376
    v_mfma_f32_16x16x32_bf16 v[56:59], a[156:159], v[228:231], v[56:59]
    s_waitcnt vmcnt(14)
    v_mfma_f32_16x16x32_bf16 v[40:43], a[160:163], v[232:235], v[40:43]
    ds_read_b128 v[104:107], v4 offset:10752
    v_mfma_f32_16x16x32_bf16 v[44:47], a[164:167], v[232:235], v[44:47]
    s_add_u32 s84, s8, 294912
    buffer_load_dwordx4 v[220:223], v1, s[20:23], s84 offen offset:0 sc1
    v_mfma_f32_16x16x32_bf16 v[48:51], a[168:171], v[232:235], v[48:51]
    ds_read_b128 v[108:111], v4 offset:16128
    v_mfma_f32_16x16x32_bf16 v[52:55], a[172:175], v[232:235], v[52:55]
    v_mfma_f32_16x16x32_bf16 v[56:59], a[176:179], v[232:235], v[56:59]
    v_mfma_f32_16x16x32_bf16 v[40:43], a[180:183], v[160:163], v[40:43]
    v_mfma_f32_16x16x32_bf16 v[44:47], a[184:187], v[160:163], v[44:47]
    buffer_load_dwordx4 v[224:227], v1, s[20:23], s84 offen offset:1024 sc1
    v_mfma_f32_16x16x32_bf16 v[48:51], a[188:191], v[160:163], v[48:51]
    s_waitcnt lgkmcnt(0)
    v_add_f32 v80, v80, v84
    v_mfma_f32_16x16x32_bf16 v[52:55], a[192:195], v[160:163], v[52:55]
    v_add_f32 v81, v81, v85
    v_add_f32 v82, v82, v86
    v_mfma_f32_16x16x32_bf16 v[56:59], a[196:199], v[160:163], v[56:59]
    s_waitcnt vmcnt(14)
    v_mfma_f32_16x16x32_bf16 v[40:43], a[200:203], v[164:167], v[40:43]
    v_add_f32 v83, v83, v87
    v_add_f32 v88, v88, v92
    v_mfma_f32_16x16x32_bf16 v[44:47], a[204:207], v[164:167], v[44:47]
    s_add_u32 s84, s9, 294912
    buffer_load_dwordx4 v[228:231], v1, s[20:23], s84 offen offset:0 sc1
    v_mfma_f32_16x16x32_bf16 v[48:51], a[208:211], v[164:167], v[48:51]
    v_add_f32 v89, v89, v93
    v_add_f32 v90, v90, v94
    v_mfma_f32_16x16x32_bf16 v[52:55], a[212:215], v[164:167], v[52:55]
    v_add_f32 v91, v91, v95
    v_add_f32 v124, v80, v88
    v_mfma_f32_16x16x32_bf16 v[56:59], a[216:219], v[164:167], v[56:59]
    v_mfma_f32_16x16x32_bf16 v[40:43], a[220:223], v[168:171], v[40:43]
    v_add_f32 v125, v81, v89
    v_add_f32 v126, v82, v90
    v_mfma_f32_16x16x32_bf16 v[44:47], a[224:227], v[168:171], v[44:47]
    buffer_load_dwordx4 v[232:235], v1, s[20:23], s84 offen offset:1024 sc1
    v_mfma_f32_16x16x32_bf16 v[48:51], a[228:231], v[168:171], v[48:51]
    v_add_f32 v127, v83, v91
    v_cvt_pk_bf16_f32 v156, v119, v120
    v_mfma_f32_16x16x32_bf16 v[52:55], a[232:235], v[168:171], v[52:55]
    v_cvt_pk_bf16_f32 v157, v121, v122
    v_cvt_pk_bf16_f32 v158, v123, v124
    v_mfma_f32_16x16x32_bf16 v[56:59], a[236:239], v[168:171], v[56:59]
    s_waitcnt vmcnt(14)
    v_mfma_f32_16x16x32_bf16 v[60:63], a[0:3], v[172:175], 0
    v_cvt_pk_bf16_f32 v159, v125, v125
    v_bfi_b32 v159, s58, v159, v28
    v_mfma_f32_16x16x32_bf16 v[64:67], a[4:7], v[172:175], 0
    s_add_u32 s84, s10, 294912
    buffer_load_dwordx4 v[160:163], v1, s[20:23], s84 offen offset:0 sc1
    v_mfma_f32_16x16x32_bf16 v[68:71], a[8:11], v[172:175], 0
    buffer_store_dwordx4 v[156:159], v1, s[20:23], s67 offen offset:1024 sc1
    v_add_f32 v96, v96, v100
    v_mfma_f32_16x16x32_bf16 v[72:75], a[12:15], v[172:175], 0
    v_add_f32 v97, v97, v101
    v_add_f32 v98, v98, v102
    v_mfma_f32_16x16x32_bf16 v[76:79], a[16:19], v[172:175], 0
    v_mfma_f32_16x16x32_bf16 v[60:63], a[20:23], v[176:179], v[60:63]
    v_add_f32 v99, v99, v103
    v_add_f32 v104, v104, v108
    v_mfma_f32_16x16x32_bf16 v[64:67], a[24:27], v[176:179], v[64:67]
    buffer_load_dwordx4 v[164:167], v1, s[20:23], s84 offen offset:1024 sc1
    v_mfma_f32_16x16x32_bf16 v[68:71], a[28:31], v[176:179], v[68:71]
    v_add_f32 v105, v105, v109
    v_add_f32 v106, v106, v110
    v_mfma_f32_16x16x32_bf16 v[72:75], a[32:35], v[176:179], v[72:75]
    v_add_u32 v24, 86016, v2
    v_add_f32 v107, v107, v111
    v_mfma_f32_16x16x32_bf16 v[76:79], a[36:39], v[176:179], v[76:79]
    s_waitcnt vmcnt(15)
    v_mfma_f32_16x16x32_bf16 v[60:63], a[40:43], v[180:183], v[60:63]
    ds_write_b128 v24, v[40:43] offset:0
    v_add_f32 v128, v96, v104
    v_mfma_f32_16x16x32_bf16 v[64:67], a[44:47], v[180:183], v[64:67]
    s_add_u32 s84, s11, 294912
    buffer_load_dwordx4 v[168:171], v1, s[20:23], s84 offen offset:0 sc1
    v_mfma_f32_16x16x32_bf16 v[68:71], a[48:51], v[180:183], v[68:71]
    v_add_f32 v129, v97, v105
    v_add_f32 v130, v98, v106
    v_mfma_f32_16x16x32_bf16 v[72:75], a[52:55], v[180:183], v[72:75]
    ds_write_b128 v24, v[44:47] offset:64
    v_add_f32 v131, v99, v107
    v_mfma_f32_16x16x32_bf16 v[76:79], a[56:59], v[180:183], v[76:79]
    v_mfma_f32_16x16x32_bf16 v[60:63], a[60:63], v[184:187], v[60:63]
    v_cvt_pk_bf16_f32 v152, v126, v127
    v_cvt_pk_bf16_f32 v153, v128, v129
    v_mfma_f32_16x16x32_bf16 v[64:67], a[64:67], v[184:187], v[64:67]
    buffer_load_dwordx4 v[172:175], v1, s[20:23], s84 offen offset:1024 sc1
    v_mfma_f32_16x16x32_bf16 v[68:71], a[68:71], v[184:187], v[68:71]
    ds_write_b128 v24, v[48:51] offset:128
    v_cvt_pk_bf16_f32 v154, v130, v131
    v_mfma_f32_16x16x32_bf16 v[72:75], a[72:75], v[184:187], v[72:75]
    v_mov_b32 v155, v28
    buffer_store_dwordx4 v[152:155], v1, s[20:23], s67 offen offset:2048 sc1
    v_mfma_f32_16x16x32_bf16 v[76:79], a[76:79], v[184:187], v[76:79]
    s_waitcnt vmcnt(16)
    v_mfma_f32_16x16x32_bf16 v[60:63], a[80:83], v[188:191], v[60:63]
    ds_write_b128 v24, v[52:55] offset:192
    v_mfma_f32_16x16x32_bf16 v[64:67], a[84:87], v[188:191], v[64:67]
    s_add_u32 s84, s12, 294912
    buffer_load_dwordx4 v[176:179], v1, s[20:23], s84 offen offset:0 sc1
    v_mfma_f32_16x16x32_bf16 v[68:71], a[88:91], v[188:191], v[68:71]
    v_mfma_f32_16x16x32_bf16 v[72:75], a[92:95], v[188:191], v[72:75]
    ds_write_b128 v24, v[56:59] offset:256
    v_mfma_f32_16x16x32_bf16 v[76:79], a[96:99], v[188:191], v[76:79]
    v_mfma_f32_16x16x32_bf16 v[60:63], a[100:103], v[192:195], v[60:63]
    v_mfma_f32_16x16x32_bf16 v[64:67], a[104:107], v[192:195], v[64:67]
    buffer_load_dwordx4 v[180:183], v1, s[20:23], s84 offen offset:1024 sc1
    v_mfma_f32_16x16x32_bf16 v[68:71], a[108:111], v[192:195], v[68:71]
    s_waitcnt lgkmcnt(0)
    s_barrier
    v_mfma_f32_16x16x32_bf16 v[72:75], a[112:115], v[192:195], v[72:75]
    v_add_u32 v32, 86016, v3
    v_mfma_f32_16x16x32_bf16 v[76:79], a[116:119], v[192:195], v[76:79]
    s_waitcnt vmcnt(16)
    v_mfma_f32_16x16x32_bf16 v[60:63], a[120:123], v[196:199], v[60:63]
    ds_read_b128 v[80:83], v32 offset:0
    v_mfma_f32_16x16x32_bf16 v[64:67], a[124:127], v[196:199], v[64:67]
    s_add_u32 s84, s13, 294912
    buffer_load_dwordx4 v[184:187], v1, s[20:23], s84 offen offset:0 sc1
    v_mfma_f32_16x16x32_bf16 v[68:71], a[128:131], v[196:199], v[68:71]
    ds_read_b128 v[84:87], v32 offset:5376
    v_mfma_f32_16x16x32_bf16 v[72:75], a[132:135], v[196:199], v[72:75]
    ds_read_b128 v[88:91], v32 offset:10752
    v_mfma_f32_16x16x32_bf16 v[76:79], a[136:139], v[196:199], v[76:79]
    v_mfma_f32_16x16x32_bf16 v[60:63], a[140:143], v[200:203], v[60:63]
    ds_read_b128 v[92:95], v32 offset:16128
    v_mfma_f32_16x16x32_bf16 v[64:67], a[144:147], v[200:203], v[64:67]
    buffer_load_dwordx4 v[188:191], v1, s[20:23], s84 offen offset:1024 sc1
    v_mfma_f32_16x16x32_bf16 v[68:71], a[148:151], v[200:203], v[68:71]
    v_mfma_f32_16x16x32_bf16 v[72:75], a[152:155], v[200:203], v[72:75]
    v_mfma_f32_16x16x32_bf16 v[76:79], a[156:159], v[200:203], v[76:79]
    s_waitcnt vmcnt(16)
    v_mfma_f32_16x16x32_bf16 v[60:63], a[160:163], v[204:207], v[60:63]
    s_waitcnt lgkmcnt(0)
    v_add_f32 v80, v80, v84
    v_mfma_f32_16x16x32_bf16 v[64:67], a[164:167], v[204:207], v[64:67]
    s_add_u32 s84, s8, 344064
    buffer_load_dwordx4 v[192:195], v1, s[20:23], s84 offen offset:0 sc1
    v_mfma_f32_16x16x32_bf16 v[68:71], a[168:171], v[204:207], v[68:71]
    v_add_f32 v81, v81, v85
    v_add_f32 v82, v82, v86
    v_mfma_f32_16x16x32_bf16 v[72:75], a[172:175], v[204:207], v[72:75]
    v_add_f32 v83, v83, v87
    v_add_f32 v88, v88, v92
    v_mfma_f32_16x16x32_bf16 v[76:79], a[176:179], v[204:207], v[76:79]
    v_mfma_f32_16x16x32_bf16 v[60:63], a[180:183], v[208:211], v[60:63]
    v_add_f32 v89, v89, v93
    v_add_f32 v90, v90, v94
    v_mfma_f32_16x16x32_bf16 v[64:67], a[184:187], v[208:211], v[64:67]
    buffer_load_dwordx4 v[196:199], v1, s[20:23], s84 offen offset:1024 sc1
    v_mfma_f32_16x16x32_bf16 v[68:71], a[188:191], v[208:211], v[68:71]
    v_add_f32 v91, v91, v95
    v_add_f32 v112, v80, v88
    v_mfma_f32_16x16x32_bf16 v[72:75], a[192:195], v[208:211], v[72:75]
    v_add_f32 v113, v81, v89
    v_add_f32 v114, v82, v90
    v_mfma_f32_16x16x32_bf16 v[76:79], a[196:199], v[208:211], v[76:79]
    s_waitcnt vmcnt(16)
    v_mfma_f32_16x16x32_bf16 v[60:63], a[200:203], v[212:215], v[60:63]
    v_add_f32 v115, v83, v91
    v_mfma_f32_16x16x32_bf16 v[64:67], a[204:207], v[212:215], v[64:67]
    s_add_u32 s84, s9, 344064
    buffer_load_dwordx4 v[200:203], v1, s[20:23], s84 offen offset:0 sc1
    v_mfma_f32_16x16x32_bf16 v[68:71], a[208:211], v[212:215], v[68:71]
    v_mfma_f32_16x16x32_bf16 v[72:75], a[212:215], v[212:215], v[72:75]
    v_mfma_f32_16x16x32_bf16 v[76:79], a[216:219], v[212:215], v[76:79]
    v_mfma_f32_16x16x32_bf16 v[60:63], a[220:223], v[216:219], v[60:63]
    v_mfma_f32_16x16x32_bf16 v[64:67], a[224:227], v[216:219], v[64:67]
    buffer_load_dwordx4 v[204:207], v1, s[20:23], s84 offen offset:1024 sc1
    v_mfma_f32_16x16x32_bf16 v[68:71], a[228:231], v[216:219], v[68:71]
    v_mfma_f32_16x16x32_bf16 v[72:75], a[232:235], v[216:219], v[72:75]
    v_mfma_f32_16x16x32_bf16 v[76:79], a[236:239], v[216:219], v[76:79]
    s_waitcnt vmcnt(16)
    v_mfma_f32_16x16x32_bf16 v[40:43], a[0:3], v[220:223], 0
    v_mfma_f32_16x16x32_bf16 v[44:47], a[4:7], v[220:223], 0
    s_add_u32 s84, s10, 344064
    buffer_load_dwordx4 v[208:211], v1, s[20:23], s84 offen offset:0 sc1
    v_mfma_f32_16x16x32_bf16 v[48:51], a[8:11], v[220:223], 0
    v_mfma_f32_16x16x32_bf16 v[52:55], a[12:15], v[220:223], 0
    v_mfma_f32_16x16x32_bf16 v[56:59], a[16:19], v[220:223], 0
    v_mfma_f32_16x16x32_bf16 v[40:43], a[20:23], v[224:227], v[40:43]
    v_mfma_f32_16x16x32_bf16 v[44:47], a[24:27], v[224:227], v[44:47]
    buffer_load_dwordx4 v[212:215], v1, s[20:23], s84 offen offset:1024 sc1
    v_mfma_f32_16x16x32_bf16 v[48:51], a[28:31], v[224:227], v[48:51]
    v_mfma_f32_16x16x32_bf16 v[52:55], a[32:35], v[224:227], v[52:55]
    v_add_u32 v24, 107520, v2
    v_mfma_f32_16x16x32_bf16 v[56:59], a[36:39], v[224:227], v[56:59]
    s_waitcnt vmcnt(16)
    v_mfma_f32_16x16x32_bf16 v[40:43], a[40:43], v[228:231], v[40:43]
    ds_write_b128 v24, v[60:63] offset:0
    v_mfma_f32_16x16x32_bf16 v[44:47], a[44:47], v[228:231], v[44:47]
    s_add_u32 s84, s11, 344064
    buffer_load_dwordx4 v[216:219], v1, s[20:23], s84 offen offset:0 sc1
    v_mfma_f32_16x16x32_bf16 v[48:51], a[48:51], v[228:231], v[48:51]
    v_mfma_f32_16x16x32_bf16 v[52:55], a[52:55], v[228:231], v[52:55]
    ds_write_b128 v24, v[64:67] offset:64
    v_mfma_f32_16x16x32_bf16 v[56:59], a[56:59], v[228:231], v[56:59]
    v_mfma_f32_16x16x32_bf16 v[40:43], a[60:63], v[232:235], v[40:43]
    v_mfma_f32_16x16x32_bf16 v[44:47], a[64:67], v[232:235], v[44:47]
    buffer_load_dwordx4 v[220:223], v1, s[20:23], s84 offen offset:1024 sc1
    v_mfma_f32_16x16x32_bf16 v[48:51], a[68:71], v[232:235], v[48:51]
    ds_write_b128 v24, v[68:71] offset:128
    v_mfma_f32_16x16x32_bf16 v[52:55], a[72:75], v[232:235], v[52:55]
    v_mfma_f32_16x16x32_bf16 v[56:59], a[76:79], v[232:235], v[56:59]
    s_waitcnt vmcnt(15)
    v_mfma_f32_16x16x32_bf16 v[40:43], a[80:83], v[160:163], v[40:43]
    ds_write_b128 v24, v[72:75] offset:192
    v_mfma_f32_16x16x32_bf16 v[44:47], a[84:87], v[160:163], v[44:47]
    s_add_u32 s84, s12, 344064
    buffer_load_dwordx4 v[224:227], v1, s[20:23], s84 offen offset:0 sc1
    v_mfma_f32_16x16x32_bf16 v[48:51], a[88:91], v[160:163], v[48:51]
    v_mfma_f32_16x16x32_bf16 v[52:55], a[92:95], v[160:163], v[52:55]
    ds_write_b128 v24, v[76:79] offset:256
    v_mfma_f32_16x16x32_bf16 v[56:59], a[96:99], v[160:163], v[56:59]
    v_mfma_f32_16x16x32_bf16 v[40:43], a[100:103], v[164:167], v[40:43]
    v_mfma_f32_16x16x32_bf16 v[44:47], a[104:107], v[164:167], v[44:47]
    buffer_load_dwordx4 v[228:231], v1, s[20:23], s84 offen offset:1024 sc1
    v_mfma_f32_16x16x32_bf16 v[48:51], a[108:111], v[164:167], v[48:51]
    s_waitcnt lgkmcnt(0)
    s_barrier
    v_mfma_f32_16x16x32_bf16 v[52:55], a[112:115], v[164:167], v[52:55]
    v_add_u32 v32, 107520, v3
    v_mfma_f32_16x16x32_bf16 v[56:59], a[116:119], v[164:167], v[56:59]
    s_waitcnt vmcnt(15)
    v_mfma_f32_16x16x32_bf16 v[40:43], a[120:123], v[168:171], v[40:43]
    ds_read_b128 v[80:83], v32 offset:0
    v_mfma_f32_16x16x32_bf16 v[44:47], a[124:127], v[168:171], v[44:47]
    s_add_u32 s84, s13, 344064
    buffer_load_dwordx4 v[232:235], v1, s[20:23], s84 offen offset:0 sc1
    v_mfma_f32_16x16x32_bf16 v[48:51], a[128:131], v[168:171], v[48:51]
    ds_read_b128 v[84:87], v32 offset:5376
    v_mfma_f32_16x16x32_bf16 v[52:55], a[132:135], v[168:171], v[52:55]
    ds_read_b128 v[88:91], v32 offset:10752
    v_mfma_f32_16x16x32_bf16 v[56:59], a[136:139], v[168:171], v[56:59]
    v_mfma_f32_16x16x32_bf16 v[40:43], a[140:143], v[172:175], v[40:43]
    ds_read_b128 v[92:95], v32 offset:16128
    v_mfma_f32_16x16x32_bf16 v[44:47], a[144:147], v[172:175], v[44:47]
    buffer_load_dwordx4 v[160:163], v1, s[20:23], s84 offen offset:1024 sc1
    v_mfma_f32_16x16x32_bf16 v[48:51], a[148:151], v[172:175], v[48:51]
    buffer_load_dwordx4 v[140:143], v1, s[20:23], s83 offen offset:0 sc1
    v_mfma_f32_16x16x32_bf16 v[52:55], a[152:155], v[172:175], v[52:55]
    buffer_load_dwordx4 v[144:147], v1, s[20:23], s83 offen offset:1024 sc1
    v_mfma_f32_16x16x32_bf16 v[56:59], a[156:159], v[172:175], v[56:59]
    s_waitcnt vmcnt(16)
    v_mfma_f32_16x16x32_bf16 v[40:43], a[160:163], v[176:179], v[40:43]
    s_waitcnt lgkmcnt(0)
    v_add_f32 v80, v80, v84
    v_mfma_f32_16x16x32_bf16 v[44:47], a[164:167], v[176:179], v[44:47]
    v_add_f32 v81, v81, v85
    v_mfma_f32_16x16x32_bf16 v[48:51], a[168:171], v[176:179], v[48:51]
    v_add_f32 v82, v82, v86
    v_add_f32 v83, v83, v87
    v_mfma_f32_16x16x32_bf16 v[52:55], a[172:175], v[176:179], v[52:55]
    v_add_f32 v88, v88, v92
    v_add_f32 v89, v89, v93
    v_mfma_f32_16x16x32_bf16 v[56:59], a[176:179], v[176:179], v[56:59]
    v_add_f32 v90, v90, v94
    v_mfma_f32_16x16x32_bf16 v[40:43], a[180:183], v[180:183], v[40:43]
    v_add_f32 v91, v91, v95
    v_add_f32 v116, v80, v88
    v_mfma_f32_16x16x32_bf16 v[44:47], a[184:187], v[180:183], v[44:47]
    v_add_f32 v117, v81, v89
    v_mfma_f32_16x16x32_bf16 v[48:51], a[188:191], v[180:183], v[48:51]
    v_add_f32 v118, v82, v90
    v_add_f32 v119, v83, v91
    v_mfma_f32_16x16x32_bf16 v[52:55], a[192:195], v[180:183], v[52:55]
    buffer_load_dwordx4 v[148:151], v1, s[20:23], s83 offen offset:2048 sc1
    v_mfma_f32_16x16x32_bf16 v[56:59], a[196:199], v[180:183], v[56:59]
    s_waitcnt vmcnt(15)
    v_mfma_f32_16x16x32_bf16 v[40:43], a[200:203], v[184:187], v[40:43]
    v_mfma_f32_16x16x32_bf16 v[44:47], a[204:207], v[184:187], v[44:47]
    v_mfma_f32_16x16x32_bf16 v[48:51], a[208:211], v[184:187], v[48:51]
    v_mfma_f32_16x16x32_bf16 v[52:55], a[212:215], v[184:187], v[52:55]
    v_mfma_f32_16x16x32_bf16 v[56:59], a[216:219], v[184:187], v[56:59]
    v_mfma_f32_16x16x32_bf16 v[40:43], a[220:223], v[188:191], v[40:43]
    v_mfma_f32_16x16x32_bf16 v[44:47], a[224:227], v[188:191], v[44:47]
    v_mfma_f32_16x16x32_bf16 v[48:51], a[228:231], v[188:191], v[48:51]
    v_mfma_f32_16x16x32_bf16 v[52:55], a[232:235], v[188:191], v[52:55]
    v_mfma_f32_16x16x32_bf16 v[56:59], a[236:239], v[188:191], v[56:59]
    s_waitcnt vmcnt(13)
    v_mfma_f32_16x16x32_bf16 v[60:63], a[0:3], v[192:195], 0
    v_mfma_f32_16x16x32_bf16 v[64:67], a[4:7], v[192:195], 0
    v_mfma_f32_16x16x32_bf16 v[68:71], a[8:11], v[192:195], 0
    v_mfma_f32_16x16x32_bf16 v[72:75], a[12:15], v[192:195], 0
    v_mfma_f32_16x16x32_bf16 v[76:79], a[16:19], v[192:195], 0
    v_mfma_f32_16x16x32_bf16 v[60:63], a[20:23], v[196:199], v[60:63]
    v_mfma_f32_16x16x32_bf16 v[64:67], a[24:27], v[196:199], v[64:67]
    v_mfma_f32_16x16x32_bf16 v[68:71], a[28:31], v[196:199], v[68:71]
    v_mfma_f32_16x16x32_bf16 v[72:75], a[32:35], v[196:199], v[72:75]
    ds_write_b128 v2, v[40:43] offset:0
    v_mfma_f32_16x16x32_bf16 v[76:79], a[36:39], v[196:199], v[76:79]
    s_waitcnt vmcnt(11)
    v_mfma_f32_16x16x32_bf16 v[60:63], a[40:43], v[200:203], v[60:63]
    v_mfma_f32_16x16x32_bf16 v[64:67], a[44:47], v[200:203], v[64:67]
    ds_write_b128 v2, v[44:47] offset:64
    v_mfma_f32_16x16x32_bf16 v[68:71], a[48:51], v[200:203], v[68:71]
    v_mfma_f32_16x16x32_bf16 v[72:75], a[52:55], v[200:203], v[72:75]
    v_mfma_f32_16x16x32_bf16 v[76:79], a[56:59], v[200:203], v[76:79]
    ds_write_b128 v2, v[48:51] offset:128
    v_mfma_f32_16x16x32_bf16 v[60:63], a[60:63], v[204:207], v[60:63]
    v_mfma_f32_16x16x32_bf16 v[64:67], a[64:67], v[204:207], v[64:67]
    v_mfma_f32_16x16x32_bf16 v[68:71], a[68:71], v[204:207], v[68:71]
    ds_write_b128 v2, v[52:55] offset:192
    v_mfma_f32_16x16x32_bf16 v[72:75], a[72:75], v[204:207], v[72:75]
    v_mfma_f32_16x16x32_bf16 v[76:79], a[76:79], v[204:207], v[76:79]
    s_waitcnt vmcnt(9)
    v_mfma_f32_16x16x32_bf16 v[60:63], a[80:83], v[208:211], v[60:63]
    ds_write_b128 v2, v[56:59] offset:256
    v_mfma_f32_16x16x32_bf16 v[64:67], a[84:87], v[208:211], v[64:67]
    v_mfma_f32_16x16x32_bf16 v[68:71], a[88:91], v[208:211], v[68:71]
    v_mfma_f32_16x16x32_bf16 v[72:75], a[92:95], v[208:211], v[72:75]
    v_mfma_f32_16x16x32_bf16 v[76:79], a[96:99], v[208:211], v[76:79]
    v_mfma_f32_16x16x32_bf16 v[60:63], a[100:103], v[212:215], v[60:63]
    s_waitcnt lgkmcnt(0)
    s_barrier
    v_mfma_f32_16x16x32_bf16 v[64:67], a[104:107], v[212:215], v[64:67]
    ds_read_b128 v[80:83], v3 offset:0
    v_mfma_f32_16x16x32_bf16 v[68:71], a[108:111], v[212:215], v[68:71]
    ds_read_b128 v[84:87], v3 offset:5376
    v_mfma_f32_16x16x32_bf16 v[72:75], a[112:115], v[212:215], v[72:75]
    ds_read_b128 v[88:91], v3 offset:10752
    v_mfma_f32_16x16x32_bf16 v[76:79], a[116:119], v[212:215], v[76:79]
    ds_read_b128 v[92:95], v3 offset:16128
    s_waitcnt vmcnt(7)
    v_mfma_f32_16x16x32_bf16 v[60:63], a[120:123], v[216:219], v[60:63]
    v_mfma_f32_16x16x32_bf16 v[64:67], a[124:127], v[216:219], v[64:67]
    v_mfma_f32_16x16x32_bf16 v[68:71], a[128:131], v[216:219], v[68:71]
    v_mfma_f32_16x16x32_bf16 v[72:75], a[132:135], v[216:219], v[72:75]
    v_mfma_f32_16x16x32_bf16 v[76:79], a[136:139], v[216:219], v[76:79]
    s_waitcnt lgkmcnt(0)
    v_mfma_f32_16x16x32_bf16 v[60:63], a[140:143], v[220:223], v[60:63]
    v_add_f32 v80, v80, v84
    v_add_f32 v81, v81, v85
    v_mfma_f32_16x16x32_bf16 v[64:67], a[144:147], v[220:223], v[64:67]
    v_add_f32 v82, v82, v86
    v_mfma_f32_16x16x32_bf16 v[68:71], a[148:151], v[220:223], v[68:71]
    v_add_f32 v83, v83, v87
    v_add_f32 v88, v88, v92
    v_mfma_f32_16x16x32_bf16 v[72:75], a[152:155], v[220:223], v[72:75]
    v_add_f32 v89, v89, v93
    v_add_f32 v90, v90, v94
    v_mfma_f32_16x16x32_bf16 v[76:79], a[156:159], v[220:223], v[76:79]
    v_add_f32 v91, v91, v95
    s_waitcnt vmcnt(3)
    v_mfma_f32_16x16x32_bf16 v[60:63], a[160:163], v[224:227], v[60:63]
    v_add_f32 v120, v80, v88
    v_add_f32 v121, v81, v89
    v_mfma_f32_16x16x32_bf16 v[60:63], a[180:183], v[228:231], v[60:63]
    v_add_f32 v122, v82, v90
    v_mfma_f32_16x16x32_bf16 v[60:63], a[200:203], v[232:235], v[60:63]
    v_add_f32 v123, v83, v91
    s_waitcnt vmcnt(0)
    v_mfma_f32_16x16x32_bf16 v[60:63], a[220:223], v[160:163], v[60:63]
    v_xor_b32 v26, v143, v28
    v_bitop3_b32 v26, v26, v147, v28 bitop3:0xf6
    v_mfma_f32_16x16x32_bf16 v[64:67], a[164:167], v[224:227], v[64:67]
    v_bitop3_b32 v26, v26, v151, v28 bitop3:0xf6
    v_mfma_f32_16x16x32_bf16 v[64:67], a[184:187], v[228:231], v[64:67]
    v_cmp_lt_u32 vcc, s58, v26
    v_mfma_f32_16x16x32_bf16 v[64:67], a[204:207], v[232:235], v[64:67]
    s_cmp_lg_u64 vcc, 0
    s_cbranch_scc1 L_xslow33
L_xok33:
    v_mfma_f32_16x16x32_bf16 v[64:67], a[224:227], v[160:163], v[64:67]
    v_lshlrev_b32 v22, 16, v12
    v_lshlrev_b32 v18, 16, v140
    v_mfma_f32_16x16x32_bf16 v[68:71], a[168:171], v[224:227], v[68:71]
    v_and_b32 v19, 0xffff0000, v140
    v_lshlrev_b32 v20, 16, v141
    v_mfma_f32_16x16x32_bf16 v[68:71], a[188:191], v[228:231], v[68:71]
    v_and_b32 v21, 0xffff0000, v141
    v_mfma_f32_16x16x32_bf16 v[68:71], a[208:211], v[232:235], v[68:71]
    v_fmac_f32 v236, v22, v18
    v_fmac_f32 v237, v22, v19
    v_mfma_f32_16x16x32_bf16 v[68:71], a[228:231], v[160:163], v[68:71]
    v_fmac_f32 v238, v22, v20
    ds_write_b128 v2, v[60:63] offset:21504
    v_mfma_f32_16x16x32_bf16 v[72:75], a[172:175], v[224:227], v[72:75]
    v_fmac_f32 v239, v22, v21
    v_mfma_f32_16x16x32_bf16 v[72:75], a[192:195], v[228:231], v[72:75]
    v_and_b32 v23, 0xffff0000, v12
    v_fmac_f32 v236, v23, v112
    v_mfma_f32_16x16x32_bf16 v[72:75], a[212:215], v[232:235], v[72:75]
    v_fmac_f32 v237, v23, v113
    v_mfma_f32_16x16x32_bf16 v[72:75], a[232:235], v[160:163], v[72:75]
    v_fmac_f32 v238, v23, v114
    v_fmac_f32 v239, v23, v115
    ds_write_b128 v2, v[64:67] offset:21568
    v_mfma_f32_16x16x32_bf16 v[76:79], a[176:179], v[224:227], v[76:79]
    s_add_u32 s85, s94, 0
    buffer_store_dwordx4 v[236:239], v6, s[24:27], s85 offen nt
    v_mfma_f32_16x16x32_bf16 v[76:79], a[196:199], v[228:231], v[76:79]
    v_lshlrev_b32 v22, 16, v13
    v_lshlrev_b32 v18, 16, v142
    v_mfma_f32_16x16x32_bf16 v[76:79], a[216:219], v[232:235], v[76:79]
    v_and_b32 v19, 0xffff0000, v142
    v_lshlrev_b32 v20, 16, v143
    v_mfma_f32_16x16x32_bf16 v[76:79], a[236:239], v[160:163], v[76:79]
    v_lshlrev_b32 v21, 16, v144
    v_fmac_f32 v240, v22, v18
    v_fmac_f32 v241, v22, v19
    v_fmac_f32 v242, v22, v20
    v_fmac_f32 v243, v22, v21
    v_and_b32 v23, 0xffff0000, v13
    v_fmac_f32 v240, v23, v116
    v_fmac_f32 v241, v23, v117
    v_fmac_f32 v242, v23, v118
    v_fmac_f32 v243, v23, v119
    s_add_u32 s85, s94, 10240
    buffer_store_dwordx4 v[240:243], v6, s[24:27], s85 offen nt
    v_lshlrev_b32 v22, 16, v14
    v_and_b32 v18, 0xffff0000, v144
    v_lshlrev_b32 v19, 16, v145
    v_and_b32 v20, 0xffff0000, v145
    v_lshlrev_b32 v21, 16, v146
    v_fmac_f32 v244, v22, v18
    v_fmac_f32 v245, v22, v19
    v_fmac_f32 v246, v22, v20
    v_fmac_f32 v247, v22, v21
    v_lshlrev_b32 v22, 16, v15
    v_and_b32 v18, 0xffff0000, v146
    v_lshlrev_b32 v19, 16, v147
    v_lshlrev_b32 v20, 16, v148
    v_and_b32 v21, 0xffff0000, v148
    v_fmac_f32 v248, v22, v18
    v_fmac_f32 v249, v22, v19
    v_fmac_f32 v250, v22, v20
    v_fmac_f32 v251, v22, v21
    v_lshlrev_b32 v22, 16, v16
    v_lshlrev_b32 v18, 16, v149
    v_and_b32 v19, 0xffff0000, v149
    v_lshlrev_b32 v20, 16, v150
    v_and_b32 v21, 0xffff0000, v150
    v_fmac_f32 v136, v22, v18
    v_fmac_f32 v137, v22, v19
    v_fmac_f32 v138, v22, v20
    v_fmac_f32 v139, v22, v21
    v_and_b32 v23, 0xffff0000, v14
    v_fmac_f32 v244, v23, v120
    v_fmac_f32 v245, v23, v121
    v_fmac_f32 v246, v23, v122
    v_fmac_f32 v247, v23, v123
    s_add_u32 s85, s94, 20480
    buffer_store_dwordx4 v[244:247], v6, s[24:27], s85 offen nt
    ds_write_b128 v2, v[68:71] offset:21632
    ds_write_b128 v2, v[72:75] offset:21696
    ds_write_b128 v2, v[76:79] offset:21760
    s_waitcnt lgkmcnt(0)
    s_barrier
    ds_read_b128 v[80:83], v3 offset:21504
    ds_read_b128 v[84:87], v3 offset:26880
    ds_read_b128 v[88:91], v3 offset:32256
    ds_read_b128 v[92:95], v3 offset:37632
    ds_read_b128 v[96:99], v5 offset:0
    ds_read_b128 v[100:103], v5 offset:5376
    ds_read_b128 v[104:107], v5 offset:10752
    ds_read_b128 v[108:111], v5 offset:16128
    v_and_b32 v23, 0xffff0000, v15
    s_waitcnt lgkmcnt(4)
    v_pk_add_f32 v[80:81], v[80:81], v[84:85]
    v_pk_add_f32 v[82:83], v[82:83], v[86:87]
    v_pk_add_f32 v[88:89], v[88:89], v[92:93]
    v_pk_add_f32 v[90:91], v[90:91], v[94:95]
    v_pk_add_f32 v[124:125], v[80:81], v[88:89]
    v_pk_add_f32 v[126:127], v[82:83], v[90:91]
    v_fmac_f32 v248, v23, v124
    v_fmac_f32 v249, v23, v125
    v_fmac_f32 v250, v23, v126
    v_fmac_f32 v251, v23, v127
    s_add_u32 s85, s94, 30720
    buffer_store_dwordx4 v[248:251], v6, s[24:27], s85 offen nt
    v_and_b32 v23, 0xffff0000, v16
    s_waitcnt lgkmcnt(0)
    v_pk_add_f32 v[96:97], v[96:97], v[100:101]
    v_pk_add_f32 v[98:99], v[98:99], v[102:103]
    v_pk_add_f32 v[104:105], v[104:105], v[108:109]
    v_pk_add_f32 v[106:107], v[106:107], v[110:111]
    v_pk_add_f32 v[128:129], v[96:97], v[104:105]
    v_pk_add_f32 v[130:131], v[98:99], v[106:107]
    v_fmac_f32 v136, v23, v128
    v_fmac_f32 v137, v23, v129
    v_fmac_f32 v138, v23, v130
    v_fmac_f32 v139, v23, v131
    buffer_store_dwordx4 v[136:139], v7, s[24:27], s94 offen nt
L_fin:
L_end:
    s_endpgm
    s_nop 7
L_tagslow3:
    global_load_dword v35, v34, s[68:69] sc1
    s_waitcnt vmcnt(0)
    v_readfirstlane_b32 s88, v35
    s_nop 1
    s_cmp_lg_u32 s88, 0
    s_cbranch_scc1 L_tagok3
    s_sub_u32 s101, s101, 1
    s_cmp_eq_u32 s101, 0
    s_cbranch_scc1 L_end
    s_branch L_tagslow3
    s_nop 7
L_lbslow00:
    s_sub_u32 s101, s101, 1
    s_cmp_eq_u32 s101, 0
    s_cbranch_scc1 L_end
    buffer_load_dwordx4 v[84:87], v91, s[72:75], 0 offen sc1
    buffer_load_dwordx4 v[80:83], v90, s[72:75], 0 offen sc1
    buffer_load_dwordx4 v[76:79], v89, s[72:75], 0 offen sc1
    buffer_load_dwordx4 v[72:75], v88, s[72:75], 0 offen sc1
    s_waitcnt vmcnt(0)
    s_branch L_lb00
    s_nop 7
L_lbslow10:
    s_sub_u32 s101, s101, 1
    s_cmp_eq_u32 s101, 0
    s_cbranch_scc1 L_end
    buffer_load_dwordx4 v[84:87], v91, s[72:75], 0 offen sc1
    buffer_load_dwordx4 v[80:83], v90, s[72:75], 0 offen sc1
    buffer_load_dwordx4 v[76:79], v89, s[72:75], 0 offen sc1
    buffer_load_dwordx4 v[72:75], v88, s[72:75], 0 offen sc1
    s_waitcnt vmcnt(0)
    s_branch L_lb10
    s_nop 7
L_lbslow01:
    s_sub_u32 s101, s101, 1
    s_cmp_eq_u32 s101, 0
    s_cbranch_scc1 L_end
    buffer_load_dwordx4 v[84:87], v91, s[72:75], 0 offen sc1
    buffer_load_dwordx4 v[80:83], v90, s[72:75], 0 offen sc1
    buffer_load_dwordx4 v[76:79], v89, s[72:75], 0 offen sc1
    buffer_load_dwordx4 v[72:75], v88, s[72:75], 0 offen sc1
    s_waitcnt vmcnt(0)
    s_branch L_lb01
    s_nop 7
L_lbslow11:
    s_sub_u32 s101, s101, 1
    s_cmp_eq_u32 s101, 0
    s_cbranch_scc1 L_end
    buffer_load_dwordx4 v[84:87], v91, s[72:75], 0 offen sc1
    buffer_load_dwordx4 v[80:83], v90, s[72:75], 0 offen sc1
    buffer_load_dwordx4 v[76:79], v89, s[72:75], 0 offen sc1
    buffer_load_dwordx4 v[72:75], v88, s[72:75], 0 offen sc1
    s_waitcnt vmcnt(0)
    s_branch L_lb11
    s_nop 7
L_pslow11:
    buffer_load_dwordx2 v[30:31], v28, s[20:23], s79 offen sc1
    s_waitcnt vmcnt(0)
    v_cmp_ne_u32 vcc, s88, v30
    v_cmp_ne_u32 s[96:97], s88, v31
    s_nop 1
    s_or_b64 vcc, vcc, s[96:97]
    s_cbranch_scc0 L_pok11
    s_sub_u32 s101, s101, 1
    s_cmp_eq_u32 s101, 0
    s_cbranch_scc1 L_end
    s_branch L_pslow11
    s_nop 7
L_tagslow14:
    global_load_dword v35, v34, s[68:69] sc1
    s_waitcnt vmcnt(0)
    v_readfirstlane_b32 s88, v35
    s_nop 1
    s_cmp_lg_u32 s88, 0
    s_cbranch_scc1 L_tagok14
    s_sub_u32 s101, s101, 1
    s_cmp_eq_u32 s101, 0
    s_cbranch_scc1 L_end
    s_branch L_tagslow14
    s_nop 7
L_pslow19:
    buffer_load_dwordx2 v[30:31], v28, s[20:23], s79 offen sc1
    s_waitcnt vmcnt(0)
    v_cmp_ne_u32 vcc, s88, v30
    v_cmp_ne_u32 s[96:97], s88, v31
    s_nop 1
    s_or_b64 vcc, vcc, s[96:97]
    s_cbranch_scc0 L_pok19
    s_sub_u32 s101, s101, 1
    s_cmp_eq_u32 s101, 0
    s_cbranch_scc1 L_end
    s_branch L_pslow19
    s_nop 7
L_tagslow22:
    global_load_dword v35, v34, s[68:69] sc1
    s_waitcnt vmcnt(0)
    v_readfirstlane_b32 s88, v35
    s_nop 1
    s_cmp_lg_u32 s88, 0
    s_cbranch_scc1 L_tagok22
    s_sub_u32 s101, s101, 1
    s_cmp_eq_u32 s101, 0
    s_cbranch_scc1 L_end
    s_branch L_tagslow22
    s_nop 7
L_pslow29:
    buffer_load_dwordx2 v[30:31], v28, s[20:23], s79 offen sc1
    s_waitcnt vmcnt(0)
    v_cmp_ne_u32 vcc, s88, v30
    v_cmp_ne_u32 s[96:97], s88, v31
    s_nop 1
    s_or_b64 vcc, vcc, s[96:97]
    s_cbranch_scc0 L_pok29
    s_sub_u32 s101, s101, 1
    s_cmp_eq_u32 s101, 0
    s_cbranch_scc1 L_end
    s_branch L_pslow29
    s_nop 7
L_pslow30:
    buffer_load_dwordx2 v[26:27], v8, s[20:23], s32 offen sc1
    s_waitcnt vmcnt(0)
    v_cmp_ne_u32 vcc, s88, v26
    v_cmp_ne_u32 s[96:97], s88, v27
    s_nop 1
    s_or_b64 vcc, vcc, s[96:97]
    s_cbranch_scc0 L_pok30
    s_sub_u32 s101, s101, 1
    s_cmp_eq_u32 s101, 0
    s_cbranch_scc1 L_end
    s_branch L_pslow30
    s_nop 7
L_xslow31:
    s_sub_u32 s101, s101, 1
    s_cmp_eq_u32 s101, 0
    s_cbranch_scc1 L_end
    buffer_load_dwordx4 v[140:143], v1, s[20:23], s83 offen offset:0 sc1
    buffer_load_dwordx4 v[144:147], v1, s[20:23], s83 offen offset:1024 sc1
    buffer_load_dwordx4 v[148:151], v1, s[20:23], s83 offen offset:2048 sc1
    s_waitcnt vmcnt(0)
    v_xor_b32 v26, v143, v28
    v_bitop3_b32 v26, v26, v147, v28 bitop3:0xf6
    v_bitop3_b32 v26, v26, v151, v28 bitop3:0xf6
    v_cmp_lt_u32 vcc, s58, v26
    s_nop 1
    s_cmp_lg_u64 vcc, 0
    s_cbranch_scc1 L_xslow31
    s_branch L_xok31
    s_nop 7
L_pslow32:
    buffer_load_dwordx2 v[26:27], v8, s[20:23], s32 offen sc1
    s_waitcnt vmcnt(0)
    v_cmp_ne_u32 vcc, s88, v26
    v_cmp_ne_u32 s[96:97], s88, v27
    s_nop 1
    s_or_b64 vcc, vcc, s[96:97]
    s_cbranch_scc0 L_pok32
    s_sub_u32 s101, s101, 1
    s_cmp_eq_u32 s101, 0
    s_cbranch_scc1 L_end
    s_branch L_pslow32
    s_nop 7
L_xslow33:
    s_sub_u32 s101, s101, 1
    s_cmp_eq_u32 s101, 0
    s_cbranch_scc1 L_end
    buffer_load_dwordx4 v[140:143], v1, s[20:23], s83 offen offset:0 sc1
    buffer_load_dwordx4 v[144:147], v1, s[20:23], s83 offen offset:1024 sc1
    buffer_load_dwordx4 v[148:151], v1, s[20:23], s83 offen offset:2048 sc1
    s_waitcnt vmcnt(0)
    v_xor_b32 v26, v143, v28
    v_bitop3_b32 v26, v26, v147, v28 bitop3:0xf6
    v_bitop3_b32 v26, v26, v151, v28 bitop3:0xf6
    v_cmp_lt_u32 vcc, s58, v26
    s_nop 1
    s_cmp_lg_u64 vcc, 0
    s_cbranch_scc1 L_xslow33
    s_branch L_xok33
    s_endpgm
.fill 4096, 4, 0xBF800000
.section .rodata,"a"
.p2align 6
.amdhsa_kernel gated_mix__ssm_conv_s5__dense_activation_silu__prompt_kernel
  .amdhsa_next_free_vgpr 512
  .amdhsa_next_free_sgpr 102
  .amdhsa_accum_offset 256
  .amdhsa_group_segment_fixed_size 0
  .amdhsa_kernarg_size 128
  .amdhsa_user_sgpr_count 2
  .amdhsa_user_sgpr_kernarg_segment_ptr 1
  .amdhsa_system_sgpr_workgroup_id_x 1
  .amdhsa_float_denorm_mode_32 3
.end_amdhsa_kernel
```
